```python
import torch

def _softmax(x, axis=-1):
    return torch.softmax(x, dim=axis)
def _gelu(x):
    return torch.nn.functional.gelu(x, approximate="tanh")
def _silu(x):
    return torch.nn.functional.silu(x)
def _sigmoid(x):
    return torch.sigmoid(x)
def _layernorm(x, axis=-1, eps=1e-5):
    m = x.mean(dim=axis, keepdim=True)
    v = x.var(dim=axis, keepdim=True, unbiased=False)
    return (x - m) / torch.sqrt(v + eps)
def _scatter_add(tgt, idx, src, axis=0):
    return tgt.clone().index_add_(axis, idx, src)
def _segment_sum(src, seg, n):
    out = torch.zeros((n,) + src.shape[1:], dtype=src.dtype)
    return out.index_add_(0, seg, src)
def _pad(x, pw):
    flat = tuple(v for pair in reversed(pw) for v in pair)
    return torch.nn.functional.pad(x, flat)

kernel_name = 'parallel_sum__softmax_full_mha__swiglu_ffn__prompt'

def setup_inputs():

    _w = (lambda a: (lambda t: t.to(torch.bfloat16) if t.is_floating_point() else t)(torch.as_tensor(a)))
    def _A_setup():
        B, S, D = 1, 2048, 576
        return {
            "x": _w((lambda *s: torch.randn(*s, dtype=torch.bfloat16) * 0.05)(B, S, D)),
            "wqkv": _w((lambda *s: torch.randn(*s, dtype=torch.bfloat16) * 0.2)(D, 3 * D)),
            "wo": _w((lambda *s: torch.randn(*s, dtype=torch.bfloat16) * 0.1)(D, D)),
        }
    _A_in = _A_setup()

    def _B_setup():
        B, S, D, F = 1, 2048, 576, 4608
        return {
            "x": _w((lambda *s: torch.randn(*s, dtype=torch.bfloat16) * 0.05)(B, S, D)),
            "w_gate": _w((lambda *s: torch.randn(*s, dtype=torch.bfloat16) * 0.1)(D, F)),
            "w_up": _w((lambda *s: torch.randn(*s, dtype=torch.bfloat16) * 0.1)(D, F)),
            "w_down": _w((lambda *s: torch.randn(*s, dtype=torch.bfloat16) * 0.1)(F, D)),
        }
    _B_in = _B_setup()

    return {
        "A_x": _A_in["x"],
        "A_wqkv": _A_in["wqkv"],
        "A_wo": _A_in["wo"],
        "B_x": _B_in["x"],
        "B_w_gate": _B_in["w_gate"],
        "B_w_up": _B_in["w_up"],
        "B_w_down": _B_in["w_down"],
    }

def reference(A_x, A_wqkv, A_wo, B_x, B_w_gate, B_w_up, B_w_down):
    def _A_ref(x, wqkv, wo):
        B, S, D = x.shape
        H = 32; Dh = D // H
        qkv = (lambda x, *d: x.permute(*d))((x @ wqkv).reshape(B, S, 3, H, Dh), 2, 0, 3, 1, 4)
        q, k, v = qkv[0], qkv[1], qkv[2]
        scale = Dh ** -0.5
        scores = torch.einsum("bhqd,bhkd->bhqk", q, k) * scale
        p = _softmax(scores, axis=-1)
        o = torch.einsum("bhqk,bhkd->bhqd", p, v)
        return (lambda x, *d: x.permute(*d))(o, 0, 2, 1, 3).reshape(B, S, D) @ wo

    def _B_ref(x, w_gate, w_up, w_down):
        g = _silu(x @ w_gate)
        u = x @ w_up
        return (g * u) @ w_down

    x = A_x
    xn = _layernorm(x, axis=-1)
    return x + _A_ref(xn, A_wqkv, A_wo) + _B_ref(xn, B_w_gate, B_w_up, B_w_down)
```

```asm
; @launch kernel=k0_ln_kernel grid=(256,1,1) block=(256,1,1) lds=12288
; @launch kernel=k1_gemm1_kernel grid=(256,1,1) block=(256,1,1) lds=147456
; @launch kernel=k2_attn_kernel grid=(256,1,1) block=(512,1,1) lds=161792
; @launch kernel=k3_out_kernel grid=(216,1,1) block=(384,1,1) lds=125952
.amdgcn_target "amdgcn-amd-amdhsa--gfx950"
.text
.globl k0_ln_kernel
.p2align 8
.type k0_ln_kernel,@function
k0_ln_kernel:
  s_cmp_ge_u32 s2, 256
  s_cbranch_scc1 k0_end
  s_load_dwordx2 s[4:5], s[0:1], 0
  s_load_dwordx2 s[6:7], s[0:1], 72
  s_load_dwordx2 s[24:25], s[0:1], 8
  s_load_dwordx4 s[28:31], s[0:1], 32
  v_lshrrev_b32 v1, 5, v0
  v_and_b32 v2, 31, v0
  s_lshr_b32 s3, s2, 3
  s_lshl_b32 s3, s3, 6
  s_bfe_u32 s16, s2, 0x10002
  s_lshl_b32 s16, s16, 5
  s_add_u32 s3, s3, s16
  s_and_b32 s16, s2, 3
  s_add_u32 s3, s3, s16
  v_lshl_add_u32 v3, v1, 2, s3
  v_mul_u32_u24 v4, 1152, v3
  v_lshl_add_u32 v4, v2, 4, v4
  v_add_u32 v5, 1024, v4
  v_mov_b32 v6, 0x7ffffff0
  v_cmp_gt_u32 vcc, 8, v2
  s_nop 1
  v_cndmask_b32 v5, v6, v5, vcc
  s_waitcnt lgkmcnt(0)
  s_mov_b32 s8, s4
  s_and_b32 s9, s5, 0xffff
  s_mov_b32 s10, 2359296
  s_mov_b32 s11, 0x20000
  s_mov_b32 s12, s6
  s_and_b32 s13, s7, 0xffff
  s_mov_b32 s14, 50331648
  s_mov_b32 s15, 0x20000
  buffer_load_dwordx4 v[8:11], v4, s[8:11], 0 offen
  buffer_load_dwordx4 v[12:15], v4, s[8:11], 0 offen offset:512
  buffer_load_dwordx4 v[16:19], v5, s[8:11], 0 offen
  s_mov_b32 s32, s24
  s_and_b32 s33, s25, 0xffff
  s_mov_b32 s34, 1990656
  s_mov_b32 s35, 0x20000
  s_mov_b32 s36, s28
  s_and_b32 s37, s29, 0xffff
  s_mov_b32 s38, 5308416
  s_mov_b32 s39, 0x20000
  s_mov_b32 s40, s30
  s_and_b32 s41, s31, 0xffff
  s_mov_b32 s42, 5308416
  s_mov_b32 s43, 0x20000
  s_and_b32 s16, s2, 7
  s_lshr_b32 s17, s2, 3
  s_mul_i32 s18, s17, 18
  s_mul_i32 s19, s18, 9216
  s_mul_i32 s20, s16, 1152
  s_add_u32 s19, s19, s20
  v_mul_u32_u24 v53, 7282, v0
  v_lshrrev_b32 v53, 16, v53
  v_mul_u32_u24 v54, 9, v53
  v_sub_u32 v54, v0, v54
  v_mul_u32_u24 v53, 9216, v53
  v_lshl_add_u32 v53, v54, 7, v53
  v_cmp_gt_u32 vcc, 162, v0
  s_nop 1
  v_cndmask_b32 v53, v6, v53, vcc
  buffer_load_dword v55, v53, s[36:39], s19 offen
  buffer_load_dword v56, v53, s[40:43], s19 offen
  s_lshl_b32 s20, s16, 9
  s_cmp_eq_u32 s16, 6
  s_cselect_b32 s20, 2944, s20
  s_cmp_eq_u32 s16, 7
  s_cselect_b32 s20, 3200, s20
  s_mul_i32 s19, s18, 3456
  s_add_u32 s19, s19, s20
  v_lshrrev_b32 v53, 3, v0
  v_and_b32 v54, 7, v0
  v_mul_u32_u24 v53, 3456, v53
  v_lshl_add_u32 v53, v54, 6, v53
  v_cmp_gt_u32 vcc, 144, v0
  s_nop 1
  v_cndmask_b32 v53, v6, v53, vcc
  buffer_load_dword v59, v53, s[32:35], s19 offen
  v_cmp_gt_u32 vcc, 8, v2
  v_and_b32 v60, 63, v0
  s_getpc_b64 s[44:45]
cpf_k0:
  s_add_u32 s44, s44, k1_gemm1_kernel-cpf_k0
  s_addc_u32 s45, s45, 0
  s_lshr_b32 s46, s2, 3
  s_lshl_b32 s46, s46, 12
  v_lshlrev_b32 v61, 6, v60
  v_add_u32 v61, s46, v61
  v_min_u32 v61, k3_code_end-k1_gemm1_kernel-4, v61
  global_load_dword v62, v61, s[44:45]
  v_lshrrev_b32 v44, 4, v3
  v_mul_u32_u24 v44, 18, v44
  v_lshrrev_b32 v45, 2, v2
  v_add_u32 v44, v44, v45
  v_lshlrev_b32 v44, 6, v44
  v_and_b32 v45, 3, v2
  v_lshlrev_b32 v45, 4, v45
  v_and_b32 v46, 15, v3
  v_add3_u32 v44, v44, v45, v46
  v_lshlrev_b32 v44, 4, v44
  v_add_u32 v45, 8192, v44
  v_add_u32 v46, 16384, v44
  v_cndmask_b32 v46, v6, v46, vcc
  s_waitcnt vmcnt(4)
  v_lshlrev_b32 v20, 16, v8
  v_and_b32 v21, 0xffff0000, v8
  v_lshlrev_b32 v22, 16, v9
  v_and_b32 v23, 0xffff0000, v9
  v_lshlrev_b32 v24, 16, v10
  v_and_b32 v25, 0xffff0000, v10
  v_lshlrev_b32 v26, 16, v11
  v_and_b32 v27, 0xffff0000, v11
  v_lshlrev_b32 v28, 16, v12
  v_and_b32 v29, 0xffff0000, v12
  v_lshlrev_b32 v30, 16, v13
  v_and_b32 v31, 0xffff0000, v13
  v_lshlrev_b32 v32, 16, v14
  v_and_b32 v33, 0xffff0000, v14
  v_lshlrev_b32 v34, 16, v15
  v_and_b32 v35, 0xffff0000, v15
  v_lshlrev_b32 v36, 16, v16
  v_and_b32 v37, 0xffff0000, v16
  v_lshlrev_b32 v38, 16, v17
  v_and_b32 v39, 0xffff0000, v17
  v_lshlrev_b32 v40, 16, v18
  v_and_b32 v41, 0xffff0000, v18
  v_lshlrev_b32 v42, 16, v19
  v_and_b32 v43, 0xffff0000, v19
  v_add_f32 v47, v20, v21
  v_add_f32 v47, v47, v22
  v_add_f32 v47, v47, v23
  v_add_f32 v47, v47, v24
  v_add_f32 v47, v47, v25
  v_add_f32 v47, v47, v26
  v_add_f32 v47, v47, v27
  v_add_f32 v47, v47, v28
  v_add_f32 v47, v47, v29
  v_add_f32 v47, v47, v30
  v_add_f32 v47, v47, v31
  v_add_f32 v47, v47, v32
  v_add_f32 v47, v47, v33
  v_add_f32 v47, v47, v34
  v_add_f32 v47, v47, v35
  v_add_f32 v47, v47, v36
  v_add_f32 v47, v47, v37
  v_add_f32 v47, v47, v38
  v_add_f32 v47, v47, v39
  v_add_f32 v47, v47, v40
  v_add_f32 v47, v47, v41
  v_add_f32 v47, v47, v42
  v_add_f32 v47, v47, v43
  ds_swizzle_b32 v48, v47 offset:16415
  s_waitcnt lgkmcnt(0)
  v_add_f32 v47, v47, v48
  ds_swizzle_b32 v48, v47 offset:8223
  s_waitcnt lgkmcnt(0)
  v_add_f32 v47, v47, v48
  ds_swizzle_b32 v48, v47 offset:4127
  s_waitcnt lgkmcnt(0)
  v_add_f32 v47, v47, v48
  ds_swizzle_b32 v48, v47 offset:2079
  s_waitcnt lgkmcnt(0)
  v_add_f32 v47, v47, v48
  ds_swizzle_b32 v48, v47 offset:1055
  s_waitcnt lgkmcnt(0)
  v_add_f32 v47, v47, v48
  v_mul_f32 v47, 0x3ae38e39, v47
  v_sub_f32 v20, v20, v47
  v_sub_f32 v21, v21, v47
  v_sub_f32 v22, v22, v47
  v_sub_f32 v23, v23, v47
  v_sub_f32 v24, v24, v47
  v_sub_f32 v25, v25, v47
  v_sub_f32 v26, v26, v47
  v_sub_f32 v27, v27, v47
  v_sub_f32 v28, v28, v47
  v_sub_f32 v29, v29, v47
  v_sub_f32 v30, v30, v47
  v_sub_f32 v31, v31, v47
  v_sub_f32 v32, v32, v47
  v_sub_f32 v33, v33, v47
  v_sub_f32 v34, v34, v47
  v_sub_f32 v35, v35, v47
  v_sub_f32 v36, v36, v47
  v_sub_f32 v37, v37, v47
  v_sub_f32 v38, v38, v47
  v_sub_f32 v39, v39, v47
  v_sub_f32 v40, v40, v47
  v_sub_f32 v41, v41, v47
  v_sub_f32 v42, v42, v47
  v_sub_f32 v43, v43, v47
  v_cndmask_b32 v36, 0, v36, vcc
  v_cndmask_b32 v37, 0, v37, vcc
  v_cndmask_b32 v38, 0, v38, vcc
  v_cndmask_b32 v39, 0, v39, vcc
  v_cndmask_b32 v40, 0, v40, vcc
  v_cndmask_b32 v41, 0, v41, vcc
  v_cndmask_b32 v42, 0, v42, vcc
  v_cndmask_b32 v43, 0, v43, vcc
  v_mul_f32 v49, v20, v20
  v_fmac_f32 v49, v21, v21
  v_fmac_f32 v49, v22, v22
  v_fmac_f32 v49, v23, v23
  v_fmac_f32 v49, v24, v24
  v_fmac_f32 v49, v25, v25
  v_fmac_f32 v49, v26, v26
  v_fmac_f32 v49, v27, v27
  v_fmac_f32 v49, v28, v28
  v_fmac_f32 v49, v29, v29
  v_fmac_f32 v49, v30, v30
  v_fmac_f32 v49, v31, v31
  v_fmac_f32 v49, v32, v32
  v_fmac_f32 v49, v33, v33
  v_fmac_f32 v49, v34, v34
  v_fmac_f32 v49, v35, v35
  v_fmac_f32 v49, v36, v36
  v_fmac_f32 v49, v37, v37
  v_fmac_f32 v49, v38, v38
  v_fmac_f32 v49, v39, v39
  v_fmac_f32 v49, v40, v40
  v_fmac_f32 v49, v41, v41
  v_fmac_f32 v49, v42, v42
  v_fmac_f32 v49, v43, v43
  ds_swizzle_b32 v48, v49 offset:16415
  s_waitcnt lgkmcnt(0)
  v_add_f32 v49, v49, v48
  ds_swizzle_b32 v48, v49 offset:8223
  s_waitcnt lgkmcnt(0)
  v_add_f32 v49, v49, v48
  ds_swizzle_b32 v48, v49 offset:4127
  s_waitcnt lgkmcnt(0)
  v_add_f32 v49, v49, v48
  ds_swizzle_b32 v48, v49 offset:2079
  s_waitcnt lgkmcnt(0)
  v_add_f32 v49, v49, v48
  ds_swizzle_b32 v48, v49 offset:1055
  s_waitcnt lgkmcnt(0)
  v_add_f32 v49, v49, v48
  v_mov_b32 v50, 0x3727c5ac
  v_fmac_f32 v50, 0x3ae38e39, v49
  v_rsq_f32 v50, v50
  s_nop 0
  v_mul_f32 v50, 0x3fb8aa3b, v50
  v_mul_f32 v20, v20, v50
  v_mul_f32 v21, v21, v50
  v_mul_f32 v22, v22, v50
  v_mul_f32 v23, v23, v50
  v_mul_f32 v24, v24, v50
  v_mul_f32 v25, v25, v50
  v_mul_f32 v26, v26, v50
  v_mul_f32 v27, v27, v50
  v_mul_f32 v28, v28, v50
  v_mul_f32 v29, v29, v50
  v_mul_f32 v30, v30, v50
  v_mul_f32 v31, v31, v50
  v_mul_f32 v32, v32, v50
  v_mul_f32 v33, v33, v50
  v_mul_f32 v34, v34, v50
  v_mul_f32 v35, v35, v50
  v_mul_f32 v36, v36, v50
  v_mul_f32 v37, v37, v50
  v_mul_f32 v38, v38, v50
  v_mul_f32 v39, v39, v50
  v_mul_f32 v40, v40, v50
  v_mul_f32 v41, v41, v50
  v_mul_f32 v42, v42, v50
  v_mul_f32 v43, v43, v50
  v_cvt_pk_bf16_f32 v8, v20, v21
  v_cvt_pk_bf16_f32 v9, v22, v23
  v_cvt_pk_bf16_f32 v10, v24, v25
  v_cvt_pk_bf16_f32 v11, v26, v27
  v_cvt_pk_bf16_f32 v12, v28, v29
  v_cvt_pk_bf16_f32 v13, v30, v31
  v_cvt_pk_bf16_f32 v14, v32, v33
  v_cvt_pk_bf16_f32 v15, v34, v35
  v_cvt_pk_bf16_f32 v16, v36, v37
  v_cvt_pk_bf16_f32 v17, v38, v39
  v_cvt_pk_bf16_f32 v18, v40, v41
  v_cvt_pk_bf16_f32 v19, v42, v43
  v_lshlrev_b32 v44, 7, v2
  v_lshl_add_u32 v44, v1, 4, v44
  ds_write_b128 v44, v[8:11]
  ds_write_b128 v44, v[12:15] offset:4096
  s_and_saveexec_b64 s[20:21], vcc
  ds_write_b128 v44, v[16:19] offset:8192
  s_mov_b64 exec, s[20:21]
  s_waitcnt lgkmcnt(0)
  s_barrier
  v_lshlrev_b32 v45, 4, v0
  ds_read_b128 v[8:11], v45
  ds_read_b128 v[12:15], v45 offset:4096
  ds_read_b128 v[16:19], v45 offset:8192
  s_lshr_b32 s22, s2, 3
  s_lshl_b32 s22, s22, 2
  s_and_b32 s23, s2, 3
  s_add_u32 s22, s22, s23
  s_mul_i32 s22, s22, 18432
  s_bfe_u32 s23, s2, 0x10002
  s_lshl_b32 s23, s23, 7
  s_add_u32 s22, s22, s23
  v_lshrrev_b32 v46, 3, v0
  v_lshrrev_b32 v47, 2, v46
  v_lshlrev_b32 v47, 10, v47
  v_and_b32 v46, 3, v46
  v_lshl_add_u32 v47, v46, 8, v47
  v_and_b32 v46, 7, v0
  v_lshl_add_u32 v47, v46, 4, v47
  v_add_u32 v48, 16384, v47
  v_cmp_gt_u32 vcc, 64, v0
  s_nop 1
  v_cndmask_b32 v48, v6, v48, vcc
  s_waitcnt lgkmcnt(0)
  v_add_u32 v49, 8192, v47
  buffer_store_dwordx4 v[8:11], v47, s[12:15], s22 offen sc1
  buffer_store_dwordx4 v[12:15], v49, s[12:15], s22 offen sc1
  buffer_store_dwordx4 v[16:19], v48, s[12:15], s22 offen sc1
  s_waitcnt vmcnt(0)
k0_end:
  s_endpgm
.section .rodata,"a"
.p2align 6
.amdhsa_kernel k0_ln_kernel
  .amdhsa_next_free_vgpr 64
  .amdhsa_next_free_sgpr 52
  .amdhsa_accum_offset 64
  .amdhsa_group_segment_fixed_size 0
  .amdhsa_kernarg_size 80
  .amdhsa_user_sgpr_count 2
  .amdhsa_user_sgpr_kernarg_segment_ptr 1
  .amdhsa_system_sgpr_workgroup_id_x 1
  .amdhsa_float_denorm_mode_32 3
.end_amdhsa_kernel
.text
.globl k1_gemm1_kernel
.p2align 8
.type k1_gemm1_kernel,@function
k1_gemm1_kernel:
  s_cmp_ge_u32 s2, 256
  s_cbranch_scc1 k1_end
  s_load_dwordx2 s[4:5], s[0:1], 8
  s_load_dwordx4 s[48:51], s[0:1], 32
  s_load_dwordx2 s[46:47], s[0:1], 72
  s_load_dwordx2 s[6:7], s[0:1], 48
  v_and_b32 v1, 63, v0
  v_lshrrev_b32 v16, 6, v0
  v_lshlrev_b32 v15, 4, v1
  v_readfirstlane_b32 s20, v16
  s_and_b32 s26, s2, 7
  s_lshr_b32 s27, s2, 3
  s_and_b32 s21, s27, 3
  s_lshl_b32 s26, s26, 2
  s_add_u32 s21, s21, s26
  s_lshr_b32 s22, s27, 2
  s_add_u32 s26, s21, 22
  s_lshr_b32 s26, s26, 1
  s_cmp_lt_u32 s21, 22
  s_cselect_b32 s23, s21, s26
  s_lshl_b32 s38, s22, 4
  s_lshl_b32 s26, s20, 2
  s_add_u32 s38, s38, s26
  s_mul_i32 s39, s38, 18432
  s_add_u32 s39, s39, 0
  s_waitcnt lgkmcnt(0)
  s_mov_b32 s16, s46
  s_and_b32 s17, s47, 0xffff
  s_mov_b32 s18, 50331648
  s_mov_b32 s19, 0x20000
  s_add_u32 s28, s39, 0
  buffer_load_dwordx4 a[0:3], v15, s[16:19], s28 offen offset:0
  buffer_load_dwordx4 a[4:7], v15, s[16:19], s28 offen offset:1024
  buffer_load_dwordx4 a[8:11], v15, s[16:19], s28 offen offset:2048
  s_add_u32 s28, s39, 18432
  buffer_load_dwordx4 a[72:75], v15, s[16:19], s28 offen offset:0
  buffer_load_dwordx4 a[76:79], v15, s[16:19], s28 offen offset:1024
  buffer_load_dwordx4 a[80:83], v15, s[16:19], s28 offen offset:2048
  s_add_u32 s28, s39, 36864
  buffer_load_dwordx4 a[144:147], v15, s[16:19], s28 offen offset:0
  buffer_load_dwordx4 a[148:151], v15, s[16:19], s28 offen offset:1024
  buffer_load_dwordx4 a[152:155], v15, s[16:19], s28 offen offset:2048
  s_add_u32 s28, s39, 55296
  buffer_load_dwordx4 a[216:219], v15, s[16:19], s28 offen offset:0
  buffer_load_dwordx4 a[220:223], v15, s[16:19], s28 offen offset:1024
  buffer_load_dwordx4 a[224:227], v15, s[16:19], s28 offen offset:2048
  v_lshrrev_b32 v16, 2, v1
  v_and_b32 v17, 3, v1
  v_lshrrev_b32 v18, 3, v16
  v_lshlrev_b32 v18, 1, v18
  v_xor_b32 v17, v17, v18
  v_lshlrev_b32 v17, 4, v17
  v_mul_u32_u24 v2, 9216, v16
  v_add_u32 v2, v2, v17
  v_lshrrev_b32 v16, 3, v1
  v_and_b32 v17, 7, v1
  v_bfe_u32 v18, v16, 1, 1
  v_lshlrev_b32 v18, 1, v18
  v_xor_b32 v17, v17, v18
  v_mul_u32_u24 v16, 3456, v16
  s_and_b32 s26, s20, 1
  s_lshl_b32 s26, s26, 2
  v_xor_b32 v18, s26, v17
  v_lshl_add_u32 v3, v18, 4, v16
  v_xor_b32 v18, 4, v18
  v_lshl_add_u32 v4, v18, 4, v16
  s_mov_b32 s8, s4
  s_and_b32 s9, s5, 0xffff
  s_mov_b32 s10, 1990656
  s_mov_b32 s11, 0x20000
  s_cmp_lt_u32 s20, 2
  s_cselect_b32 s4, s48, s50
  s_cselect_b32 s5, s49, s51
  s_mov_b32 s12, s4
  s_and_b32 s13, s5, 0xffff
  s_mov_b32 s14, 5308416
  s_mov_b32 s15, 0x20000
  s_and_b32 s26, s20, 1
  s_mul_i32 s32, s26, 442368
  s_mul_i32 s33, s26, 3072
  s_lshr_b32 s26, s20, 1
  s_mul_i32 s26, s26, 6144
  s_add_u32 s33, s33, s26
  s_mul_i32 s34, s20, 82944
  s_lshl_b32 s26, s23, 7
  s_add_u32 s34, s34, s26
  s_mul_i32 s35, s20, 3072
  s_mul_i32 s31, s21, 288
  s_and_b32 s26, s21, 1
  s_lshl_b32 s27, s26, 5
  s_add_u32 s31, s31, s27
  v_add_u32 v2, s31, v2
  v_add_u32 v0, 64, v2
  s_cmp_eq_u32 s26, 0
  s_mov_b32 s45, -192
  s_cselect_b32 s45, 128, s45
  s_add_u32 s48, s32, 0
  s_add_u32 s49, s32, 146432
  s_add_u32 s50, s32, 292864
  s_add_u32 s51, s32, 884736
  s_add_u32 s52, s32, 1031168
  s_add_u32 s53, s32, 1177600
  s_add_u32 s54, s32, 1769472
  s_add_u32 s55, s32, 1915904
  s_add_u32 s56, s32, 2062336
  s_add_u32 s57, s32, 2654208
  s_add_u32 s58, s32, 2800640
  s_add_u32 s59, s32, 2947072
  s_add_u32 s60, s32, 3538944
  s_add_u32 s61, s32, 3685376
  s_add_u32 s62, s32, 3831808
  s_add_u32 s63, s32, 4423680
  s_add_u32 s64, s32, 4570112
  s_add_u32 s65, s32, 4716544
  s_add_u32 m0, s35, 0
  s_add_u32 s25, s34, 0
  buffer_load_dwordx4 v3, s[8:11], s25 offen lds
  s_add_u32 m0, s35, 1024
  s_add_u32 s25, s34, 27648
  buffer_load_dwordx4 v4, s[8:11], s25 offen lds
  s_add_u32 m0, s35, 2048
  s_add_u32 s25, s34, 55296
  buffer_load_dwordx4 v3, s[8:11], s25 offen lds
  s_add_u32 m0, s33, 73728
  s_nop 0
  buffer_load_dwordx4 v2, s[12:15], s48 offen offset:0 lds
  buffer_load_dwordx4 v2, s[12:15], s49 offen offset:1024 lds
  buffer_load_dwordx4 v2, s[12:15], s50 offen offset:2048 lds
  v_and_b32 v16, 15, v1
  v_lshrrev_b32 v17, 2, v16
  v_and_b32 v16, 3, v16
  v_lshlrev_b32 v16, 3, v16
  v_lshrrev_b32 v18, 4, v1
  v_lshl_add_u32 v19, v18, 3, v17
  v_lshl_add_u32 v20, v19, 6, v16
  v_and_b32 v21, 1, v18
  v_lshl_add_u32 v9, v21, 5, v20
  v_xor_b32 v21, 1, v21
  v_lshl_add_u32 v10, v21, 5, v20
  v_lshl_add_u32 v20, v19, 7, v16
  v_bfe_u32 v21, v17, 1, 1
  v_and_b32 v22, 1, v18
  v_lshl_or_b32 v21, v22, 1, v21
  v_xor_b32 v22, 0, v21
  v_lshl_add_u32 v5, v22, 5, v20
  v_xor_b32 v22, 1, v21
  v_lshl_add_u32 v6, v22, 5, v20
  v_xor_b32 v22, 2, v21
  v_lshl_add_u32 v7, v22, 5, v20
  v_xor_b32 v22, 3, v21
  v_lshl_add_u32 v8, v22, 5, v20
  v_and_b32 v16, 15, v1
  v_and_b32 v17, 1, v18
  v_lshl_add_u32 v16, v17, 5, v16
  v_lshlrev_b32 v16, 4, v16
  v_lshrrev_b32 v17, 1, v18
  v_lshl_add_u32 v13, v17, 3, v16
  s_add_u32 m0, s35, 12288
  s_add_u32 s25, s34, 331776
  buffer_load_dwordx4 v3, s[8:11], s25 offen lds
  s_add_u32 m0, s35, 13312
  s_add_u32 s25, s34, 359424
  buffer_load_dwordx4 v4, s[8:11], s25 offen lds
  s_add_u32 m0, s35, 14336
  s_add_u32 s25, s34, 387072
  buffer_load_dwordx4 v3, s[8:11], s25 offen lds
  s_add_u32 m0, s33, 86016
  s_nop 0
  buffer_load_dwordx4 v2, s[12:15], s51 offen offset:0 lds
  buffer_load_dwordx4 v2, s[12:15], s52 offen offset:1024 lds
  buffer_load_dwordx4 v2, s[12:15], s53 offen offset:2048 lds
  s_add_u32 s28, s39, 3072
  buffer_load_dwordx4 a[12:15], v15, s[16:19], s28 offen offset:0
  buffer_load_dwordx4 a[16:19], v15, s[16:19], s28 offen offset:1024
  buffer_load_dwordx4 a[20:23], v15, s[16:19], s28 offen offset:2048
  s_add_u32 s28, s39, 21504
  buffer_load_dwordx4 a[84:87], v15, s[16:19], s28 offen offset:0
  buffer_load_dwordx4 a[88:91], v15, s[16:19], s28 offen offset:1024
  buffer_load_dwordx4 a[92:95], v15, s[16:19], s28 offen offset:2048
  s_add_u32 s28, s39, 39936
  buffer_load_dwordx4 a[156:159], v15, s[16:19], s28 offen offset:0
  buffer_load_dwordx4 a[160:163], v15, s[16:19], s28 offen offset:1024
  buffer_load_dwordx4 a[164:167], v15, s[16:19], s28 offen offset:2048
  s_add_u32 s28, s39, 58368
  buffer_load_dwordx4 a[228:231], v15, s[16:19], s28 offen offset:0
  buffer_load_dwordx4 a[232:235], v15, s[16:19], s28 offen offset:1024
  buffer_load_dwordx4 a[236:239], v15, s[16:19], s28 offen offset:2048
  s_lshr_b32 s29, s38, 1
  s_mul_i32 s29, s29, 288
  s_mul_i32 s26, s21, 9
  s_add_u32 s29, s29, s26
  s_lshl_b32 s29, s29, 10
  s_add_u32 s29, s29, 12582912
  s_and_b32 s26, s21, 1
  s_cmp_eq_u32 s26, 0
  s_cselect_b32 s27, 8192, 0
  s_add_u32 s44, s29, s27
  s_lshl_b32 s26, s26, 10
  s_add_u32 s29, s29, s26
  v_add_u32 v11, 73728, v9
  v_add_u32 v12, 73728, v10
  s_waitcnt vmcnt(18)
  s_barrier
  s_cmp_ge_u32 s23, 18
  s_cbranch_scc1 k1_vpath
  s_mov_b32 s36, 0x3e274c22
  s_cmp_lt_u32 s23, 9
  s_cselect_b32 s36, s36, 1.0
  s_lshl_b32 s37, s23, 18
  s_lshl_b32 s26, s38, 6
  s_add_u32 s37, s37, s26
  s_add_u32 s37, s37, 2359296
  v_lshrrev_b32 v16, 4, v1
  v_and_b32 v17, 15, v1
  v_lshlrev_b32 v17, 4, v17
  v_lshl_add_u32 v14, v16, 14, v17
  ds_read_b64_tr_b16 v[16:17], v5 offset:0
  ds_read_b64_tr_b16 v[18:19], v5 offset:512
  ds_read_b64_tr_b16 v[20:21], v6 offset:0
  ds_read_b64_tr_b16 v[22:23], v6 offset:512
  ds_read_b64_tr_b16 v[24:25], v7 offset:0
  ds_read_b64_tr_b16 v[26:27], v7 offset:512
  ds_read_b64_tr_b16 v[28:29], v8 offset:0
  ds_read_b64_tr_b16 v[30:31], v8 offset:512
  s_waitcnt lgkmcnt(4)
  v_mfma_f32_16x16x32_bf16 v[40:43], v[16:19], a[0:3], 0
  ds_read_b64_tr_b16 v[32:33], v11 offset:0
  s_add_u32 m0, s35, 24576
  v_mfma_f32_16x16x32_bf16 v[44:47], v[16:19], a[72:75], 0
  ds_read_b64_tr_b16 v[34:35], v11 offset:256
  s_add_u32 s25, s34, 663552
  v_mfma_f32_16x16x32_bf16 v[48:51], v[16:19], a[144:147], 0
  buffer_load_dwordx4 v3, s[8:11], s25 offen lds
  v_mfma_f32_16x16x32_bf16 v[52:55], v[16:19], a[216:219], 0
  v_mfma_f32_16x16x32_bf16 v[56:59], v[20:23], a[0:3], 0
  ds_read_b64_tr_b16 v[36:37], v11 offset:6144
  v_mfma_f32_16x16x32_bf16 v[60:63], v[20:23], a[72:75], 0
  ds_read_b64_tr_b16 v[38:39], v11 offset:6400
  s_add_u32 m0, s35, 25600
  v_mfma_f32_16x16x32_bf16 v[64:67], v[20:23], a[144:147], 0
  v_mfma_f32_16x16x32_bf16 v[68:71], v[20:23], a[216:219], 0
  s_waitcnt lgkmcnt(4)
  v_mfma_f32_16x16x32_bf16 v[72:75], v[24:27], a[0:3], 0
  ds_read_b64_tr_b16 v[16:17], v12 offset:0
  s_add_u32 s25, s34, 691200
  v_mfma_f32_16x16x32_bf16 v[76:79], v[24:27], a[72:75], 0
  ds_read_b64_tr_b16 v[18:19], v12 offset:256
  v_mfma_f32_16x16x32_bf16 v[80:83], v[24:27], a[144:147], 0
  v_mfma_f32_16x16x32_bf16 v[84:87], v[24:27], a[216:219], 0
  buffer_load_dwordx4 v4, s[8:11], s25 offen lds
  v_mfma_f32_16x16x32_bf16 v[88:91], v[28:31], a[0:3], 0
  ds_read_b64_tr_b16 v[20:21], v12 offset:6144
  v_mfma_f32_16x16x32_bf16 v[92:95], v[28:31], a[72:75], 0
  ds_read_b64_tr_b16 v[22:23], v12 offset:6400
  s_add_u32 m0, s35, 26624
  v_mfma_f32_16x16x32_bf16 v[96:99], v[28:31], a[144:147], 0
  v_mfma_f32_16x16x32_bf16 v[100:103], v[28:31], a[216:219], 0
  s_waitcnt lgkmcnt(4)
  v_mfma_f32_16x16x32_bf16 v[104:107], v[32:35], a[0:3], 0
  ds_read_b64_tr_b16 v[24:25], v5 offset:4096
  s_add_u32 s25, s34, 718848
  v_mfma_f32_16x16x32_bf16 v[108:111], v[32:35], a[72:75], 0
  ds_read_b64_tr_b16 v[26:27], v5 offset:4608
  v_mfma_f32_16x16x32_bf16 v[112:115], v[32:35], a[144:147], 0
  v_mfma_f32_16x16x32_bf16 v[116:119], v[32:35], a[216:219], 0
  buffer_load_dwordx4 v3, s[8:11], s25 offen lds
  v_mfma_f32_16x16x32_bf16 v[120:123], v[36:39], a[0:3], 0
  ds_read_b64_tr_b16 v[28:29], v6 offset:4096
  v_mfma_f32_16x16x32_bf16 v[124:127], v[36:39], a[72:75], 0
  ds_read_b64_tr_b16 v[30:31], v6 offset:4608
  v_mfma_f32_16x16x32_bf16 v[128:131], v[36:39], a[144:147], 0
  s_add_u32 m0, s33, 98304
  v_mfma_f32_16x16x32_bf16 v[132:135], v[36:39], a[216:219], 0
  s_waitcnt lgkmcnt(4)
  v_mfma_f32_16x16x32_bf16 v[136:139], v[16:19], a[0:3], 0
  ds_read_b64_tr_b16 v[32:33], v7 offset:4096
  buffer_load_dwordx4 v2, s[12:15], s54 offen offset:0 lds
  v_mfma_f32_16x16x32_bf16 v[140:143], v[16:19], a[72:75], 0
  ds_read_b64_tr_b16 v[34:35], v7 offset:4608
  v_mfma_f32_16x16x32_bf16 v[144:147], v[16:19], a[144:147], 0
  v_mfma_f32_16x16x32_bf16 v[148:151], v[16:19], a[216:219], 0
  buffer_load_dwordx4 v2, s[12:15], s55 offen offset:1024 lds
  v_mfma_f32_16x16x32_bf16 v[152:155], v[20:23], a[0:3], 0
  ds_read_b64_tr_b16 v[36:37], v8 offset:4096
  v_mfma_f32_16x16x32_bf16 v[156:159], v[20:23], a[72:75], 0
  ds_read_b64_tr_b16 v[38:39], v8 offset:4608
  v_mfma_f32_16x16x32_bf16 v[160:163], v[20:23], a[144:147], 0
  buffer_load_dwordx4 v2, s[12:15], s56 offen offset:2048 lds
  v_mfma_f32_16x16x32_bf16 v[164:167], v[20:23], a[216:219], 0
  s_waitcnt lgkmcnt(4)
  v_mfma_f32_16x16x32_bf16 v[40:43], v[24:27], a[4:7], v[40:43]
  ds_read_b64_tr_b16 v[16:17], v11 offset:2048
  v_mfma_f32_16x16x32_bf16 v[44:47], v[24:27], a[76:79], v[44:47]
  ds_read_b64_tr_b16 v[18:19], v11 offset:2304
  s_add_u32 s28, s39, 6144
  v_mfma_f32_16x16x32_bf16 v[48:51], v[24:27], a[148:151], v[48:51]
  v_mfma_f32_16x16x32_bf16 v[52:55], v[24:27], a[220:223], v[52:55]
  buffer_load_dwordx4 a[24:27], v15, s[16:19], s28 offen offset:0
  v_mfma_f32_16x16x32_bf16 v[56:59], v[28:31], a[4:7], v[56:59]
  ds_read_b64_tr_b16 v[20:21], v11 offset:8192
  v_mfma_f32_16x16x32_bf16 v[60:63], v[28:31], a[76:79], v[60:63]
  ds_read_b64_tr_b16 v[22:23], v11 offset:8448
  v_mfma_f32_16x16x32_bf16 v[64:67], v[28:31], a[148:151], v[64:67]
  buffer_load_dwordx4 a[28:31], v15, s[16:19], s28 offen offset:1024
  v_mfma_f32_16x16x32_bf16 v[68:71], v[28:31], a[220:223], v[68:71]
  s_waitcnt lgkmcnt(4)
  v_mfma_f32_16x16x32_bf16 v[72:75], v[32:35], a[4:7], v[72:75]
  ds_read_b64_tr_b16 v[24:25], v12 offset:2048
  v_mfma_f32_16x16x32_bf16 v[76:79], v[32:35], a[76:79], v[76:79]
  ds_read_b64_tr_b16 v[26:27], v12 offset:2304
  buffer_load_dwordx4 a[32:35], v15, s[16:19], s28 offen offset:2048
  v_mfma_f32_16x16x32_bf16 v[80:83], v[32:35], a[148:151], v[80:83]
  v_mfma_f32_16x16x32_bf16 v[84:87], v[32:35], a[220:223], v[84:87]
  v_mfma_f32_16x16x32_bf16 v[88:91], v[36:39], a[4:7], v[88:91]
  ds_read_b64_tr_b16 v[28:29], v12 offset:8192
  s_add_u32 s28, s39, 24576
  v_mfma_f32_16x16x32_bf16 v[92:95], v[36:39], a[76:79], v[92:95]
  ds_read_b64_tr_b16 v[30:31], v12 offset:8448
  v_mfma_f32_16x16x32_bf16 v[96:99], v[36:39], a[148:151], v[96:99]
  buffer_load_dwordx4 a[96:99], v15, s[16:19], s28 offen offset:0
  v_mfma_f32_16x16x32_bf16 v[100:103], v[36:39], a[220:223], v[100:103]
  s_waitcnt lgkmcnt(4)
  v_mfma_f32_16x16x32_bf16 v[104:107], v[16:19], a[4:7], v[104:107]
  ds_read_b64_tr_b16 v[32:33], v5 offset:8192
  v_mfma_f32_16x16x32_bf16 v[108:111], v[16:19], a[76:79], v[108:111]
  ds_read_b64_tr_b16 v[34:35], v5 offset:8704
  buffer_load_dwordx4 a[100:103], v15, s[16:19], s28 offen offset:1024
  v_mfma_f32_16x16x32_bf16 v[112:115], v[16:19], a[148:151], v[112:115]
  v_mfma_f32_16x16x32_bf16 v[116:119], v[16:19], a[220:223], v[116:119]
  v_mfma_f32_16x16x32_bf16 v[120:123], v[20:23], a[4:7], v[120:123]
  ds_read_b64_tr_b16 v[36:37], v6 offset:8192
  buffer_load_dwordx4 a[104:107], v15, s[16:19], s28 offen offset:2048
  v_mfma_f32_16x16x32_bf16 v[124:127], v[20:23], a[76:79], v[124:127]
  ds_read_b64_tr_b16 v[38:39], v6 offset:8704
  v_mfma_f32_16x16x32_bf16 v[128:131], v[20:23], a[148:151], v[128:131]
  v_mfma_f32_16x16x32_bf16 v[132:135], v[20:23], a[220:223], v[132:135]
  s_waitcnt lgkmcnt(4)
  s_add_u32 s28, s39, 43008
  v_mfma_f32_16x16x32_bf16 v[136:139], v[24:27], a[4:7], v[136:139]
  ds_read_b64_tr_b16 v[16:17], v7 offset:8192
  v_mfma_f32_16x16x32_bf16 v[140:143], v[24:27], a[76:79], v[140:143]
  ds_read_b64_tr_b16 v[18:19], v7 offset:8704
  buffer_load_dwordx4 a[168:171], v15, s[16:19], s28 offen offset:0
  v_mfma_f32_16x16x32_bf16 v[144:147], v[24:27], a[148:151], v[144:147]
  v_mfma_f32_16x16x32_bf16 v[148:151], v[24:27], a[220:223], v[148:151]
  v_mfma_f32_16x16x32_bf16 v[152:155], v[28:31], a[4:7], v[152:155]
  ds_read_b64_tr_b16 v[20:21], v8 offset:8192
  buffer_load_dwordx4 a[172:175], v15, s[16:19], s28 offen offset:1024
  v_mfma_f32_16x16x32_bf16 v[156:159], v[28:31], a[76:79], v[156:159]
  ds_read_b64_tr_b16 v[22:23], v8 offset:8704
  v_mfma_f32_16x16x32_bf16 v[160:163], v[28:31], a[148:151], v[160:163]
  v_mfma_f32_16x16x32_bf16 v[164:167], v[28:31], a[220:223], v[164:167]
  s_waitcnt lgkmcnt(4)
  buffer_load_dwordx4 a[176:179], v15, s[16:19], s28 offen offset:2048
  v_mfma_f32_16x16x32_bf16 v[40:43], v[32:35], a[8:11], v[40:43]
  ds_read_b64_tr_b16 v[24:25], v11 offset:4096
  v_mfma_f32_16x16x32_bf16 v[44:47], v[32:35], a[80:83], v[44:47]
  ds_read_b64_tr_b16 v[26:27], v11 offset:4352
  v_mfma_f32_16x16x32_bf16 v[48:51], v[32:35], a[152:155], v[48:51]
  s_add_u32 s28, s39, 61440
  v_mfma_f32_16x16x32_bf16 v[52:55], v[32:35], a[224:227], v[52:55]
  v_mfma_f32_16x16x32_bf16 v[56:59], v[36:39], a[8:11], v[56:59]
  ds_read_b64_tr_b16 v[28:29], v11 offset:10240
  buffer_load_dwordx4 a[240:243], v15, s[16:19], s28 offen offset:0
  v_mfma_f32_16x16x32_bf16 v[60:63], v[36:39], a[80:83], v[60:63]
  ds_read_b64_tr_b16 v[30:31], v11 offset:10496
  v_mfma_f32_16x16x32_bf16 v[64:67], v[36:39], a[152:155], v[64:67]
  v_mfma_f32_16x16x32_bf16 v[68:71], v[36:39], a[224:227], v[68:71]
  s_waitcnt lgkmcnt(4)
  buffer_load_dwordx4 a[244:247], v15, s[16:19], s28 offen offset:1024
  v_mfma_f32_16x16x32_bf16 v[72:75], v[16:19], a[8:11], v[72:75]
  ds_read_b64_tr_b16 v[32:33], v12 offset:4096
  v_mfma_f32_16x16x32_bf16 v[76:79], v[16:19], a[80:83], v[76:79]
  ds_read_b64_tr_b16 v[34:35], v12 offset:4352
  v_mfma_f32_16x16x32_bf16 v[80:83], v[16:19], a[152:155], v[80:83]
  buffer_load_dwordx4 a[248:251], v15, s[16:19], s28 offen offset:2048
  v_mfma_f32_16x16x32_bf16 v[84:87], v[16:19], a[224:227], v[84:87]
  v_mfma_f32_16x16x32_bf16 v[88:91], v[20:23], a[8:11], v[88:91]
  ds_read_b64_tr_b16 v[36:37], v12 offset:10240
  v_mfma_f32_16x16x32_bf16 v[92:95], v[20:23], a[80:83], v[92:95]
  ds_read_b64_tr_b16 v[38:39], v12 offset:10496
  v_mfma_f32_16x16x32_bf16 v[96:99], v[20:23], a[152:155], v[96:99]
  v_mfma_f32_16x16x32_bf16 v[100:103], v[20:23], a[224:227], v[100:103]
  s_waitcnt lgkmcnt(4)
  v_mfma_f32_16x16x32_bf16 v[104:107], v[24:27], a[8:11], v[104:107]
  s_waitcnt vmcnt(18)
  s_barrier
  ds_read_b64_tr_b16 v[16:17], v5 offset:12288
  v_mfma_f32_16x16x32_bf16 v[108:111], v[24:27], a[80:83], v[108:111]
  ds_read_b64_tr_b16 v[18:19], v5 offset:12800
  v_mfma_f32_16x16x32_bf16 v[112:115], v[24:27], a[152:155], v[112:115]
  v_mfma_f32_16x16x32_bf16 v[116:119], v[24:27], a[224:227], v[116:119]
  v_mfma_f32_16x16x32_bf16 v[120:123], v[28:31], a[8:11], v[120:123]
  ds_read_b64_tr_b16 v[20:21], v6 offset:12288
  v_mfma_f32_16x16x32_bf16 v[124:127], v[28:31], a[80:83], v[124:127]
  ds_read_b64_tr_b16 v[22:23], v6 offset:12800
  v_mfma_f32_16x16x32_bf16 v[128:131], v[28:31], a[152:155], v[128:131]
  v_mfma_f32_16x16x32_bf16 v[132:135], v[28:31], a[224:227], v[132:135]
  s_waitcnt lgkmcnt(4)
  v_mfma_f32_16x16x32_bf16 v[136:139], v[32:35], a[8:11], v[136:139]
  ds_read_b64_tr_b16 v[24:25], v7 offset:12288
  v_mfma_f32_16x16x32_bf16 v[140:143], v[32:35], a[80:83], v[140:143]
  ds_read_b64_tr_b16 v[26:27], v7 offset:12800
  v_mfma_f32_16x16x32_bf16 v[144:147], v[32:35], a[152:155], v[144:147]
  v_mfma_f32_16x16x32_bf16 v[148:151], v[32:35], a[224:227], v[148:151]
  v_mfma_f32_16x16x32_bf16 v[152:155], v[36:39], a[8:11], v[152:155]
  ds_read_b64_tr_b16 v[28:29], v8 offset:12288
  v_mfma_f32_16x16x32_bf16 v[156:159], v[36:39], a[80:83], v[156:159]
  ds_read_b64_tr_b16 v[30:31], v8 offset:12800
  v_mfma_f32_16x16x32_bf16 v[160:163], v[36:39], a[152:155], v[160:163]
  v_mfma_f32_16x16x32_bf16 v[164:167], v[36:39], a[224:227], v[164:167]
  s_waitcnt lgkmcnt(4)
  v_mfma_f32_16x16x32_bf16 v[40:43], v[16:19], a[12:15], v[40:43]
  ds_read_b64_tr_b16 v[32:33], v11 offset:12288
  s_add_u32 m0, s35, 36864
  v_mfma_f32_16x16x32_bf16 v[44:47], v[16:19], a[84:87], v[44:47]
  ds_read_b64_tr_b16 v[34:35], v11 offset:12544
  s_add_u32 s25, s34, 995328
  v_mfma_f32_16x16x32_bf16 v[48:51], v[16:19], a[156:159], v[48:51]
  buffer_load_dwordx4 v3, s[8:11], s25 offen lds
  v_mfma_f32_16x16x32_bf16 v[52:55], v[16:19], a[228:231], v[52:55]
  v_mfma_f32_16x16x32_bf16 v[56:59], v[20:23], a[12:15], v[56:59]
  ds_read_b64_tr_b16 v[36:37], v11 offset:18432
  v_mfma_f32_16x16x32_bf16 v[60:63], v[20:23], a[84:87], v[60:63]
  ds_read_b64_tr_b16 v[38:39], v11 offset:18688
  s_add_u32 m0, s35, 37888
  v_mfma_f32_16x16x32_bf16 v[64:67], v[20:23], a[156:159], v[64:67]
  v_mfma_f32_16x16x32_bf16 v[68:71], v[20:23], a[228:231], v[68:71]
  s_waitcnt lgkmcnt(4)
  v_mfma_f32_16x16x32_bf16 v[72:75], v[24:27], a[12:15], v[72:75]
  ds_read_b64_tr_b16 v[16:17], v12 offset:12288
  s_add_u32 s25, s34, 1022976
  v_mfma_f32_16x16x32_bf16 v[76:79], v[24:27], a[84:87], v[76:79]
  ds_read_b64_tr_b16 v[18:19], v12 offset:12544
  v_mfma_f32_16x16x32_bf16 v[80:83], v[24:27], a[156:159], v[80:83]
  v_mfma_f32_16x16x32_bf16 v[84:87], v[24:27], a[228:231], v[84:87]
  buffer_load_dwordx4 v4, s[8:11], s25 offen lds
  v_mfma_f32_16x16x32_bf16 v[88:91], v[28:31], a[12:15], v[88:91]
  ds_read_b64_tr_b16 v[20:21], v12 offset:18432
  v_mfma_f32_16x16x32_bf16 v[92:95], v[28:31], a[84:87], v[92:95]
  ds_read_b64_tr_b16 v[22:23], v12 offset:18688
  s_add_u32 m0, s35, 38912
  v_mfma_f32_16x16x32_bf16 v[96:99], v[28:31], a[156:159], v[96:99]
  v_mfma_f32_16x16x32_bf16 v[100:103], v[28:31], a[228:231], v[100:103]
  s_waitcnt lgkmcnt(4)
  v_mfma_f32_16x16x32_bf16 v[104:107], v[32:35], a[12:15], v[104:107]
  ds_read_b64_tr_b16 v[24:25], v5 offset:16384
  s_add_u32 s25, s34, 1050624
  v_mfma_f32_16x16x32_bf16 v[108:111], v[32:35], a[84:87], v[108:111]
  ds_read_b64_tr_b16 v[26:27], v5 offset:16896
  v_mfma_f32_16x16x32_bf16 v[112:115], v[32:35], a[156:159], v[112:115]
  v_mfma_f32_16x16x32_bf16 v[116:119], v[32:35], a[228:231], v[116:119]
  buffer_load_dwordx4 v3, s[8:11], s25 offen lds
  v_mfma_f32_16x16x32_bf16 v[120:123], v[36:39], a[12:15], v[120:123]
  ds_read_b64_tr_b16 v[28:29], v6 offset:16384
  v_mfma_f32_16x16x32_bf16 v[124:127], v[36:39], a[84:87], v[124:127]
  ds_read_b64_tr_b16 v[30:31], v6 offset:16896
  v_mfma_f32_16x16x32_bf16 v[128:131], v[36:39], a[156:159], v[128:131]
  s_add_u32 m0, s33, 110592
  v_mfma_f32_16x16x32_bf16 v[132:135], v[36:39], a[228:231], v[132:135]
  s_waitcnt lgkmcnt(4)
  v_mfma_f32_16x16x32_bf16 v[136:139], v[16:19], a[12:15], v[136:139]
  ds_read_b64_tr_b16 v[32:33], v7 offset:16384
  buffer_load_dwordx4 v2, s[12:15], s57 offen offset:0 lds
  v_mfma_f32_16x16x32_bf16 v[140:143], v[16:19], a[84:87], v[140:143]
  ds_read_b64_tr_b16 v[34:35], v7 offset:16896
  v_mfma_f32_16x16x32_bf16 v[144:147], v[16:19], a[156:159], v[144:147]
  v_mfma_f32_16x16x32_bf16 v[148:151], v[16:19], a[228:231], v[148:151]
  buffer_load_dwordx4 v2, s[12:15], s58 offen offset:1024 lds
  v_mfma_f32_16x16x32_bf16 v[152:155], v[20:23], a[12:15], v[152:155]
  ds_read_b64_tr_b16 v[36:37], v8 offset:16384
  v_mfma_f32_16x16x32_bf16 v[156:159], v[20:23], a[84:87], v[156:159]
  ds_read_b64_tr_b16 v[38:39], v8 offset:16896
  v_mfma_f32_16x16x32_bf16 v[160:163], v[20:23], a[156:159], v[160:163]
  buffer_load_dwordx4 v2, s[12:15], s59 offen offset:2048 lds
  v_mfma_f32_16x16x32_bf16 v[164:167], v[20:23], a[228:231], v[164:167]
  s_waitcnt lgkmcnt(4)
  v_mfma_f32_16x16x32_bf16 v[40:43], v[24:27], a[16:19], v[40:43]
  ds_read_b64_tr_b16 v[16:17], v11 offset:14336
  v_mfma_f32_16x16x32_bf16 v[44:47], v[24:27], a[88:91], v[44:47]
  ds_read_b64_tr_b16 v[18:19], v11 offset:14592
  s_add_u32 s28, s39, 9216
  v_mfma_f32_16x16x32_bf16 v[48:51], v[24:27], a[160:163], v[48:51]
  v_mfma_f32_16x16x32_bf16 v[52:55], v[24:27], a[232:235], v[52:55]
  buffer_load_dwordx4 a[36:39], v15, s[16:19], s28 offen offset:0
  v_mfma_f32_16x16x32_bf16 v[56:59], v[28:31], a[16:19], v[56:59]
  ds_read_b64_tr_b16 v[20:21], v11 offset:20480
  v_mfma_f32_16x16x32_bf16 v[60:63], v[28:31], a[88:91], v[60:63]
  ds_read_b64_tr_b16 v[22:23], v11 offset:20736
  v_mfma_f32_16x16x32_bf16 v[64:67], v[28:31], a[160:163], v[64:67]
  buffer_load_dwordx4 a[40:43], v15, s[16:19], s28 offen offset:1024
  v_mfma_f32_16x16x32_bf16 v[68:71], v[28:31], a[232:235], v[68:71]
  s_waitcnt lgkmcnt(4)
  v_mfma_f32_16x16x32_bf16 v[72:75], v[32:35], a[16:19], v[72:75]
  ds_read_b64_tr_b16 v[24:25], v12 offset:14336
  v_mfma_f32_16x16x32_bf16 v[76:79], v[32:35], a[88:91], v[76:79]
  ds_read_b64_tr_b16 v[26:27], v12 offset:14592
  buffer_load_dwordx4 a[44:47], v15, s[16:19], s28 offen offset:2048
  v_mfma_f32_16x16x32_bf16 v[80:83], v[32:35], a[160:163], v[80:83]
  v_mfma_f32_16x16x32_bf16 v[84:87], v[32:35], a[232:235], v[84:87]
  v_mfma_f32_16x16x32_bf16 v[88:91], v[36:39], a[16:19], v[88:91]
  ds_read_b64_tr_b16 v[28:29], v12 offset:20480
  s_add_u32 s28, s39, 27648
  v_mfma_f32_16x16x32_bf16 v[92:95], v[36:39], a[88:91], v[92:95]
  ds_read_b64_tr_b16 v[30:31], v12 offset:20736
  v_mfma_f32_16x16x32_bf16 v[96:99], v[36:39], a[160:163], v[96:99]
  buffer_load_dwordx4 a[108:111], v15, s[16:19], s28 offen offset:0
  v_mfma_f32_16x16x32_bf16 v[100:103], v[36:39], a[232:235], v[100:103]
  s_waitcnt lgkmcnt(4)
  v_mfma_f32_16x16x32_bf16 v[104:107], v[16:19], a[16:19], v[104:107]
  ds_read_b64_tr_b16 v[32:33], v5 offset:20480
  v_mfma_f32_16x16x32_bf16 v[108:111], v[16:19], a[88:91], v[108:111]
  ds_read_b64_tr_b16 v[34:35], v5 offset:20992
  buffer_load_dwordx4 a[112:115], v15, s[16:19], s28 offen offset:1024
  v_mfma_f32_16x16x32_bf16 v[112:115], v[16:19], a[160:163], v[112:115]
  v_mfma_f32_16x16x32_bf16 v[116:119], v[16:19], a[232:235], v[116:119]
  v_mfma_f32_16x16x32_bf16 v[120:123], v[20:23], a[16:19], v[120:123]
  ds_read_b64_tr_b16 v[36:37], v6 offset:20480
  buffer_load_dwordx4 a[116:119], v15, s[16:19], s28 offen offset:2048
  v_mfma_f32_16x16x32_bf16 v[124:127], v[20:23], a[88:91], v[124:127]
  ds_read_b64_tr_b16 v[38:39], v6 offset:20992
  v_mfma_f32_16x16x32_bf16 v[128:131], v[20:23], a[160:163], v[128:131]
  v_mfma_f32_16x16x32_bf16 v[132:135], v[20:23], a[232:235], v[132:135]
  s_waitcnt lgkmcnt(4)
  s_add_u32 s28, s39, 46080
  v_mfma_f32_16x16x32_bf16 v[136:139], v[24:27], a[16:19], v[136:139]
  ds_read_b64_tr_b16 v[16:17], v7 offset:20480
  v_mfma_f32_16x16x32_bf16 v[140:143], v[24:27], a[88:91], v[140:143]
  ds_read_b64_tr_b16 v[18:19], v7 offset:20992
  buffer_load_dwordx4 a[180:183], v15, s[16:19], s28 offen offset:0
  v_mfma_f32_16x16x32_bf16 v[144:147], v[24:27], a[160:163], v[144:147]
  v_mfma_f32_16x16x32_bf16 v[148:151], v[24:27], a[232:235], v[148:151]
  v_mfma_f32_16x16x32_bf16 v[152:155], v[28:31], a[16:19], v[152:155]
  ds_read_b64_tr_b16 v[20:21], v8 offset:20480
  buffer_load_dwordx4 a[184:187], v15, s[16:19], s28 offen offset:1024
  v_mfma_f32_16x16x32_bf16 v[156:159], v[28:31], a[88:91], v[156:159]
  ds_read_b64_tr_b16 v[22:23], v8 offset:20992
  v_mfma_f32_16x16x32_bf16 v[160:163], v[28:31], a[160:163], v[160:163]
  v_mfma_f32_16x16x32_bf16 v[164:167], v[28:31], a[232:235], v[164:167]
  s_waitcnt lgkmcnt(4)
  buffer_load_dwordx4 a[188:191], v15, s[16:19], s28 offen offset:2048
  v_mfma_f32_16x16x32_bf16 v[40:43], v[32:35], a[20:23], v[40:43]
  ds_read_b64_tr_b16 v[24:25], v11 offset:16384
  v_mfma_f32_16x16x32_bf16 v[44:47], v[32:35], a[92:95], v[44:47]
  ds_read_b64_tr_b16 v[26:27], v11 offset:16640
  v_mfma_f32_16x16x32_bf16 v[48:51], v[32:35], a[164:167], v[48:51]
  s_add_u32 s28, s39, 64512
  v_mfma_f32_16x16x32_bf16 v[52:55], v[32:35], a[236:239], v[52:55]
  v_mfma_f32_16x16x32_bf16 v[56:59], v[36:39], a[20:23], v[56:59]
  ds_read_b64_tr_b16 v[28:29], v11 offset:22528
  buffer_load_dwordx4 a[252:255], v15, s[16:19], s28 offen offset:0
  v_mfma_f32_16x16x32_bf16 v[60:63], v[36:39], a[92:95], v[60:63]
  ds_read_b64_tr_b16 v[30:31], v11 offset:22784
  v_mfma_f32_16x16x32_bf16 v[64:67], v[36:39], a[164:167], v[64:67]
  v_mfma_f32_16x16x32_bf16 v[68:71], v[36:39], a[236:239], v[68:71]
  s_waitcnt lgkmcnt(4)
  buffer_load_dwordx4 v[224:227], v15, s[16:19], s28 offen offset:1024
  v_mfma_f32_16x16x32_bf16 v[72:75], v[16:19], a[20:23], v[72:75]
  ds_read_b64_tr_b16 v[32:33], v12 offset:16384
  v_mfma_f32_16x16x32_bf16 v[76:79], v[16:19], a[92:95], v[76:79]
  ds_read_b64_tr_b16 v[34:35], v12 offset:16640
  v_mfma_f32_16x16x32_bf16 v[80:83], v[16:19], a[164:167], v[80:83]
  buffer_load_dwordx4 v[228:231], v15, s[16:19], s28 offen offset:2048
  v_mfma_f32_16x16x32_bf16 v[84:87], v[16:19], a[236:239], v[84:87]
  v_mfma_f32_16x16x32_bf16 v[88:91], v[20:23], a[20:23], v[88:91]
  ds_read_b64_tr_b16 v[36:37], v12 offset:22528
  v_mfma_f32_16x16x32_bf16 v[92:95], v[20:23], a[92:95], v[92:95]
  ds_read_b64_tr_b16 v[38:39], v12 offset:22784
  v_mfma_f32_16x16x32_bf16 v[96:99], v[20:23], a[164:167], v[96:99]
  v_mfma_f32_16x16x32_bf16 v[100:103], v[20:23], a[236:239], v[100:103]
  s_waitcnt lgkmcnt(4)
  v_mfma_f32_16x16x32_bf16 v[104:107], v[24:27], a[20:23], v[104:107]
  s_waitcnt vmcnt(18)
  s_barrier
  ds_read_b64_tr_b16 v[16:17], v5 offset:24576
  v_mfma_f32_16x16x32_bf16 v[108:111], v[24:27], a[92:95], v[108:111]
  ds_read_b64_tr_b16 v[18:19], v5 offset:25088
  v_mfma_f32_16x16x32_bf16 v[112:115], v[24:27], a[164:167], v[112:115]
  v_mfma_f32_16x16x32_bf16 v[116:119], v[24:27], a[236:239], v[116:119]
  v_mfma_f32_16x16x32_bf16 v[120:123], v[28:31], a[20:23], v[120:123]
  ds_read_b64_tr_b16 v[20:21], v6 offset:24576
  v_mfma_f32_16x16x32_bf16 v[124:127], v[28:31], a[92:95], v[124:127]
  ds_read_b64_tr_b16 v[22:23], v6 offset:25088
  v_mfma_f32_16x16x32_bf16 v[128:131], v[28:31], a[164:167], v[128:131]
  v_mfma_f32_16x16x32_bf16 v[132:135], v[28:31], a[236:239], v[132:135]
  s_waitcnt lgkmcnt(4)
  v_mfma_f32_16x16x32_bf16 v[136:139], v[32:35], a[20:23], v[136:139]
  ds_read_b64_tr_b16 v[24:25], v7 offset:24576
  v_mfma_f32_16x16x32_bf16 v[140:143], v[32:35], a[92:95], v[140:143]
  ds_read_b64_tr_b16 v[26:27], v7 offset:25088
  v_mfma_f32_16x16x32_bf16 v[144:147], v[32:35], a[164:167], v[144:147]
  v_mfma_f32_16x16x32_bf16 v[148:151], v[32:35], a[236:239], v[148:151]
  v_mfma_f32_16x16x32_bf16 v[152:155], v[36:39], a[20:23], v[152:155]
  ds_read_b64_tr_b16 v[28:29], v8 offset:24576
  v_mfma_f32_16x16x32_bf16 v[156:159], v[36:39], a[92:95], v[156:159]
  ds_read_b64_tr_b16 v[30:31], v8 offset:25088
  v_mfma_f32_16x16x32_bf16 v[160:163], v[36:39], a[164:167], v[160:163]
  v_mfma_f32_16x16x32_bf16 v[164:167], v[36:39], a[236:239], v[164:167]
  s_waitcnt lgkmcnt(4)
  v_mfma_f32_16x16x32_bf16 v[40:43], v[16:19], a[24:27], v[40:43]
  ds_read_b64_tr_b16 v[32:33], v11 offset:24576
  s_add_u32 m0, s35, 49152
  v_mfma_f32_16x16x32_bf16 v[44:47], v[16:19], a[96:99], v[44:47]
  ds_read_b64_tr_b16 v[34:35], v11 offset:24832
  s_add_u32 s25, s34, 1327104
  v_mfma_f32_16x16x32_bf16 v[48:51], v[16:19], a[168:171], v[48:51]
  buffer_load_dwordx4 v3, s[8:11], s25 offen lds
  v_mfma_f32_16x16x32_bf16 v[52:55], v[16:19], a[240:243], v[52:55]
  v_mfma_f32_16x16x32_bf16 v[56:59], v[20:23], a[24:27], v[56:59]
  ds_read_b64_tr_b16 v[36:37], v11 offset:30720
  s_add_u32 m0, s35, 50176
  v_mfma_f32_16x16x32_bf16 v[60:63], v[20:23], a[96:99], v[60:63]
  ds_read_b64_tr_b16 v[38:39], v11 offset:30976
  v_mfma_f32_16x16x32_bf16 v[64:67], v[20:23], a[168:171], v[64:67]
  v_mfma_f32_16x16x32_bf16 v[68:71], v[20:23], a[240:243], v[68:71]
  s_waitcnt lgkmcnt(4)
  s_add_u32 s25, s34, 1354752
  v_mfma_f32_16x16x32_bf16 v[72:75], v[24:27], a[24:27], v[72:75]
  ds_read_b64_tr_b16 v[16:17], v12 offset:24576
  v_mfma_f32_16x16x32_bf16 v[76:79], v[24:27], a[96:99], v[76:79]
  ds_read_b64_tr_b16 v[18:19], v12 offset:24832
  buffer_load_dwordx4 v4, s[8:11], s25 offen lds
  v_mfma_f32_16x16x32_bf16 v[80:83], v[24:27], a[168:171], v[80:83]
  v_mfma_f32_16x16x32_bf16 v[84:87], v[24:27], a[240:243], v[84:87]
  v_mfma_f32_16x16x32_bf16 v[88:91], v[28:31], a[24:27], v[88:91]
  ds_read_b64_tr_b16 v[20:21], v12 offset:30720
  s_add_u32 m0, s35, 51200
  v_mfma_f32_16x16x32_bf16 v[92:95], v[28:31], a[96:99], v[92:95]
  ds_read_b64_tr_b16 v[22:23], v12 offset:30976
  v_mfma_f32_16x16x32_bf16 v[96:99], v[28:31], a[168:171], v[96:99]
  s_add_u32 s25, s34, 1382400
  v_mfma_f32_16x16x32_bf16 v[100:103], v[28:31], a[240:243], v[100:103]
  s_waitcnt lgkmcnt(4)
  v_mfma_f32_16x16x32_bf16 v[104:107], v[32:35], a[24:27], v[104:107]
  ds_read_b64_tr_b16 v[24:25], v5 offset:28672
  buffer_load_dwordx4 v3, s[8:11], s25 offen lds
  v_mfma_f32_16x16x32_bf16 v[108:111], v[32:35], a[96:99], v[108:111]
  ds_read_b64_tr_b16 v[26:27], v5 offset:29184
  v_mfma_f32_16x16x32_bf16 v[112:115], v[32:35], a[168:171], v[112:115]
  v_mfma_f32_16x16x32_bf16 v[116:119], v[32:35], a[240:243], v[116:119]
  s_add_u32 m0, s33, 122880
  v_mfma_f32_16x16x32_bf16 v[120:123], v[36:39], a[24:27], v[120:123]
  ds_read_b64_tr_b16 v[28:29], v6 offset:28672
  v_mfma_f32_16x16x32_bf16 v[124:127], v[36:39], a[96:99], v[124:127]
  ds_read_b64_tr_b16 v[30:31], v6 offset:29184
  buffer_load_dwordx4 v2, s[12:15], s60 offen offset:0 lds
  v_mfma_f32_16x16x32_bf16 v[128:131], v[36:39], a[168:171], v[128:131]
  v_mfma_f32_16x16x32_bf16 v[132:135], v[36:39], a[240:243], v[132:135]
  s_waitcnt lgkmcnt(4)
  v_mfma_f32_16x16x32_bf16 v[136:139], v[16:19], a[24:27], v[136:139]
  ds_read_b64_tr_b16 v[32:33], v7 offset:28672
  buffer_load_dwordx4 v2, s[12:15], s61 offen offset:1024 lds
  v_mfma_f32_16x16x32_bf16 v[140:143], v[16:19], a[96:99], v[140:143]
  ds_read_b64_tr_b16 v[34:35], v7 offset:29184
  v_mfma_f32_16x16x32_bf16 v[144:147], v[16:19], a[168:171], v[144:147]
  buffer_load_dwordx4 v2, s[12:15], s62 offen offset:2048 lds
  v_mfma_f32_16x16x32_bf16 v[148:151], v[16:19], a[240:243], v[148:151]
  v_mfma_f32_16x16x32_bf16 v[152:155], v[20:23], a[24:27], v[152:155]
  ds_read_b64_tr_b16 v[36:37], v8 offset:28672
  v_mfma_f32_16x16x32_bf16 v[156:159], v[20:23], a[96:99], v[156:159]
  ds_read_b64_tr_b16 v[38:39], v8 offset:29184
  s_add_u32 s28, s39, 12288
  v_mfma_f32_16x16x32_bf16 v[160:163], v[20:23], a[168:171], v[160:163]
  v_mfma_f32_16x16x32_bf16 v[164:167], v[20:23], a[240:243], v[164:167]
  s_waitcnt lgkmcnt(4)
  buffer_load_dwordx4 a[48:51], v15, s[16:19], s28 offen offset:0
  v_mfma_f32_16x16x32_bf16 v[40:43], v[24:27], a[28:31], v[40:43]
  ds_read_b64_tr_b16 v[16:17], v11 offset:26624
  v_mfma_f32_16x16x32_bf16 v[44:47], v[24:27], a[100:103], v[44:47]
  ds_read_b64_tr_b16 v[18:19], v11 offset:26880
  buffer_load_dwordx4 a[52:55], v15, s[16:19], s28 offen offset:1024
  v_mfma_f32_16x16x32_bf16 v[48:51], v[24:27], a[172:175], v[48:51]
  v_mfma_f32_16x16x32_bf16 v[52:55], v[24:27], a[244:247], v[52:55]
  v_mfma_f32_16x16x32_bf16 v[56:59], v[28:31], a[28:31], v[56:59]
  ds_read_b64_tr_b16 v[20:21], v11 offset:32768
  buffer_load_dwordx4 a[56:59], v15, s[16:19], s28 offen offset:2048
  v_mfma_f32_16x16x32_bf16 v[60:63], v[28:31], a[100:103], v[60:63]
  ds_read_b64_tr_b16 v[22:23], v11 offset:33024
  v_mfma_f32_16x16x32_bf16 v[64:67], v[28:31], a[172:175], v[64:67]
  s_add_u32 s28, s39, 30720
  v_mfma_f32_16x16x32_bf16 v[68:71], v[28:31], a[244:247], v[68:71]
  s_waitcnt lgkmcnt(4)
  v_mfma_f32_16x16x32_bf16 v[72:75], v[32:35], a[28:31], v[72:75]
  ds_read_b64_tr_b16 v[24:25], v12 offset:26624
  v_mfma_f32_16x16x32_bf16 v[76:79], v[32:35], a[100:103], v[76:79]
  ds_read_b64_tr_b16 v[26:27], v12 offset:26880
  buffer_load_dwordx4 a[120:123], v15, s[16:19], s28 offen offset:0
  v_mfma_f32_16x16x32_bf16 v[80:83], v[32:35], a[172:175], v[80:83]
  v_mfma_f32_16x16x32_bf16 v[84:87], v[32:35], a[244:247], v[84:87]
  buffer_load_dwordx4 a[124:127], v15, s[16:19], s28 offen offset:1024
  v_mfma_f32_16x16x32_bf16 v[88:91], v[36:39], a[28:31], v[88:91]
  ds_read_b64_tr_b16 v[28:29], v12 offset:32768
  v_mfma_f32_16x16x32_bf16 v[92:95], v[36:39], a[100:103], v[92:95]
  ds_read_b64_tr_b16 v[30:31], v12 offset:33024
  v_mfma_f32_16x16x32_bf16 v[96:99], v[36:39], a[172:175], v[96:99]
  buffer_load_dwordx4 a[128:131], v15, s[16:19], s28 offen offset:2048
  v_mfma_f32_16x16x32_bf16 v[100:103], v[36:39], a[244:247], v[100:103]
  s_waitcnt lgkmcnt(4)
  v_mfma_f32_16x16x32_bf16 v[104:107], v[16:19], a[28:31], v[104:107]
  ds_read_b64_tr_b16 v[32:33], v5 offset:32768
  s_add_u32 s28, s39, 49152
  v_mfma_f32_16x16x32_bf16 v[108:111], v[16:19], a[100:103], v[108:111]
  ds_read_b64_tr_b16 v[34:35], v5 offset:33280
  v_mfma_f32_16x16x32_bf16 v[112:115], v[16:19], a[172:175], v[112:115]
  buffer_load_dwordx4 a[192:195], v15, s[16:19], s28 offen offset:0
  v_mfma_f32_16x16x32_bf16 v[116:119], v[16:19], a[244:247], v[116:119]
  v_mfma_f32_16x16x32_bf16 v[120:123], v[20:23], a[28:31], v[120:123]
  ds_read_b64_tr_b16 v[36:37], v6 offset:32768
  v_mfma_f32_16x16x32_bf16 v[124:127], v[20:23], a[100:103], v[124:127]
  ds_read_b64_tr_b16 v[38:39], v6 offset:33280
  buffer_load_dwordx4 a[196:199], v15, s[16:19], s28 offen offset:1024
  v_mfma_f32_16x16x32_bf16 v[128:131], v[20:23], a[172:175], v[128:131]
  v_mfma_f32_16x16x32_bf16 v[132:135], v[20:23], a[244:247], v[132:135]
  s_waitcnt lgkmcnt(4)
  buffer_load_dwordx4 a[200:203], v15, s[16:19], s28 offen offset:2048
  v_mfma_f32_16x16x32_bf16 v[136:139], v[24:27], a[28:31], v[136:139]
  ds_read_b64_tr_b16 v[16:17], v7 offset:32768
  v_mfma_f32_16x16x32_bf16 v[140:143], v[24:27], a[100:103], v[140:143]
  ds_read_b64_tr_b16 v[18:19], v7 offset:33280
  v_mfma_f32_16x16x32_bf16 v[144:147], v[24:27], a[172:175], v[144:147]
  s_add_u32 s28, s39, 67584
  v_mfma_f32_16x16x32_bf16 v[148:151], v[24:27], a[244:247], v[148:151]
  v_mfma_f32_16x16x32_bf16 v[152:155], v[28:31], a[28:31], v[152:155]
  ds_read_b64_tr_b16 v[20:21], v8 offset:32768
  buffer_load_dwordx4 v[232:235], v15, s[16:19], s28 offen offset:0
  v_mfma_f32_16x16x32_bf16 v[156:159], v[28:31], a[100:103], v[156:159]
  ds_read_b64_tr_b16 v[22:23], v8 offset:33280
  v_mfma_f32_16x16x32_bf16 v[160:163], v[28:31], a[172:175], v[160:163]
  v_mfma_f32_16x16x32_bf16 v[164:167], v[28:31], a[244:247], v[164:167]
  s_waitcnt lgkmcnt(4)
  buffer_load_dwordx4 v[236:239], v15, s[16:19], s28 offen offset:1024
  v_mfma_f32_16x16x32_bf16 v[40:43], v[32:35], a[32:35], v[40:43]
  ds_read_b64_tr_b16 v[24:25], v11 offset:28672
  v_mfma_f32_16x16x32_bf16 v[44:47], v[32:35], a[104:107], v[44:47]
  ds_read_b64_tr_b16 v[26:27], v11 offset:28928
  buffer_load_dwordx4 v[240:243], v15, s[16:19], s28 offen offset:2048
  v_mfma_f32_16x16x32_bf16 v[48:51], v[32:35], a[176:179], v[48:51]
  v_mfma_f32_16x16x32_bf16 v[52:55], v[32:35], a[248:251], v[52:55]
  s_add_u32 m0, s33, 0
  v_mfma_f32_16x16x32_bf16 v[56:59], v[36:39], a[32:35], v[56:59]
  ds_read_b64_tr_b16 v[28:29], v11 offset:34816
  v_mfma_f32_16x16x32_bf16 v[60:63], v[36:39], a[104:107], v[60:63]
  ds_read_b64_tr_b16 v[30:31], v11 offset:35072
  v_mfma_f32_16x16x32_bf16 v[64:67], v[36:39], a[176:179], v[64:67]
  buffer_load_dwordx4 v0, s[12:15], s48 offen offset:0 lds
  v_mfma_f32_16x16x32_bf16 v[68:71], v[36:39], a[248:251], v[68:71]
  s_waitcnt lgkmcnt(4)
  v_mfma_f32_16x16x32_bf16 v[72:75], v[16:19], a[32:35], v[72:75]
  ds_read_b64_tr_b16 v[32:33], v12 offset:28672
  buffer_load_dwordx4 v0, s[12:15], s49 offen offset:1024 lds
  v_mfma_f32_16x16x32_bf16 v[76:79], v[16:19], a[104:107], v[76:79]
  ds_read_b64_tr_b16 v[34:35], v12 offset:28928
  v_mfma_f32_16x16x32_bf16 v[80:83], v[16:19], a[176:179], v[80:83]
  v_mfma_f32_16x16x32_bf16 v[84:87], v[16:19], a[248:251], v[84:87]
  buffer_load_dwordx4 v0, s[12:15], s50 offen offset:2048 lds
  v_mfma_f32_16x16x32_bf16 v[88:91], v[20:23], a[32:35], v[88:91]
  ds_read_b64_tr_b16 v[36:37], v12 offset:34816
  v_mfma_f32_16x16x32_bf16 v[92:95], v[20:23], a[104:107], v[92:95]
  ds_read_b64_tr_b16 v[38:39], v12 offset:35072
  v_mfma_f32_16x16x32_bf16 v[96:99], v[20:23], a[176:179], v[96:99]
  v_mfma_f32_16x16x32_bf16 v[100:103], v[20:23], a[248:251], v[100:103]
  s_waitcnt lgkmcnt(4)
  v_mfma_f32_16x16x32_bf16 v[104:107], v[24:27], a[32:35], v[104:107]
  s_waitcnt vmcnt(21)
  s_barrier
  v_add_u32 v5, 36864, v5
  v_add_u32 v6, 36864, v6
  v_add_u32 v7, 36864, v7
  v_add_u32 v8, 36864, v8
  v_add_u32 v11, 36864, v11
  v_add_u32 v12, 36864, v12
  ds_read_b64_tr_b16 v[16:17], v5 offset:0
  v_mfma_f32_16x16x32_bf16 v[108:111], v[24:27], a[104:107], v[108:111]
  ds_read_b64_tr_b16 v[18:19], v5 offset:512
  v_mfma_f32_16x16x32_bf16 v[112:115], v[24:27], a[176:179], v[112:115]
  v_mfma_f32_16x16x32_bf16 v[116:119], v[24:27], a[248:251], v[116:119]
  v_mfma_f32_16x16x32_bf16 v[120:123], v[28:31], a[32:35], v[120:123]
  ds_read_b64_tr_b16 v[20:21], v6 offset:0
  v_mfma_f32_16x16x32_bf16 v[124:127], v[28:31], a[104:107], v[124:127]
  ds_read_b64_tr_b16 v[22:23], v6 offset:512
  v_mfma_f32_16x16x32_bf16 v[128:131], v[28:31], a[176:179], v[128:131]
  v_mfma_f32_16x16x32_bf16 v[132:135], v[28:31], a[248:251], v[132:135]
  s_waitcnt lgkmcnt(4)
  v_mfma_f32_16x16x32_bf16 v[136:139], v[32:35], a[32:35], v[136:139]
  ds_read_b64_tr_b16 v[24:25], v7 offset:0
  v_mfma_f32_16x16x32_bf16 v[140:143], v[32:35], a[104:107], v[140:143]
  ds_read_b64_tr_b16 v[26:27], v7 offset:512
  v_mfma_f32_16x16x32_bf16 v[144:147], v[32:35], a[176:179], v[144:147]
  v_mfma_f32_16x16x32_bf16 v[148:151], v[32:35], a[248:251], v[148:151]
  v_mfma_f32_16x16x32_bf16 v[152:155], v[36:39], a[32:35], v[152:155]
  ds_read_b64_tr_b16 v[28:29], v8 offset:0
  v_mfma_f32_16x16x32_bf16 v[156:159], v[36:39], a[104:107], v[156:159]
  ds_read_b64_tr_b16 v[30:31], v8 offset:512
  v_mfma_f32_16x16x32_bf16 v[160:163], v[36:39], a[176:179], v[160:163]
  v_mfma_f32_16x16x32_bf16 v[164:167], v[36:39], a[248:251], v[164:167]
  s_waitcnt lgkmcnt(4)
  v_mfma_f32_16x16x32_bf16 v[40:43], v[16:19], a[36:39], v[40:43]
  ds_read_b64_tr_b16 v[32:33], v11 offset:0
  s_add_u32 m0, s35, 61440
  v_mfma_f32_16x16x32_bf16 v[44:47], v[16:19], a[108:111], v[44:47]
  ds_read_b64_tr_b16 v[34:35], v11 offset:256
  s_add_u32 s25, s34, 1658880
  v_mfma_f32_16x16x32_bf16 v[48:51], v[16:19], a[180:183], v[48:51]
  buffer_load_dwordx4 v3, s[8:11], s25 offen lds
  v_mfma_f32_16x16x32_bf16 v[52:55], v[16:19], a[252:255], v[52:55]
  v_mfma_f32_16x16x32_bf16 v[56:59], v[20:23], a[36:39], v[56:59]
  ds_read_b64_tr_b16 v[36:37], v11 offset:6144
  s_add_u32 m0, s35, 62464
  v_mfma_f32_16x16x32_bf16 v[60:63], v[20:23], a[108:111], v[60:63]
  ds_read_b64_tr_b16 v[38:39], v11 offset:6400
  v_mfma_f32_16x16x32_bf16 v[64:67], v[20:23], a[180:183], v[64:67]
  v_mfma_f32_16x16x32_bf16 v[68:71], v[20:23], a[252:255], v[68:71]
  s_waitcnt lgkmcnt(4)
  s_add_u32 s25, s34, 1686528
  v_mfma_f32_16x16x32_bf16 v[72:75], v[24:27], a[36:39], v[72:75]
  ds_read_b64_tr_b16 v[16:17], v12 offset:0
  v_mfma_f32_16x16x32_bf16 v[76:79], v[24:27], a[108:111], v[76:79]
  ds_read_b64_tr_b16 v[18:19], v12 offset:256
  buffer_load_dwordx4 v4, s[8:11], s25 offen lds
  v_mfma_f32_16x16x32_bf16 v[80:83], v[24:27], a[180:183], v[80:83]
  v_mfma_f32_16x16x32_bf16 v[84:87], v[24:27], a[252:255], v[84:87]
  v_mfma_f32_16x16x32_bf16 v[88:91], v[28:31], a[36:39], v[88:91]
  ds_read_b64_tr_b16 v[20:21], v12 offset:6144
  s_add_u32 m0, s35, 63488
  v_mfma_f32_16x16x32_bf16 v[92:95], v[28:31], a[108:111], v[92:95]
  ds_read_b64_tr_b16 v[22:23], v12 offset:6400
  v_mfma_f32_16x16x32_bf16 v[96:99], v[28:31], a[180:183], v[96:99]
  s_add_u32 s25, s34, 1714176
  v_mfma_f32_16x16x32_bf16 v[100:103], v[28:31], a[252:255], v[100:103]
  s_waitcnt lgkmcnt(4)
  v_mfma_f32_16x16x32_bf16 v[104:107], v[32:35], a[36:39], v[104:107]
  ds_read_b64_tr_b16 v[24:25], v5 offset:4096
  buffer_load_dwordx4 v3, s[8:11], s25 offen lds
  v_mfma_f32_16x16x32_bf16 v[108:111], v[32:35], a[108:111], v[108:111]
  ds_read_b64_tr_b16 v[26:27], v5 offset:4608
  v_mfma_f32_16x16x32_bf16 v[112:115], v[32:35], a[180:183], v[112:115]
  v_mfma_f32_16x16x32_bf16 v[116:119], v[32:35], a[252:255], v[116:119]
  s_add_u32 m0, s33, 135168
  v_mfma_f32_16x16x32_bf16 v[120:123], v[36:39], a[36:39], v[120:123]
  ds_read_b64_tr_b16 v[28:29], v6 offset:4096
  v_mfma_f32_16x16x32_bf16 v[124:127], v[36:39], a[108:111], v[124:127]
  ds_read_b64_tr_b16 v[30:31], v6 offset:4608
  buffer_load_dwordx4 v2, s[12:15], s63 offen offset:0 lds
  v_mfma_f32_16x16x32_bf16 v[128:131], v[36:39], a[180:183], v[128:131]
  v_mfma_f32_16x16x32_bf16 v[132:135], v[36:39], a[252:255], v[132:135]
  s_waitcnt lgkmcnt(4)
  v_mfma_f32_16x16x32_bf16 v[136:139], v[16:19], a[36:39], v[136:139]
  ds_read_b64_tr_b16 v[32:33], v7 offset:4096
  buffer_load_dwordx4 v2, s[12:15], s64 offen offset:1024 lds
  v_mfma_f32_16x16x32_bf16 v[140:143], v[16:19], a[108:111], v[140:143]
  ds_read_b64_tr_b16 v[34:35], v7 offset:4608
  v_mfma_f32_16x16x32_bf16 v[144:147], v[16:19], a[180:183], v[144:147]
  buffer_load_dwordx4 v2, s[12:15], s65 offen offset:2048 lds
  v_mfma_f32_16x16x32_bf16 v[148:151], v[16:19], a[252:255], v[148:151]
  v_mfma_f32_16x16x32_bf16 v[152:155], v[20:23], a[36:39], v[152:155]
  ds_read_b64_tr_b16 v[36:37], v8 offset:4096
  v_mfma_f32_16x16x32_bf16 v[156:159], v[20:23], a[108:111], v[156:159]
  ds_read_b64_tr_b16 v[38:39], v8 offset:4608
  s_add_u32 s28, s39, 15360
  v_mfma_f32_16x16x32_bf16 v[160:163], v[20:23], a[180:183], v[160:163]
  v_mfma_f32_16x16x32_bf16 v[164:167], v[20:23], a[252:255], v[164:167]
  s_waitcnt lgkmcnt(4)
  buffer_load_dwordx4 a[60:63], v15, s[16:19], s28 offen offset:0
  v_mfma_f32_16x16x32_bf16 v[40:43], v[24:27], a[40:43], v[40:43]
  ds_read_b64_tr_b16 v[16:17], v11 offset:2048
  v_mfma_f32_16x16x32_bf16 v[44:47], v[24:27], a[112:115], v[44:47]
  ds_read_b64_tr_b16 v[18:19], v11 offset:2304
  buffer_load_dwordx4 a[64:67], v15, s[16:19], s28 offen offset:1024
  v_mfma_f32_16x16x32_bf16 v[48:51], v[24:27], a[184:187], v[48:51]
  v_mfma_f32_16x16x32_bf16 v[52:55], v[24:27], v[224:227], v[52:55]
  v_mfma_f32_16x16x32_bf16 v[56:59], v[28:31], a[40:43], v[56:59]
  ds_read_b64_tr_b16 v[20:21], v11 offset:8192
  buffer_load_dwordx4 a[68:71], v15, s[16:19], s28 offen offset:2048
  v_mfma_f32_16x16x32_bf16 v[60:63], v[28:31], a[112:115], v[60:63]
  ds_read_b64_tr_b16 v[22:23], v11 offset:8448
  v_mfma_f32_16x16x32_bf16 v[64:67], v[28:31], a[184:187], v[64:67]
  s_add_u32 s28, s39, 33792
  v_mfma_f32_16x16x32_bf16 v[68:71], v[28:31], v[224:227], v[68:71]
  s_waitcnt lgkmcnt(4)
  v_mfma_f32_16x16x32_bf16 v[72:75], v[32:35], a[40:43], v[72:75]
  ds_read_b64_tr_b16 v[24:25], v12 offset:2048
  v_mfma_f32_16x16x32_bf16 v[76:79], v[32:35], a[112:115], v[76:79]
  ds_read_b64_tr_b16 v[26:27], v12 offset:2304
  buffer_load_dwordx4 a[132:135], v15, s[16:19], s28 offen offset:0
  v_mfma_f32_16x16x32_bf16 v[80:83], v[32:35], a[184:187], v[80:83]
  v_mfma_f32_16x16x32_bf16 v[84:87], v[32:35], v[224:227], v[84:87]
  buffer_load_dwordx4 a[136:139], v15, s[16:19], s28 offen offset:1024
  v_mfma_f32_16x16x32_bf16 v[88:91], v[36:39], a[40:43], v[88:91]
  ds_read_b64_tr_b16 v[28:29], v12 offset:8192
  v_mfma_f32_16x16x32_bf16 v[92:95], v[36:39], a[112:115], v[92:95]
  ds_read_b64_tr_b16 v[30:31], v12 offset:8448
  v_mfma_f32_16x16x32_bf16 v[96:99], v[36:39], a[184:187], v[96:99]
  buffer_load_dwordx4 a[140:143], v15, s[16:19], s28 offen offset:2048
  v_mfma_f32_16x16x32_bf16 v[100:103], v[36:39], v[224:227], v[100:103]
  s_waitcnt lgkmcnt(4)
  v_mfma_f32_16x16x32_bf16 v[104:107], v[16:19], a[40:43], v[104:107]
  ds_read_b64_tr_b16 v[32:33], v5 offset:8192
  s_add_u32 s28, s39, 52224
  v_mfma_f32_16x16x32_bf16 v[108:111], v[16:19], a[112:115], v[108:111]
  ds_read_b64_tr_b16 v[34:35], v5 offset:8704
  v_mfma_f32_16x16x32_bf16 v[112:115], v[16:19], a[184:187], v[112:115]
  buffer_load_dwordx4 a[204:207], v15, s[16:19], s28 offen offset:0
  v_mfma_f32_16x16x32_bf16 v[116:119], v[16:19], v[224:227], v[116:119]
  v_mfma_f32_16x16x32_bf16 v[120:123], v[20:23], a[40:43], v[120:123]
  ds_read_b64_tr_b16 v[36:37], v6 offset:8192
  v_mfma_f32_16x16x32_bf16 v[124:127], v[20:23], a[112:115], v[124:127]
  ds_read_b64_tr_b16 v[38:39], v6 offset:8704
  buffer_load_dwordx4 a[208:211], v15, s[16:19], s28 offen offset:1024
  v_mfma_f32_16x16x32_bf16 v[128:131], v[20:23], a[184:187], v[128:131]
  v_mfma_f32_16x16x32_bf16 v[132:135], v[20:23], v[224:227], v[132:135]
  s_waitcnt lgkmcnt(4)
  buffer_load_dwordx4 a[212:215], v15, s[16:19], s28 offen offset:2048
  v_mfma_f32_16x16x32_bf16 v[136:139], v[24:27], a[40:43], v[136:139]
  ds_read_b64_tr_b16 v[16:17], v7 offset:8192
  v_mfma_f32_16x16x32_bf16 v[140:143], v[24:27], a[112:115], v[140:143]
  ds_read_b64_tr_b16 v[18:19], v7 offset:8704
  v_mfma_f32_16x16x32_bf16 v[144:147], v[24:27], a[184:187], v[144:147]
  s_add_u32 s28, s39, 70656
  v_mfma_f32_16x16x32_bf16 v[148:151], v[24:27], v[224:227], v[148:151]
  v_mfma_f32_16x16x32_bf16 v[152:155], v[28:31], a[40:43], v[152:155]
  ds_read_b64_tr_b16 v[20:21], v8 offset:8192
  buffer_load_dwordx4 v[244:247], v15, s[16:19], s28 offen offset:0
  v_mfma_f32_16x16x32_bf16 v[156:159], v[28:31], a[112:115], v[156:159]
  ds_read_b64_tr_b16 v[22:23], v8 offset:8704
  v_mfma_f32_16x16x32_bf16 v[160:163], v[28:31], a[184:187], v[160:163]
  v_mfma_f32_16x16x32_bf16 v[164:167], v[28:31], v[224:227], v[164:167]
  s_waitcnt lgkmcnt(4)
  buffer_load_dwordx4 v[248:251], v15, s[16:19], s28 offen offset:1024
  v_mfma_f32_16x16x32_bf16 v[40:43], v[32:35], a[44:47], v[40:43]
  ds_read_b64_tr_b16 v[24:25], v11 offset:4096
  v_mfma_f32_16x16x32_bf16 v[44:47], v[32:35], a[116:119], v[44:47]
  ds_read_b64_tr_b16 v[26:27], v11 offset:4352
  buffer_load_dwordx4 v[252:255], v15, s[16:19], s28 offen offset:2048
  v_mfma_f32_16x16x32_bf16 v[48:51], v[32:35], a[188:191], v[48:51]
  v_mfma_f32_16x16x32_bf16 v[52:55], v[32:35], v[228:231], v[52:55]
  s_add_u32 m0, s33, 12288
  v_mfma_f32_16x16x32_bf16 v[56:59], v[36:39], a[44:47], v[56:59]
  ds_read_b64_tr_b16 v[28:29], v11 offset:10240
  v_mfma_f32_16x16x32_bf16 v[60:63], v[36:39], a[116:119], v[60:63]
  ds_read_b64_tr_b16 v[30:31], v11 offset:10496
  v_mfma_f32_16x16x32_bf16 v[64:67], v[36:39], a[188:191], v[64:67]
  buffer_load_dwordx4 v0, s[12:15], s51 offen offset:0 lds
  v_mfma_f32_16x16x32_bf16 v[68:71], v[36:39], v[228:231], v[68:71]
  s_waitcnt lgkmcnt(4)
  v_mfma_f32_16x16x32_bf16 v[72:75], v[16:19], a[44:47], v[72:75]
  ds_read_b64_tr_b16 v[32:33], v12 offset:4096
  buffer_load_dwordx4 v0, s[12:15], s52 offen offset:1024 lds
  v_mfma_f32_16x16x32_bf16 v[76:79], v[16:19], a[116:119], v[76:79]
  ds_read_b64_tr_b16 v[34:35], v12 offset:4352
  v_mfma_f32_16x16x32_bf16 v[80:83], v[16:19], a[188:191], v[80:83]
  v_mfma_f32_16x16x32_bf16 v[84:87], v[16:19], v[228:231], v[84:87]
  buffer_load_dwordx4 v0, s[12:15], s53 offen offset:2048 lds
  v_mfma_f32_16x16x32_bf16 v[88:91], v[20:23], a[44:47], v[88:91]
  ds_read_b64_tr_b16 v[36:37], v12 offset:10240
  v_mfma_f32_16x16x32_bf16 v[92:95], v[20:23], a[116:119], v[92:95]
  ds_read_b64_tr_b16 v[38:39], v12 offset:10496
  v_mfma_f32_16x16x32_bf16 v[96:99], v[20:23], a[188:191], v[96:99]
  v_mfma_f32_16x16x32_bf16 v[100:103], v[20:23], v[228:231], v[100:103]
  s_waitcnt lgkmcnt(4)
  v_mfma_f32_16x16x32_bf16 v[104:107], v[24:27], a[44:47], v[104:107]
  s_waitcnt vmcnt(24)
  s_barrier
  ds_read_b64_tr_b16 v[16:17], v5 offset:12288
  v_mfma_f32_16x16x32_bf16 v[108:111], v[24:27], a[116:119], v[108:111]
  ds_read_b64_tr_b16 v[18:19], v5 offset:12800
  v_mfma_f32_16x16x32_bf16 v[112:115], v[24:27], a[188:191], v[112:115]
  v_mfma_f32_16x16x32_bf16 v[116:119], v[24:27], v[228:231], v[116:119]
  v_mfma_f32_16x16x32_bf16 v[120:123], v[28:31], a[44:47], v[120:123]
  ds_read_b64_tr_b16 v[20:21], v6 offset:12288
  v_mfma_f32_16x16x32_bf16 v[124:127], v[28:31], a[116:119], v[124:127]
  ds_read_b64_tr_b16 v[22:23], v6 offset:12800
  v_mfma_f32_16x16x32_bf16 v[128:131], v[28:31], a[188:191], v[128:131]
  v_mfma_f32_16x16x32_bf16 v[132:135], v[28:31], v[228:231], v[132:135]
  s_waitcnt lgkmcnt(4)
  v_mfma_f32_16x16x32_bf16 v[136:139], v[32:35], a[44:47], v[136:139]
  ds_read_b64_tr_b16 v[24:25], v7 offset:12288
  v_mfma_f32_16x16x32_bf16 v[140:143], v[32:35], a[116:119], v[140:143]
  ds_read_b64_tr_b16 v[26:27], v7 offset:12800
  v_mfma_f32_16x16x32_bf16 v[144:147], v[32:35], a[188:191], v[144:147]
  v_mfma_f32_16x16x32_bf16 v[148:151], v[32:35], v[228:231], v[148:151]
  v_mfma_f32_16x16x32_bf16 v[152:155], v[36:39], a[44:47], v[152:155]
  ds_read_b64_tr_b16 v[28:29], v8 offset:12288
  v_mfma_f32_16x16x32_bf16 v[156:159], v[36:39], a[116:119], v[156:159]
  ds_read_b64_tr_b16 v[30:31], v8 offset:12800
  v_mfma_f32_16x16x32_bf16 v[160:163], v[36:39], a[188:191], v[160:163]
  v_mfma_f32_16x16x32_bf16 v[164:167], v[36:39], v[228:231], v[164:167]
  s_waitcnt lgkmcnt(4)
  v_mfma_f32_16x16x32_bf16 v[40:43], v[16:19], a[48:51], v[40:43]
  ds_read_b64_tr_b16 v[32:33], v11 offset:12288
  s_add_u32 m0, s33, 24576
  v_mfma_f32_16x16x32_bf16 v[44:47], v[16:19], a[120:123], v[44:47]
  ds_read_b64_tr_b16 v[34:35], v11 offset:12544
  buffer_load_dwordx4 v0, s[12:15], s54 offen offset:0 lds
  v_mfma_f32_16x16x32_bf16 v[48:51], v[16:19], a[192:195], v[48:51]
  v_mfma_f32_16x16x32_bf16 v[52:55], v[16:19], v[232:235], v[52:55]
  v_mfma_f32_16x16x32_bf16 v[56:59], v[20:23], a[48:51], v[56:59]
  ds_read_b64_tr_b16 v[36:37], v11 offset:18432
  v_mfma_f32_16x16x32_bf16 v[60:63], v[20:23], a[120:123], v[60:63]
  ds_read_b64_tr_b16 v[38:39], v11 offset:18688
  v_mfma_f32_16x16x32_bf16 v[64:67], v[20:23], a[192:195], v[64:67]
  v_mfma_f32_16x16x32_bf16 v[68:71], v[20:23], v[232:235], v[68:71]
  s_waitcnt lgkmcnt(4)
  v_mfma_f32_16x16x32_bf16 v[72:75], v[24:27], a[48:51], v[72:75]
  ds_read_b64_tr_b16 v[16:17], v12 offset:12288
  v_mfma_f32_16x16x32_bf16 v[76:79], v[24:27], a[120:123], v[76:79]
  ds_read_b64_tr_b16 v[18:19], v12 offset:12544
  v_mfma_f32_16x16x32_bf16 v[80:83], v[24:27], a[192:195], v[80:83]
  v_mfma_f32_16x16x32_bf16 v[84:87], v[24:27], v[232:235], v[84:87]
  v_mfma_f32_16x16x32_bf16 v[88:91], v[28:31], a[48:51], v[88:91]
  ds_read_b64_tr_b16 v[20:21], v12 offset:18432
  v_mfma_f32_16x16x32_bf16 v[92:95], v[28:31], a[120:123], v[92:95]
  ds_read_b64_tr_b16 v[22:23], v12 offset:18688
  v_mfma_f32_16x16x32_bf16 v[96:99], v[28:31], a[192:195], v[96:99]
  v_mfma_f32_16x16x32_bf16 v[100:103], v[28:31], v[232:235], v[100:103]
  s_waitcnt lgkmcnt(4)
  v_mfma_f32_16x16x32_bf16 v[104:107], v[32:35], a[48:51], v[104:107]
  ds_read_b64_tr_b16 v[24:25], v5 offset:16384
  v_mfma_f32_16x16x32_bf16 v[108:111], v[32:35], a[120:123], v[108:111]
  ds_read_b64_tr_b16 v[26:27], v5 offset:16896
  v_mfma_f32_16x16x32_bf16 v[112:115], v[32:35], a[192:195], v[112:115]
  v_mfma_f32_16x16x32_bf16 v[116:119], v[32:35], v[232:235], v[116:119]
  v_mfma_f32_16x16x32_bf16 v[120:123], v[36:39], a[48:51], v[120:123]
  ds_read_b64_tr_b16 v[28:29], v6 offset:16384
  buffer_load_dwordx4 v0, s[12:15], s55 offen offset:1024 lds
  v_mfma_f32_16x16x32_bf16 v[124:127], v[36:39], a[120:123], v[124:127]
  ds_read_b64_tr_b16 v[30:31], v6 offset:16896
  v_mfma_f32_16x16x32_bf16 v[128:131], v[36:39], a[192:195], v[128:131]
  v_mfma_f32_16x16x32_bf16 v[132:135], v[36:39], v[232:235], v[132:135]
  s_waitcnt lgkmcnt(4)
  v_mfma_f32_16x16x32_bf16 v[136:139], v[16:19], a[48:51], v[136:139]
  ds_read_b64_tr_b16 v[32:33], v7 offset:16384
  v_mfma_f32_16x16x32_bf16 v[140:143], v[16:19], a[120:123], v[140:143]
  ds_read_b64_tr_b16 v[34:35], v7 offset:16896
  v_mfma_f32_16x16x32_bf16 v[144:147], v[16:19], a[192:195], v[144:147]
  v_mfma_f32_16x16x32_bf16 v[148:151], v[16:19], v[232:235], v[148:151]
  v_mfma_f32_16x16x32_bf16 v[152:155], v[20:23], a[48:51], v[152:155]
  ds_read_b64_tr_b16 v[36:37], v8 offset:16384
  v_mfma_f32_16x16x32_bf16 v[156:159], v[20:23], a[120:123], v[156:159]
  ds_read_b64_tr_b16 v[38:39], v8 offset:16896
  v_mfma_f32_16x16x32_bf16 v[160:163], v[20:23], a[192:195], v[160:163]
  v_mfma_f32_16x16x32_bf16 v[164:167], v[20:23], v[232:235], v[164:167]
  s_waitcnt lgkmcnt(4)
  v_mfma_f32_16x16x32_bf16 v[40:43], v[24:27], a[52:55], v[40:43]
  ds_read_b64_tr_b16 v[16:17], v11 offset:14336
  v_mfma_f32_16x16x32_bf16 v[44:47], v[24:27], a[124:127], v[44:47]
  ds_read_b64_tr_b16 v[18:19], v11 offset:14592
  v_mfma_f32_16x16x32_bf16 v[48:51], v[24:27], a[196:199], v[48:51]
  v_mfma_f32_16x16x32_bf16 v[52:55], v[24:27], v[236:239], v[52:55]
  v_mfma_f32_16x16x32_bf16 v[56:59], v[28:31], a[52:55], v[56:59]
  ds_read_b64_tr_b16 v[20:21], v11 offset:20480
  v_mfma_f32_16x16x32_bf16 v[60:63], v[28:31], a[124:127], v[60:63]
  ds_read_b64_tr_b16 v[22:23], v11 offset:20736
  v_mfma_f32_16x16x32_bf16 v[64:67], v[28:31], a[196:199], v[64:67]
  v_mfma_f32_16x16x32_bf16 v[68:71], v[28:31], v[236:239], v[68:71]
  s_waitcnt lgkmcnt(4)
  v_mfma_f32_16x16x32_bf16 v[72:75], v[32:35], a[52:55], v[72:75]
  ds_read_b64_tr_b16 v[24:25], v12 offset:14336
  buffer_load_dwordx4 v0, s[12:15], s56 offen offset:2048 lds
  v_mfma_f32_16x16x32_bf16 v[76:79], v[32:35], a[124:127], v[76:79]
  ds_read_b64_tr_b16 v[26:27], v12 offset:14592
  v_mfma_f32_16x16x32_bf16 v[80:83], v[32:35], a[196:199], v[80:83]
  v_mfma_f32_16x16x32_bf16 v[84:87], v[32:35], v[236:239], v[84:87]
  v_mfma_f32_16x16x32_bf16 v[88:91], v[36:39], a[52:55], v[88:91]
  ds_read_b64_tr_b16 v[28:29], v12 offset:20480
  v_mfma_f32_16x16x32_bf16 v[92:95], v[36:39], a[124:127], v[92:95]
  ds_read_b64_tr_b16 v[30:31], v12 offset:20736
  v_mfma_f32_16x16x32_bf16 v[96:99], v[36:39], a[196:199], v[96:99]
  v_mfma_f32_16x16x32_bf16 v[100:103], v[36:39], v[236:239], v[100:103]
  s_waitcnt lgkmcnt(4)
  v_mfma_f32_16x16x32_bf16 v[104:107], v[16:19], a[52:55], v[104:107]
  ds_read_b64_tr_b16 v[32:33], v5 offset:20480
  v_mfma_f32_16x16x32_bf16 v[108:111], v[16:19], a[124:127], v[108:111]
  ds_read_b64_tr_b16 v[34:35], v5 offset:20992
  v_mfma_f32_16x16x32_bf16 v[112:115], v[16:19], a[196:199], v[112:115]
  v_mfma_f32_16x16x32_bf16 v[116:119], v[16:19], v[236:239], v[116:119]
  v_mfma_f32_16x16x32_bf16 v[120:123], v[20:23], a[52:55], v[120:123]
  ds_read_b64_tr_b16 v[36:37], v6 offset:20480
  v_mfma_f32_16x16x32_bf16 v[124:127], v[20:23], a[124:127], v[124:127]
  ds_read_b64_tr_b16 v[38:39], v6 offset:20992
  v_mfma_f32_16x16x32_bf16 v[128:131], v[20:23], a[196:199], v[128:131]
  v_mfma_f32_16x16x32_bf16 v[132:135], v[20:23], v[236:239], v[132:135]
  s_waitcnt lgkmcnt(4)
  v_mfma_f32_16x16x32_bf16 v[136:139], v[24:27], a[52:55], v[136:139]
  ds_read_b64_tr_b16 v[16:17], v7 offset:20480
  v_mfma_f32_16x16x32_bf16 v[140:143], v[24:27], a[124:127], v[140:143]
  ds_read_b64_tr_b16 v[18:19], v7 offset:20992
  v_mfma_f32_16x16x32_bf16 v[144:147], v[24:27], a[196:199], v[144:147]
  v_mfma_f32_16x16x32_bf16 v[148:151], v[24:27], v[236:239], v[148:151]
  v_mfma_f32_16x16x32_bf16 v[152:155], v[28:31], a[52:55], v[152:155]
  ds_read_b64_tr_b16 v[20:21], v8 offset:20480
  v_mfma_f32_16x16x32_bf16 v[156:159], v[28:31], a[124:127], v[156:159]
  ds_read_b64_tr_b16 v[22:23], v8 offset:20992
  v_mfma_f32_16x16x32_bf16 v[160:163], v[28:31], a[196:199], v[160:163]
  v_mfma_f32_16x16x32_bf16 v[164:167], v[28:31], v[236:239], v[164:167]
  s_waitcnt lgkmcnt(4)
  v_mfma_f32_16x16x32_bf16 v[40:43], v[32:35], a[56:59], v[40:43]
  ds_read_b64_tr_b16 v[24:25], v11 offset:16384
  v_mfma_f32_16x16x32_bf16 v[44:47], v[32:35], a[128:131], v[44:47]
  ds_read_b64_tr_b16 v[26:27], v11 offset:16640
  v_mfma_f32_16x16x32_bf16 v[48:51], v[32:35], a[200:203], v[48:51]
  v_mfma_f32_16x16x32_bf16 v[52:55], v[32:35], v[240:243], v[52:55]
  v_mfma_f32_16x16x32_bf16 v[56:59], v[36:39], a[56:59], v[56:59]
  ds_read_b64_tr_b16 v[28:29], v11 offset:22528
  v_mfma_f32_16x16x32_bf16 v[60:63], v[36:39], a[128:131], v[60:63]
  ds_read_b64_tr_b16 v[30:31], v11 offset:22784
  v_mfma_f32_16x16x32_bf16 v[64:67], v[36:39], a[200:203], v[64:67]
  v_mfma_f32_16x16x32_bf16 v[68:71], v[36:39], v[240:243], v[68:71]
  s_waitcnt lgkmcnt(4)
  v_mfma_f32_16x16x32_bf16 v[72:75], v[16:19], a[56:59], v[72:75]
  ds_read_b64_tr_b16 v[32:33], v12 offset:16384
  v_mfma_f32_16x16x32_bf16 v[76:79], v[16:19], a[128:131], v[76:79]
  ds_read_b64_tr_b16 v[34:35], v12 offset:16640
  v_mfma_f32_16x16x32_bf16 v[80:83], v[16:19], a[200:203], v[80:83]
  v_mfma_f32_16x16x32_bf16 v[84:87], v[16:19], v[240:243], v[84:87]
  v_mfma_f32_16x16x32_bf16 v[88:91], v[20:23], a[56:59], v[88:91]
  ds_read_b64_tr_b16 v[36:37], v12 offset:22528
  v_mfma_f32_16x16x32_bf16 v[92:95], v[20:23], a[128:131], v[92:95]
  ds_read_b64_tr_b16 v[38:39], v12 offset:22784
  v_mfma_f32_16x16x32_bf16 v[96:99], v[20:23], a[200:203], v[96:99]
  v_mfma_f32_16x16x32_bf16 v[100:103], v[20:23], v[240:243], v[100:103]
  s_waitcnt lgkmcnt(4)
  v_mfma_f32_16x16x32_bf16 v[104:107], v[24:27], a[56:59], v[104:107]
  s_waitcnt vmcnt(6)
  s_barrier
  ds_read_b64_tr_b16 v[16:17], v5 offset:24576
  v_mfma_f32_16x16x32_bf16 v[108:111], v[24:27], a[128:131], v[108:111]
  ds_read_b64_tr_b16 v[18:19], v5 offset:25088
  v_mfma_f32_16x16x32_bf16 v[112:115], v[24:27], a[200:203], v[112:115]
  v_mfma_f32_16x16x32_bf16 v[116:119], v[24:27], v[240:243], v[116:119]
  v_mfma_f32_16x16x32_bf16 v[120:123], v[28:31], a[56:59], v[120:123]
  ds_read_b64_tr_b16 v[20:21], v6 offset:24576
  v_mfma_f32_16x16x32_bf16 v[124:127], v[28:31], a[128:131], v[124:127]
  ds_read_b64_tr_b16 v[22:23], v6 offset:25088
  v_mfma_f32_16x16x32_bf16 v[128:131], v[28:31], a[200:203], v[128:131]
  v_mfma_f32_16x16x32_bf16 v[132:135], v[28:31], v[240:243], v[132:135]
  s_waitcnt lgkmcnt(4)
  v_mfma_f32_16x16x32_bf16 v[136:139], v[32:35], a[56:59], v[136:139]
  ds_read_b64_tr_b16 v[24:25], v7 offset:24576
  v_mfma_f32_16x16x32_bf16 v[140:143], v[32:35], a[128:131], v[140:143]
  ds_read_b64_tr_b16 v[26:27], v7 offset:25088
  v_mfma_f32_16x16x32_bf16 v[144:147], v[32:35], a[200:203], v[144:147]
  v_mfma_f32_16x16x32_bf16 v[148:151], v[32:35], v[240:243], v[148:151]
  v_mfma_f32_16x16x32_bf16 v[152:155], v[36:39], a[56:59], v[152:155]
  ds_read_b64_tr_b16 v[28:29], v8 offset:24576
  v_mfma_f32_16x16x32_bf16 v[156:159], v[36:39], a[128:131], v[156:159]
  ds_read_b64_tr_b16 v[30:31], v8 offset:25088
  v_mfma_f32_16x16x32_bf16 v[160:163], v[36:39], a[200:203], v[160:163]
  v_mfma_f32_16x16x32_bf16 v[164:167], v[36:39], v[240:243], v[164:167]
  s_waitcnt lgkmcnt(4)
  v_mfma_f32_16x16x32_bf16 v[40:43], v[16:19], a[60:63], v[40:43]
  ds_read_b64_tr_b16 v[32:33], v11 offset:24576
  s_add_u32 m0, s33, 36864
  v_mfma_f32_16x16x32_bf16 v[44:47], v[16:19], a[132:135], v[44:47]
  ds_read_b64_tr_b16 v[34:35], v11 offset:24832
  buffer_load_dwordx4 v0, s[12:15], s57 offen offset:0 lds
  v_mfma_f32_16x16x32_bf16 v[48:51], v[16:19], a[204:207], v[48:51]
  v_mfma_f32_16x16x32_bf16 v[52:55], v[16:19], v[244:247], v[52:55]
  v_mfma_f32_16x16x32_bf16 v[56:59], v[20:23], a[60:63], v[56:59]
  ds_read_b64_tr_b16 v[36:37], v11 offset:30720
  v_mfma_f32_16x16x32_bf16 v[60:63], v[20:23], a[132:135], v[60:63]
  ds_read_b64_tr_b16 v[38:39], v11 offset:30976
  v_mfma_f32_16x16x32_bf16 v[64:67], v[20:23], a[204:207], v[64:67]
  v_mfma_f32_16x16x32_bf16 v[68:71], v[20:23], v[244:247], v[68:71]
  s_waitcnt lgkmcnt(4)
  v_mfma_f32_16x16x32_bf16 v[72:75], v[24:27], a[60:63], v[72:75]
  ds_read_b64_tr_b16 v[16:17], v12 offset:24576
  v_mfma_f32_16x16x32_bf16 v[76:79], v[24:27], a[132:135], v[76:79]
  ds_read_b64_tr_b16 v[18:19], v12 offset:24832
  v_mfma_f32_16x16x32_bf16 v[80:83], v[24:27], a[204:207], v[80:83]
  v_mfma_f32_16x16x32_bf16 v[84:87], v[24:27], v[244:247], v[84:87]
  v_mfma_f32_16x16x32_bf16 v[88:91], v[28:31], a[60:63], v[88:91]
  ds_read_b64_tr_b16 v[20:21], v12 offset:30720
  v_mfma_f32_16x16x32_bf16 v[92:95], v[28:31], a[132:135], v[92:95]
  ds_read_b64_tr_b16 v[22:23], v12 offset:30976
  v_mfma_f32_16x16x32_bf16 v[96:99], v[28:31], a[204:207], v[96:99]
  v_mfma_f32_16x16x32_bf16 v[100:103], v[28:31], v[244:247], v[100:103]
  s_waitcnt lgkmcnt(4)
  v_mfma_f32_16x16x32_bf16 v[104:107], v[32:35], a[60:63], v[104:107]
  ds_read_b64_tr_b16 v[24:25], v5 offset:28672
  v_mfma_f32_16x16x32_bf16 v[108:111], v[32:35], a[132:135], v[108:111]
  ds_read_b64_tr_b16 v[26:27], v5 offset:29184
  v_mfma_f32_16x16x32_bf16 v[112:115], v[32:35], a[204:207], v[112:115]
  v_mfma_f32_16x16x32_bf16 v[116:119], v[32:35], v[244:247], v[116:119]
  v_mfma_f32_16x16x32_bf16 v[120:123], v[36:39], a[60:63], v[120:123]
  ds_read_b64_tr_b16 v[28:29], v6 offset:28672
  buffer_load_dwordx4 v0, s[12:15], s58 offen offset:1024 lds
  v_mfma_f32_16x16x32_bf16 v[124:127], v[36:39], a[132:135], v[124:127]
  ds_read_b64_tr_b16 v[30:31], v6 offset:29184
  v_mfma_f32_16x16x32_bf16 v[128:131], v[36:39], a[204:207], v[128:131]
  v_mfma_f32_16x16x32_bf16 v[132:135], v[36:39], v[244:247], v[132:135]
  s_waitcnt lgkmcnt(4)
  v_mfma_f32_16x16x32_bf16 v[136:139], v[16:19], a[60:63], v[136:139]
  ds_read_b64_tr_b16 v[32:33], v7 offset:28672
  v_mfma_f32_16x16x32_bf16 v[140:143], v[16:19], a[132:135], v[140:143]
  ds_read_b64_tr_b16 v[34:35], v7 offset:29184
  v_mfma_f32_16x16x32_bf16 v[144:147], v[16:19], a[204:207], v[144:147]
  v_mfma_f32_16x16x32_bf16 v[148:151], v[16:19], v[244:247], v[148:151]
  v_mfma_f32_16x16x32_bf16 v[152:155], v[20:23], a[60:63], v[152:155]
  ds_read_b64_tr_b16 v[36:37], v8 offset:28672
  v_mfma_f32_16x16x32_bf16 v[156:159], v[20:23], a[132:135], v[156:159]
  ds_read_b64_tr_b16 v[38:39], v8 offset:29184
  v_mfma_f32_16x16x32_bf16 v[160:163], v[20:23], a[204:207], v[160:163]
  v_mfma_f32_16x16x32_bf16 v[164:167], v[20:23], v[244:247], v[164:167]
  s_waitcnt lgkmcnt(4)
  v_mfma_f32_16x16x32_bf16 v[40:43], v[24:27], a[64:67], v[40:43]
  ds_read_b64_tr_b16 v[16:17], v11 offset:26624
  v_mfma_f32_16x16x32_bf16 v[44:47], v[24:27], a[136:139], v[44:47]
  ds_read_b64_tr_b16 v[18:19], v11 offset:26880
  v_mfma_f32_16x16x32_bf16 v[48:51], v[24:27], a[208:211], v[48:51]
  v_mfma_f32_16x16x32_bf16 v[52:55], v[24:27], v[248:251], v[52:55]
  v_mfma_f32_16x16x32_bf16 v[56:59], v[28:31], a[64:67], v[56:59]
  ds_read_b64_tr_b16 v[20:21], v11 offset:32768
  v_mfma_f32_16x16x32_bf16 v[60:63], v[28:31], a[136:139], v[60:63]
  ds_read_b64_tr_b16 v[22:23], v11 offset:33024
  v_mfma_f32_16x16x32_bf16 v[64:67], v[28:31], a[208:211], v[64:67]
  v_mfma_f32_16x16x32_bf16 v[68:71], v[28:31], v[248:251], v[68:71]
  s_waitcnt lgkmcnt(4)
  v_mfma_f32_16x16x32_bf16 v[72:75], v[32:35], a[64:67], v[72:75]
  ds_read_b64_tr_b16 v[24:25], v12 offset:26624
  buffer_load_dwordx4 v0, s[12:15], s59 offen offset:2048 lds
  v_mfma_f32_16x16x32_bf16 v[76:79], v[32:35], a[136:139], v[76:79]
  ds_read_b64_tr_b16 v[26:27], v12 offset:26880
  v_mfma_f32_16x16x32_bf16 v[80:83], v[32:35], a[208:211], v[80:83]
  v_mfma_f32_16x16x32_bf16 v[84:87], v[32:35], v[248:251], v[84:87]
  v_mfma_f32_16x16x32_bf16 v[88:91], v[36:39], a[64:67], v[88:91]
  ds_read_b64_tr_b16 v[28:29], v12 offset:32768
  v_mfma_f32_16x16x32_bf16 v[92:95], v[36:39], a[136:139], v[92:95]
  ds_read_b64_tr_b16 v[30:31], v12 offset:33024
  v_mfma_f32_16x16x32_bf16 v[96:99], v[36:39], a[208:211], v[96:99]
  v_mfma_f32_16x16x32_bf16 v[100:103], v[36:39], v[248:251], v[100:103]
  s_waitcnt lgkmcnt(4)
  v_mfma_f32_16x16x32_bf16 v[104:107], v[16:19], a[64:67], v[104:107]
  ds_read_b64_tr_b16 v[32:33], v5 offset:32768
  v_mfma_f32_16x16x32_bf16 v[108:111], v[16:19], a[136:139], v[108:111]
  ds_read_b64_tr_b16 v[34:35], v5 offset:33280
  v_mfma_f32_16x16x32_bf16 v[112:115], v[16:19], a[208:211], v[112:115]
  v_mfma_f32_16x16x32_bf16 v[116:119], v[16:19], v[248:251], v[116:119]
  v_mfma_f32_16x16x32_bf16 v[120:123], v[20:23], a[64:67], v[120:123]
  ds_read_b64_tr_b16 v[36:37], v6 offset:32768
  v_mfma_f32_16x16x32_bf16 v[124:127], v[20:23], a[136:139], v[124:127]
  ds_read_b64_tr_b16 v[38:39], v6 offset:33280
  v_mfma_f32_16x16x32_bf16 v[128:131], v[20:23], a[208:211], v[128:131]
  v_mfma_f32_16x16x32_bf16 v[132:135], v[20:23], v[248:251], v[132:135]
  s_waitcnt lgkmcnt(4)
  v_mfma_f32_16x16x32_bf16 v[136:139], v[24:27], a[64:67], v[136:139]
  ds_read_b64_tr_b16 v[16:17], v7 offset:32768
  v_mfma_f32_16x16x32_bf16 v[140:143], v[24:27], a[136:139], v[140:143]
  ds_read_b64_tr_b16 v[18:19], v7 offset:33280
  v_mfma_f32_16x16x32_bf16 v[144:147], v[24:27], a[208:211], v[144:147]
  v_mfma_f32_16x16x32_bf16 v[148:151], v[24:27], v[248:251], v[148:151]
  v_mfma_f32_16x16x32_bf16 v[152:155], v[28:31], a[64:67], v[152:155]
  ds_read_b64_tr_b16 v[20:21], v8 offset:32768
  v_mfma_f32_16x16x32_bf16 v[156:159], v[28:31], a[136:139], v[156:159]
  ds_read_b64_tr_b16 v[22:23], v8 offset:33280
  v_mfma_f32_16x16x32_bf16 v[160:163], v[28:31], a[208:211], v[160:163]
  v_mfma_f32_16x16x32_bf16 v[164:167], v[28:31], v[248:251], v[164:167]
  s_waitcnt lgkmcnt(4)
  v_mfma_f32_16x16x32_bf16 v[40:43], v[32:35], a[68:71], v[40:43]
  ds_read_b64_tr_b16 v[24:25], v11 offset:28672
  v_mfma_f32_16x16x32_bf16 v[44:47], v[32:35], a[140:143], v[44:47]
  ds_read_b64_tr_b16 v[26:27], v11 offset:28928
  v_mfma_f32_16x16x32_bf16 v[48:51], v[32:35], a[212:215], v[48:51]
  v_mfma_f32_16x16x32_bf16 v[52:55], v[32:35], v[252:255], v[52:55]
  v_mfma_f32_16x16x32_bf16 v[56:59], v[36:39], a[68:71], v[56:59]
  ds_read_b64_tr_b16 v[28:29], v11 offset:34816
  v_mfma_f32_16x16x32_bf16 v[60:63], v[36:39], a[140:143], v[60:63]
  ds_read_b64_tr_b16 v[30:31], v11 offset:35072
  v_mfma_f32_16x16x32_bf16 v[64:67], v[36:39], a[212:215], v[64:67]
  v_mfma_f32_16x16x32_bf16 v[68:71], v[36:39], v[252:255], v[68:71]
  s_waitcnt lgkmcnt(4)
  v_mfma_f32_16x16x32_bf16 v[72:75], v[16:19], a[68:71], v[72:75]
  ds_read_b64_tr_b16 v[32:33], v12 offset:28672
  v_mfma_f32_16x16x32_bf16 v[76:79], v[16:19], a[140:143], v[76:79]
  ds_read_b64_tr_b16 v[34:35], v12 offset:28928
  v_mfma_f32_16x16x32_bf16 v[80:83], v[16:19], a[212:215], v[80:83]
  v_mfma_f32_16x16x32_bf16 v[84:87], v[16:19], v[252:255], v[84:87]
  v_mfma_f32_16x16x32_bf16 v[88:91], v[20:23], a[68:71], v[88:91]
  ds_read_b64_tr_b16 v[36:37], v12 offset:34816
  v_mfma_f32_16x16x32_bf16 v[92:95], v[20:23], a[140:143], v[92:95]
  ds_read_b64_tr_b16 v[38:39], v12 offset:35072
  v_mfma_f32_16x16x32_bf16 v[96:99], v[20:23], a[212:215], v[96:99]
  v_mfma_f32_16x16x32_bf16 v[100:103], v[20:23], v[252:255], v[100:103]
  s_waitcnt lgkmcnt(4)
  v_mfma_f32_16x16x32_bf16 v[104:107], v[24:27], a[68:71], v[104:107]
  v_mfma_f32_16x16x32_bf16 v[108:111], v[24:27], a[140:143], v[108:111]
  v_mfma_f32_16x16x32_bf16 v[112:115], v[24:27], a[212:215], v[112:115]
  v_mfma_f32_16x16x32_bf16 v[116:119], v[24:27], v[252:255], v[116:119]
  v_mfma_f32_16x16x32_bf16 v[120:123], v[28:31], a[68:71], v[120:123]
  v_mfma_f32_16x16x32_bf16 v[124:127], v[28:31], a[140:143], v[124:127]
  v_mfma_f32_16x16x32_bf16 v[128:131], v[28:31], a[212:215], v[128:131]
  v_mfma_f32_16x16x32_bf16 v[132:135], v[28:31], v[252:255], v[132:135]
  s_waitcnt lgkmcnt(0)
  v_mfma_f32_16x16x32_bf16 v[136:139], v[32:35], a[68:71], v[136:139]
  v_mfma_f32_16x16x32_bf16 v[140:143], v[32:35], a[140:143], v[140:143]
  v_mfma_f32_16x16x32_bf16 v[144:147], v[32:35], a[212:215], v[144:147]
  v_mfma_f32_16x16x32_bf16 v[148:151], v[32:35], v[252:255], v[148:151]
  v_mfma_f32_16x16x32_bf16 v[152:155], v[36:39], a[68:71], v[152:155]
  v_mfma_f32_16x16x32_bf16 v[156:159], v[36:39], a[140:143], v[156:159]
  v_mfma_f32_16x16x32_bf16 v[160:163], v[36:39], a[212:215], v[160:163]
  v_mfma_f32_16x16x32_bf16 v[164:167], v[36:39], v[252:255], v[164:167]
  s_waitcnt vmcnt(0)
  s_waitcnt lgkmcnt(0)
  s_barrier
  s_add_u32 m0, s33, 49152
  s_nop 0
  buffer_load_dwordx4 v0, s[12:15], s60 offen offset:0 lds
  buffer_load_dwordx4 v0, s[12:15], s61 offen offset:1024 lds
  buffer_load_dwordx4 v0, s[12:15], s62 offen offset:2048 lds
  s_add_u32 m0, s33, 61440
  s_nop 0
  buffer_load_dwordx4 v0, s[12:15], s63 offen offset:0 lds
  buffer_load_dwordx4 v0, s[12:15], s64 offen offset:1024 lds
  buffer_load_dwordx4 v0, s[12:15], s65 offen offset:2048 lds
  v_mov_b32 v11, v9
  v_mov_b32 v12, v10
  ds_read_b64_tr_b16 v[16:17], v11 offset:0
  ds_read_b64_tr_b16 v[18:19], v11 offset:256
  ds_read_b64_tr_b16 v[20:21], v11 offset:6144
  ds_read_b64_tr_b16 v[22:23], v11 offset:6400
  ds_read_b64_tr_b16 v[24:25], v11 offset:2048
  ds_read_b64_tr_b16 v[26:27], v11 offset:2304
  ds_read_b64_tr_b16 v[28:29], v11 offset:8192
  ds_read_b64_tr_b16 v[30:31], v11 offset:8448
  s_waitcnt lgkmcnt(4)
  v_mfma_f32_16x16x32_bf16 v[168:171], v[16:19], a[0:3], 0
  ds_read_b64_tr_b16 v[32:33], v11 offset:4096
  v_mfma_f32_16x16x32_bf16 v[172:175], v[16:19], a[72:75], 0
  ds_read_b64_tr_b16 v[34:35], v11 offset:4352
  v_mfma_f32_16x16x32_bf16 v[176:179], v[16:19], a[144:147], 0
  v_add_u32 v2, 128, v2
  v_mul_f32 v40, s36, v40
  v_mfma_f32_16x16x32_bf16 v[180:183], v[16:19], a[216:219], 0
  v_mul_f32 v41, s36, v41
  v_mfma_f32_16x16x32_bf16 v[184:187], v[20:23], a[0:3], 0
  ds_read_b64_tr_b16 v[36:37], v11 offset:10240
  v_mul_f32 v42, s36, v42
  v_mfma_f32_16x16x32_bf16 v[188:191], v[20:23], a[72:75], 0
  ds_read_b64_tr_b16 v[38:39], v11 offset:10496
  v_mul_f32 v43, s36, v43
  v_mfma_f32_16x16x32_bf16 v[192:195], v[20:23], a[144:147], 0
  v_mul_f32 v44, s36, v44
  v_mfma_f32_16x16x32_bf16 v[196:199], v[20:23], a[216:219], 0
  s_waitcnt lgkmcnt(4)
  v_mul_f32 v45, s36, v45
  v_mfma_f32_16x16x32_bf16 v[168:171], v[24:27], a[4:7], v[168:171]
  ds_read_b64_tr_b16 v[16:17], v11 offset:12288
  v_mul_f32 v46, s36, v46
  v_mfma_f32_16x16x32_bf16 v[172:175], v[24:27], a[76:79], v[172:175]
  ds_read_b64_tr_b16 v[18:19], v11 offset:12544
  v_mul_f32 v47, s36, v47
  v_mfma_f32_16x16x32_bf16 v[176:179], v[24:27], a[148:151], v[176:179]
  v_mul_f32 v48, s36, v48
  v_mfma_f32_16x16x32_bf16 v[180:183], v[24:27], a[220:223], v[180:183]
  s_add_u32 m0, s33, 73728
  v_mfma_f32_16x16x32_bf16 v[184:187], v[28:31], a[4:7], v[184:187]
  ds_read_b64_tr_b16 v[20:21], v11 offset:18432
  v_mfma_f32_16x16x32_bf16 v[188:191], v[28:31], a[76:79], v[188:191]
  ds_read_b64_tr_b16 v[22:23], v11 offset:18688
  v_mul_f32 v49, s36, v49
  v_mfma_f32_16x16x32_bf16 v[192:195], v[28:31], a[148:151], v[192:195]
  v_mul_f32 v50, s36, v50
  v_mfma_f32_16x16x32_bf16 v[196:199], v[28:31], a[220:223], v[196:199]
  s_waitcnt lgkmcnt(4)
  v_mul_f32 v51, s36, v51
  v_mfma_f32_16x16x32_bf16 v[168:171], v[32:35], a[8:11], v[168:171]
  ds_read_b64_tr_b16 v[24:25], v11 offset:14336
  v_mul_f32 v52, s36, v52
  v_mfma_f32_16x16x32_bf16 v[172:175], v[32:35], a[80:83], v[172:175]
  ds_read_b64_tr_b16 v[26:27], v11 offset:14592
  v_mul_f32 v53, s36, v53
  v_mfma_f32_16x16x32_bf16 v[176:179], v[32:35], a[152:155], v[176:179]
  v_mul_f32 v54, s36, v54
  v_mfma_f32_16x16x32_bf16 v[180:183], v[32:35], a[224:227], v[180:183]
  v_mul_f32 v55, s36, v55
  v_mfma_f32_16x16x32_bf16 v[184:187], v[36:39], a[8:11], v[184:187]
  ds_read_b64_tr_b16 v[28:29], v11 offset:20480
  v_cvt_pk_bf16_f32 v200, v40, v41
  v_mfma_f32_16x16x32_bf16 v[188:191], v[36:39], a[80:83], v[188:191]
  ds_read_b64_tr_b16 v[30:31], v11 offset:20736
  buffer_load_dwordx4 v2, s[12:15], s48 offen offset:0 lds
  v_mfma_f32_16x16x32_bf16 v[192:195], v[36:39], a[152:155], v[192:195]
  v_cvt_pk_bf16_f32 v201, v44, v45
  v_mfma_f32_16x16x32_bf16 v[196:199], v[36:39], a[224:227], v[196:199]
  s_waitcnt lgkmcnt(4)
  v_mfma_f32_16x16x32_bf16 v[168:171], v[16:19], a[12:15], v[168:171]
  ds_read_b64_tr_b16 v[32:33], v11 offset:16384
  v_cvt_pk_bf16_f32 v202, v48, v49
  v_mfma_f32_16x16x32_bf16 v[172:175], v[16:19], a[84:87], v[172:175]
  ds_read_b64_tr_b16 v[34:35], v11 offset:16640
  v_cvt_pk_bf16_f32 v203, v52, v53
  v_mfma_f32_16x16x32_bf16 v[176:179], v[16:19], a[156:159], v[176:179]
  v_cvt_pk_bf16_f32 v204, v42, v43
  v_mfma_f32_16x16x32_bf16 v[180:183], v[16:19], a[228:231], v[180:183]
  v_cvt_pk_bf16_f32 v205, v46, v47
  v_mfma_f32_16x16x32_bf16 v[184:187], v[20:23], a[12:15], v[184:187]
  ds_read_b64_tr_b16 v[36:37], v11 offset:22528
  v_cvt_pk_bf16_f32 v206, v50, v51
  v_mfma_f32_16x16x32_bf16 v[188:191], v[20:23], a[84:87], v[188:191]
  ds_read_b64_tr_b16 v[38:39], v11 offset:22784
  v_cvt_pk_bf16_f32 v207, v54, v55
  v_mfma_f32_16x16x32_bf16 v[192:195], v[20:23], a[156:159], v[192:195]
  v_mul_f32 v56, s36, v56
  v_mfma_f32_16x16x32_bf16 v[196:199], v[20:23], a[228:231], v[196:199]
  s_waitcnt lgkmcnt(4)
  buffer_load_dwordx4 v2, s[12:15], s49 offen offset:1024 lds
  v_mfma_f32_16x16x32_bf16 v[168:171], v[24:27], a[16:19], v[168:171]
  ds_read_b64_tr_b16 v[16:17], v11 offset:24576
  v_mul_f32 v57, s36, v57
  v_mfma_f32_16x16x32_bf16 v[172:175], v[24:27], a[88:91], v[172:175]
  ds_read_b64_tr_b16 v[18:19], v11 offset:24832
  v_mfma_f32_16x16x32_bf16 v[176:179], v[24:27], a[160:163], v[176:179]
  v_mul_f32 v58, s36, v58
  v_mfma_f32_16x16x32_bf16 v[180:183], v[24:27], a[232:235], v[180:183]
  v_mul_f32 v59, s36, v59
  v_mfma_f32_16x16x32_bf16 v[184:187], v[28:31], a[16:19], v[184:187]
  ds_read_b64_tr_b16 v[20:21], v11 offset:30720
  v_mul_f32 v60, s36, v60
  v_mfma_f32_16x16x32_bf16 v[188:191], v[28:31], a[88:91], v[188:191]
  ds_read_b64_tr_b16 v[22:23], v11 offset:30976
  v_mul_f32 v61, s36, v61
  v_mfma_f32_16x16x32_bf16 v[192:195], v[28:31], a[160:163], v[192:195]
  v_mul_f32 v62, s36, v62
  v_mfma_f32_16x16x32_bf16 v[196:199], v[28:31], a[232:235], v[196:199]
  s_waitcnt lgkmcnt(4)
  v_mul_f32 v63, s36, v63
  v_mfma_f32_16x16x32_bf16 v[168:171], v[32:35], a[20:23], v[168:171]
  ds_read_b64_tr_b16 v[24:25], v11 offset:26624
  v_mul_f32 v64, s36, v64
  v_mfma_f32_16x16x32_bf16 v[172:175], v[32:35], a[92:95], v[172:175]
  ds_read_b64_tr_b16 v[26:27], v11 offset:26880
  v_mul_f32 v65, s36, v65
  v_mfma_f32_16x16x32_bf16 v[176:179], v[32:35], a[164:167], v[176:179]
  buffer_load_dwordx4 v2, s[12:15], s50 offen offset:2048 lds
  v_mfma_f32_16x16x32_bf16 v[180:183], v[32:35], a[236:239], v[180:183]
  v_mul_f32 v66, s36, v66
  v_mfma_f32_16x16x32_bf16 v[184:187], v[36:39], a[20:23], v[184:187]
  ds_read_b64_tr_b16 v[28:29], v11 offset:32768
  v_mfma_f32_16x16x32_bf16 v[188:191], v[36:39], a[92:95], v[188:191]
  ds_read_b64_tr_b16 v[30:31], v11 offset:33024
  v_mul_f32 v67, s36, v67
  v_mfma_f32_16x16x32_bf16 v[192:195], v[36:39], a[164:167], v[192:195]
  v_mul_f32 v68, s36, v68
  v_mfma_f32_16x16x32_bf16 v[196:199], v[36:39], a[236:239], v[196:199]
  s_waitcnt lgkmcnt(4)
  v_mul_f32 v69, s36, v69
  v_mfma_f32_16x16x32_bf16 v[168:171], v[16:19], a[24:27], v[168:171]
  ds_read_b64_tr_b16 v[32:33], v11 offset:28672
  v_mul_f32 v70, s36, v70
  v_mfma_f32_16x16x32_bf16 v[172:175], v[16:19], a[96:99], v[172:175]
  ds_read_b64_tr_b16 v[34:35], v11 offset:28928
  v_mul_f32 v71, s36, v71
  v_mfma_f32_16x16x32_bf16 v[176:179], v[16:19], a[168:171], v[176:179]
  v_cvt_pk_bf16_f32 v208, v56, v57
  v_mfma_f32_16x16x32_bf16 v[180:183], v[16:19], a[240:243], v[180:183]
  v_cvt_pk_bf16_f32 v209, v60, v61
  v_mfma_f32_16x16x32_bf16 v[184:187], v[20:23], a[24:27], v[184:187]
  ds_read_b64_tr_b16 v[36:37], v11 offset:34816
  s_add_u32 m0, s33, 86016
  v_mfma_f32_16x16x32_bf16 v[188:191], v[20:23], a[96:99], v[188:191]
  ds_read_b64_tr_b16 v[38:39], v11 offset:35072
  v_cvt_pk_bf16_f32 v210, v64, v65
  v_mfma_f32_16x16x32_bf16 v[192:195], v[20:23], a[168:171], v[192:195]
  v_cvt_pk_bf16_f32 v211, v68, v69
  v_mfma_f32_16x16x32_bf16 v[196:199], v[20:23], a[240:243], v[196:199]
  s_waitcnt lgkmcnt(4)
  v_mfma_f32_16x16x32_bf16 v[168:171], v[24:27], a[28:31], v[168:171]
  v_add_u32 v11, 36864, v11
  ds_read_b64_tr_b16 v[16:17], v11 offset:0
  v_mfma_f32_16x16x32_bf16 v[172:175], v[24:27], a[100:103], v[172:175]
  ds_read_b64_tr_b16 v[18:19], v11 offset:256
  v_cvt_pk_bf16_f32 v212, v58, v59
  v_mfma_f32_16x16x32_bf16 v[176:179], v[24:27], a[172:175], v[176:179]
  v_cvt_pk_bf16_f32 v213, v62, v63
  v_cvt_pk_bf16_f32 v214, v66, v67
  v_mfma_f32_16x16x32_bf16 v[180:183], v[24:27], a[244:247], v[180:183]
  v_cvt_pk_bf16_f32 v215, v70, v71
  v_mfma_f32_16x16x32_bf16 v[184:187], v[28:31], a[28:31], v[184:187]
  ds_read_b64_tr_b16 v[20:21], v11 offset:6144
  s_add_u32 s27, s37, 0
  v_mfma_f32_16x16x32_bf16 v[188:191], v[28:31], a[100:103], v[188:191]
  ds_read_b64_tr_b16 v[22:23], v11 offset:6400
  buffer_store_dwordx4 v[200:203], v14, s[16:19], s27 offen sc1
  v_mfma_f32_16x16x32_bf16 v[192:195], v[28:31], a[172:175], v[192:195]
  buffer_load_dwordx4 v2, s[12:15], s51 offen offset:0 lds
  v_mfma_f32_16x16x32_bf16 v[196:199], v[28:31], a[244:247], v[196:199]
  s_waitcnt lgkmcnt(4)
  s_add_u32 s27, s37, 8192
  v_mfma_f32_16x16x32_bf16 v[168:171], v[32:35], a[32:35], v[168:171]
  ds_read_b64_tr_b16 v[24:25], v11 offset:2048
  buffer_store_dwordx4 v[204:207], v14, s[16:19], s27 offen sc1
  v_mfma_f32_16x16x32_bf16 v[172:175], v[32:35], a[104:107], v[172:175]
  ds_read_b64_tr_b16 v[26:27], v11 offset:2304
  v_mfma_f32_16x16x32_bf16 v[176:179], v[32:35], a[176:179], v[176:179]
  s_add_u32 s27, s37, 65536
  v_mfma_f32_16x16x32_bf16 v[180:183], v[32:35], a[248:251], v[180:183]
  buffer_store_dwordx4 v[208:211], v14, s[16:19], s27 offen sc1
  v_mfma_f32_16x16x32_bf16 v[184:187], v[36:39], a[32:35], v[184:187]
  ds_read_b64_tr_b16 v[28:29], v11 offset:8192
  s_add_u32 s27, s37, 73728
  v_mfma_f32_16x16x32_bf16 v[188:191], v[36:39], a[104:107], v[188:191]
  ds_read_b64_tr_b16 v[30:31], v11 offset:8448
  buffer_store_dwordx4 v[212:215], v14, s[16:19], s27 offen sc1
  v_mfma_f32_16x16x32_bf16 v[192:195], v[36:39], a[176:179], v[192:195]
  s_add_u32 s37, s37, 131072
  v_mfma_f32_16x16x32_bf16 v[196:199], v[36:39], a[248:251], v[196:199]
  s_waitcnt lgkmcnt(4)
  v_mul_f32 v72, s36, v72
  v_mfma_f32_16x16x32_bf16 v[168:171], v[16:19], a[36:39], v[168:171]
  ds_read_b64_tr_b16 v[32:33], v11 offset:4096
  v_mul_f32 v73, s36, v73
  v_mfma_f32_16x16x32_bf16 v[172:175], v[16:19], a[108:111], v[172:175]
  ds_read_b64_tr_b16 v[34:35], v11 offset:4352
  buffer_load_dwordx4 v2, s[12:15], s52 offen offset:1024 lds
  v_mfma_f32_16x16x32_bf16 v[176:179], v[16:19], a[180:183], v[176:179]
  v_mul_f32 v74, s36, v74
  v_mfma_f32_16x16x32_bf16 v[180:183], v[16:19], a[252:255], v[180:183]
  v_mul_f32 v75, s36, v75
  v_mfma_f32_16x16x32_bf16 v[184:187], v[20:23], a[36:39], v[184:187]
  ds_read_b64_tr_b16 v[36:37], v11 offset:10240
  v_mfma_f32_16x16x32_bf16 v[188:191], v[20:23], a[108:111], v[188:191]
  ds_read_b64_tr_b16 v[38:39], v11 offset:10496
  v_mul_f32 v76, s36, v76
  v_mfma_f32_16x16x32_bf16 v[192:195], v[20:23], a[180:183], v[192:195]
  v_mul_f32 v77, s36, v77
  v_mfma_f32_16x16x32_bf16 v[196:199], v[20:23], a[252:255], v[196:199]
  s_waitcnt lgkmcnt(4)
  v_mul_f32 v78, s36, v78
  v_mfma_f32_16x16x32_bf16 v[168:171], v[24:27], a[40:43], v[168:171]
  s_waitcnt vmcnt(9)
  s_barrier
  ds_read_b64_tr_b16 v[16:17], v11 offset:12288
  v_mul_f32 v79, s36, v79
  v_mfma_f32_16x16x32_bf16 v[172:175], v[24:27], a[112:115], v[172:175]
  ds_read_b64_tr_b16 v[18:19], v11 offset:12544
  v_mul_f32 v80, s36, v80
  v_mfma_f32_16x16x32_bf16 v[176:179], v[24:27], a[184:187], v[176:179]
  v_mul_f32 v81, s36, v81
  v_mfma_f32_16x16x32_bf16 v[180:183], v[24:27], v[224:227], v[180:183]
  buffer_load_dwordx4 v2, s[12:15], s53 offen offset:2048 lds
  v_mfma_f32_16x16x32_bf16 v[184:187], v[28:31], a[40:43], v[184:187]
  ds_read_b64_tr_b16 v[20:21], v11 offset:18432
  v_mul_f32 v82, s36, v82
  v_mfma_f32_16x16x32_bf16 v[188:191], v[28:31], a[112:115], v[188:191]
  ds_read_b64_tr_b16 v[22:23], v11 offset:18688
  v_mul_f32 v83, s36, v83
  v_mfma_f32_16x16x32_bf16 v[192:195], v[28:31], a[184:187], v[192:195]
  v_mfma_f32_16x16x32_bf16 v[196:199], v[28:31], v[224:227], v[196:199]
  s_waitcnt lgkmcnt(4)
  v_mul_f32 v84, s36, v84
  v_mfma_f32_16x16x32_bf16 v[168:171], v[32:35], a[44:47], v[168:171]
  ds_read_b64_tr_b16 v[24:25], v11 offset:14336
  v_mul_f32 v85, s36, v85
  v_mfma_f32_16x16x32_bf16 v[172:175], v[32:35], a[116:119], v[172:175]
  ds_read_b64_tr_b16 v[26:27], v11 offset:14592
  v_mul_f32 v86, s36, v86
  v_mfma_f32_16x16x32_bf16 v[176:179], v[32:35], a[188:191], v[176:179]
  v_mul_f32 v87, s36, v87
  v_mfma_f32_16x16x32_bf16 v[180:183], v[32:35], v[228:231], v[180:183]
  v_cvt_pk_bf16_f32 v40, v72, v73
  v_mfma_f32_16x16x32_bf16 v[184:187], v[36:39], a[44:47], v[184:187]
  ds_read_b64_tr_b16 v[28:29], v11 offset:20480
  v_cvt_pk_bf16_f32 v41, v76, v77
  v_mfma_f32_16x16x32_bf16 v[188:191], v[36:39], a[116:119], v[188:191]
  ds_read_b64_tr_b16 v[30:31], v11 offset:20736
  s_add_u32 m0, s33, 98304
  v_mfma_f32_16x16x32_bf16 v[192:195], v[36:39], a[188:191], v[192:195]
  v_cvt_pk_bf16_f32 v42, v80, v81
  v_mfma_f32_16x16x32_bf16 v[196:199], v[36:39], v[228:231], v[196:199]
  s_waitcnt lgkmcnt(4)
  v_cvt_pk_bf16_f32 v43, v84, v85
  v_mfma_f32_16x16x32_bf16 v[168:171], v[16:19], a[48:51], v[168:171]
  ds_read_b64_tr_b16 v[32:33], v11 offset:16384
  v_cvt_pk_bf16_f32 v44, v74, v75
  v_mfma_f32_16x16x32_bf16 v[172:175], v[16:19], a[120:123], v[172:175]
  ds_read_b64_tr_b16 v[34:35], v11 offset:16640
  v_mfma_f32_16x16x32_bf16 v[176:179], v[16:19], a[192:195], v[176:179]
  v_cvt_pk_bf16_f32 v45, v78, v79
  v_mfma_f32_16x16x32_bf16 v[180:183], v[16:19], v[232:235], v[180:183]
  v_cvt_pk_bf16_f32 v46, v82, v83
  v_mfma_f32_16x16x32_bf16 v[184:187], v[20:23], a[48:51], v[184:187]
  ds_read_b64_tr_b16 v[36:37], v11 offset:22528
  v_cvt_pk_bf16_f32 v47, v86, v87
  v_mfma_f32_16x16x32_bf16 v[188:191], v[20:23], a[120:123], v[188:191]
  ds_read_b64_tr_b16 v[38:39], v11 offset:22784
  v_mul_f32 v88, s36, v88
  v_mfma_f32_16x16x32_bf16 v[192:195], v[20:23], a[192:195], v[192:195]
  v_mul_f32 v89, s36, v89
  v_mfma_f32_16x16x32_bf16 v[196:199], v[20:23], v[232:235], v[196:199]
  s_waitcnt lgkmcnt(4)
  buffer_load_dwordx4 v2, s[12:15], s54 offen offset:0 lds
  v_mfma_f32_16x16x32_bf16 v[168:171], v[24:27], a[52:55], v[168:171]
  ds_read_b64_tr_b16 v[16:17], v11 offset:24576
  v_mul_f32 v90, s36, v90
  v_mfma_f32_16x16x32_bf16 v[172:175], v[24:27], a[124:127], v[172:175]
  ds_read_b64_tr_b16 v[18:19], v11 offset:24832
  v_mul_f32 v91, s36, v91
  v_mfma_f32_16x16x32_bf16 v[176:179], v[24:27], a[196:199], v[176:179]
  v_mul_f32 v92, s36, v92
  v_mfma_f32_16x16x32_bf16 v[180:183], v[24:27], v[236:239], v[180:183]
  v_mul_f32 v93, s36, v93
  v_mfma_f32_16x16x32_bf16 v[184:187], v[28:31], a[52:55], v[184:187]
  ds_read_b64_tr_b16 v[20:21], v11 offset:30720
  v_mfma_f32_16x16x32_bf16 v[188:191], v[28:31], a[124:127], v[188:191]
  ds_read_b64_tr_b16 v[22:23], v11 offset:30976
  v_mul_f32 v94, s36, v94
  v_mfma_f32_16x16x32_bf16 v[192:195], v[28:31], a[196:199], v[192:195]
  v_mul_f32 v95, s36, v95
  v_mfma_f32_16x16x32_bf16 v[196:199], v[28:31], v[236:239], v[196:199]
  s_waitcnt lgkmcnt(4)
  v_mul_f32 v96, s36, v96
  v_mfma_f32_16x16x32_bf16 v[168:171], v[32:35], a[56:59], v[168:171]
  ds_read_b64_tr_b16 v[24:25], v11 offset:26624
  v_mul_f32 v97, s36, v97
  v_mfma_f32_16x16x32_bf16 v[172:175], v[32:35], a[128:131], v[172:175]
  ds_read_b64_tr_b16 v[26:27], v11 offset:26880
  v_mul_f32 v98, s36, v98
  v_mfma_f32_16x16x32_bf16 v[176:179], v[32:35], a[200:203], v[176:179]
  v_mul_f32 v99, s36, v99
  v_mfma_f32_16x16x32_bf16 v[180:183], v[32:35], v[240:243], v[180:183]
  v_mul_f32 v100, s36, v100
  v_mfma_f32_16x16x32_bf16 v[184:187], v[36:39], a[56:59], v[184:187]
  ds_read_b64_tr_b16 v[28:29], v11 offset:32768
  v_mul_f32 v101, s36, v101
  v_mfma_f32_16x16x32_bf16 v[188:191], v[36:39], a[128:131], v[188:191]
  ds_read_b64_tr_b16 v[30:31], v11 offset:33024
  v_mul_f32 v102, s36, v102
  v_mfma_f32_16x16x32_bf16 v[192:195], v[36:39], a[200:203], v[192:195]
  v_mfma_f32_16x16x32_bf16 v[196:199], v[36:39], v[240:243], v[196:199]
  s_waitcnt lgkmcnt(4)
  v_mul_f32 v103, s36, v103
  v_mfma_f32_16x16x32_bf16 v[168:171], v[16:19], a[60:63], v[168:171]
  ds_read_b64_tr_b16 v[32:33], v11 offset:28672
  v_cvt_pk_bf16_f32 v48, v88, v89
  v_mfma_f32_16x16x32_bf16 v[172:175], v[16:19], a[132:135], v[172:175]
  ds_read_b64_tr_b16 v[34:35], v11 offset:28928
  v_cvt_pk_bf16_f32 v49, v92, v93
  v_mfma_f32_16x16x32_bf16 v[176:179], v[16:19], a[204:207], v[176:179]
  v_cvt_pk_bf16_f32 v50, v96, v97
  v_mfma_f32_16x16x32_bf16 v[180:183], v[16:19], v[244:247], v[180:183]
  v_cvt_pk_bf16_f32 v51, v100, v101
  v_mfma_f32_16x16x32_bf16 v[184:187], v[20:23], a[60:63], v[184:187]
  ds_read_b64_tr_b16 v[36:37], v11 offset:34816
  v_cvt_pk_bf16_f32 v52, v90, v91
  v_mfma_f32_16x16x32_bf16 v[188:191], v[20:23], a[132:135], v[188:191]
  ds_read_b64_tr_b16 v[38:39], v11 offset:35072
  v_cvt_pk_bf16_f32 v53, v94, v95
  v_mfma_f32_16x16x32_bf16 v[192:195], v[20:23], a[204:207], v[192:195]
  v_cvt_pk_bf16_f32 v54, v98, v99
  v_mfma_f32_16x16x32_bf16 v[196:199], v[20:23], v[244:247], v[196:199]
  s_waitcnt lgkmcnt(4)
  v_cvt_pk_bf16_f32 v55, v102, v103
  v_mfma_f32_16x16x32_bf16 v[168:171], v[24:27], a[64:67], v[168:171]
  ds_read_b64_tr_b16 v[16:17], v12 offset:0
  s_add_u32 s27, s37, 0
  v_mfma_f32_16x16x32_bf16 v[172:175], v[24:27], a[136:139], v[172:175]
  ds_read_b64_tr_b16 v[18:19], v12 offset:256
  v_mfma_f32_16x16x32_bf16 v[176:179], v[24:27], a[208:211], v[176:179]
  buffer_store_dwordx4 v[40:43], v14, s[16:19], s27 offen sc1
  v_mfma_f32_16x16x32_bf16 v[180:183], v[24:27], v[248:251], v[180:183]
  s_add_u32 s27, s37, 8192
  v_mfma_f32_16x16x32_bf16 v[184:187], v[28:31], a[64:67], v[184:187]
  ds_read_b64_tr_b16 v[20:21], v12 offset:6144
  buffer_store_dwordx4 v[44:47], v14, s[16:19], s27 offen sc1
  v_mfma_f32_16x16x32_bf16 v[188:191], v[28:31], a[136:139], v[188:191]
  ds_read_b64_tr_b16 v[22:23], v12 offset:6400
  s_add_u32 s27, s37, 65536
  v_mfma_f32_16x16x32_bf16 v[192:195], v[28:31], a[208:211], v[192:195]
  buffer_store_dwordx4 v[48:51], v14, s[16:19], s27 offen sc1
  v_mfma_f32_16x16x32_bf16 v[196:199], v[28:31], v[248:251], v[196:199]
  s_waitcnt lgkmcnt(4)
  s_add_u32 s27, s37, 73728
  v_mfma_f32_16x16x32_bf16 v[168:171], v[32:35], a[68:71], v[168:171]
  ds_read_b64_tr_b16 v[24:25], v12 offset:2048
  buffer_store_dwordx4 v[52:55], v14, s[16:19], s27 offen sc1
  v_mfma_f32_16x16x32_bf16 v[172:175], v[32:35], a[140:143], v[172:175]
  ds_read_b64_tr_b16 v[26:27], v12 offset:2304
  s_add_u32 s37, s37, 131072
  v_mfma_f32_16x16x32_bf16 v[176:179], v[32:35], a[212:215], v[176:179]
  v_mfma_f32_16x16x32_bf16 v[180:183], v[32:35], v[252:255], v[180:183]
  v_mfma_f32_16x16x32_bf16 v[184:187], v[36:39], a[68:71], v[184:187]
  ds_read_b64_tr_b16 v[28:29], v12 offset:8192
  v_mfma_f32_16x16x32_bf16 v[188:191], v[36:39], a[140:143], v[188:191]
  ds_read_b64_tr_b16 v[30:31], v12 offset:8448
  v_mfma_f32_16x16x32_bf16 v[192:195], v[36:39], a[212:215], v[192:195]
  v_mfma_f32_16x16x32_bf16 v[196:199], v[36:39], v[252:255], v[196:199]
  s_waitcnt lgkmcnt(4)
  v_mov_b32 v11, v12
  v_add_u32 v12, 73728, v9
  v_mfma_f32_16x16x32_bf16 v[40:43], v[16:19], a[0:3], 0
  ds_read_b64_tr_b16 v[32:33], v11 offset:4096
  v_mfma_f32_16x16x32_bf16 v[44:47], v[16:19], a[72:75], 0
  ds_read_b64_tr_b16 v[34:35], v11 offset:4352
  v_mfma_f32_16x16x32_bf16 v[48:51], v[16:19], a[144:147], 0
  buffer_load_dwordx4 v2, s[12:15], s55 offen offset:1024 lds
  v_mfma_f32_16x16x32_bf16 v[52:55], v[16:19], a[216:219], 0
  v_exp_f32 v200, -v104
  v_mfma_f32_16x16x32_bf16 v[56:59], v[20:23], a[0:3], 0
  ds_read_b64_tr_b16 v[36:37], v11 offset:10240
  v_mfma_f32_16x16x32_bf16 v[60:63], v[20:23], a[72:75], 0
  ds_read_b64_tr_b16 v[38:39], v11 offset:10496
  v_mfma_f32_16x16x32_bf16 v[64:67], v[20:23], a[144:147], 0
  v_exp_f32 v201, -v105
  v_mfma_f32_16x16x32_bf16 v[68:71], v[20:23], a[216:219], 0
  s_waitcnt lgkmcnt(4)
  v_mfma_f32_16x16x32_bf16 v[40:43], v[24:27], a[4:7], v[40:43]
  ds_read_b64_tr_b16 v[16:17], v11 offset:12288
  v_exp_f32 v202, -v106
  v_mfma_f32_16x16x32_bf16 v[44:47], v[24:27], a[76:79], v[44:47]
  ds_read_b64_tr_b16 v[18:19], v11 offset:12544
  v_exp_f32 v203, -v107
  v_mfma_f32_16x16x32_bf16 v[48:51], v[24:27], a[148:151], v[48:51]
  v_exp_f32 v204, -v108
  v_mfma_f32_16x16x32_bf16 v[52:55], v[24:27], a[220:223], v[52:55]
  v_exp_f32 v205, -v109
  v_mfma_f32_16x16x32_bf16 v[56:59], v[28:31], a[4:7], v[56:59]
  ds_read_b64_tr_b16 v[20:21], v11 offset:18432
  v_mfma_f32_16x16x32_bf16 v[60:63], v[28:31], a[76:79], v[60:63]
  ds_read_b64_tr_b16 v[22:23], v11 offset:18688
  v_exp_f32 v206, -v110
  v_mfma_f32_16x16x32_bf16 v[64:67], v[28:31], a[148:151], v[64:67]
  v_exp_f32 v207, -v111
  v_mfma_f32_16x16x32_bf16 v[68:71], v[28:31], a[220:223], v[68:71]
  s_waitcnt lgkmcnt(4)
  v_mul_f32 v104, v104, v120
  v_mfma_f32_16x16x32_bf16 v[40:43], v[32:35], a[8:11], v[40:43]
  ds_read_b64_tr_b16 v[24:25], v11 offset:14336
  buffer_load_dwordx4 v2, s[12:15], s56 offen offset:2048 lds
  v_mul_f32 v105, v105, v121
  v_mfma_f32_16x16x32_bf16 v[44:47], v[32:35], a[80:83], v[44:47]
  ds_read_b64_tr_b16 v[26:27], v11 offset:14592
  v_mul_f32 v106, v106, v122
  v_mfma_f32_16x16x32_bf16 v[48:51], v[32:35], a[152:155], v[48:51]
  v_mul_f32 v107, v107, v123
  v_mul_f32 v108, v108, v124
  v_mfma_f32_16x16x32_bf16 v[52:55], v[32:35], a[224:227], v[52:55]
  v_mul_f32 v109, v109, v125
  v_mul_f32 v110, v110, v126
  v_mfma_f32_16x16x32_bf16 v[56:59], v[36:39], a[8:11], v[56:59]
  ds_read_b64_tr_b16 v[28:29], v11 offset:20480
  v_mul_f32 v111, v111, v127
  v_mfma_f32_16x16x32_bf16 v[60:63], v[36:39], a[80:83], v[60:63]
  ds_read_b64_tr_b16 v[30:31], v11 offset:20736
  v_add_f32 v200, 1.0, v200
  s_add_u32 m0, s33, 110592
  v_mfma_f32_16x16x32_bf16 v[64:67], v[36:39], a[152:155], v[64:67]
  v_add_f32 v201, 1.0, v201
  v_add_f32 v202, 1.0, v202
  v_mfma_f32_16x16x32_bf16 v[68:71], v[36:39], a[224:227], v[68:71]
  s_waitcnt lgkmcnt(4)
  v_add_f32 v203, 1.0, v203
  v_mfma_f32_16x16x32_bf16 v[40:43], v[16:19], a[12:15], v[40:43]
  ds_read_b64_tr_b16 v[32:33], v11 offset:16384
  v_add_f32 v204, 1.0, v204
  v_add_f32 v205, 1.0, v205
  v_mfma_f32_16x16x32_bf16 v[44:47], v[16:19], a[84:87], v[44:47]
  ds_read_b64_tr_b16 v[34:35], v11 offset:16640
  v_add_f32 v206, 1.0, v206
  v_add_f32 v207, 1.0, v207
  v_mfma_f32_16x16x32_bf16 v[48:51], v[16:19], a[156:159], v[48:51]
  v_rcp_f32 v200, v200
  v_mfma_f32_16x16x32_bf16 v[52:55], v[16:19], a[228:231], v[52:55]
  buffer_load_dwordx4 v2, s[12:15], s57 offen offset:0 lds
  v_mfma_f32_16x16x32_bf16 v[56:59], v[20:23], a[12:15], v[56:59]
  ds_read_b64_tr_b16 v[36:37], v11 offset:22528
  v_rcp_f32 v201, v201
  v_mfma_f32_16x16x32_bf16 v[60:63], v[20:23], a[84:87], v[60:63]
  ds_read_b64_tr_b16 v[38:39], v11 offset:22784
  v_rcp_f32 v202, v202
  v_mfma_f32_16x16x32_bf16 v[64:67], v[20:23], a[156:159], v[64:67]
  v_rcp_f32 v203, v203
  v_mfma_f32_16x16x32_bf16 v[68:71], v[20:23], a[228:231], v[68:71]
  s_waitcnt lgkmcnt(4)
  v_rcp_f32 v204, v204
  v_mfma_f32_16x16x32_bf16 v[40:43], v[24:27], a[16:19], v[40:43]
  ds_read_b64_tr_b16 v[16:17], v11 offset:24576
  v_mfma_f32_16x16x32_bf16 v[44:47], v[24:27], a[88:91], v[44:47]
  ds_read_b64_tr_b16 v[18:19], v11 offset:24832
  v_rcp_f32 v205, v205
  v_mfma_f32_16x16x32_bf16 v[48:51], v[24:27], a[160:163], v[48:51]
  v_rcp_f32 v206, v206
  v_mfma_f32_16x16x32_bf16 v[52:55], v[24:27], a[232:235], v[52:55]
  v_rcp_f32 v207, v207
  v_mfma_f32_16x16x32_bf16 v[56:59], v[28:31], a[16:19], v[56:59]
  ds_read_b64_tr_b16 v[20:21], v11 offset:30720
  v_mul_f32 v104, v104, v200
  v_mfma_f32_16x16x32_bf16 v[60:63], v[28:31], a[88:91], v[60:63]
  ds_read_b64_tr_b16 v[22:23], v11 offset:30976
  buffer_load_dwordx4 v2, s[12:15], s58 offen offset:1024 lds
  v_mul_f32 v105, v105, v201
  v_mfma_f32_16x16x32_bf16 v[64:67], v[28:31], a[160:163], v[64:67]
  v_mul_f32 v106, v106, v202
  v_mul_f32 v107, v107, v203
  v_mfma_f32_16x16x32_bf16 v[68:71], v[28:31], a[232:235], v[68:71]
  s_waitcnt lgkmcnt(4)
  v_mul_f32 v108, v108, v204
  v_mfma_f32_16x16x32_bf16 v[40:43], v[32:35], a[20:23], v[40:43]
  ds_read_b64_tr_b16 v[24:25], v11 offset:26624
  v_mul_f32 v109, v109, v205
  v_mul_f32 v110, v110, v206
  v_mfma_f32_16x16x32_bf16 v[44:47], v[32:35], a[92:95], v[44:47]
  ds_read_b64_tr_b16 v[26:27], v11 offset:26880
  v_mul_f32 v111, v111, v207
  v_mfma_f32_16x16x32_bf16 v[48:51], v[32:35], a[164:167], v[48:51]
  v_cvt_pk_bf16_f32 v216, v104, v105
  buffer_load_dwordx4 v2, s[12:15], s59 offen offset:2048 lds
  v_mfma_f32_16x16x32_bf16 v[52:55], v[32:35], a[236:239], v[52:55]
  v_cvt_pk_bf16_f32 v217, v106, v107
  v_cvt_pk_bf16_f32 v218, v108, v109
  v_mfma_f32_16x16x32_bf16 v[56:59], v[36:39], a[20:23], v[56:59]
  ds_read_b64_tr_b16 v[28:29], v11 offset:32768
  v_cvt_pk_bf16_f32 v219, v110, v111
  v_mfma_f32_16x16x32_bf16 v[60:63], v[36:39], a[92:95], v[60:63]
  ds_read_b64_tr_b16 v[30:31], v11 offset:33024
  buffer_store_dwordx2 v[216:217], v13, s[16:19], s29 offen offset:0 sc1
  buffer_store_dwordx2 v[218:219], v13, s[16:19], s29 offen offset:256 sc1
  v_mfma_f32_16x16x32_bf16 v[64:67], v[36:39], a[164:167], v[64:67]
  v_exp_f32 v208, -v112
  v_mfma_f32_16x16x32_bf16 v[68:71], v[36:39], a[236:239], v[68:71]
  s_waitcnt lgkmcnt(4)
  v_exp_f32 v209, -v113
  v_mfma_f32_16x16x32_bf16 v[40:43], v[16:19], a[24:27], v[40:43]
  ds_read_b64_tr_b16 v[32:33], v11 offset:28672
  v_exp_f32 v210, -v114
  v_mfma_f32_16x16x32_bf16 v[44:47], v[16:19], a[96:99], v[44:47]
  ds_read_b64_tr_b16 v[34:35], v11 offset:28928
  s_add_u32 m0, s33, 122880
  v_mfma_f32_16x16x32_bf16 v[48:51], v[16:19], a[168:171], v[48:51]
  v_exp_f32 v211, -v115
  v_mfma_f32_16x16x32_bf16 v[52:55], v[16:19], a[240:243], v[52:55]
  v_exp_f32 v212, -v116
  v_mfma_f32_16x16x32_bf16 v[56:59], v[20:23], a[24:27], v[56:59]
  ds_read_b64_tr_b16 v[36:37], v11 offset:34816
  v_exp_f32 v213, -v117
  v_mfma_f32_16x16x32_bf16 v[60:63], v[20:23], a[96:99], v[60:63]
  ds_read_b64_tr_b16 v[38:39], v11 offset:35072
  v_mfma_f32_16x16x32_bf16 v[64:67], v[20:23], a[168:171], v[64:67]
  v_exp_f32 v214, -v118
  v_mfma_f32_16x16x32_bf16 v[68:71], v[20:23], a[240:243], v[68:71]
  s_waitcnt lgkmcnt(4)
  v_exp_f32 v215, -v119
  v_mfma_f32_16x16x32_bf16 v[40:43], v[24:27], a[28:31], v[40:43]
  v_add_u32 v11, 36864, v11
  ds_read_b64_tr_b16 v[16:17], v11 offset:0
  v_mul_f32 v112, v112, v128
  v_mfma_f32_16x16x32_bf16 v[44:47], v[24:27], a[100:103], v[44:47]
  ds_read_b64_tr_b16 v[18:19], v11 offset:256
  v_mul_f32 v113, v113, v129
  v_mul_f32 v114, v114, v130
  v_mfma_f32_16x16x32_bf16 v[48:51], v[24:27], a[172:175], v[48:51]
  buffer_load_dwordx4 v2, s[12:15], s60 offen offset:0 lds
  v_mul_f32 v115, v115, v131
  v_mfma_f32_16x16x32_bf16 v[52:55], v[24:27], a[244:247], v[52:55]
  v_mul_f32 v116, v116, v132
  v_mul_f32 v117, v117, v133
  v_mfma_f32_16x16x32_bf16 v[56:59], v[28:31], a[28:31], v[56:59]
  ds_read_b64_tr_b16 v[20:21], v11 offset:6144
  v_mul_f32 v118, v118, v134
  v_mfma_f32_16x16x32_bf16 v[60:63], v[28:31], a[100:103], v[60:63]
  ds_read_b64_tr_b16 v[22:23], v11 offset:6400
  v_mul_f32 v119, v119, v135
  v_add_f32 v208, 1.0, v208
  v_mfma_f32_16x16x32_bf16 v[64:67], v[28:31], a[172:175], v[64:67]
  v_add_f32 v209, 1.0, v209
  v_add_f32 v210, 1.0, v210
  v_mfma_f32_16x16x32_bf16 v[68:71], v[28:31], a[244:247], v[68:71]
  s_waitcnt lgkmcnt(4)
  buffer_load_dwordx4 v2, s[12:15], s61 offen offset:1024 lds
  v_mfma_f32_16x16x32_bf16 v[40:43], v[32:35], a[32:35], v[40:43]
  ds_read_b64_tr_b16 v[24:25], v11 offset:2048
  v_add_f32 v211, 1.0, v211
  v_add_f32 v212, 1.0, v212
  v_mfma_f32_16x16x32_bf16 v[44:47], v[32:35], a[104:107], v[44:47]
  ds_read_b64_tr_b16 v[26:27], v11 offset:2304
  v_add_f32 v213, 1.0, v213
  v_add_f32 v214, 1.0, v214
  v_mfma_f32_16x16x32_bf16 v[48:51], v[32:35], a[176:179], v[48:51]
  v_add_f32 v215, 1.0, v215
  v_mfma_f32_16x16x32_bf16 v[52:55], v[32:35], a[248:251], v[52:55]
  v_rcp_f32 v208, v208
  v_mfma_f32_16x16x32_bf16 v[56:59], v[36:39], a[32:35], v[56:59]
  ds_read_b64_tr_b16 v[28:29], v11 offset:8192
  v_rcp_f32 v209, v209
  v_mfma_f32_16x16x32_bf16 v[60:63], v[36:39], a[104:107], v[60:63]
  ds_read_b64_tr_b16 v[30:31], v11 offset:8448
  v_rcp_f32 v210, v210
  v_mfma_f32_16x16x32_bf16 v[64:67], v[36:39], a[176:179], v[64:67]
  buffer_load_dwordx4 v2, s[12:15], s62 offen offset:2048 lds
  v_mfma_f32_16x16x32_bf16 v[68:71], v[36:39], a[248:251], v[68:71]
  s_waitcnt lgkmcnt(4)
  v_rcp_f32 v211, v211
  v_mfma_f32_16x16x32_bf16 v[40:43], v[16:19], a[36:39], v[40:43]
  ds_read_b64_tr_b16 v[32:33], v11 offset:4096
  v_rcp_f32 v212, v212
  v_mfma_f32_16x16x32_bf16 v[44:47], v[16:19], a[108:111], v[44:47]
  ds_read_b64_tr_b16 v[34:35], v11 offset:4352
  v_rcp_f32 v213, v213
  v_mfma_f32_16x16x32_bf16 v[48:51], v[16:19], a[180:183], v[48:51]
  v_rcp_f32 v214, v214
  v_mfma_f32_16x16x32_bf16 v[52:55], v[16:19], a[252:255], v[52:55]
  v_rcp_f32 v215, v215
  v_mfma_f32_16x16x32_bf16 v[56:59], v[20:23], a[36:39], v[56:59]
  ds_read_b64_tr_b16 v[36:37], v11 offset:10240
  v_mul_f32 v112, v112, v208
  v_mfma_f32_16x16x32_bf16 v[60:63], v[20:23], a[108:111], v[60:63]
  ds_read_b64_tr_b16 v[38:39], v11 offset:10496
  v_mul_f32 v113, v113, v209
  v_mfma_f32_16x16x32_bf16 v[64:67], v[20:23], a[180:183], v[64:67]
  v_mul_f32 v114, v114, v210
  s_add_u32 m0, s33, 135168
  v_mfma_f32_16x16x32_bf16 v[68:71], v[20:23], a[252:255], v[68:71]
  s_waitcnt lgkmcnt(4)
  v_mul_f32 v115, v115, v211
  v_mfma_f32_16x16x32_bf16 v[40:43], v[24:27], a[40:43], v[40:43]
  ds_read_b64_tr_b16 v[16:17], v11 offset:12288
  v_mul_f32 v116, v116, v212
  v_mul_f32 v117, v117, v213
  v_mfma_f32_16x16x32_bf16 v[44:47], v[24:27], a[112:115], v[44:47]
  ds_read_b64_tr_b16 v[18:19], v11 offset:12544
  v_mul_f32 v118, v118, v214
  v_mfma_f32_16x16x32_bf16 v[48:51], v[24:27], a[184:187], v[48:51]
  v_mul_f32 v119, v119, v215
  v_cvt_pk_bf16_f32 v220, v112, v113
  v_mfma_f32_16x16x32_bf16 v[52:55], v[24:27], v[224:227], v[52:55]
  v_cvt_pk_bf16_f32 v221, v114, v115
  v_cvt_pk_bf16_f32 v222, v116, v117
  v_mfma_f32_16x16x32_bf16 v[56:59], v[28:31], a[40:43], v[56:59]
  ds_read_b64_tr_b16 v[20:21], v11 offset:18432
  buffer_load_dwordx4 v2, s[12:15], s63 offen offset:0 lds
  v_mfma_f32_16x16x32_bf16 v[60:63], v[28:31], a[112:115], v[60:63]
  ds_read_b64_tr_b16 v[22:23], v11 offset:18688
  v_cvt_pk_bf16_f32 v223, v118, v119
  s_add_u32 s30, s29, 294912
  v_mfma_f32_16x16x32_bf16 v[64:67], v[28:31], a[184:187], v[64:67]
  buffer_store_dwordx2 v[220:221], v13, s[16:19], s30 offen offset:0 sc1
  buffer_store_dwordx2 v[222:223], v13, s[16:19], s30 offen offset:256 sc1
  v_mfma_f32_16x16x32_bf16 v[68:71], v[28:31], v[224:227], v[68:71]
  s_waitcnt lgkmcnt(4)
  s_add_u32 s29, s29, 1024
  v_mfma_f32_16x16x32_bf16 v[40:43], v[32:35], a[44:47], v[40:43]
  ds_read_b64_tr_b16 v[24:25], v11 offset:14336
  v_exp_f32 v200, -v136
  v_mfma_f32_16x16x32_bf16 v[44:47], v[32:35], a[116:119], v[44:47]
  ds_read_b64_tr_b16 v[26:27], v11 offset:14592
  v_exp_f32 v201, -v137
  v_mfma_f32_16x16x32_bf16 v[48:51], v[32:35], a[188:191], v[48:51]
  v_exp_f32 v202, -v138
  v_mfma_f32_16x16x32_bf16 v[52:55], v[32:35], v[228:231], v[52:55]
  buffer_load_dwordx4 v2, s[12:15], s64 offen offset:1024 lds
  v_mfma_f32_16x16x32_bf16 v[56:59], v[36:39], a[44:47], v[56:59]
  ds_read_b64_tr_b16 v[28:29], v11 offset:20480
  v_exp_f32 v203, -v139
  v_mfma_f32_16x16x32_bf16 v[60:63], v[36:39], a[116:119], v[60:63]
  ds_read_b64_tr_b16 v[30:31], v11 offset:20736
  v_exp_f32 v204, -v140
  v_mfma_f32_16x16x32_bf16 v[64:67], v[36:39], a[188:191], v[64:67]
  v_exp_f32 v205, -v141
  v_mfma_f32_16x16x32_bf16 v[68:71], v[36:39], v[228:231], v[68:71]
  s_waitcnt lgkmcnt(4)
  v_exp_f32 v206, -v142
  v_mfma_f32_16x16x32_bf16 v[40:43], v[16:19], a[48:51], v[40:43]
  ds_read_b64_tr_b16 v[32:33], v11 offset:16384
  v_mfma_f32_16x16x32_bf16 v[44:47], v[16:19], a[120:123], v[44:47]
  ds_read_b64_tr_b16 v[34:35], v11 offset:16640
  v_exp_f32 v207, -v143
  v_mfma_f32_16x16x32_bf16 v[48:51], v[16:19], a[192:195], v[48:51]
  v_mul_f32 v136, v136, v152
  v_mul_f32 v137, v137, v153
  v_mfma_f32_16x16x32_bf16 v[52:55], v[16:19], v[232:235], v[52:55]
  v_mul_f32 v138, v138, v154
  buffer_load_dwordx4 v2, s[12:15], s65 offen offset:2048 lds
  v_mfma_f32_16x16x32_bf16 v[56:59], v[20:23], a[48:51], v[56:59]
  ds_read_b64_tr_b16 v[36:37], v11 offset:22528
  v_mul_f32 v139, v139, v155
  v_mfma_f32_16x16x32_bf16 v[60:63], v[20:23], a[120:123], v[60:63]
  ds_read_b64_tr_b16 v[38:39], v11 offset:22784
  v_mul_f32 v140, v140, v156
  v_mul_f32 v141, v141, v157
  v_mfma_f32_16x16x32_bf16 v[64:67], v[20:23], a[192:195], v[64:67]
  v_mul_f32 v142, v142, v158
  v_mul_f32 v143, v143, v159
  v_mfma_f32_16x16x32_bf16 v[68:71], v[20:23], v[232:235], v[68:71]
  s_waitcnt lgkmcnt(4)
  v_add_f32 v200, 1.0, v200
  v_mfma_f32_16x16x32_bf16 v[40:43], v[24:27], a[52:55], v[40:43]
  ds_read_b64_tr_b16 v[16:17], v11 offset:24576
  v_add_f32 v201, 1.0, v201
  v_add_f32 v202, 1.0, v202
  v_mfma_f32_16x16x32_bf16 v[44:47], v[24:27], a[124:127], v[44:47]
  ds_read_b64_tr_b16 v[18:19], v11 offset:24832
  v_add_f32 v203, 1.0, v203
  v_mfma_f32_16x16x32_bf16 v[48:51], v[24:27], a[196:199], v[48:51]
  v_add_f32 v204, 1.0, v204
  v_add_f32 v205, 1.0, v205
  v_mfma_f32_16x16x32_bf16 v[52:55], v[24:27], v[236:239], v[52:55]
  v_add_f32 v206, 1.0, v206
  v_add_f32 v207, 1.0, v207
  v_mfma_f32_16x16x32_bf16 v[56:59], v[28:31], a[52:55], v[56:59]
  ds_read_b64_tr_b16 v[20:21], v11 offset:30720
  v_rcp_f32 v200, v200
  v_mfma_f32_16x16x32_bf16 v[60:63], v[28:31], a[124:127], v[60:63]
  ds_read_b64_tr_b16 v[22:23], v11 offset:30976
  v_rcp_f32 v201, v201
  v_mfma_f32_16x16x32_bf16 v[64:67], v[28:31], a[196:199], v[64:67]
  v_rcp_f32 v202, v202
  v_mfma_f32_16x16x32_bf16 v[68:71], v[28:31], v[236:239], v[68:71]
  s_waitcnt lgkmcnt(4)
  v_mfma_f32_16x16x32_bf16 v[40:43], v[32:35], a[56:59], v[40:43]
  ds_read_b64_tr_b16 v[24:25], v11 offset:26624
  v_rcp_f32 v203, v203
  v_mfma_f32_16x16x32_bf16 v[44:47], v[32:35], a[128:131], v[44:47]
  ds_read_b64_tr_b16 v[26:27], v11 offset:26880
  v_rcp_f32 v204, v204
  v_mfma_f32_16x16x32_bf16 v[48:51], v[32:35], a[200:203], v[48:51]
  v_rcp_f32 v205, v205
  v_mfma_f32_16x16x32_bf16 v[52:55], v[32:35], v[240:243], v[52:55]
  v_rcp_f32 v206, v206
  v_mfma_f32_16x16x32_bf16 v[56:59], v[36:39], a[56:59], v[56:59]
  ds_read_b64_tr_b16 v[28:29], v11 offset:32768
  v_rcp_f32 v207, v207
  v_mfma_f32_16x16x32_bf16 v[60:63], v[36:39], a[128:131], v[60:63]
  ds_read_b64_tr_b16 v[30:31], v11 offset:33024
  v_mul_f32 v136, v136, v200
  v_mfma_f32_16x16x32_bf16 v[64:67], v[36:39], a[200:203], v[64:67]
  v_mul_f32 v137, v137, v201
  v_mul_f32 v138, v138, v202
  v_mfma_f32_16x16x32_bf16 v[68:71], v[36:39], v[240:243], v[68:71]
  s_waitcnt lgkmcnt(4)
  v_mul_f32 v139, v139, v203
  v_mfma_f32_16x16x32_bf16 v[40:43], v[16:19], a[60:63], v[40:43]
  ds_read_b64_tr_b16 v[32:33], v11 offset:28672
  v_mul_f32 v140, v140, v204
  v_mfma_f32_16x16x32_bf16 v[44:47], v[16:19], a[132:135], v[44:47]
  ds_read_b64_tr_b16 v[34:35], v11 offset:28928
  v_mul_f32 v141, v141, v205
  v_mul_f32 v142, v142, v206
  v_mfma_f32_16x16x32_bf16 v[48:51], v[16:19], a[204:207], v[48:51]
  v_mul_f32 v143, v143, v207
  v_cvt_pk_bf16_f32 v216, v136, v137
  v_mfma_f32_16x16x32_bf16 v[52:55], v[16:19], v[244:247], v[52:55]
  v_cvt_pk_bf16_f32 v217, v138, v139
  v_cvt_pk_bf16_f32 v218, v140, v141
  v_mfma_f32_16x16x32_bf16 v[56:59], v[20:23], a[60:63], v[56:59]
  ds_read_b64_tr_b16 v[36:37], v11 offset:34816
  v_mfma_f32_16x16x32_bf16 v[60:63], v[20:23], a[132:135], v[60:63]
  ds_read_b64_tr_b16 v[38:39], v11 offset:35072
  v_mfma_f32_16x16x32_bf16 v[64:67], v[20:23], a[204:207], v[64:67]
  v_mfma_f32_16x16x32_bf16 v[68:71], v[20:23], v[244:247], v[68:71]
  s_waitcnt lgkmcnt(4)
  v_mfma_f32_16x16x32_bf16 v[40:43], v[24:27], a[64:67], v[40:43]
  s_waitcnt vmcnt(0)
  s_waitcnt lgkmcnt(0)
  s_barrier
  ds_read_b64_tr_b16 v[16:17], v12 offset:0
  v_mfma_f32_16x16x32_bf16 v[44:47], v[24:27], a[136:139], v[44:47]
  ds_read_b64_tr_b16 v[18:19], v12 offset:256
  v_mfma_f32_16x16x32_bf16 v[48:51], v[24:27], a[208:211], v[48:51]
  v_mfma_f32_16x16x32_bf16 v[52:55], v[24:27], v[248:251], v[52:55]
  v_mfma_f32_16x16x32_bf16 v[56:59], v[28:31], a[64:67], v[56:59]
  ds_read_b64_tr_b16 v[20:21], v12 offset:6144
  v_mfma_f32_16x16x32_bf16 v[60:63], v[28:31], a[136:139], v[60:63]
  ds_read_b64_tr_b16 v[22:23], v12 offset:6400
  v_mfma_f32_16x16x32_bf16 v[64:67], v[28:31], a[208:211], v[64:67]
  v_mfma_f32_16x16x32_bf16 v[68:71], v[28:31], v[248:251], v[68:71]
  s_waitcnt lgkmcnt(4)
  v_mfma_f32_16x16x32_bf16 v[40:43], v[32:35], a[68:71], v[40:43]
  ds_read_b64_tr_b16 v[24:25], v12 offset:2048
  v_mfma_f32_16x16x32_bf16 v[44:47], v[32:35], a[140:143], v[44:47]
  ds_read_b64_tr_b16 v[26:27], v12 offset:2304
  v_mfma_f32_16x16x32_bf16 v[48:51], v[32:35], a[212:215], v[48:51]
  v_mfma_f32_16x16x32_bf16 v[52:55], v[32:35], v[252:255], v[52:55]
  v_mfma_f32_16x16x32_bf16 v[56:59], v[36:39], a[68:71], v[56:59]
  ds_read_b64_tr_b16 v[28:29], v12 offset:8192
  v_mfma_f32_16x16x32_bf16 v[60:63], v[36:39], a[140:143], v[60:63]
  ds_read_b64_tr_b16 v[30:31], v12 offset:8448
  v_mfma_f32_16x16x32_bf16 v[64:67], v[36:39], a[212:215], v[64:67]
  v_mfma_f32_16x16x32_bf16 v[68:71], v[36:39], v[252:255], v[68:71]
  s_waitcnt lgkmcnt(4)
  v_cvt_pk_bf16_f32 v219, v142, v143
  buffer_store_dwordx2 v[216:217], v13, s[16:19], s29 offen offset:0 sc1
  buffer_store_dwordx2 v[218:219], v13, s[16:19], s29 offen offset:256 sc1
  v_exp_f32 v208, -v144
  s_branch k1_ffn
k1_vpath:
  s_mul_i32 s37, s38, 576
  s_add_u32 s37, s37, 7077888
  ds_read_b64_tr_b16 v[16:17], v5 offset:0
  ds_read_b64_tr_b16 v[18:19], v5 offset:512
  ds_read_b64_tr_b16 v[20:21], v6 offset:0
  ds_read_b64_tr_b16 v[22:23], v6 offset:512
  ds_read_b64_tr_b16 v[24:25], v7 offset:0
  ds_read_b64_tr_b16 v[26:27], v7 offset:512
  ds_read_b64_tr_b16 v[28:29], v8 offset:0
  ds_read_b64_tr_b16 v[30:31], v8 offset:512
  s_waitcnt lgkmcnt(4)
  v_mfma_f32_16x16x32_bf16 v[40:43], a[0:3], v[16:19], 0
  ds_read_b64_tr_b16 v[32:33], v11 offset:0
  s_add_u32 m0, s35, 24576
  v_mfma_f32_16x16x32_bf16 v[44:47], a[72:75], v[16:19], 0
  ds_read_b64_tr_b16 v[34:35], v11 offset:256
  s_add_u32 s25, s34, 663552
  v_mfma_f32_16x16x32_bf16 v[48:51], a[144:147], v[16:19], 0
  buffer_load_dwordx4 v3, s[8:11], s25 offen lds
  v_mfma_f32_16x16x32_bf16 v[52:55], a[216:219], v[16:19], 0
  v_mfma_f32_16x16x32_bf16 v[56:59], a[0:3], v[20:23], 0
  ds_read_b64_tr_b16 v[36:37], v11 offset:6144
  v_mfma_f32_16x16x32_bf16 v[60:63], a[72:75], v[20:23], 0
  ds_read_b64_tr_b16 v[38:39], v11 offset:6400
  s_add_u32 m0, s35, 25600
  v_mfma_f32_16x16x32_bf16 v[64:67], a[144:147], v[20:23], 0
  v_mfma_f32_16x16x32_bf16 v[68:71], a[216:219], v[20:23], 0
  s_waitcnt lgkmcnt(4)
  v_mfma_f32_16x16x32_bf16 v[72:75], a[0:3], v[24:27], 0
  ds_read_b64_tr_b16 v[16:17], v12 offset:0
  s_add_u32 s25, s34, 691200
  v_mfma_f32_16x16x32_bf16 v[76:79], a[72:75], v[24:27], 0
  ds_read_b64_tr_b16 v[18:19], v12 offset:256
  v_mfma_f32_16x16x32_bf16 v[80:83], a[144:147], v[24:27], 0
  v_mfma_f32_16x16x32_bf16 v[84:87], a[216:219], v[24:27], 0
  buffer_load_dwordx4 v4, s[8:11], s25 offen lds
  v_mfma_f32_16x16x32_bf16 v[88:91], a[0:3], v[28:31], 0
  ds_read_b64_tr_b16 v[20:21], v12 offset:6144
  v_mfma_f32_16x16x32_bf16 v[92:95], a[72:75], v[28:31], 0
  ds_read_b64_tr_b16 v[22:23], v12 offset:6400
  s_add_u32 m0, s35, 26624
  v_mfma_f32_16x16x32_bf16 v[96:99], a[144:147], v[28:31], 0
  v_mfma_f32_16x16x32_bf16 v[100:103], a[216:219], v[28:31], 0
  s_waitcnt lgkmcnt(4)
  v_mfma_f32_16x16x32_bf16 v[104:107], v[32:35], a[0:3], 0
  ds_read_b64_tr_b16 v[24:25], v5 offset:4096
  s_add_u32 s25, s34, 718848
  v_mfma_f32_16x16x32_bf16 v[108:111], v[32:35], a[72:75], 0
  ds_read_b64_tr_b16 v[26:27], v5 offset:4608
  v_mfma_f32_16x16x32_bf16 v[112:115], v[32:35], a[144:147], 0
  v_mfma_f32_16x16x32_bf16 v[116:119], v[32:35], a[216:219], 0
  buffer_load_dwordx4 v3, s[8:11], s25 offen lds
  v_mfma_f32_16x16x32_bf16 v[120:123], v[36:39], a[0:3], 0
  ds_read_b64_tr_b16 v[28:29], v6 offset:4096
  v_mfma_f32_16x16x32_bf16 v[124:127], v[36:39], a[72:75], 0
  ds_read_b64_tr_b16 v[30:31], v6 offset:4608
  v_mfma_f32_16x16x32_bf16 v[128:131], v[36:39], a[144:147], 0
  s_add_u32 m0, s33, 98304
  v_mfma_f32_16x16x32_bf16 v[132:135], v[36:39], a[216:219], 0
  s_waitcnt lgkmcnt(4)
  v_mfma_f32_16x16x32_bf16 v[136:139], v[16:19], a[0:3], 0
  ds_read_b64_tr_b16 v[32:33], v7 offset:4096
  buffer_load_dwordx4 v2, s[12:15], s54 offen offset:0 lds
  v_mfma_f32_16x16x32_bf16 v[140:143], v[16:19], a[72:75], 0
  ds_read_b64_tr_b16 v[34:35], v7 offset:4608
  v_mfma_f32_16x16x32_bf16 v[144:147], v[16:19], a[144:147], 0
  v_mfma_f32_16x16x32_bf16 v[148:151], v[16:19], a[216:219], 0
  buffer_load_dwordx4 v2, s[12:15], s55 offen offset:1024 lds
  v_mfma_f32_16x16x32_bf16 v[152:155], v[20:23], a[0:3], 0
  ds_read_b64_tr_b16 v[36:37], v8 offset:4096
  v_mfma_f32_16x16x32_bf16 v[156:159], v[20:23], a[72:75], 0
  ds_read_b64_tr_b16 v[38:39], v8 offset:4608
  v_mfma_f32_16x16x32_bf16 v[160:163], v[20:23], a[144:147], 0
  buffer_load_dwordx4 v2, s[12:15], s56 offen offset:2048 lds
  v_mfma_f32_16x16x32_bf16 v[164:167], v[20:23], a[216:219], 0
  s_waitcnt lgkmcnt(4)
  v_mfma_f32_16x16x32_bf16 v[40:43], a[4:7], v[24:27], v[40:43]
  ds_read_b64_tr_b16 v[16:17], v11 offset:2048
  v_mfma_f32_16x16x32_bf16 v[44:47], a[76:79], v[24:27], v[44:47]
  ds_read_b64_tr_b16 v[18:19], v11 offset:2304
  s_add_u32 s28, s39, 6144
  v_mfma_f32_16x16x32_bf16 v[48:51], a[148:151], v[24:27], v[48:51]
  v_mfma_f32_16x16x32_bf16 v[52:55], a[220:223], v[24:27], v[52:55]
  buffer_load_dwordx4 a[24:27], v15, s[16:19], s28 offen offset:0
  v_mfma_f32_16x16x32_bf16 v[56:59], a[4:7], v[28:31], v[56:59]
  ds_read_b64_tr_b16 v[20:21], v11 offset:8192
  v_mfma_f32_16x16x32_bf16 v[60:63], a[76:79], v[28:31], v[60:63]
  ds_read_b64_tr_b16 v[22:23], v11 offset:8448
  v_mfma_f32_16x16x32_bf16 v[64:67], a[148:151], v[28:31], v[64:67]
  buffer_load_dwordx4 a[28:31], v15, s[16:19], s28 offen offset:1024
  v_mfma_f32_16x16x32_bf16 v[68:71], a[220:223], v[28:31], v[68:71]
  s_waitcnt lgkmcnt(4)
  v_mfma_f32_16x16x32_bf16 v[72:75], a[4:7], v[32:35], v[72:75]
  ds_read_b64_tr_b16 v[24:25], v12 offset:2048
  v_mfma_f32_16x16x32_bf16 v[76:79], a[76:79], v[32:35], v[76:79]
  ds_read_b64_tr_b16 v[26:27], v12 offset:2304
  buffer_load_dwordx4 a[32:35], v15, s[16:19], s28 offen offset:2048
  v_mfma_f32_16x16x32_bf16 v[80:83], a[148:151], v[32:35], v[80:83]
  v_mfma_f32_16x16x32_bf16 v[84:87], a[220:223], v[32:35], v[84:87]
  v_mfma_f32_16x16x32_bf16 v[88:91], a[4:7], v[36:39], v[88:91]
  ds_read_b64_tr_b16 v[28:29], v12 offset:8192
  s_add_u32 s28, s39, 24576
  v_mfma_f32_16x16x32_bf16 v[92:95], a[76:79], v[36:39], v[92:95]
  ds_read_b64_tr_b16 v[30:31], v12 offset:8448
  v_mfma_f32_16x16x32_bf16 v[96:99], a[148:151], v[36:39], v[96:99]
  buffer_load_dwordx4 a[96:99], v15, s[16:19], s28 offen offset:0
  v_mfma_f32_16x16x32_bf16 v[100:103], a[220:223], v[36:39], v[100:103]
  s_waitcnt lgkmcnt(4)
  v_mfma_f32_16x16x32_bf16 v[104:107], v[16:19], a[4:7], v[104:107]
  ds_read_b64_tr_b16 v[32:33], v5 offset:8192
  v_mfma_f32_16x16x32_bf16 v[108:111], v[16:19], a[76:79], v[108:111]
  ds_read_b64_tr_b16 v[34:35], v5 offset:8704
  buffer_load_dwordx4 a[100:103], v15, s[16:19], s28 offen offset:1024
  v_mfma_f32_16x16x32_bf16 v[112:115], v[16:19], a[148:151], v[112:115]
  v_mfma_f32_16x16x32_bf16 v[116:119], v[16:19], a[220:223], v[116:119]
  v_mfma_f32_16x16x32_bf16 v[120:123], v[20:23], a[4:7], v[120:123]
  ds_read_b64_tr_b16 v[36:37], v6 offset:8192
  buffer_load_dwordx4 a[104:107], v15, s[16:19], s28 offen offset:2048
  v_mfma_f32_16x16x32_bf16 v[124:127], v[20:23], a[76:79], v[124:127]
  ds_read_b64_tr_b16 v[38:39], v6 offset:8704
  v_mfma_f32_16x16x32_bf16 v[128:131], v[20:23], a[148:151], v[128:131]
  v_mfma_f32_16x16x32_bf16 v[132:135], v[20:23], a[220:223], v[132:135]
  s_waitcnt lgkmcnt(4)
  s_add_u32 s28, s39, 43008
  v_mfma_f32_16x16x32_bf16 v[136:139], v[24:27], a[4:7], v[136:139]
  ds_read_b64_tr_b16 v[16:17], v7 offset:8192
  v_mfma_f32_16x16x32_bf16 v[140:143], v[24:27], a[76:79], v[140:143]
  ds_read_b64_tr_b16 v[18:19], v7 offset:8704
  buffer_load_dwordx4 a[168:171], v15, s[16:19], s28 offen offset:0
  v_mfma_f32_16x16x32_bf16 v[144:147], v[24:27], a[148:151], v[144:147]
  v_mfma_f32_16x16x32_bf16 v[148:151], v[24:27], a[220:223], v[148:151]
  v_mfma_f32_16x16x32_bf16 v[152:155], v[28:31], a[4:7], v[152:155]
  ds_read_b64_tr_b16 v[20:21], v8 offset:8192
  buffer_load_dwordx4 a[172:175], v15, s[16:19], s28 offen offset:1024
  v_mfma_f32_16x16x32_bf16 v[156:159], v[28:31], a[76:79], v[156:159]
  ds_read_b64_tr_b16 v[22:23], v8 offset:8704
  v_mfma_f32_16x16x32_bf16 v[160:163], v[28:31], a[148:151], v[160:163]
  v_mfma_f32_16x16x32_bf16 v[164:167], v[28:31], a[220:223], v[164:167]
  s_waitcnt lgkmcnt(4)
  buffer_load_dwordx4 a[176:179], v15, s[16:19], s28 offen offset:2048
  v_mfma_f32_16x16x32_bf16 v[40:43], a[8:11], v[32:35], v[40:43]
  ds_read_b64_tr_b16 v[24:25], v11 offset:4096
  v_mfma_f32_16x16x32_bf16 v[44:47], a[80:83], v[32:35], v[44:47]
  ds_read_b64_tr_b16 v[26:27], v11 offset:4352
  v_mfma_f32_16x16x32_bf16 v[48:51], a[152:155], v[32:35], v[48:51]
  s_add_u32 s28, s39, 61440
  v_mfma_f32_16x16x32_bf16 v[52:55], a[224:227], v[32:35], v[52:55]
  v_mfma_f32_16x16x32_bf16 v[56:59], a[8:11], v[36:39], v[56:59]
  ds_read_b64_tr_b16 v[28:29], v11 offset:10240
  buffer_load_dwordx4 a[240:243], v15, s[16:19], s28 offen offset:0
  v_mfma_f32_16x16x32_bf16 v[60:63], a[80:83], v[36:39], v[60:63]
  ds_read_b64_tr_b16 v[30:31], v11 offset:10496
  v_mfma_f32_16x16x32_bf16 v[64:67], a[152:155], v[36:39], v[64:67]
  v_mfma_f32_16x16x32_bf16 v[68:71], a[224:227], v[36:39], v[68:71]
  s_waitcnt lgkmcnt(4)
  buffer_load_dwordx4 a[244:247], v15, s[16:19], s28 offen offset:1024
  v_mfma_f32_16x16x32_bf16 v[72:75], a[8:11], v[16:19], v[72:75]
  ds_read_b64_tr_b16 v[32:33], v12 offset:4096
  v_mfma_f32_16x16x32_bf16 v[76:79], a[80:83], v[16:19], v[76:79]
  ds_read_b64_tr_b16 v[34:35], v12 offset:4352
  v_mfma_f32_16x16x32_bf16 v[80:83], a[152:155], v[16:19], v[80:83]
  buffer_load_dwordx4 a[248:251], v15, s[16:19], s28 offen offset:2048
  v_mfma_f32_16x16x32_bf16 v[84:87], a[224:227], v[16:19], v[84:87]
  v_mfma_f32_16x16x32_bf16 v[88:91], a[8:11], v[20:23], v[88:91]
  ds_read_b64_tr_b16 v[36:37], v12 offset:10240
  v_mfma_f32_16x16x32_bf16 v[92:95], a[80:83], v[20:23], v[92:95]
  ds_read_b64_tr_b16 v[38:39], v12 offset:10496
  v_mfma_f32_16x16x32_bf16 v[96:99], a[152:155], v[20:23], v[96:99]
  v_mfma_f32_16x16x32_bf16 v[100:103], a[224:227], v[20:23], v[100:103]
  s_waitcnt lgkmcnt(4)
  v_mfma_f32_16x16x32_bf16 v[104:107], v[24:27], a[8:11], v[104:107]
  s_waitcnt vmcnt(18)
  s_barrier
  ds_read_b64_tr_b16 v[16:17], v5 offset:12288
  v_mfma_f32_16x16x32_bf16 v[108:111], v[24:27], a[80:83], v[108:111]
  ds_read_b64_tr_b16 v[18:19], v5 offset:12800
  v_mfma_f32_16x16x32_bf16 v[112:115], v[24:27], a[152:155], v[112:115]
  v_mfma_f32_16x16x32_bf16 v[116:119], v[24:27], a[224:227], v[116:119]
  v_mfma_f32_16x16x32_bf16 v[120:123], v[28:31], a[8:11], v[120:123]
  ds_read_b64_tr_b16 v[20:21], v6 offset:12288
  v_mfma_f32_16x16x32_bf16 v[124:127], v[28:31], a[80:83], v[124:127]
  ds_read_b64_tr_b16 v[22:23], v6 offset:12800
  v_mfma_f32_16x16x32_bf16 v[128:131], v[28:31], a[152:155], v[128:131]
  v_mfma_f32_16x16x32_bf16 v[132:135], v[28:31], a[224:227], v[132:135]
  s_waitcnt lgkmcnt(4)
  v_mfma_f32_16x16x32_bf16 v[136:139], v[32:35], a[8:11], v[136:139]
  ds_read_b64_tr_b16 v[24:25], v7 offset:12288
  v_mfma_f32_16x16x32_bf16 v[140:143], v[32:35], a[80:83], v[140:143]
  ds_read_b64_tr_b16 v[26:27], v7 offset:12800
  v_mfma_f32_16x16x32_bf16 v[144:147], v[32:35], a[152:155], v[144:147]
  v_mfma_f32_16x16x32_bf16 v[148:151], v[32:35], a[224:227], v[148:151]
  v_mfma_f32_16x16x32_bf16 v[152:155], v[36:39], a[8:11], v[152:155]
  ds_read_b64_tr_b16 v[28:29], v8 offset:12288
  v_mfma_f32_16x16x32_bf16 v[156:159], v[36:39], a[80:83], v[156:159]
  ds_read_b64_tr_b16 v[30:31], v8 offset:12800
  v_mfma_f32_16x16x32_bf16 v[160:163], v[36:39], a[152:155], v[160:163]
  v_mfma_f32_16x16x32_bf16 v[164:167], v[36:39], a[224:227], v[164:167]
  s_waitcnt lgkmcnt(4)
  v_mfma_f32_16x16x32_bf16 v[40:43], a[12:15], v[16:19], v[40:43]
  ds_read_b64_tr_b16 v[32:33], v11 offset:12288
  s_add_u32 m0, s35, 36864
  v_mfma_f32_16x16x32_bf16 v[44:47], a[84:87], v[16:19], v[44:47]
  ds_read_b64_tr_b16 v[34:35], v11 offset:12544
  s_add_u32 s25, s34, 995328
  v_mfma_f32_16x16x32_bf16 v[48:51], a[156:159], v[16:19], v[48:51]
  buffer_load_dwordx4 v3, s[8:11], s25 offen lds
  v_mfma_f32_16x16x32_bf16 v[52:55], a[228:231], v[16:19], v[52:55]
  v_mfma_f32_16x16x32_bf16 v[56:59], a[12:15], v[20:23], v[56:59]
  ds_read_b64_tr_b16 v[36:37], v11 offset:18432
  v_mfma_f32_16x16x32_bf16 v[60:63], a[84:87], v[20:23], v[60:63]
  ds_read_b64_tr_b16 v[38:39], v11 offset:18688
  s_add_u32 m0, s35, 37888
  v_mfma_f32_16x16x32_bf16 v[64:67], a[156:159], v[20:23], v[64:67]
  v_mfma_f32_16x16x32_bf16 v[68:71], a[228:231], v[20:23], v[68:71]
  s_waitcnt lgkmcnt(4)
  v_mfma_f32_16x16x32_bf16 v[72:75], a[12:15], v[24:27], v[72:75]
  ds_read_b64_tr_b16 v[16:17], v12 offset:12288
  s_add_u32 s25, s34, 1022976
  v_mfma_f32_16x16x32_bf16 v[76:79], a[84:87], v[24:27], v[76:79]
  ds_read_b64_tr_b16 v[18:19], v12 offset:12544
  v_mfma_f32_16x16x32_bf16 v[80:83], a[156:159], v[24:27], v[80:83]
  v_mfma_f32_16x16x32_bf16 v[84:87], a[228:231], v[24:27], v[84:87]
  buffer_load_dwordx4 v4, s[8:11], s25 offen lds
  v_mfma_f32_16x16x32_bf16 v[88:91], a[12:15], v[28:31], v[88:91]
  ds_read_b64_tr_b16 v[20:21], v12 offset:18432
  v_mfma_f32_16x16x32_bf16 v[92:95], a[84:87], v[28:31], v[92:95]
  ds_read_b64_tr_b16 v[22:23], v12 offset:18688
  s_add_u32 m0, s35, 38912
  v_mfma_f32_16x16x32_bf16 v[96:99], a[156:159], v[28:31], v[96:99]
  v_mfma_f32_16x16x32_bf16 v[100:103], a[228:231], v[28:31], v[100:103]
  s_waitcnt lgkmcnt(4)
  v_mfma_f32_16x16x32_bf16 v[104:107], v[32:35], a[12:15], v[104:107]
  ds_read_b64_tr_b16 v[24:25], v5 offset:16384
  s_add_u32 s25, s34, 1050624
  v_mfma_f32_16x16x32_bf16 v[108:111], v[32:35], a[84:87], v[108:111]
  ds_read_b64_tr_b16 v[26:27], v5 offset:16896
  v_mfma_f32_16x16x32_bf16 v[112:115], v[32:35], a[156:159], v[112:115]
  v_mfma_f32_16x16x32_bf16 v[116:119], v[32:35], a[228:231], v[116:119]
  buffer_load_dwordx4 v3, s[8:11], s25 offen lds
  v_mfma_f32_16x16x32_bf16 v[120:123], v[36:39], a[12:15], v[120:123]
  ds_read_b64_tr_b16 v[28:29], v6 offset:16384
  v_mfma_f32_16x16x32_bf16 v[124:127], v[36:39], a[84:87], v[124:127]
  ds_read_b64_tr_b16 v[30:31], v6 offset:16896
  v_mfma_f32_16x16x32_bf16 v[128:131], v[36:39], a[156:159], v[128:131]
  s_add_u32 m0, s33, 110592
  v_mfma_f32_16x16x32_bf16 v[132:135], v[36:39], a[228:231], v[132:135]
  s_waitcnt lgkmcnt(4)
  v_mfma_f32_16x16x32_bf16 v[136:139], v[16:19], a[12:15], v[136:139]
  ds_read_b64_tr_b16 v[32:33], v7 offset:16384
  buffer_load_dwordx4 v2, s[12:15], s57 offen offset:0 lds
  v_mfma_f32_16x16x32_bf16 v[140:143], v[16:19], a[84:87], v[140:143]
  ds_read_b64_tr_b16 v[34:35], v7 offset:16896
  v_mfma_f32_16x16x32_bf16 v[144:147], v[16:19], a[156:159], v[144:147]
  v_mfma_f32_16x16x32_bf16 v[148:151], v[16:19], a[228:231], v[148:151]
  buffer_load_dwordx4 v2, s[12:15], s58 offen offset:1024 lds
  v_mfma_f32_16x16x32_bf16 v[152:155], v[20:23], a[12:15], v[152:155]
  ds_read_b64_tr_b16 v[36:37], v8 offset:16384
  v_mfma_f32_16x16x32_bf16 v[156:159], v[20:23], a[84:87], v[156:159]
  ds_read_b64_tr_b16 v[38:39], v8 offset:16896
  v_mfma_f32_16x16x32_bf16 v[160:163], v[20:23], a[156:159], v[160:163]
  buffer_load_dwordx4 v2, s[12:15], s59 offen offset:2048 lds
  v_mfma_f32_16x16x32_bf16 v[164:167], v[20:23], a[228:231], v[164:167]
  s_waitcnt lgkmcnt(4)
  v_mfma_f32_16x16x32_bf16 v[40:43], a[16:19], v[24:27], v[40:43]
  ds_read_b64_tr_b16 v[16:17], v11 offset:14336
  v_mfma_f32_16x16x32_bf16 v[44:47], a[88:91], v[24:27], v[44:47]
  ds_read_b64_tr_b16 v[18:19], v11 offset:14592
  s_add_u32 s28, s39, 9216
  v_mfma_f32_16x16x32_bf16 v[48:51], a[160:163], v[24:27], v[48:51]
  v_mfma_f32_16x16x32_bf16 v[52:55], a[232:235], v[24:27], v[52:55]
  buffer_load_dwordx4 a[36:39], v15, s[16:19], s28 offen offset:0
  v_mfma_f32_16x16x32_bf16 v[56:59], a[16:19], v[28:31], v[56:59]
  ds_read_b64_tr_b16 v[20:21], v11 offset:20480
  v_mfma_f32_16x16x32_bf16 v[60:63], a[88:91], v[28:31], v[60:63]
  ds_read_b64_tr_b16 v[22:23], v11 offset:20736
  v_mfma_f32_16x16x32_bf16 v[64:67], a[160:163], v[28:31], v[64:67]
  buffer_load_dwordx4 a[40:43], v15, s[16:19], s28 offen offset:1024
  v_mfma_f32_16x16x32_bf16 v[68:71], a[232:235], v[28:31], v[68:71]
  s_waitcnt lgkmcnt(4)
  v_mfma_f32_16x16x32_bf16 v[72:75], a[16:19], v[32:35], v[72:75]
  ds_read_b64_tr_b16 v[24:25], v12 offset:14336
  v_mfma_f32_16x16x32_bf16 v[76:79], a[88:91], v[32:35], v[76:79]
  ds_read_b64_tr_b16 v[26:27], v12 offset:14592
  buffer_load_dwordx4 a[44:47], v15, s[16:19], s28 offen offset:2048
  v_mfma_f32_16x16x32_bf16 v[80:83], a[160:163], v[32:35], v[80:83]
  v_mfma_f32_16x16x32_bf16 v[84:87], a[232:235], v[32:35], v[84:87]
  v_mfma_f32_16x16x32_bf16 v[88:91], a[16:19], v[36:39], v[88:91]
  ds_read_b64_tr_b16 v[28:29], v12 offset:20480
  s_add_u32 s28, s39, 27648
  v_mfma_f32_16x16x32_bf16 v[92:95], a[88:91], v[36:39], v[92:95]
  ds_read_b64_tr_b16 v[30:31], v12 offset:20736
  v_mfma_f32_16x16x32_bf16 v[96:99], a[160:163], v[36:39], v[96:99]
  buffer_load_dwordx4 a[108:111], v15, s[16:19], s28 offen offset:0
  v_mfma_f32_16x16x32_bf16 v[100:103], a[232:235], v[36:39], v[100:103]
  s_waitcnt lgkmcnt(4)
  v_mfma_f32_16x16x32_bf16 v[104:107], v[16:19], a[16:19], v[104:107]
  ds_read_b64_tr_b16 v[32:33], v5 offset:20480
  v_mfma_f32_16x16x32_bf16 v[108:111], v[16:19], a[88:91], v[108:111]
  ds_read_b64_tr_b16 v[34:35], v5 offset:20992
  buffer_load_dwordx4 a[112:115], v15, s[16:19], s28 offen offset:1024
  v_mfma_f32_16x16x32_bf16 v[112:115], v[16:19], a[160:163], v[112:115]
  v_mfma_f32_16x16x32_bf16 v[116:119], v[16:19], a[232:235], v[116:119]
  v_mfma_f32_16x16x32_bf16 v[120:123], v[20:23], a[16:19], v[120:123]
  ds_read_b64_tr_b16 v[36:37], v6 offset:20480
  buffer_load_dwordx4 a[116:119], v15, s[16:19], s28 offen offset:2048
  v_mfma_f32_16x16x32_bf16 v[124:127], v[20:23], a[88:91], v[124:127]
  ds_read_b64_tr_b16 v[38:39], v6 offset:20992
  v_mfma_f32_16x16x32_bf16 v[128:131], v[20:23], a[160:163], v[128:131]
  v_mfma_f32_16x16x32_bf16 v[132:135], v[20:23], a[232:235], v[132:135]
  s_waitcnt lgkmcnt(4)
  s_add_u32 s28, s39, 46080
  v_mfma_f32_16x16x32_bf16 v[136:139], v[24:27], a[16:19], v[136:139]
  ds_read_b64_tr_b16 v[16:17], v7 offset:20480
  v_mfma_f32_16x16x32_bf16 v[140:143], v[24:27], a[88:91], v[140:143]
  ds_read_b64_tr_b16 v[18:19], v7 offset:20992
  buffer_load_dwordx4 a[180:183], v15, s[16:19], s28 offen offset:0
  v_mfma_f32_16x16x32_bf16 v[144:147], v[24:27], a[160:163], v[144:147]
  v_mfma_f32_16x16x32_bf16 v[148:151], v[24:27], a[232:235], v[148:151]
  v_mfma_f32_16x16x32_bf16 v[152:155], v[28:31], a[16:19], v[152:155]
  ds_read_b64_tr_b16 v[20:21], v8 offset:20480
  buffer_load_dwordx4 a[184:187], v15, s[16:19], s28 offen offset:1024
  v_mfma_f32_16x16x32_bf16 v[156:159], v[28:31], a[88:91], v[156:159]
  ds_read_b64_tr_b16 v[22:23], v8 offset:20992
  v_mfma_f32_16x16x32_bf16 v[160:163], v[28:31], a[160:163], v[160:163]
  v_mfma_f32_16x16x32_bf16 v[164:167], v[28:31], a[232:235], v[164:167]
  s_waitcnt lgkmcnt(4)
  buffer_load_dwordx4 a[188:191], v15, s[16:19], s28 offen offset:2048
  v_mfma_f32_16x16x32_bf16 v[40:43], a[20:23], v[32:35], v[40:43]
  ds_read_b64_tr_b16 v[24:25], v11 offset:16384
  v_mfma_f32_16x16x32_bf16 v[44:47], a[92:95], v[32:35], v[44:47]
  ds_read_b64_tr_b16 v[26:27], v11 offset:16640
  v_mfma_f32_16x16x32_bf16 v[48:51], a[164:167], v[32:35], v[48:51]
  s_add_u32 s28, s39, 64512
  v_mfma_f32_16x16x32_bf16 v[52:55], a[236:239], v[32:35], v[52:55]
  v_mfma_f32_16x16x32_bf16 v[56:59], a[20:23], v[36:39], v[56:59]
  ds_read_b64_tr_b16 v[28:29], v11 offset:22528
  buffer_load_dwordx4 a[252:255], v15, s[16:19], s28 offen offset:0
  v_mfma_f32_16x16x32_bf16 v[60:63], a[92:95], v[36:39], v[60:63]
  ds_read_b64_tr_b16 v[30:31], v11 offset:22784
  v_mfma_f32_16x16x32_bf16 v[64:67], a[164:167], v[36:39], v[64:67]
  v_mfma_f32_16x16x32_bf16 v[68:71], a[236:239], v[36:39], v[68:71]
  s_waitcnt lgkmcnt(4)
  buffer_load_dwordx4 v[224:227], v15, s[16:19], s28 offen offset:1024
  v_mfma_f32_16x16x32_bf16 v[72:75], a[20:23], v[16:19], v[72:75]
  ds_read_b64_tr_b16 v[32:33], v12 offset:16384
  v_mfma_f32_16x16x32_bf16 v[76:79], a[92:95], v[16:19], v[76:79]
  ds_read_b64_tr_b16 v[34:35], v12 offset:16640
  v_mfma_f32_16x16x32_bf16 v[80:83], a[164:167], v[16:19], v[80:83]
  buffer_load_dwordx4 v[228:231], v15, s[16:19], s28 offen offset:2048
  v_mfma_f32_16x16x32_bf16 v[84:87], a[236:239], v[16:19], v[84:87]
  v_mfma_f32_16x16x32_bf16 v[88:91], a[20:23], v[20:23], v[88:91]
  ds_read_b64_tr_b16 v[36:37], v12 offset:22528
  v_mfma_f32_16x16x32_bf16 v[92:95], a[92:95], v[20:23], v[92:95]
  ds_read_b64_tr_b16 v[38:39], v12 offset:22784
  v_mfma_f32_16x16x32_bf16 v[96:99], a[164:167], v[20:23], v[96:99]
  v_mfma_f32_16x16x32_bf16 v[100:103], a[236:239], v[20:23], v[100:103]
  s_waitcnt lgkmcnt(4)
  v_mfma_f32_16x16x32_bf16 v[104:107], v[24:27], a[20:23], v[104:107]
  s_waitcnt vmcnt(18)
  s_barrier
  ds_read_b64_tr_b16 v[16:17], v5 offset:24576
  v_mfma_f32_16x16x32_bf16 v[108:111], v[24:27], a[92:95], v[108:111]
  ds_read_b64_tr_b16 v[18:19], v5 offset:25088
  v_mfma_f32_16x16x32_bf16 v[112:115], v[24:27], a[164:167], v[112:115]
  v_mfma_f32_16x16x32_bf16 v[116:119], v[24:27], a[236:239], v[116:119]
  v_mfma_f32_16x16x32_bf16 v[120:123], v[28:31], a[20:23], v[120:123]
  ds_read_b64_tr_b16 v[20:21], v6 offset:24576
  v_mfma_f32_16x16x32_bf16 v[124:127], v[28:31], a[92:95], v[124:127]
  ds_read_b64_tr_b16 v[22:23], v6 offset:25088
  v_mfma_f32_16x16x32_bf16 v[128:131], v[28:31], a[164:167], v[128:131]
  v_mfma_f32_16x16x32_bf16 v[132:135], v[28:31], a[236:239], v[132:135]
  s_waitcnt lgkmcnt(4)
  v_mfma_f32_16x16x32_bf16 v[136:139], v[32:35], a[20:23], v[136:139]
  ds_read_b64_tr_b16 v[24:25], v7 offset:24576
  v_mfma_f32_16x16x32_bf16 v[140:143], v[32:35], a[92:95], v[140:143]
  ds_read_b64_tr_b16 v[26:27], v7 offset:25088
  v_mfma_f32_16x16x32_bf16 v[144:147], v[32:35], a[164:167], v[144:147]
  v_mfma_f32_16x16x32_bf16 v[148:151], v[32:35], a[236:239], v[148:151]
  v_mfma_f32_16x16x32_bf16 v[152:155], v[36:39], a[20:23], v[152:155]
  ds_read_b64_tr_b16 v[28:29], v8 offset:24576
  v_mfma_f32_16x16x32_bf16 v[156:159], v[36:39], a[92:95], v[156:159]
  ds_read_b64_tr_b16 v[30:31], v8 offset:25088
  v_mfma_f32_16x16x32_bf16 v[160:163], v[36:39], a[164:167], v[160:163]
  v_mfma_f32_16x16x32_bf16 v[164:167], v[36:39], a[236:239], v[164:167]
  s_waitcnt lgkmcnt(4)
  v_mfma_f32_16x16x32_bf16 v[40:43], a[24:27], v[16:19], v[40:43]
  ds_read_b64_tr_b16 v[32:33], v11 offset:24576
  s_add_u32 m0, s35, 49152
  v_mfma_f32_16x16x32_bf16 v[44:47], a[96:99], v[16:19], v[44:47]
  ds_read_b64_tr_b16 v[34:35], v11 offset:24832
  s_add_u32 s25, s34, 1327104
  v_mfma_f32_16x16x32_bf16 v[48:51], a[168:171], v[16:19], v[48:51]
  buffer_load_dwordx4 v3, s[8:11], s25 offen lds
  v_mfma_f32_16x16x32_bf16 v[52:55], a[240:243], v[16:19], v[52:55]
  v_mfma_f32_16x16x32_bf16 v[56:59], a[24:27], v[20:23], v[56:59]
  ds_read_b64_tr_b16 v[36:37], v11 offset:30720
  s_add_u32 m0, s35, 50176
  v_mfma_f32_16x16x32_bf16 v[60:63], a[96:99], v[20:23], v[60:63]
  ds_read_b64_tr_b16 v[38:39], v11 offset:30976
  v_mfma_f32_16x16x32_bf16 v[64:67], a[168:171], v[20:23], v[64:67]
  v_mfma_f32_16x16x32_bf16 v[68:71], a[240:243], v[20:23], v[68:71]
  s_waitcnt lgkmcnt(4)
  s_add_u32 s25, s34, 1354752
  v_mfma_f32_16x16x32_bf16 v[72:75], a[24:27], v[24:27], v[72:75]
  ds_read_b64_tr_b16 v[16:17], v12 offset:24576
  v_mfma_f32_16x16x32_bf16 v[76:79], a[96:99], v[24:27], v[76:79]
  ds_read_b64_tr_b16 v[18:19], v12 offset:24832
  buffer_load_dwordx4 v4, s[8:11], s25 offen lds
  v_mfma_f32_16x16x32_bf16 v[80:83], a[168:171], v[24:27], v[80:83]
  v_mfma_f32_16x16x32_bf16 v[84:87], a[240:243], v[24:27], v[84:87]
  v_mfma_f32_16x16x32_bf16 v[88:91], a[24:27], v[28:31], v[88:91]
  ds_read_b64_tr_b16 v[20:21], v12 offset:30720
  s_add_u32 m0, s35, 51200
  v_mfma_f32_16x16x32_bf16 v[92:95], a[96:99], v[28:31], v[92:95]
  ds_read_b64_tr_b16 v[22:23], v12 offset:30976
  v_mfma_f32_16x16x32_bf16 v[96:99], a[168:171], v[28:31], v[96:99]
  s_add_u32 s25, s34, 1382400
  v_mfma_f32_16x16x32_bf16 v[100:103], a[240:243], v[28:31], v[100:103]
  s_waitcnt lgkmcnt(4)
  v_mfma_f32_16x16x32_bf16 v[104:107], v[32:35], a[24:27], v[104:107]
  ds_read_b64_tr_b16 v[24:25], v5 offset:28672
  buffer_load_dwordx4 v3, s[8:11], s25 offen lds
  v_mfma_f32_16x16x32_bf16 v[108:111], v[32:35], a[96:99], v[108:111]
  ds_read_b64_tr_b16 v[26:27], v5 offset:29184
  v_mfma_f32_16x16x32_bf16 v[112:115], v[32:35], a[168:171], v[112:115]
  v_mfma_f32_16x16x32_bf16 v[116:119], v[32:35], a[240:243], v[116:119]
  s_add_u32 m0, s33, 122880
  v_mfma_f32_16x16x32_bf16 v[120:123], v[36:39], a[24:27], v[120:123]
  ds_read_b64_tr_b16 v[28:29], v6 offset:28672
  v_mfma_f32_16x16x32_bf16 v[124:127], v[36:39], a[96:99], v[124:127]
  ds_read_b64_tr_b16 v[30:31], v6 offset:29184
  buffer_load_dwordx4 v2, s[12:15], s60 offen offset:0 lds
  v_mfma_f32_16x16x32_bf16 v[128:131], v[36:39], a[168:171], v[128:131]
  v_mfma_f32_16x16x32_bf16 v[132:135], v[36:39], a[240:243], v[132:135]
  s_waitcnt lgkmcnt(4)
  v_mfma_f32_16x16x32_bf16 v[136:139], v[16:19], a[24:27], v[136:139]
  ds_read_b64_tr_b16 v[32:33], v7 offset:28672
  buffer_load_dwordx4 v2, s[12:15], s61 offen offset:1024 lds
  v_mfma_f32_16x16x32_bf16 v[140:143], v[16:19], a[96:99], v[140:143]
  ds_read_b64_tr_b16 v[34:35], v7 offset:29184
  v_mfma_f32_16x16x32_bf16 v[144:147], v[16:19], a[168:171], v[144:147]
  buffer_load_dwordx4 v2, s[12:15], s62 offen offset:2048 lds
  v_mfma_f32_16x16x32_bf16 v[148:151], v[16:19], a[240:243], v[148:151]
  v_mfma_f32_16x16x32_bf16 v[152:155], v[20:23], a[24:27], v[152:155]
  ds_read_b64_tr_b16 v[36:37], v8 offset:28672
  v_mfma_f32_16x16x32_bf16 v[156:159], v[20:23], a[96:99], v[156:159]
  ds_read_b64_tr_b16 v[38:39], v8 offset:29184
  s_add_u32 s28, s39, 12288
  v_mfma_f32_16x16x32_bf16 v[160:163], v[20:23], a[168:171], v[160:163]
  v_mfma_f32_16x16x32_bf16 v[164:167], v[20:23], a[240:243], v[164:167]
  s_waitcnt lgkmcnt(4)
  buffer_load_dwordx4 a[48:51], v15, s[16:19], s28 offen offset:0
  v_mfma_f32_16x16x32_bf16 v[40:43], a[28:31], v[24:27], v[40:43]
  ds_read_b64_tr_b16 v[16:17], v11 offset:26624
  v_mfma_f32_16x16x32_bf16 v[44:47], a[100:103], v[24:27], v[44:47]
  ds_read_b64_tr_b16 v[18:19], v11 offset:26880
  buffer_load_dwordx4 a[52:55], v15, s[16:19], s28 offen offset:1024
  v_mfma_f32_16x16x32_bf16 v[48:51], a[172:175], v[24:27], v[48:51]
  v_mfma_f32_16x16x32_bf16 v[52:55], a[244:247], v[24:27], v[52:55]
  v_mfma_f32_16x16x32_bf16 v[56:59], a[28:31], v[28:31], v[56:59]
  ds_read_b64_tr_b16 v[20:21], v11 offset:32768
  buffer_load_dwordx4 a[56:59], v15, s[16:19], s28 offen offset:2048
  v_mfma_f32_16x16x32_bf16 v[60:63], a[100:103], v[28:31], v[60:63]
  ds_read_b64_tr_b16 v[22:23], v11 offset:33024
  v_mfma_f32_16x16x32_bf16 v[64:67], a[172:175], v[28:31], v[64:67]
  s_add_u32 s28, s39, 30720
  v_mfma_f32_16x16x32_bf16 v[68:71], a[244:247], v[28:31], v[68:71]
  s_waitcnt lgkmcnt(4)
  v_mfma_f32_16x16x32_bf16 v[72:75], a[28:31], v[32:35], v[72:75]
  ds_read_b64_tr_b16 v[24:25], v12 offset:26624
  v_mfma_f32_16x16x32_bf16 v[76:79], a[100:103], v[32:35], v[76:79]
  ds_read_b64_tr_b16 v[26:27], v12 offset:26880
  buffer_load_dwordx4 a[120:123], v15, s[16:19], s28 offen offset:0
  v_mfma_f32_16x16x32_bf16 v[80:83], a[172:175], v[32:35], v[80:83]
  v_mfma_f32_16x16x32_bf16 v[84:87], a[244:247], v[32:35], v[84:87]
  buffer_load_dwordx4 a[124:127], v15, s[16:19], s28 offen offset:1024
  v_mfma_f32_16x16x32_bf16 v[88:91], a[28:31], v[36:39], v[88:91]
  ds_read_b64_tr_b16 v[28:29], v12 offset:32768
  v_mfma_f32_16x16x32_bf16 v[92:95], a[100:103], v[36:39], v[92:95]
  ds_read_b64_tr_b16 v[30:31], v12 offset:33024
  v_mfma_f32_16x16x32_bf16 v[96:99], a[172:175], v[36:39], v[96:99]
  buffer_load_dwordx4 a[128:131], v15, s[16:19], s28 offen offset:2048
  v_mfma_f32_16x16x32_bf16 v[100:103], a[244:247], v[36:39], v[100:103]
  s_waitcnt lgkmcnt(4)
  v_mfma_f32_16x16x32_bf16 v[104:107], v[16:19], a[28:31], v[104:107]
  ds_read_b64_tr_b16 v[32:33], v5 offset:32768
  s_add_u32 s28, s39, 49152
  v_mfma_f32_16x16x32_bf16 v[108:111], v[16:19], a[100:103], v[108:111]
  ds_read_b64_tr_b16 v[34:35], v5 offset:33280
  v_mfma_f32_16x16x32_bf16 v[112:115], v[16:19], a[172:175], v[112:115]
  buffer_load_dwordx4 a[192:195], v15, s[16:19], s28 offen offset:0
  v_mfma_f32_16x16x32_bf16 v[116:119], v[16:19], a[244:247], v[116:119]
  v_mfma_f32_16x16x32_bf16 v[120:123], v[20:23], a[28:31], v[120:123]
  ds_read_b64_tr_b16 v[36:37], v6 offset:32768
  v_mfma_f32_16x16x32_bf16 v[124:127], v[20:23], a[100:103], v[124:127]
  ds_read_b64_tr_b16 v[38:39], v6 offset:33280
  buffer_load_dwordx4 a[196:199], v15, s[16:19], s28 offen offset:1024
  v_mfma_f32_16x16x32_bf16 v[128:131], v[20:23], a[172:175], v[128:131]
  v_mfma_f32_16x16x32_bf16 v[132:135], v[20:23], a[244:247], v[132:135]
  s_waitcnt lgkmcnt(4)
  buffer_load_dwordx4 a[200:203], v15, s[16:19], s28 offen offset:2048
  v_mfma_f32_16x16x32_bf16 v[136:139], v[24:27], a[28:31], v[136:139]
  ds_read_b64_tr_b16 v[16:17], v7 offset:32768
  v_mfma_f32_16x16x32_bf16 v[140:143], v[24:27], a[100:103], v[140:143]
  ds_read_b64_tr_b16 v[18:19], v7 offset:33280
  v_mfma_f32_16x16x32_bf16 v[144:147], v[24:27], a[172:175], v[144:147]
  s_add_u32 s28, s39, 67584
  v_mfma_f32_16x16x32_bf16 v[148:151], v[24:27], a[244:247], v[148:151]
  v_mfma_f32_16x16x32_bf16 v[152:155], v[28:31], a[28:31], v[152:155]
  ds_read_b64_tr_b16 v[20:21], v8 offset:32768
  buffer_load_dwordx4 v[232:235], v15, s[16:19], s28 offen offset:0
  v_mfma_f32_16x16x32_bf16 v[156:159], v[28:31], a[100:103], v[156:159]
  ds_read_b64_tr_b16 v[22:23], v8 offset:33280
  v_mfma_f32_16x16x32_bf16 v[160:163], v[28:31], a[172:175], v[160:163]
  v_mfma_f32_16x16x32_bf16 v[164:167], v[28:31], a[244:247], v[164:167]
  s_waitcnt lgkmcnt(4)
  buffer_load_dwordx4 v[236:239], v15, s[16:19], s28 offen offset:1024
  v_mfma_f32_16x16x32_bf16 v[40:43], a[32:35], v[32:35], v[40:43]
  ds_read_b64_tr_b16 v[24:25], v11 offset:28672
  v_mfma_f32_16x16x32_bf16 v[44:47], a[104:107], v[32:35], v[44:47]
  ds_read_b64_tr_b16 v[26:27], v11 offset:28928
  buffer_load_dwordx4 v[240:243], v15, s[16:19], s28 offen offset:2048
  v_mfma_f32_16x16x32_bf16 v[48:51], a[176:179], v[32:35], v[48:51]
  v_mfma_f32_16x16x32_bf16 v[52:55], a[248:251], v[32:35], v[52:55]
  s_add_u32 m0, s33, 0
  v_mfma_f32_16x16x32_bf16 v[56:59], a[32:35], v[36:39], v[56:59]
  ds_read_b64_tr_b16 v[28:29], v11 offset:34816
  v_mfma_f32_16x16x32_bf16 v[60:63], a[104:107], v[36:39], v[60:63]
  ds_read_b64_tr_b16 v[30:31], v11 offset:35072
  v_mfma_f32_16x16x32_bf16 v[64:67], a[176:179], v[36:39], v[64:67]
  buffer_load_dwordx4 v0, s[12:15], s48 offen offset:0 lds
  v_mfma_f32_16x16x32_bf16 v[68:71], a[248:251], v[36:39], v[68:71]
  s_waitcnt lgkmcnt(4)
  v_mfma_f32_16x16x32_bf16 v[72:75], a[32:35], v[16:19], v[72:75]
  ds_read_b64_tr_b16 v[32:33], v12 offset:28672
  buffer_load_dwordx4 v0, s[12:15], s49 offen offset:1024 lds
  v_mfma_f32_16x16x32_bf16 v[76:79], a[104:107], v[16:19], v[76:79]
  ds_read_b64_tr_b16 v[34:35], v12 offset:28928
  v_mfma_f32_16x16x32_bf16 v[80:83], a[176:179], v[16:19], v[80:83]
  v_mfma_f32_16x16x32_bf16 v[84:87], a[248:251], v[16:19], v[84:87]
  buffer_load_dwordx4 v0, s[12:15], s50 offen offset:2048 lds
  v_mfma_f32_16x16x32_bf16 v[88:91], a[32:35], v[20:23], v[88:91]
  ds_read_b64_tr_b16 v[36:37], v12 offset:34816
  v_mfma_f32_16x16x32_bf16 v[92:95], a[104:107], v[20:23], v[92:95]
  ds_read_b64_tr_b16 v[38:39], v12 offset:35072
  v_mfma_f32_16x16x32_bf16 v[96:99], a[176:179], v[20:23], v[96:99]
  v_mfma_f32_16x16x32_bf16 v[100:103], a[248:251], v[20:23], v[100:103]
  s_waitcnt lgkmcnt(4)
  v_mfma_f32_16x16x32_bf16 v[104:107], v[24:27], a[32:35], v[104:107]
  s_waitcnt vmcnt(21)
  s_barrier
  v_add_u32 v5, 36864, v5
  v_add_u32 v6, 36864, v6
  v_add_u32 v7, 36864, v7
  v_add_u32 v8, 36864, v8
  v_add_u32 v11, 36864, v11
  v_add_u32 v12, 36864, v12
  ds_read_b64_tr_b16 v[16:17], v5 offset:0
  v_mfma_f32_16x16x32_bf16 v[108:111], v[24:27], a[104:107], v[108:111]
  ds_read_b64_tr_b16 v[18:19], v5 offset:512
  v_mfma_f32_16x16x32_bf16 v[112:115], v[24:27], a[176:179], v[112:115]
  v_mfma_f32_16x16x32_bf16 v[116:119], v[24:27], a[248:251], v[116:119]
  v_mfma_f32_16x16x32_bf16 v[120:123], v[28:31], a[32:35], v[120:123]
  ds_read_b64_tr_b16 v[20:21], v6 offset:0
  v_mfma_f32_16x16x32_bf16 v[124:127], v[28:31], a[104:107], v[124:127]
  ds_read_b64_tr_b16 v[22:23], v6 offset:512
  v_mfma_f32_16x16x32_bf16 v[128:131], v[28:31], a[176:179], v[128:131]
  v_mfma_f32_16x16x32_bf16 v[132:135], v[28:31], a[248:251], v[132:135]
  s_waitcnt lgkmcnt(4)
  v_mfma_f32_16x16x32_bf16 v[136:139], v[32:35], a[32:35], v[136:139]
  ds_read_b64_tr_b16 v[24:25], v7 offset:0
  v_mfma_f32_16x16x32_bf16 v[140:143], v[32:35], a[104:107], v[140:143]
  ds_read_b64_tr_b16 v[26:27], v7 offset:512
  v_mfma_f32_16x16x32_bf16 v[144:147], v[32:35], a[176:179], v[144:147]
  v_mfma_f32_16x16x32_bf16 v[148:151], v[32:35], a[248:251], v[148:151]
  v_mfma_f32_16x16x32_bf16 v[152:155], v[36:39], a[32:35], v[152:155]
  ds_read_b64_tr_b16 v[28:29], v8 offset:0
  v_mfma_f32_16x16x32_bf16 v[156:159], v[36:39], a[104:107], v[156:159]
  ds_read_b64_tr_b16 v[30:31], v8 offset:512
  v_mfma_f32_16x16x32_bf16 v[160:163], v[36:39], a[176:179], v[160:163]
  v_mfma_f32_16x16x32_bf16 v[164:167], v[36:39], a[248:251], v[164:167]
  s_waitcnt lgkmcnt(4)
  v_mfma_f32_16x16x32_bf16 v[40:43], a[36:39], v[16:19], v[40:43]
  ds_read_b64_tr_b16 v[32:33], v11 offset:0
  s_add_u32 m0, s35, 61440
  v_mfma_f32_16x16x32_bf16 v[44:47], a[108:111], v[16:19], v[44:47]
  ds_read_b64_tr_b16 v[34:35], v11 offset:256
  s_add_u32 s25, s34, 1658880
  v_mfma_f32_16x16x32_bf16 v[48:51], a[180:183], v[16:19], v[48:51]
  buffer_load_dwordx4 v3, s[8:11], s25 offen lds
  v_mfma_f32_16x16x32_bf16 v[52:55], a[252:255], v[16:19], v[52:55]
  v_mfma_f32_16x16x32_bf16 v[56:59], a[36:39], v[20:23], v[56:59]
  ds_read_b64_tr_b16 v[36:37], v11 offset:6144
  s_add_u32 m0, s35, 62464
  v_mfma_f32_16x16x32_bf16 v[60:63], a[108:111], v[20:23], v[60:63]
  ds_read_b64_tr_b16 v[38:39], v11 offset:6400
  v_mfma_f32_16x16x32_bf16 v[64:67], a[180:183], v[20:23], v[64:67]
  v_mfma_f32_16x16x32_bf16 v[68:71], a[252:255], v[20:23], v[68:71]
  s_waitcnt lgkmcnt(4)
  s_add_u32 s25, s34, 1686528
  v_mfma_f32_16x16x32_bf16 v[72:75], a[36:39], v[24:27], v[72:75]
  ds_read_b64_tr_b16 v[16:17], v12 offset:0
  v_mfma_f32_16x16x32_bf16 v[76:79], a[108:111], v[24:27], v[76:79]
  ds_read_b64_tr_b16 v[18:19], v12 offset:256
  buffer_load_dwordx4 v4, s[8:11], s25 offen lds
  v_mfma_f32_16x16x32_bf16 v[80:83], a[180:183], v[24:27], v[80:83]
  v_mfma_f32_16x16x32_bf16 v[84:87], a[252:255], v[24:27], v[84:87]
  v_mfma_f32_16x16x32_bf16 v[88:91], a[36:39], v[28:31], v[88:91]
  ds_read_b64_tr_b16 v[20:21], v12 offset:6144
  s_add_u32 m0, s35, 63488
  v_mfma_f32_16x16x32_bf16 v[92:95], a[108:111], v[28:31], v[92:95]
  ds_read_b64_tr_b16 v[22:23], v12 offset:6400
  v_mfma_f32_16x16x32_bf16 v[96:99], a[180:183], v[28:31], v[96:99]
  s_add_u32 s25, s34, 1714176
  v_mfma_f32_16x16x32_bf16 v[100:103], a[252:255], v[28:31], v[100:103]
  s_waitcnt lgkmcnt(4)
  v_mfma_f32_16x16x32_bf16 v[104:107], v[32:35], a[36:39], v[104:107]
  ds_read_b64_tr_b16 v[24:25], v5 offset:4096
  buffer_load_dwordx4 v3, s[8:11], s25 offen lds
  v_mfma_f32_16x16x32_bf16 v[108:111], v[32:35], a[108:111], v[108:111]
  ds_read_b64_tr_b16 v[26:27], v5 offset:4608
  v_mfma_f32_16x16x32_bf16 v[112:115], v[32:35], a[180:183], v[112:115]
  v_mfma_f32_16x16x32_bf16 v[116:119], v[32:35], a[252:255], v[116:119]
  s_add_u32 m0, s33, 135168
  v_mfma_f32_16x16x32_bf16 v[120:123], v[36:39], a[36:39], v[120:123]
  ds_read_b64_tr_b16 v[28:29], v6 offset:4096
  v_mfma_f32_16x16x32_bf16 v[124:127], v[36:39], a[108:111], v[124:127]
  ds_read_b64_tr_b16 v[30:31], v6 offset:4608
  buffer_load_dwordx4 v2, s[12:15], s63 offen offset:0 lds
  v_mfma_f32_16x16x32_bf16 v[128:131], v[36:39], a[180:183], v[128:131]
  v_mfma_f32_16x16x32_bf16 v[132:135], v[36:39], a[252:255], v[132:135]
  s_waitcnt lgkmcnt(4)
  v_mfma_f32_16x16x32_bf16 v[136:139], v[16:19], a[36:39], v[136:139]
  ds_read_b64_tr_b16 v[32:33], v7 offset:4096
  buffer_load_dwordx4 v2, s[12:15], s64 offen offset:1024 lds
  v_mfma_f32_16x16x32_bf16 v[140:143], v[16:19], a[108:111], v[140:143]
  ds_read_b64_tr_b16 v[34:35], v7 offset:4608
  v_mfma_f32_16x16x32_bf16 v[144:147], v[16:19], a[180:183], v[144:147]
  buffer_load_dwordx4 v2, s[12:15], s65 offen offset:2048 lds
  v_mfma_f32_16x16x32_bf16 v[148:151], v[16:19], a[252:255], v[148:151]
  v_mfma_f32_16x16x32_bf16 v[152:155], v[20:23], a[36:39], v[152:155]
  ds_read_b64_tr_b16 v[36:37], v8 offset:4096
  v_mfma_f32_16x16x32_bf16 v[156:159], v[20:23], a[108:111], v[156:159]
  ds_read_b64_tr_b16 v[38:39], v8 offset:4608
  s_add_u32 s28, s39, 15360
  v_mfma_f32_16x16x32_bf16 v[160:163], v[20:23], a[180:183], v[160:163]
  v_mfma_f32_16x16x32_bf16 v[164:167], v[20:23], a[252:255], v[164:167]
  s_waitcnt lgkmcnt(4)
  buffer_load_dwordx4 a[60:63], v15, s[16:19], s28 offen offset:0
  v_mfma_f32_16x16x32_bf16 v[40:43], a[40:43], v[24:27], v[40:43]
  ds_read_b64_tr_b16 v[16:17], v11 offset:2048
  v_mfma_f32_16x16x32_bf16 v[44:47], a[112:115], v[24:27], v[44:47]
  ds_read_b64_tr_b16 v[18:19], v11 offset:2304
  buffer_load_dwordx4 a[64:67], v15, s[16:19], s28 offen offset:1024
  v_mfma_f32_16x16x32_bf16 v[48:51], a[184:187], v[24:27], v[48:51]
  v_mfma_f32_16x16x32_bf16 v[52:55], v[224:227], v[24:27], v[52:55]
  v_mfma_f32_16x16x32_bf16 v[56:59], a[40:43], v[28:31], v[56:59]
  ds_read_b64_tr_b16 v[20:21], v11 offset:8192
  buffer_load_dwordx4 a[68:71], v15, s[16:19], s28 offen offset:2048
  v_mfma_f32_16x16x32_bf16 v[60:63], a[112:115], v[28:31], v[60:63]
  ds_read_b64_tr_b16 v[22:23], v11 offset:8448
  v_mfma_f32_16x16x32_bf16 v[64:67], a[184:187], v[28:31], v[64:67]
  s_add_u32 s28, s39, 33792
  v_mfma_f32_16x16x32_bf16 v[68:71], v[224:227], v[28:31], v[68:71]
  s_waitcnt lgkmcnt(4)
  v_mfma_f32_16x16x32_bf16 v[72:75], a[40:43], v[32:35], v[72:75]
  ds_read_b64_tr_b16 v[24:25], v12 offset:2048
  v_mfma_f32_16x16x32_bf16 v[76:79], a[112:115], v[32:35], v[76:79]
  ds_read_b64_tr_b16 v[26:27], v12 offset:2304
  buffer_load_dwordx4 a[132:135], v15, s[16:19], s28 offen offset:0
  v_mfma_f32_16x16x32_bf16 v[80:83], a[184:187], v[32:35], v[80:83]
  v_mfma_f32_16x16x32_bf16 v[84:87], v[224:227], v[32:35], v[84:87]
  buffer_load_dwordx4 a[136:139], v15, s[16:19], s28 offen offset:1024
  v_mfma_f32_16x16x32_bf16 v[88:91], a[40:43], v[36:39], v[88:91]
  ds_read_b64_tr_b16 v[28:29], v12 offset:8192
  v_mfma_f32_16x16x32_bf16 v[92:95], a[112:115], v[36:39], v[92:95]
  ds_read_b64_tr_b16 v[30:31], v12 offset:8448
  v_mfma_f32_16x16x32_bf16 v[96:99], a[184:187], v[36:39], v[96:99]
  buffer_load_dwordx4 a[140:143], v15, s[16:19], s28 offen offset:2048
  v_mfma_f32_16x16x32_bf16 v[100:103], v[224:227], v[36:39], v[100:103]
  s_waitcnt lgkmcnt(4)
  v_mfma_f32_16x16x32_bf16 v[104:107], v[16:19], a[40:43], v[104:107]
  ds_read_b64_tr_b16 v[32:33], v5 offset:8192
  s_add_u32 s28, s39, 52224
  v_mfma_f32_16x16x32_bf16 v[108:111], v[16:19], a[112:115], v[108:111]
  ds_read_b64_tr_b16 v[34:35], v5 offset:8704
  v_mfma_f32_16x16x32_bf16 v[112:115], v[16:19], a[184:187], v[112:115]
  buffer_load_dwordx4 a[204:207], v15, s[16:19], s28 offen offset:0
  v_mfma_f32_16x16x32_bf16 v[116:119], v[16:19], v[224:227], v[116:119]
  v_mfma_f32_16x16x32_bf16 v[120:123], v[20:23], a[40:43], v[120:123]
  ds_read_b64_tr_b16 v[36:37], v6 offset:8192
  v_mfma_f32_16x16x32_bf16 v[124:127], v[20:23], a[112:115], v[124:127]
  ds_read_b64_tr_b16 v[38:39], v6 offset:8704
  buffer_load_dwordx4 a[208:211], v15, s[16:19], s28 offen offset:1024
  v_mfma_f32_16x16x32_bf16 v[128:131], v[20:23], a[184:187], v[128:131]
  v_mfma_f32_16x16x32_bf16 v[132:135], v[20:23], v[224:227], v[132:135]
  s_waitcnt lgkmcnt(4)
  buffer_load_dwordx4 a[212:215], v15, s[16:19], s28 offen offset:2048
  v_mfma_f32_16x16x32_bf16 v[136:139], v[24:27], a[40:43], v[136:139]
  ds_read_b64_tr_b16 v[16:17], v7 offset:8192
  v_mfma_f32_16x16x32_bf16 v[140:143], v[24:27], a[112:115], v[140:143]
  ds_read_b64_tr_b16 v[18:19], v7 offset:8704
  v_mfma_f32_16x16x32_bf16 v[144:147], v[24:27], a[184:187], v[144:147]
  s_add_u32 s28, s39, 70656
  v_mfma_f32_16x16x32_bf16 v[148:151], v[24:27], v[224:227], v[148:151]
  v_mfma_f32_16x16x32_bf16 v[152:155], v[28:31], a[40:43], v[152:155]
  ds_read_b64_tr_b16 v[20:21], v8 offset:8192
  buffer_load_dwordx4 v[244:247], v15, s[16:19], s28 offen offset:0
  v_mfma_f32_16x16x32_bf16 v[156:159], v[28:31], a[112:115], v[156:159]
  ds_read_b64_tr_b16 v[22:23], v8 offset:8704
  v_mfma_f32_16x16x32_bf16 v[160:163], v[28:31], a[184:187], v[160:163]
  v_mfma_f32_16x16x32_bf16 v[164:167], v[28:31], v[224:227], v[164:167]
  s_waitcnt lgkmcnt(4)
  buffer_load_dwordx4 v[248:251], v15, s[16:19], s28 offen offset:1024
  v_mfma_f32_16x16x32_bf16 v[40:43], a[44:47], v[32:35], v[40:43]
  ds_read_b64_tr_b16 v[24:25], v11 offset:4096
  v_mfma_f32_16x16x32_bf16 v[44:47], a[116:119], v[32:35], v[44:47]
  ds_read_b64_tr_b16 v[26:27], v11 offset:4352
  buffer_load_dwordx4 v[252:255], v15, s[16:19], s28 offen offset:2048
  v_mfma_f32_16x16x32_bf16 v[48:51], a[188:191], v[32:35], v[48:51]
  v_mfma_f32_16x16x32_bf16 v[52:55], v[228:231], v[32:35], v[52:55]
  s_add_u32 m0, s33, 12288
  v_mfma_f32_16x16x32_bf16 v[56:59], a[44:47], v[36:39], v[56:59]
  ds_read_b64_tr_b16 v[28:29], v11 offset:10240
  v_mfma_f32_16x16x32_bf16 v[60:63], a[116:119], v[36:39], v[60:63]
  ds_read_b64_tr_b16 v[30:31], v11 offset:10496
  v_mfma_f32_16x16x32_bf16 v[64:67], a[188:191], v[36:39], v[64:67]
  buffer_load_dwordx4 v0, s[12:15], s51 offen offset:0 lds
  v_mfma_f32_16x16x32_bf16 v[68:71], v[228:231], v[36:39], v[68:71]
  s_waitcnt lgkmcnt(4)
  v_mfma_f32_16x16x32_bf16 v[72:75], a[44:47], v[16:19], v[72:75]
  ds_read_b64_tr_b16 v[32:33], v12 offset:4096
  buffer_load_dwordx4 v0, s[12:15], s52 offen offset:1024 lds
  v_mfma_f32_16x16x32_bf16 v[76:79], a[116:119], v[16:19], v[76:79]
  ds_read_b64_tr_b16 v[34:35], v12 offset:4352
  v_mfma_f32_16x16x32_bf16 v[80:83], a[188:191], v[16:19], v[80:83]
  v_mfma_f32_16x16x32_bf16 v[84:87], v[228:231], v[16:19], v[84:87]
  buffer_load_dwordx4 v0, s[12:15], s53 offen offset:2048 lds
  v_mfma_f32_16x16x32_bf16 v[88:91], a[44:47], v[20:23], v[88:91]
  ds_read_b64_tr_b16 v[36:37], v12 offset:10240
  v_mfma_f32_16x16x32_bf16 v[92:95], a[116:119], v[20:23], v[92:95]
  ds_read_b64_tr_b16 v[38:39], v12 offset:10496
  v_mfma_f32_16x16x32_bf16 v[96:99], a[188:191], v[20:23], v[96:99]
  v_mfma_f32_16x16x32_bf16 v[100:103], v[228:231], v[20:23], v[100:103]
  s_waitcnt lgkmcnt(4)
  v_mfma_f32_16x16x32_bf16 v[104:107], v[24:27], a[44:47], v[104:107]
  s_waitcnt vmcnt(24)
  s_barrier
  ds_read_b64_tr_b16 v[16:17], v5 offset:12288
  v_mfma_f32_16x16x32_bf16 v[108:111], v[24:27], a[116:119], v[108:111]
  ds_read_b64_tr_b16 v[18:19], v5 offset:12800
  v_mfma_f32_16x16x32_bf16 v[112:115], v[24:27], a[188:191], v[112:115]
  v_mfma_f32_16x16x32_bf16 v[116:119], v[24:27], v[228:231], v[116:119]
  v_mfma_f32_16x16x32_bf16 v[120:123], v[28:31], a[44:47], v[120:123]
  ds_read_b64_tr_b16 v[20:21], v6 offset:12288
  v_mfma_f32_16x16x32_bf16 v[124:127], v[28:31], a[116:119], v[124:127]
  ds_read_b64_tr_b16 v[22:23], v6 offset:12800
  v_mfma_f32_16x16x32_bf16 v[128:131], v[28:31], a[188:191], v[128:131]
  v_mfma_f32_16x16x32_bf16 v[132:135], v[28:31], v[228:231], v[132:135]
  s_waitcnt lgkmcnt(4)
  v_mfma_f32_16x16x32_bf16 v[136:139], v[32:35], a[44:47], v[136:139]
  ds_read_b64_tr_b16 v[24:25], v7 offset:12288
  v_mfma_f32_16x16x32_bf16 v[140:143], v[32:35], a[116:119], v[140:143]
  ds_read_b64_tr_b16 v[26:27], v7 offset:12800
  v_mfma_f32_16x16x32_bf16 v[144:147], v[32:35], a[188:191], v[144:147]
  v_mfma_f32_16x16x32_bf16 v[148:151], v[32:35], v[228:231], v[148:151]
  v_mfma_f32_16x16x32_bf16 v[152:155], v[36:39], a[44:47], v[152:155]
  ds_read_b64_tr_b16 v[28:29], v8 offset:12288
  v_mfma_f32_16x16x32_bf16 v[156:159], v[36:39], a[116:119], v[156:159]
  ds_read_b64_tr_b16 v[30:31], v8 offset:12800
  v_mfma_f32_16x16x32_bf16 v[160:163], v[36:39], a[188:191], v[160:163]
  v_mfma_f32_16x16x32_bf16 v[164:167], v[36:39], v[228:231], v[164:167]
  s_waitcnt lgkmcnt(4)
  v_mfma_f32_16x16x32_bf16 v[40:43], a[48:51], v[16:19], v[40:43]
  ds_read_b64_tr_b16 v[32:33], v11 offset:12288
  s_add_u32 m0, s33, 24576
  v_mfma_f32_16x16x32_bf16 v[44:47], a[120:123], v[16:19], v[44:47]
  ds_read_b64_tr_b16 v[34:35], v11 offset:12544
  buffer_load_dwordx4 v0, s[12:15], s54 offen offset:0 lds
  v_mfma_f32_16x16x32_bf16 v[48:51], a[192:195], v[16:19], v[48:51]
  v_mfma_f32_16x16x32_bf16 v[52:55], v[232:235], v[16:19], v[52:55]
  v_mfma_f32_16x16x32_bf16 v[56:59], a[48:51], v[20:23], v[56:59]
  ds_read_b64_tr_b16 v[36:37], v11 offset:18432
  v_mfma_f32_16x16x32_bf16 v[60:63], a[120:123], v[20:23], v[60:63]
  ds_read_b64_tr_b16 v[38:39], v11 offset:18688
  v_mfma_f32_16x16x32_bf16 v[64:67], a[192:195], v[20:23], v[64:67]
  v_mfma_f32_16x16x32_bf16 v[68:71], v[232:235], v[20:23], v[68:71]
  s_waitcnt lgkmcnt(4)
  v_mfma_f32_16x16x32_bf16 v[72:75], a[48:51], v[24:27], v[72:75]
  ds_read_b64_tr_b16 v[16:17], v12 offset:12288
  v_mfma_f32_16x16x32_bf16 v[76:79], a[120:123], v[24:27], v[76:79]
  ds_read_b64_tr_b16 v[18:19], v12 offset:12544
  v_mfma_f32_16x16x32_bf16 v[80:83], a[192:195], v[24:27], v[80:83]
  v_mfma_f32_16x16x32_bf16 v[84:87], v[232:235], v[24:27], v[84:87]
  v_mfma_f32_16x16x32_bf16 v[88:91], a[48:51], v[28:31], v[88:91]
  ds_read_b64_tr_b16 v[20:21], v12 offset:18432
  v_mfma_f32_16x16x32_bf16 v[92:95], a[120:123], v[28:31], v[92:95]
  ds_read_b64_tr_b16 v[22:23], v12 offset:18688
  v_mfma_f32_16x16x32_bf16 v[96:99], a[192:195], v[28:31], v[96:99]
  v_mfma_f32_16x16x32_bf16 v[100:103], v[232:235], v[28:31], v[100:103]
  s_waitcnt lgkmcnt(4)
  v_mfma_f32_16x16x32_bf16 v[104:107], v[32:35], a[48:51], v[104:107]
  ds_read_b64_tr_b16 v[24:25], v5 offset:16384
  v_mfma_f32_16x16x32_bf16 v[108:111], v[32:35], a[120:123], v[108:111]
  ds_read_b64_tr_b16 v[26:27], v5 offset:16896
  v_mfma_f32_16x16x32_bf16 v[112:115], v[32:35], a[192:195], v[112:115]
  v_mfma_f32_16x16x32_bf16 v[116:119], v[32:35], v[232:235], v[116:119]
  v_mfma_f32_16x16x32_bf16 v[120:123], v[36:39], a[48:51], v[120:123]
  ds_read_b64_tr_b16 v[28:29], v6 offset:16384
  buffer_load_dwordx4 v0, s[12:15], s55 offen offset:1024 lds
  v_mfma_f32_16x16x32_bf16 v[124:127], v[36:39], a[120:123], v[124:127]
  ds_read_b64_tr_b16 v[30:31], v6 offset:16896
  v_mfma_f32_16x16x32_bf16 v[128:131], v[36:39], a[192:195], v[128:131]
  v_mfma_f32_16x16x32_bf16 v[132:135], v[36:39], v[232:235], v[132:135]
  s_waitcnt lgkmcnt(4)
  v_mfma_f32_16x16x32_bf16 v[136:139], v[16:19], a[48:51], v[136:139]
  ds_read_b64_tr_b16 v[32:33], v7 offset:16384
  v_mfma_f32_16x16x32_bf16 v[140:143], v[16:19], a[120:123], v[140:143]
  ds_read_b64_tr_b16 v[34:35], v7 offset:16896
  v_mfma_f32_16x16x32_bf16 v[144:147], v[16:19], a[192:195], v[144:147]
  v_mfma_f32_16x16x32_bf16 v[148:151], v[16:19], v[232:235], v[148:151]
  v_mfma_f32_16x16x32_bf16 v[152:155], v[20:23], a[48:51], v[152:155]
  ds_read_b64_tr_b16 v[36:37], v8 offset:16384
  v_mfma_f32_16x16x32_bf16 v[156:159], v[20:23], a[120:123], v[156:159]
  ds_read_b64_tr_b16 v[38:39], v8 offset:16896
  v_mfma_f32_16x16x32_bf16 v[160:163], v[20:23], a[192:195], v[160:163]
  v_mfma_f32_16x16x32_bf16 v[164:167], v[20:23], v[232:235], v[164:167]
  s_waitcnt lgkmcnt(4)
  v_mfma_f32_16x16x32_bf16 v[40:43], a[52:55], v[24:27], v[40:43]
  ds_read_b64_tr_b16 v[16:17], v11 offset:14336
  v_mfma_f32_16x16x32_bf16 v[44:47], a[124:127], v[24:27], v[44:47]
  ds_read_b64_tr_b16 v[18:19], v11 offset:14592
  v_mfma_f32_16x16x32_bf16 v[48:51], a[196:199], v[24:27], v[48:51]
  v_mfma_f32_16x16x32_bf16 v[52:55], v[236:239], v[24:27], v[52:55]
  v_mfma_f32_16x16x32_bf16 v[56:59], a[52:55], v[28:31], v[56:59]
  ds_read_b64_tr_b16 v[20:21], v11 offset:20480
  v_mfma_f32_16x16x32_bf16 v[60:63], a[124:127], v[28:31], v[60:63]
  ds_read_b64_tr_b16 v[22:23], v11 offset:20736
  v_mfma_f32_16x16x32_bf16 v[64:67], a[196:199], v[28:31], v[64:67]
  v_mfma_f32_16x16x32_bf16 v[68:71], v[236:239], v[28:31], v[68:71]
  s_waitcnt lgkmcnt(4)
  v_mfma_f32_16x16x32_bf16 v[72:75], a[52:55], v[32:35], v[72:75]
  ds_read_b64_tr_b16 v[24:25], v12 offset:14336
  buffer_load_dwordx4 v0, s[12:15], s56 offen offset:2048 lds
  v_mfma_f32_16x16x32_bf16 v[76:79], a[124:127], v[32:35], v[76:79]
  ds_read_b64_tr_b16 v[26:27], v12 offset:14592
  v_mfma_f32_16x16x32_bf16 v[80:83], a[196:199], v[32:35], v[80:83]
  v_mfma_f32_16x16x32_bf16 v[84:87], v[236:239], v[32:35], v[84:87]
  v_mfma_f32_16x16x32_bf16 v[88:91], a[52:55], v[36:39], v[88:91]
  ds_read_b64_tr_b16 v[28:29], v12 offset:20480
  v_mfma_f32_16x16x32_bf16 v[92:95], a[124:127], v[36:39], v[92:95]
  ds_read_b64_tr_b16 v[30:31], v12 offset:20736
  v_mfma_f32_16x16x32_bf16 v[96:99], a[196:199], v[36:39], v[96:99]
  v_mfma_f32_16x16x32_bf16 v[100:103], v[236:239], v[36:39], v[100:103]
  s_waitcnt lgkmcnt(4)
  v_mfma_f32_16x16x32_bf16 v[104:107], v[16:19], a[52:55], v[104:107]
  ds_read_b64_tr_b16 v[32:33], v5 offset:20480
  v_mfma_f32_16x16x32_bf16 v[108:111], v[16:19], a[124:127], v[108:111]
  ds_read_b64_tr_b16 v[34:35], v5 offset:20992
  v_mfma_f32_16x16x32_bf16 v[112:115], v[16:19], a[196:199], v[112:115]
  v_mfma_f32_16x16x32_bf16 v[116:119], v[16:19], v[236:239], v[116:119]
  v_mfma_f32_16x16x32_bf16 v[120:123], v[20:23], a[52:55], v[120:123]
  ds_read_b64_tr_b16 v[36:37], v6 offset:20480
  v_mfma_f32_16x16x32_bf16 v[124:127], v[20:23], a[124:127], v[124:127]
  ds_read_b64_tr_b16 v[38:39], v6 offset:20992
  v_mfma_f32_16x16x32_bf16 v[128:131], v[20:23], a[196:199], v[128:131]
  v_mfma_f32_16x16x32_bf16 v[132:135], v[20:23], v[236:239], v[132:135]
  s_waitcnt lgkmcnt(4)
  v_mfma_f32_16x16x32_bf16 v[136:139], v[24:27], a[52:55], v[136:139]
  ds_read_b64_tr_b16 v[16:17], v7 offset:20480
  v_mfma_f32_16x16x32_bf16 v[140:143], v[24:27], a[124:127], v[140:143]
  ds_read_b64_tr_b16 v[18:19], v7 offset:20992
  v_mfma_f32_16x16x32_bf16 v[144:147], v[24:27], a[196:199], v[144:147]
  v_mfma_f32_16x16x32_bf16 v[148:151], v[24:27], v[236:239], v[148:151]
  v_mfma_f32_16x16x32_bf16 v[152:155], v[28:31], a[52:55], v[152:155]
  ds_read_b64_tr_b16 v[20:21], v8 offset:20480
  v_mfma_f32_16x16x32_bf16 v[156:159], v[28:31], a[124:127], v[156:159]
  ds_read_b64_tr_b16 v[22:23], v8 offset:20992
  v_mfma_f32_16x16x32_bf16 v[160:163], v[28:31], a[196:199], v[160:163]
  v_mfma_f32_16x16x32_bf16 v[164:167], v[28:31], v[236:239], v[164:167]
  s_waitcnt lgkmcnt(4)
  v_mfma_f32_16x16x32_bf16 v[40:43], a[56:59], v[32:35], v[40:43]
  ds_read_b64_tr_b16 v[24:25], v11 offset:16384
  v_mfma_f32_16x16x32_bf16 v[44:47], a[128:131], v[32:35], v[44:47]
  ds_read_b64_tr_b16 v[26:27], v11 offset:16640
  v_mfma_f32_16x16x32_bf16 v[48:51], a[200:203], v[32:35], v[48:51]
  v_mfma_f32_16x16x32_bf16 v[52:55], v[240:243], v[32:35], v[52:55]
  v_mfma_f32_16x16x32_bf16 v[56:59], a[56:59], v[36:39], v[56:59]
  ds_read_b64_tr_b16 v[28:29], v11 offset:22528
  v_mfma_f32_16x16x32_bf16 v[60:63], a[128:131], v[36:39], v[60:63]
  ds_read_b64_tr_b16 v[30:31], v11 offset:22784
  v_mfma_f32_16x16x32_bf16 v[64:67], a[200:203], v[36:39], v[64:67]
  v_mfma_f32_16x16x32_bf16 v[68:71], v[240:243], v[36:39], v[68:71]
  s_waitcnt lgkmcnt(4)
  v_mfma_f32_16x16x32_bf16 v[72:75], a[56:59], v[16:19], v[72:75]
  ds_read_b64_tr_b16 v[32:33], v12 offset:16384
  v_mfma_f32_16x16x32_bf16 v[76:79], a[128:131], v[16:19], v[76:79]
  ds_read_b64_tr_b16 v[34:35], v12 offset:16640
  v_mfma_f32_16x16x32_bf16 v[80:83], a[200:203], v[16:19], v[80:83]
  v_mfma_f32_16x16x32_bf16 v[84:87], v[240:243], v[16:19], v[84:87]
  v_mfma_f32_16x16x32_bf16 v[88:91], a[56:59], v[20:23], v[88:91]
  ds_read_b64_tr_b16 v[36:37], v12 offset:22528
  v_mfma_f32_16x16x32_bf16 v[92:95], a[128:131], v[20:23], v[92:95]
  ds_read_b64_tr_b16 v[38:39], v12 offset:22784
  v_mfma_f32_16x16x32_bf16 v[96:99], a[200:203], v[20:23], v[96:99]
  v_mfma_f32_16x16x32_bf16 v[100:103], v[240:243], v[20:23], v[100:103]
  s_waitcnt lgkmcnt(4)
  v_mfma_f32_16x16x32_bf16 v[104:107], v[24:27], a[56:59], v[104:107]
  s_waitcnt vmcnt(6)
  s_barrier
  ds_read_b64_tr_b16 v[16:17], v5 offset:24576
  v_mfma_f32_16x16x32_bf16 v[108:111], v[24:27], a[128:131], v[108:111]
  ds_read_b64_tr_b16 v[18:19], v5 offset:25088
  v_mfma_f32_16x16x32_bf16 v[112:115], v[24:27], a[200:203], v[112:115]
  v_mfma_f32_16x16x32_bf16 v[116:119], v[24:27], v[240:243], v[116:119]
  v_mfma_f32_16x16x32_bf16 v[120:123], v[28:31], a[56:59], v[120:123]
  ds_read_b64_tr_b16 v[20:21], v6 offset:24576
  v_mfma_f32_16x16x32_bf16 v[124:127], v[28:31], a[128:131], v[124:127]
  ds_read_b64_tr_b16 v[22:23], v6 offset:25088
  v_mfma_f32_16x16x32_bf16 v[128:131], v[28:31], a[200:203], v[128:131]
  v_mfma_f32_16x16x32_bf16 v[132:135], v[28:31], v[240:243], v[132:135]
  s_waitcnt lgkmcnt(4)
  v_mfma_f32_16x16x32_bf16 v[136:139], v[32:35], a[56:59], v[136:139]
  ds_read_b64_tr_b16 v[24:25], v7 offset:24576
  v_mfma_f32_16x16x32_bf16 v[140:143], v[32:35], a[128:131], v[140:143]
  ds_read_b64_tr_b16 v[26:27], v7 offset:25088
  v_mfma_f32_16x16x32_bf16 v[144:147], v[32:35], a[200:203], v[144:147]
  v_mfma_f32_16x16x32_bf16 v[148:151], v[32:35], v[240:243], v[148:151]
  v_mfma_f32_16x16x32_bf16 v[152:155], v[36:39], a[56:59], v[152:155]
  ds_read_b64_tr_b16 v[28:29], v8 offset:24576
  v_mfma_f32_16x16x32_bf16 v[156:159], v[36:39], a[128:131], v[156:159]
  ds_read_b64_tr_b16 v[30:31], v8 offset:25088
  v_mfma_f32_16x16x32_bf16 v[160:163], v[36:39], a[200:203], v[160:163]
  v_mfma_f32_16x16x32_bf16 v[164:167], v[36:39], v[240:243], v[164:167]
  s_waitcnt lgkmcnt(4)
  v_mfma_f32_16x16x32_bf16 v[40:43], a[60:63], v[16:19], v[40:43]
  ds_read_b64_tr_b16 v[32:33], v11 offset:24576
  s_add_u32 m0, s33, 36864
  v_mfma_f32_16x16x32_bf16 v[44:47], a[132:135], v[16:19], v[44:47]
  ds_read_b64_tr_b16 v[34:35], v11 offset:24832
  buffer_load_dwordx4 v0, s[12:15], s57 offen offset:0 lds
  v_mfma_f32_16x16x32_bf16 v[48:51], a[204:207], v[16:19], v[48:51]
  v_mfma_f32_16x16x32_bf16 v[52:55], v[244:247], v[16:19], v[52:55]
  v_mfma_f32_16x16x32_bf16 v[56:59], a[60:63], v[20:23], v[56:59]
  ds_read_b64_tr_b16 v[36:37], v11 offset:30720
  v_mfma_f32_16x16x32_bf16 v[60:63], a[132:135], v[20:23], v[60:63]
  ds_read_b64_tr_b16 v[38:39], v11 offset:30976
  v_mfma_f32_16x16x32_bf16 v[64:67], a[204:207], v[20:23], v[64:67]
  v_mfma_f32_16x16x32_bf16 v[68:71], v[244:247], v[20:23], v[68:71]
  s_waitcnt lgkmcnt(4)
  v_mfma_f32_16x16x32_bf16 v[72:75], a[60:63], v[24:27], v[72:75]
  ds_read_b64_tr_b16 v[16:17], v12 offset:24576
  v_mfma_f32_16x16x32_bf16 v[76:79], a[132:135], v[24:27], v[76:79]
  ds_read_b64_tr_b16 v[18:19], v12 offset:24832
  v_mfma_f32_16x16x32_bf16 v[80:83], a[204:207], v[24:27], v[80:83]
  v_mfma_f32_16x16x32_bf16 v[84:87], v[244:247], v[24:27], v[84:87]
  v_mfma_f32_16x16x32_bf16 v[88:91], a[60:63], v[28:31], v[88:91]
  ds_read_b64_tr_b16 v[20:21], v12 offset:30720
  v_mfma_f32_16x16x32_bf16 v[92:95], a[132:135], v[28:31], v[92:95]
  ds_read_b64_tr_b16 v[22:23], v12 offset:30976
  v_mfma_f32_16x16x32_bf16 v[96:99], a[204:207], v[28:31], v[96:99]
  v_mfma_f32_16x16x32_bf16 v[100:103], v[244:247], v[28:31], v[100:103]
  s_waitcnt lgkmcnt(4)
  v_mfma_f32_16x16x32_bf16 v[104:107], v[32:35], a[60:63], v[104:107]
  ds_read_b64_tr_b16 v[24:25], v5 offset:28672
  v_mfma_f32_16x16x32_bf16 v[108:111], v[32:35], a[132:135], v[108:111]
  ds_read_b64_tr_b16 v[26:27], v5 offset:29184
  v_mfma_f32_16x16x32_bf16 v[112:115], v[32:35], a[204:207], v[112:115]
  v_mfma_f32_16x16x32_bf16 v[116:119], v[32:35], v[244:247], v[116:119]
  v_mfma_f32_16x16x32_bf16 v[120:123], v[36:39], a[60:63], v[120:123]
  ds_read_b64_tr_b16 v[28:29], v6 offset:28672
  buffer_load_dwordx4 v0, s[12:15], s58 offen offset:1024 lds
  v_mfma_f32_16x16x32_bf16 v[124:127], v[36:39], a[132:135], v[124:127]
  ds_read_b64_tr_b16 v[30:31], v6 offset:29184
  v_mfma_f32_16x16x32_bf16 v[128:131], v[36:39], a[204:207], v[128:131]
  v_mfma_f32_16x16x32_bf16 v[132:135], v[36:39], v[244:247], v[132:135]
  s_waitcnt lgkmcnt(4)
  v_mfma_f32_16x16x32_bf16 v[136:139], v[16:19], a[60:63], v[136:139]
  ds_read_b64_tr_b16 v[32:33], v7 offset:28672
  v_mfma_f32_16x16x32_bf16 v[140:143], v[16:19], a[132:135], v[140:143]
  ds_read_b64_tr_b16 v[34:35], v7 offset:29184
  v_mfma_f32_16x16x32_bf16 v[144:147], v[16:19], a[204:207], v[144:147]
  v_mfma_f32_16x16x32_bf16 v[148:151], v[16:19], v[244:247], v[148:151]
  v_mfma_f32_16x16x32_bf16 v[152:155], v[20:23], a[60:63], v[152:155]
  ds_read_b64_tr_b16 v[36:37], v8 offset:28672
  v_mfma_f32_16x16x32_bf16 v[156:159], v[20:23], a[132:135], v[156:159]
  ds_read_b64_tr_b16 v[38:39], v8 offset:29184
  v_mfma_f32_16x16x32_bf16 v[160:163], v[20:23], a[204:207], v[160:163]
  v_mfma_f32_16x16x32_bf16 v[164:167], v[20:23], v[244:247], v[164:167]
  s_waitcnt lgkmcnt(4)
  v_mfma_f32_16x16x32_bf16 v[40:43], a[64:67], v[24:27], v[40:43]
  ds_read_b64_tr_b16 v[16:17], v11 offset:26624
  v_mfma_f32_16x16x32_bf16 v[44:47], a[136:139], v[24:27], v[44:47]
  ds_read_b64_tr_b16 v[18:19], v11 offset:26880
  v_mfma_f32_16x16x32_bf16 v[48:51], a[208:211], v[24:27], v[48:51]
  v_mfma_f32_16x16x32_bf16 v[52:55], v[248:251], v[24:27], v[52:55]
  v_mfma_f32_16x16x32_bf16 v[56:59], a[64:67], v[28:31], v[56:59]
  ds_read_b64_tr_b16 v[20:21], v11 offset:32768
  v_mfma_f32_16x16x32_bf16 v[60:63], a[136:139], v[28:31], v[60:63]
  ds_read_b64_tr_b16 v[22:23], v11 offset:33024
  v_mfma_f32_16x16x32_bf16 v[64:67], a[208:211], v[28:31], v[64:67]
  v_mfma_f32_16x16x32_bf16 v[68:71], v[248:251], v[28:31], v[68:71]
  s_waitcnt lgkmcnt(4)
  v_mfma_f32_16x16x32_bf16 v[72:75], a[64:67], v[32:35], v[72:75]
  ds_read_b64_tr_b16 v[24:25], v12 offset:26624
  buffer_load_dwordx4 v0, s[12:15], s59 offen offset:2048 lds
  v_mfma_f32_16x16x32_bf16 v[76:79], a[136:139], v[32:35], v[76:79]
  ds_read_b64_tr_b16 v[26:27], v12 offset:26880
  v_mfma_f32_16x16x32_bf16 v[80:83], a[208:211], v[32:35], v[80:83]
  v_mfma_f32_16x16x32_bf16 v[84:87], v[248:251], v[32:35], v[84:87]
  v_mfma_f32_16x16x32_bf16 v[88:91], a[64:67], v[36:39], v[88:91]
  ds_read_b64_tr_b16 v[28:29], v12 offset:32768
  v_mfma_f32_16x16x32_bf16 v[92:95], a[136:139], v[36:39], v[92:95]
  ds_read_b64_tr_b16 v[30:31], v12 offset:33024
  v_mfma_f32_16x16x32_bf16 v[96:99], a[208:211], v[36:39], v[96:99]
  v_mfma_f32_16x16x32_bf16 v[100:103], v[248:251], v[36:39], v[100:103]
  s_waitcnt lgkmcnt(4)
  v_mfma_f32_16x16x32_bf16 v[104:107], v[16:19], a[64:67], v[104:107]
  ds_read_b64_tr_b16 v[32:33], v5 offset:32768
  v_mfma_f32_16x16x32_bf16 v[108:111], v[16:19], a[136:139], v[108:111]
  ds_read_b64_tr_b16 v[34:35], v5 offset:33280
  v_mfma_f32_16x16x32_bf16 v[112:115], v[16:19], a[208:211], v[112:115]
  v_mfma_f32_16x16x32_bf16 v[116:119], v[16:19], v[248:251], v[116:119]
  v_mfma_f32_16x16x32_bf16 v[120:123], v[20:23], a[64:67], v[120:123]
  ds_read_b64_tr_b16 v[36:37], v6 offset:32768
  v_mfma_f32_16x16x32_bf16 v[124:127], v[20:23], a[136:139], v[124:127]
  ds_read_b64_tr_b16 v[38:39], v6 offset:33280
  v_mfma_f32_16x16x32_bf16 v[128:131], v[20:23], a[208:211], v[128:131]
  v_mfma_f32_16x16x32_bf16 v[132:135], v[20:23], v[248:251], v[132:135]
  s_waitcnt lgkmcnt(4)
  v_mfma_f32_16x16x32_bf16 v[136:139], v[24:27], a[64:67], v[136:139]
  ds_read_b64_tr_b16 v[16:17], v7 offset:32768
  v_mfma_f32_16x16x32_bf16 v[140:143], v[24:27], a[136:139], v[140:143]
  ds_read_b64_tr_b16 v[18:19], v7 offset:33280
  v_mfma_f32_16x16x32_bf16 v[144:147], v[24:27], a[208:211], v[144:147]
  v_mfma_f32_16x16x32_bf16 v[148:151], v[24:27], v[248:251], v[148:151]
  v_mfma_f32_16x16x32_bf16 v[152:155], v[28:31], a[64:67], v[152:155]
  ds_read_b64_tr_b16 v[20:21], v8 offset:32768
  v_mfma_f32_16x16x32_bf16 v[156:159], v[28:31], a[136:139], v[156:159]
  ds_read_b64_tr_b16 v[22:23], v8 offset:33280
  v_mfma_f32_16x16x32_bf16 v[160:163], v[28:31], a[208:211], v[160:163]
  v_mfma_f32_16x16x32_bf16 v[164:167], v[28:31], v[248:251], v[164:167]
  s_waitcnt lgkmcnt(4)
  v_mfma_f32_16x16x32_bf16 v[40:43], a[68:71], v[32:35], v[40:43]
  ds_read_b64_tr_b16 v[24:25], v11 offset:28672
  v_mfma_f32_16x16x32_bf16 v[44:47], a[140:143], v[32:35], v[44:47]
  ds_read_b64_tr_b16 v[26:27], v11 offset:28928
  v_mfma_f32_16x16x32_bf16 v[48:51], a[212:215], v[32:35], v[48:51]
  v_mfma_f32_16x16x32_bf16 v[52:55], v[252:255], v[32:35], v[52:55]
  v_mfma_f32_16x16x32_bf16 v[56:59], a[68:71], v[36:39], v[56:59]
  ds_read_b64_tr_b16 v[28:29], v11 offset:34816
  v_mfma_f32_16x16x32_bf16 v[60:63], a[140:143], v[36:39], v[60:63]
  ds_read_b64_tr_b16 v[30:31], v11 offset:35072
  v_mfma_f32_16x16x32_bf16 v[64:67], a[212:215], v[36:39], v[64:67]
  v_mfma_f32_16x16x32_bf16 v[68:71], v[252:255], v[36:39], v[68:71]
  s_waitcnt lgkmcnt(4)
  v_mfma_f32_16x16x32_bf16 v[72:75], a[68:71], v[16:19], v[72:75]
  ds_read_b64_tr_b16 v[32:33], v12 offset:28672
  v_mfma_f32_16x16x32_bf16 v[76:79], a[140:143], v[16:19], v[76:79]
  ds_read_b64_tr_b16 v[34:35], v12 offset:28928
  v_mfma_f32_16x16x32_bf16 v[80:83], a[212:215], v[16:19], v[80:83]
  v_mfma_f32_16x16x32_bf16 v[84:87], v[252:255], v[16:19], v[84:87]
  v_mfma_f32_16x16x32_bf16 v[88:91], a[68:71], v[20:23], v[88:91]
  ds_read_b64_tr_b16 v[36:37], v12 offset:34816
  v_mfma_f32_16x16x32_bf16 v[92:95], a[140:143], v[20:23], v[92:95]
  ds_read_b64_tr_b16 v[38:39], v12 offset:35072
  v_mfma_f32_16x16x32_bf16 v[96:99], a[212:215], v[20:23], v[96:99]
  v_mfma_f32_16x16x32_bf16 v[100:103], v[252:255], v[20:23], v[100:103]
  s_waitcnt lgkmcnt(4)
  v_mfma_f32_16x16x32_bf16 v[104:107], v[24:27], a[68:71], v[104:107]
  v_mfma_f32_16x16x32_bf16 v[108:111], v[24:27], a[140:143], v[108:111]
  v_mfma_f32_16x16x32_bf16 v[112:115], v[24:27], a[212:215], v[112:115]
  v_mfma_f32_16x16x32_bf16 v[116:119], v[24:27], v[252:255], v[116:119]
  v_mfma_f32_16x16x32_bf16 v[120:123], v[28:31], a[68:71], v[120:123]
  v_mfma_f32_16x16x32_bf16 v[124:127], v[28:31], a[140:143], v[124:127]
  v_mfma_f32_16x16x32_bf16 v[128:131], v[28:31], a[212:215], v[128:131]
  v_mfma_f32_16x16x32_bf16 v[132:135], v[28:31], v[252:255], v[132:135]
  s_waitcnt lgkmcnt(0)
  v_mfma_f32_16x16x32_bf16 v[136:139], v[32:35], a[68:71], v[136:139]
  v_mfma_f32_16x16x32_bf16 v[140:143], v[32:35], a[140:143], v[140:143]
  v_mfma_f32_16x16x32_bf16 v[144:147], v[32:35], a[212:215], v[144:147]
  v_mfma_f32_16x16x32_bf16 v[148:151], v[32:35], v[252:255], v[148:151]
  v_mfma_f32_16x16x32_bf16 v[152:155], v[36:39], a[68:71], v[152:155]
  v_mfma_f32_16x16x32_bf16 v[156:159], v[36:39], a[140:143], v[156:159]
  v_mfma_f32_16x16x32_bf16 v[160:163], v[36:39], a[212:215], v[160:163]
  v_mfma_f32_16x16x32_bf16 v[164:167], v[36:39], v[252:255], v[164:167]
  s_waitcnt vmcnt(0)
  s_waitcnt lgkmcnt(0)
  s_barrier
  s_add_u32 m0, s33, 49152
  s_nop 0
  buffer_load_dwordx4 v0, s[12:15], s60 offen offset:0 lds
  buffer_load_dwordx4 v0, s[12:15], s61 offen offset:1024 lds
  buffer_load_dwordx4 v0, s[12:15], s62 offen offset:2048 lds
  s_add_u32 m0, s33, 61440
  s_nop 0
  buffer_load_dwordx4 v0, s[12:15], s63 offen offset:0 lds
  buffer_load_dwordx4 v0, s[12:15], s64 offen offset:1024 lds
  buffer_load_dwordx4 v0, s[12:15], s65 offen offset:2048 lds
  v_mov_b32 v11, v9
  v_mov_b32 v12, v10
  ds_read_b64_tr_b16 v[16:17], v11 offset:0
  ds_read_b64_tr_b16 v[18:19], v11 offset:256
  ds_read_b64_tr_b16 v[20:21], v11 offset:6144
  ds_read_b64_tr_b16 v[22:23], v11 offset:6400
  ds_read_b64_tr_b16 v[24:25], v11 offset:2048
  ds_read_b64_tr_b16 v[26:27], v11 offset:2304
  ds_read_b64_tr_b16 v[28:29], v11 offset:8192
  ds_read_b64_tr_b16 v[30:31], v11 offset:8448
  s_waitcnt lgkmcnt(4)
  v_mfma_f32_16x16x32_bf16 v[168:171], v[16:19], a[0:3], 0
  ds_read_b64_tr_b16 v[32:33], v11 offset:4096
  v_mfma_f32_16x16x32_bf16 v[172:175], v[16:19], a[72:75], 0
  ds_read_b64_tr_b16 v[34:35], v11 offset:4352
  v_mfma_f32_16x16x32_bf16 v[176:179], v[16:19], a[144:147], 0
  v_add_u32 v2, 128, v2
  s_lshl_b32 s27, s23, 6
  v_mfma_f32_16x16x32_bf16 v[180:183], v[16:19], a[216:219], 0
  s_sub_u32 s27, s27, 1152
  v_mfma_f32_16x16x32_bf16 v[184:187], v[20:23], a[0:3], 0
  ds_read_b64_tr_b16 v[36:37], v11 offset:10240
  v_and_b32 v216, 15, v1
  v_mfma_f32_16x16x32_bf16 v[188:191], v[20:23], a[72:75], 0
  ds_read_b64_tr_b16 v[38:39], v11 offset:10496
  v_add_u32 v216, s27, v216
  v_mfma_f32_16x16x32_bf16 v[192:195], v[20:23], a[144:147], 0
  v_mul_u32_u24 v222, 3641, v216
  v_mfma_f32_16x16x32_bf16 v[196:199], v[20:23], a[216:219], 0
  s_waitcnt lgkmcnt(4)
  v_lshrrev_b32 v222, 16, v222
  v_mfma_f32_16x16x32_bf16 v[168:171], v[24:27], a[4:7], v[168:171]
  ds_read_b64_tr_b16 v[16:17], v11 offset:12288
  v_mul_u32_u24 v223, 18, v222
  v_mfma_f32_16x16x32_bf16 v[172:175], v[24:27], a[76:79], v[172:175]
  ds_read_b64_tr_b16 v[18:19], v11 offset:12544
  v_sub_u32 v216, v216, v223
  v_mfma_f32_16x16x32_bf16 v[176:179], v[24:27], a[148:151], v[176:179]
  v_lshlrev_b32 v216, 4, v216
  v_mfma_f32_16x16x32_bf16 v[180:183], v[24:27], a[220:223], v[180:183]
  v_mfma_f32_16x16x32_bf16 v[184:187], v[28:31], a[4:7], v[184:187]
  ds_read_b64_tr_b16 v[20:21], v11 offset:18432
  s_add_u32 m0, s33, 73728
  v_mfma_f32_16x16x32_bf16 v[188:191], v[28:31], a[76:79], v[188:191]
  ds_read_b64_tr_b16 v[22:23], v11 offset:18688
  v_mul_u32_u24 v222, 73728, v222
  v_mfma_f32_16x16x32_bf16 v[192:195], v[28:31], a[148:151], v[192:195]
  v_add_u32 v216, v216, v222
  v_mfma_f32_16x16x32_bf16 v[196:199], v[28:31], a[220:223], v[196:199]
  s_waitcnt lgkmcnt(4)
  v_bfe_u32 v222, v1, 4, 1
  v_mfma_f32_16x16x32_bf16 v[168:171], v[32:35], a[8:11], v[168:171]
  ds_read_b64_tr_b16 v[24:25], v11 offset:14336
  v_mul_u32_u24 v222, 288, v222
  v_mfma_f32_16x16x32_bf16 v[172:175], v[32:35], a[80:83], v[172:175]
  ds_read_b64_tr_b16 v[26:27], v11 offset:14592
  v_add_u32 v216, v216, v222
  v_mfma_f32_16x16x32_bf16 v[176:179], v[32:35], a[152:155], v[176:179]
  v_lshrrev_b32 v222, 5, v1
  v_mfma_f32_16x16x32_bf16 v[180:183], v[32:35], a[224:227], v[180:183]
  v_lshl_add_u32 v216, v222, 3, v216
  v_mfma_f32_16x16x32_bf16 v[184:187], v[36:39], a[8:11], v[184:187]
  ds_read_b64_tr_b16 v[28:29], v11 offset:20480
  v_mfma_f32_16x16x32_bf16 v[188:191], v[36:39], a[80:83], v[188:191]
  ds_read_b64_tr_b16 v[30:31], v11 offset:20736
  s_lshl_b32 s27, s23, 6
  v_mfma_f32_16x16x32_bf16 v[192:195], v[36:39], a[152:155], v[192:195]
  buffer_load_dwordx4 v2, s[12:15], s48 offen offset:0 lds
  v_mfma_f32_16x16x32_bf16 v[196:199], v[36:39], a[224:227], v[196:199]
  s_waitcnt lgkmcnt(4)
  s_sub_u32 s27, s27, 1136
  v_mfma_f32_16x16x32_bf16 v[168:171], v[16:19], a[12:15], v[168:171]
  ds_read_b64_tr_b16 v[32:33], v11 offset:16384
  v_and_b32 v217, 15, v1
  v_mfma_f32_16x16x32_bf16 v[172:175], v[16:19], a[84:87], v[172:175]
  ds_read_b64_tr_b16 v[34:35], v11 offset:16640
  v_add_u32 v217, s27, v217
  v_mfma_f32_16x16x32_bf16 v[176:179], v[16:19], a[156:159], v[176:179]
  v_mul_u32_u24 v222, 3641, v217
  v_mfma_f32_16x16x32_bf16 v[180:183], v[16:19], a[228:231], v[180:183]
  v_lshrrev_b32 v222, 16, v222
  v_mfma_f32_16x16x32_bf16 v[184:187], v[20:23], a[12:15], v[184:187]
  ds_read_b64_tr_b16 v[36:37], v11 offset:22528
  v_mul_u32_u24 v223, 18, v222
  v_mfma_f32_16x16x32_bf16 v[188:191], v[20:23], a[84:87], v[188:191]
  ds_read_b64_tr_b16 v[38:39], v11 offset:22784
  v_mfma_f32_16x16x32_bf16 v[192:195], v[20:23], a[156:159], v[192:195]
  v_sub_u32 v217, v217, v223
  v_mfma_f32_16x16x32_bf16 v[196:199], v[20:23], a[228:231], v[196:199]
  s_waitcnt lgkmcnt(4)
  v_lshlrev_b32 v217, 4, v217
  v_mfma_f32_16x16x32_bf16 v[168:171], v[24:27], a[16:19], v[168:171]
  ds_read_b64_tr_b16 v[16:17], v11 offset:24576
  buffer_load_dwordx4 v2, s[12:15], s49 offen offset:1024 lds
  v_mfma_f32_16x16x32_bf16 v[172:175], v[24:27], a[88:91], v[172:175]
  ds_read_b64_tr_b16 v[18:19], v11 offset:24832
  v_mul_u32_u24 v222, 73728, v222
  v_mfma_f32_16x16x32_bf16 v[176:179], v[24:27], a[160:163], v[176:179]
  v_add_u32 v217, v217, v222
  v_mfma_f32_16x16x32_bf16 v[180:183], v[24:27], a[232:235], v[180:183]
  v_bfe_u32 v222, v1, 4, 1
  v_mfma_f32_16x16x32_bf16 v[184:187], v[28:31], a[16:19], v[184:187]
  ds_read_b64_tr_b16 v[20:21], v11 offset:30720
  v_mul_u32_u24 v222, 288, v222
  v_mfma_f32_16x16x32_bf16 v[188:191], v[28:31], a[88:91], v[188:191]
  ds_read_b64_tr_b16 v[22:23], v11 offset:30976
  v_add_u32 v217, v217, v222
  v_mfma_f32_16x16x32_bf16 v[192:195], v[28:31], a[160:163], v[192:195]
  v_mfma_f32_16x16x32_bf16 v[196:199], v[28:31], a[232:235], v[196:199]
  s_waitcnt lgkmcnt(4)
  v_lshrrev_b32 v222, 5, v1
  v_mfma_f32_16x16x32_bf16 v[168:171], v[32:35], a[20:23], v[168:171]
  ds_read_b64_tr_b16 v[24:25], v11 offset:26624
  v_lshl_add_u32 v217, v222, 3, v217
  v_mfma_f32_16x16x32_bf16 v[172:175], v[32:35], a[92:95], v[172:175]
  ds_read_b64_tr_b16 v[26:27], v11 offset:26880
  v_cvt_pk_bf16_f32 v200, v40, v41
  v_mfma_f32_16x16x32_bf16 v[176:179], v[32:35], a[164:167], v[176:179]
  buffer_load_dwordx4 v2, s[12:15], s50 offen offset:2048 lds
  v_mfma_f32_16x16x32_bf16 v[180:183], v[32:35], a[236:239], v[180:183]
  v_cvt_pk_bf16_f32 v201, v42, v43
  v_mfma_f32_16x16x32_bf16 v[184:187], v[36:39], a[20:23], v[184:187]
  ds_read_b64_tr_b16 v[28:29], v11 offset:32768
  v_cvt_pk_bf16_f32 v202, v44, v45
  v_mfma_f32_16x16x32_bf16 v[188:191], v[36:39], a[92:95], v[188:191]
  ds_read_b64_tr_b16 v[30:31], v11 offset:33024
  v_cvt_pk_bf16_f32 v203, v46, v47
  v_mfma_f32_16x16x32_bf16 v[192:195], v[36:39], a[164:167], v[192:195]
  v_cvt_pk_bf16_f32 v204, v48, v49
  v_mfma_f32_16x16x32_bf16 v[196:199], v[36:39], a[236:239], v[196:199]
  s_waitcnt lgkmcnt(4)
  v_mfma_f32_16x16x32_bf16 v[168:171], v[16:19], a[24:27], v[168:171]
  ds_read_b64_tr_b16 v[32:33], v11 offset:28672
  v_cvt_pk_bf16_f32 v205, v50, v51
  v_mfma_f32_16x16x32_bf16 v[172:175], v[16:19], a[96:99], v[172:175]
  ds_read_b64_tr_b16 v[34:35], v11 offset:28928
  v_cvt_pk_bf16_f32 v206, v52, v53
  v_mfma_f32_16x16x32_bf16 v[176:179], v[16:19], a[168:171], v[176:179]
  v_cvt_pk_bf16_f32 v207, v54, v55
  v_mfma_f32_16x16x32_bf16 v[180:183], v[16:19], a[240:243], v[180:183]
  v_cvt_pk_bf16_f32 v208, v56, v57
  v_mfma_f32_16x16x32_bf16 v[184:187], v[20:23], a[24:27], v[184:187]
  ds_read_b64_tr_b16 v[36:37], v11 offset:34816
  s_add_u32 m0, s33, 86016
  v_mfma_f32_16x16x32_bf16 v[188:191], v[20:23], a[96:99], v[188:191]
  ds_read_b64_tr_b16 v[38:39], v11 offset:35072
  v_cvt_pk_bf16_f32 v209, v58, v59
  v_mfma_f32_16x16x32_bf16 v[192:195], v[20:23], a[168:171], v[192:195]
  v_cvt_pk_bf16_f32 v210, v60, v61
  v_mfma_f32_16x16x32_bf16 v[196:199], v[20:23], a[240:243], v[196:199]
  s_waitcnt lgkmcnt(4)
  v_cvt_pk_bf16_f32 v211, v62, v63
  v_mfma_f32_16x16x32_bf16 v[168:171], v[24:27], a[28:31], v[168:171]
  v_add_u32 v11, 36864, v11
  ds_read_b64_tr_b16 v[16:17], v11 offset:0
  v_mfma_f32_16x16x32_bf16 v[172:175], v[24:27], a[100:103], v[172:175]
  ds_read_b64_tr_b16 v[18:19], v11 offset:256
  v_cvt_pk_bf16_f32 v212, v64, v65
  v_mfma_f32_16x16x32_bf16 v[176:179], v[24:27], a[172:175], v[176:179]
  v_cvt_pk_bf16_f32 v213, v66, v67
  v_mfma_f32_16x16x32_bf16 v[180:183], v[24:27], a[244:247], v[180:183]
  v_cvt_pk_bf16_f32 v214, v68, v69
  v_mfma_f32_16x16x32_bf16 v[184:187], v[28:31], a[28:31], v[184:187]
  ds_read_b64_tr_b16 v[20:21], v11 offset:6144
  v_cvt_pk_bf16_f32 v215, v70, v71
  v_mfma_f32_16x16x32_bf16 v[188:191], v[28:31], a[100:103], v[188:191]
  ds_read_b64_tr_b16 v[22:23], v11 offset:6400
  buffer_store_dwordx2 v[200:201], v216, s[16:19], s37 offen offset:0 sc1
  v_mfma_f32_16x16x32_bf16 v[192:195], v[28:31], a[172:175], v[192:195]
  buffer_load_dwordx4 v2, s[12:15], s51 offen offset:0 lds
  v_mfma_f32_16x16x32_bf16 v[196:199], v[28:31], a[244:247], v[196:199]
  s_waitcnt lgkmcnt(4)
  buffer_store_dwordx2 v[202:203], v216, s[16:19], s37 offen offset:576 sc1
  v_mfma_f32_16x16x32_bf16 v[168:171], v[32:35], a[32:35], v[168:171]
  ds_read_b64_tr_b16 v[24:25], v11 offset:2048
  buffer_store_dwordx2 v[204:205], v216, s[16:19], s37 offen offset:1152 sc1
  v_mfma_f32_16x16x32_bf16 v[172:175], v[32:35], a[104:107], v[172:175]
  ds_read_b64_tr_b16 v[26:27], v11 offset:2304
  buffer_store_dwordx2 v[206:207], v216, s[16:19], s37 offen offset:1728 sc1
  v_mfma_f32_16x16x32_bf16 v[176:179], v[32:35], a[176:179], v[176:179]
  v_mfma_f32_16x16x32_bf16 v[180:183], v[32:35], a[248:251], v[180:183]
  buffer_store_dwordx2 v[208:209], v217, s[16:19], s37 offen offset:0 sc1
  v_mfma_f32_16x16x32_bf16 v[184:187], v[36:39], a[32:35], v[184:187]
  ds_read_b64_tr_b16 v[28:29], v11 offset:8192
  buffer_store_dwordx2 v[210:211], v217, s[16:19], s37 offen offset:576 sc1
  v_mfma_f32_16x16x32_bf16 v[188:191], v[36:39], a[104:107], v[188:191]
  ds_read_b64_tr_b16 v[30:31], v11 offset:8448
  buffer_store_dwordx2 v[212:213], v217, s[16:19], s37 offen offset:1152 sc1
  v_mfma_f32_16x16x32_bf16 v[192:195], v[36:39], a[176:179], v[192:195]
  buffer_store_dwordx2 v[214:215], v217, s[16:19], s37 offen offset:1728 sc1
  v_mfma_f32_16x16x32_bf16 v[196:199], v[36:39], a[248:251], v[196:199]
  s_waitcnt lgkmcnt(4)
  s_lshl_b32 s27, s23, 6
  v_mfma_f32_16x16x32_bf16 v[168:171], v[16:19], a[36:39], v[168:171]
  ds_read_b64_tr_b16 v[32:33], v11 offset:4096
  s_sub_u32 s27, s27, 1120
  v_mfma_f32_16x16x32_bf16 v[172:175], v[16:19], a[108:111], v[172:175]
  ds_read_b64_tr_b16 v[34:35], v11 offset:4352
  buffer_load_dwordx4 v2, s[12:15], s52 offen offset:1024 lds
  v_mfma_f32_16x16x32_bf16 v[176:179], v[16:19], a[180:183], v[176:179]
  v_and_b32 v218, 15, v1
  v_mfma_f32_16x16x32_bf16 v[180:183], v[16:19], a[252:255], v[180:183]
  v_mfma_f32_16x16x32_bf16 v[184:187], v[20:23], a[36:39], v[184:187]
  ds_read_b64_tr_b16 v[36:37], v11 offset:10240
  v_add_u32 v218, s27, v218
  v_mfma_f32_16x16x32_bf16 v[188:191], v[20:23], a[108:111], v[188:191]
  ds_read_b64_tr_b16 v[38:39], v11 offset:10496
  v_mul_u32_u24 v222, 3641, v218
  v_mfma_f32_16x16x32_bf16 v[192:195], v[20:23], a[180:183], v[192:195]
  v_lshrrev_b32 v222, 16, v222
  v_mfma_f32_16x16x32_bf16 v[196:199], v[20:23], a[252:255], v[196:199]
  s_waitcnt lgkmcnt(4)
  v_mul_u32_u24 v223, 18, v222
  v_mfma_f32_16x16x32_bf16 v[168:171], v[24:27], a[40:43], v[168:171]
  s_waitcnt vmcnt(13)
  s_barrier
  ds_read_b64_tr_b16 v[16:17], v11 offset:12288
  v_sub_u32 v218, v218, v223
  v_mfma_f32_16x16x32_bf16 v[172:175], v[24:27], a[112:115], v[172:175]
  ds_read_b64_tr_b16 v[18:19], v11 offset:12544
  v_lshlrev_b32 v218, 4, v218
  v_mfma_f32_16x16x32_bf16 v[176:179], v[24:27], a[184:187], v[176:179]
  v_mul_u32_u24 v222, 73728, v222
  v_mfma_f32_16x16x32_bf16 v[180:183], v[24:27], v[224:227], v[180:183]
  buffer_load_dwordx4 v2, s[12:15], s53 offen offset:2048 lds
  v_mfma_f32_16x16x32_bf16 v[184:187], v[28:31], a[40:43], v[184:187]
  ds_read_b64_tr_b16 v[20:21], v11 offset:18432
  v_mfma_f32_16x16x32_bf16 v[188:191], v[28:31], a[112:115], v[188:191]
  ds_read_b64_tr_b16 v[22:23], v11 offset:18688
  v_add_u32 v218, v218, v222
  v_mfma_f32_16x16x32_bf16 v[192:195], v[28:31], a[184:187], v[192:195]
  v_bfe_u32 v222, v1, 4, 1
  v_mfma_f32_16x16x32_bf16 v[196:199], v[28:31], v[224:227], v[196:199]
  s_waitcnt lgkmcnt(4)
  v_mul_u32_u24 v222, 288, v222
  v_mfma_f32_16x16x32_bf16 v[168:171], v[32:35], a[44:47], v[168:171]
  ds_read_b64_tr_b16 v[24:25], v11 offset:14336
  v_add_u32 v218, v218, v222
  v_mfma_f32_16x16x32_bf16 v[172:175], v[32:35], a[116:119], v[172:175]
  ds_read_b64_tr_b16 v[26:27], v11 offset:14592
  v_lshrrev_b32 v222, 5, v1
  v_mfma_f32_16x16x32_bf16 v[176:179], v[32:35], a[188:191], v[176:179]
  v_lshl_add_u32 v218, v222, 3, v218
  v_mfma_f32_16x16x32_bf16 v[180:183], v[32:35], v[228:231], v[180:183]
  s_lshl_b32 s27, s23, 6
  v_mfma_f32_16x16x32_bf16 v[184:187], v[36:39], a[44:47], v[184:187]
  ds_read_b64_tr_b16 v[28:29], v11 offset:20480
  s_sub_u32 s27, s27, 1104
  v_mfma_f32_16x16x32_bf16 v[188:191], v[36:39], a[116:119], v[188:191]
  ds_read_b64_tr_b16 v[30:31], v11 offset:20736
  v_mfma_f32_16x16x32_bf16 v[192:195], v[36:39], a[188:191], v[192:195]
  s_add_u32 m0, s33, 98304
  v_mfma_f32_16x16x32_bf16 v[196:199], v[36:39], v[228:231], v[196:199]
  s_waitcnt lgkmcnt(4)
  v_and_b32 v219, 15, v1
  v_mfma_f32_16x16x32_bf16 v[168:171], v[16:19], a[48:51], v[168:171]
  ds_read_b64_tr_b16 v[32:33], v11 offset:16384
  v_add_u32 v219, s27, v219
  v_mfma_f32_16x16x32_bf16 v[172:175], v[16:19], a[120:123], v[172:175]
  ds_read_b64_tr_b16 v[34:35], v11 offset:16640
  v_mul_u32_u24 v222, 3641, v219
  v_mfma_f32_16x16x32_bf16 v[176:179], v[16:19], a[192:195], v[176:179]
  v_lshrrev_b32 v222, 16, v222
  v_mfma_f32_16x16x32_bf16 v[180:183], v[16:19], v[232:235], v[180:183]
  v_mul_u32_u24 v223, 18, v222
  v_mfma_f32_16x16x32_bf16 v[184:187], v[20:23], a[48:51], v[184:187]
  ds_read_b64_tr_b16 v[36:37], v11 offset:22528
  v_sub_u32 v219, v219, v223
  v_mfma_f32_16x16x32_bf16 v[188:191], v[20:23], a[120:123], v[188:191]
  ds_read_b64_tr_b16 v[38:39], v11 offset:22784
  v_lshlrev_b32 v219, 4, v219
  v_mfma_f32_16x16x32_bf16 v[192:195], v[20:23], a[192:195], v[192:195]
  v_mul_u32_u24 v222, 73728, v222
  v_mfma_f32_16x16x32_bf16 v[196:199], v[20:23], v[232:235], v[196:199]
  s_waitcnt lgkmcnt(4)
  v_mfma_f32_16x16x32_bf16 v[168:171], v[24:27], a[52:55], v[168:171]
  ds_read_b64_tr_b16 v[16:17], v11 offset:24576
  buffer_load_dwordx4 v2, s[12:15], s54 offen offset:0 lds
  v_mfma_f32_16x16x32_bf16 v[172:175], v[24:27], a[124:127], v[172:175]
  ds_read_b64_tr_b16 v[18:19], v11 offset:24832
  v_add_u32 v219, v219, v222
  v_mfma_f32_16x16x32_bf16 v[176:179], v[24:27], a[196:199], v[176:179]
  v_bfe_u32 v222, v1, 4, 1
  v_mfma_f32_16x16x32_bf16 v[180:183], v[24:27], v[236:239], v[180:183]
  v_mul_u32_u24 v222, 288, v222
  v_mfma_f32_16x16x32_bf16 v[184:187], v[28:31], a[52:55], v[184:187]
  ds_read_b64_tr_b16 v[20:21], v11 offset:30720
  v_add_u32 v219, v219, v222
  v_mfma_f32_16x16x32_bf16 v[188:191], v[28:31], a[124:127], v[188:191]
  ds_read_b64_tr_b16 v[22:23], v11 offset:30976
  v_lshrrev_b32 v222, 5, v1
  v_mfma_f32_16x16x32_bf16 v[192:195], v[28:31], a[196:199], v[192:195]
  v_lshl_add_u32 v219, v222, 3, v219
  v_mfma_f32_16x16x32_bf16 v[196:199], v[28:31], v[236:239], v[196:199]
  s_waitcnt lgkmcnt(4)
  v_cvt_pk_bf16_f32 v40, v72, v73
  v_mfma_f32_16x16x32_bf16 v[168:171], v[32:35], a[56:59], v[168:171]
  ds_read_b64_tr_b16 v[24:25], v11 offset:26624
  v_mfma_f32_16x16x32_bf16 v[172:175], v[32:35], a[128:131], v[172:175]
  ds_read_b64_tr_b16 v[26:27], v11 offset:26880
  v_cvt_pk_bf16_f32 v41, v74, v75
  v_mfma_f32_16x16x32_bf16 v[176:179], v[32:35], a[200:203], v[176:179]
  v_cvt_pk_bf16_f32 v42, v76, v77
  v_mfma_f32_16x16x32_bf16 v[180:183], v[32:35], v[240:243], v[180:183]
  v_cvt_pk_bf16_f32 v43, v78, v79
  v_mfma_f32_16x16x32_bf16 v[184:187], v[36:39], a[56:59], v[184:187]
  ds_read_b64_tr_b16 v[28:29], v11 offset:32768
  v_cvt_pk_bf16_f32 v44, v80, v81
  v_mfma_f32_16x16x32_bf16 v[188:191], v[36:39], a[128:131], v[188:191]
  ds_read_b64_tr_b16 v[30:31], v11 offset:33024
  v_cvt_pk_bf16_f32 v45, v82, v83
  v_mfma_f32_16x16x32_bf16 v[192:195], v[36:39], a[200:203], v[192:195]
  v_cvt_pk_bf16_f32 v46, v84, v85
  v_mfma_f32_16x16x32_bf16 v[196:199], v[36:39], v[240:243], v[196:199]
  s_waitcnt lgkmcnt(4)
  v_cvt_pk_bf16_f32 v47, v86, v87
  v_mfma_f32_16x16x32_bf16 v[168:171], v[16:19], a[60:63], v[168:171]
  ds_read_b64_tr_b16 v[32:33], v11 offset:28672
  v_cvt_pk_bf16_f32 v48, v88, v89
  v_mfma_f32_16x16x32_bf16 v[172:175], v[16:19], a[132:135], v[172:175]
  ds_read_b64_tr_b16 v[34:35], v11 offset:28928
  v_mfma_f32_16x16x32_bf16 v[176:179], v[16:19], a[204:207], v[176:179]
  v_cvt_pk_bf16_f32 v49, v90, v91
  v_mfma_f32_16x16x32_bf16 v[180:183], v[16:19], v[244:247], v[180:183]
  v_cvt_pk_bf16_f32 v50, v92, v93
  v_mfma_f32_16x16x32_bf16 v[184:187], v[20:23], a[60:63], v[184:187]
  ds_read_b64_tr_b16 v[36:37], v11 offset:34816
  v_cvt_pk_bf16_f32 v51, v94, v95
  v_mfma_f32_16x16x32_bf16 v[188:191], v[20:23], a[132:135], v[188:191]
  ds_read_b64_tr_b16 v[38:39], v11 offset:35072
  v_cvt_pk_bf16_f32 v52, v96, v97
  v_mfma_f32_16x16x32_bf16 v[192:195], v[20:23], a[204:207], v[192:195]
  v_cvt_pk_bf16_f32 v53, v98, v99
  v_mfma_f32_16x16x32_bf16 v[196:199], v[20:23], v[244:247], v[196:199]
  s_waitcnt lgkmcnt(4)
  v_cvt_pk_bf16_f32 v54, v100, v101
  v_mfma_f32_16x16x32_bf16 v[168:171], v[24:27], a[64:67], v[168:171]
  ds_read_b64_tr_b16 v[16:17], v12 offset:0
  v_cvt_pk_bf16_f32 v55, v102, v103
  v_mfma_f32_16x16x32_bf16 v[172:175], v[24:27], a[136:139], v[172:175]
  ds_read_b64_tr_b16 v[18:19], v12 offset:256
  buffer_store_dwordx2 v[40:41], v218, s[16:19], s37 offen offset:0 sc1
  v_mfma_f32_16x16x32_bf16 v[176:179], v[24:27], a[208:211], v[176:179]
  v_mfma_f32_16x16x32_bf16 v[180:183], v[24:27], v[248:251], v[180:183]
  buffer_store_dwordx2 v[42:43], v218, s[16:19], s37 offen offset:576 sc1
  v_mfma_f32_16x16x32_bf16 v[184:187], v[28:31], a[64:67], v[184:187]
  ds_read_b64_tr_b16 v[20:21], v12 offset:6144
  buffer_store_dwordx2 v[44:45], v218, s[16:19], s37 offen offset:1152 sc1
  v_mfma_f32_16x16x32_bf16 v[188:191], v[28:31], a[136:139], v[188:191]
  ds_read_b64_tr_b16 v[22:23], v12 offset:6400
  buffer_store_dwordx2 v[46:47], v218, s[16:19], s37 offen offset:1728 sc1
  v_mfma_f32_16x16x32_bf16 v[192:195], v[28:31], a[208:211], v[192:195]
  buffer_store_dwordx2 v[48:49], v219, s[16:19], s37 offen offset:0 sc1
  v_mfma_f32_16x16x32_bf16 v[196:199], v[28:31], v[248:251], v[196:199]
  s_waitcnt lgkmcnt(4)
  buffer_store_dwordx2 v[50:51], v219, s[16:19], s37 offen offset:576 sc1
  v_mfma_f32_16x16x32_bf16 v[168:171], v[32:35], a[68:71], v[168:171]
  ds_read_b64_tr_b16 v[24:25], v12 offset:2048
  buffer_store_dwordx2 v[52:53], v219, s[16:19], s37 offen offset:1152 sc1
  v_mfma_f32_16x16x32_bf16 v[172:175], v[32:35], a[140:143], v[172:175]
  ds_read_b64_tr_b16 v[26:27], v12 offset:2304
  buffer_store_dwordx2 v[54:55], v219, s[16:19], s37 offen offset:1728 sc1
  v_mfma_f32_16x16x32_bf16 v[176:179], v[32:35], a[212:215], v[176:179]
  v_mfma_f32_16x16x32_bf16 v[180:183], v[32:35], v[252:255], v[180:183]
  v_mfma_f32_16x16x32_bf16 v[184:187], v[36:39], a[68:71], v[184:187]
  ds_read_b64_tr_b16 v[28:29], v12 offset:8192
  v_mfma_f32_16x16x32_bf16 v[188:191], v[36:39], a[140:143], v[188:191]
  ds_read_b64_tr_b16 v[30:31], v12 offset:8448
  v_mfma_f32_16x16x32_bf16 v[192:195], v[36:39], a[212:215], v[192:195]
  v_mfma_f32_16x16x32_bf16 v[196:199], v[36:39], v[252:255], v[196:199]
  s_waitcnt lgkmcnt(4)
  v_mov_b32 v11, v12
  v_add_u32 v12, 73728, v9
  v_mfma_f32_16x16x32_bf16 v[40:43], v[16:19], a[0:3], 0
  ds_read_b64_tr_b16 v[32:33], v11 offset:4096
  v_mfma_f32_16x16x32_bf16 v[44:47], v[16:19], a[72:75], 0
  ds_read_b64_tr_b16 v[34:35], v11 offset:4352
  v_mfma_f32_16x16x32_bf16 v[48:51], v[16:19], a[144:147], 0
  buffer_load_dwordx4 v2, s[12:15], s55 offen offset:1024 lds
  v_mfma_f32_16x16x32_bf16 v[52:55], v[16:19], a[216:219], 0
  v_exp_f32 v200, -v104
  v_mfma_f32_16x16x32_bf16 v[56:59], v[20:23], a[0:3], 0
  ds_read_b64_tr_b16 v[36:37], v11 offset:10240
  v_mfma_f32_16x16x32_bf16 v[60:63], v[20:23], a[72:75], 0
  ds_read_b64_tr_b16 v[38:39], v11 offset:10496
  v_mfma_f32_16x16x32_bf16 v[64:67], v[20:23], a[144:147], 0
  v_exp_f32 v201, -v105
  v_mfma_f32_16x16x32_bf16 v[68:71], v[20:23], a[216:219], 0
  s_waitcnt lgkmcnt(4)
  v_mfma_f32_16x16x32_bf16 v[40:43], v[24:27], a[4:7], v[40:43]
  ds_read_b64_tr_b16 v[16:17], v11 offset:12288
  v_exp_f32 v202, -v106
  v_mfma_f32_16x16x32_bf16 v[44:47], v[24:27], a[76:79], v[44:47]
  ds_read_b64_tr_b16 v[18:19], v11 offset:12544
  v_exp_f32 v203, -v107
  v_mfma_f32_16x16x32_bf16 v[48:51], v[24:27], a[148:151], v[48:51]
  v_exp_f32 v204, -v108
  v_mfma_f32_16x16x32_bf16 v[52:55], v[24:27], a[220:223], v[52:55]
  v_exp_f32 v205, -v109
  v_mfma_f32_16x16x32_bf16 v[56:59], v[28:31], a[4:7], v[56:59]
  ds_read_b64_tr_b16 v[20:21], v11 offset:18432
  v_mfma_f32_16x16x32_bf16 v[60:63], v[28:31], a[76:79], v[60:63]
  ds_read_b64_tr_b16 v[22:23], v11 offset:18688
  v_exp_f32 v206, -v110
  v_mfma_f32_16x16x32_bf16 v[64:67], v[28:31], a[148:151], v[64:67]
  v_exp_f32 v207, -v111
  v_mfma_f32_16x16x32_bf16 v[68:71], v[28:31], a[220:223], v[68:71]
  s_waitcnt lgkmcnt(4)
  v_mul_f32 v104, v104, v120
  v_mfma_f32_16x16x32_bf16 v[40:43], v[32:35], a[8:11], v[40:43]
  ds_read_b64_tr_b16 v[24:25], v11 offset:14336
  buffer_load_dwordx4 v2, s[12:15], s56 offen offset:2048 lds
  v_mul_f32 v105, v105, v121
  v_mfma_f32_16x16x32_bf16 v[44:47], v[32:35], a[80:83], v[44:47]
  ds_read_b64_tr_b16 v[26:27], v11 offset:14592
  v_mul_f32 v106, v106, v122
  v_mfma_f32_16x16x32_bf16 v[48:51], v[32:35], a[152:155], v[48:51]
  v_mul_f32 v107, v107, v123
  v_mul_f32 v108, v108, v124
  v_mfma_f32_16x16x32_bf16 v[52:55], v[32:35], a[224:227], v[52:55]
  v_mul_f32 v109, v109, v125
  v_mul_f32 v110, v110, v126
  v_mfma_f32_16x16x32_bf16 v[56:59], v[36:39], a[8:11], v[56:59]
  ds_read_b64_tr_b16 v[28:29], v11 offset:20480
  v_mul_f32 v111, v111, v127
  v_mfma_f32_16x16x32_bf16 v[60:63], v[36:39], a[80:83], v[60:63]
  ds_read_b64_tr_b16 v[30:31], v11 offset:20736
  v_add_f32 v200, 1.0, v200
  s_add_u32 m0, s33, 110592
  v_mfma_f32_16x16x32_bf16 v[64:67], v[36:39], a[152:155], v[64:67]
  v_add_f32 v201, 1.0, v201
  v_add_f32 v202, 1.0, v202
  v_mfma_f32_16x16x32_bf16 v[68:71], v[36:39], a[224:227], v[68:71]
  s_waitcnt lgkmcnt(4)
  v_add_f32 v203, 1.0, v203
  v_mfma_f32_16x16x32_bf16 v[40:43], v[16:19], a[12:15], v[40:43]
  ds_read_b64_tr_b16 v[32:33], v11 offset:16384
  v_add_f32 v204, 1.0, v204
  v_add_f32 v205, 1.0, v205
  v_mfma_f32_16x16x32_bf16 v[44:47], v[16:19], a[84:87], v[44:47]
  ds_read_b64_tr_b16 v[34:35], v11 offset:16640
  v_add_f32 v206, 1.0, v206
  v_add_f32 v207, 1.0, v207
  v_mfma_f32_16x16x32_bf16 v[48:51], v[16:19], a[156:159], v[48:51]
  v_rcp_f32 v200, v200
  v_mfma_f32_16x16x32_bf16 v[52:55], v[16:19], a[228:231], v[52:55]
  buffer_load_dwordx4 v2, s[12:15], s57 offen offset:0 lds
  v_mfma_f32_16x16x32_bf16 v[56:59], v[20:23], a[12:15], v[56:59]
  ds_read_b64_tr_b16 v[36:37], v11 offset:22528
  v_rcp_f32 v201, v201
  v_mfma_f32_16x16x32_bf16 v[60:63], v[20:23], a[84:87], v[60:63]
  ds_read_b64_tr_b16 v[38:39], v11 offset:22784
  v_rcp_f32 v202, v202
  v_mfma_f32_16x16x32_bf16 v[64:67], v[20:23], a[156:159], v[64:67]
  v_rcp_f32 v203, v203
  v_mfma_f32_16x16x32_bf16 v[68:71], v[20:23], a[228:231], v[68:71]
  s_waitcnt lgkmcnt(4)
  v_rcp_f32 v204, v204
  v_mfma_f32_16x16x32_bf16 v[40:43], v[24:27], a[16:19], v[40:43]
  ds_read_b64_tr_b16 v[16:17], v11 offset:24576
  v_mfma_f32_16x16x32_bf16 v[44:47], v[24:27], a[88:91], v[44:47]
  ds_read_b64_tr_b16 v[18:19], v11 offset:24832
  v_rcp_f32 v205, v205
  v_mfma_f32_16x16x32_bf16 v[48:51], v[24:27], a[160:163], v[48:51]
  v_rcp_f32 v206, v206
  v_mfma_f32_16x16x32_bf16 v[52:55], v[24:27], a[232:235], v[52:55]
  v_rcp_f32 v207, v207
  v_mfma_f32_16x16x32_bf16 v[56:59], v[28:31], a[16:19], v[56:59]
  ds_read_b64_tr_b16 v[20:21], v11 offset:30720
  v_mul_f32 v104, v104, v200
  v_mfma_f32_16x16x32_bf16 v[60:63], v[28:31], a[88:91], v[60:63]
  ds_read_b64_tr_b16 v[22:23], v11 offset:30976
  buffer_load_dwordx4 v2, s[12:15], s58 offen offset:1024 lds
  v_mul_f32 v105, v105, v201
  v_mfma_f32_16x16x32_bf16 v[64:67], v[28:31], a[160:163], v[64:67]
  v_mul_f32 v106, v106, v202
  v_mul_f32 v107, v107, v203
  v_mfma_f32_16x16x32_bf16 v[68:71], v[28:31], a[232:235], v[68:71]
  s_waitcnt lgkmcnt(4)
  v_mul_f32 v108, v108, v204
  v_mfma_f32_16x16x32_bf16 v[40:43], v[32:35], a[20:23], v[40:43]
  ds_read_b64_tr_b16 v[24:25], v11 offset:26624
  v_mul_f32 v109, v109, v205
  v_mul_f32 v110, v110, v206
  v_mfma_f32_16x16x32_bf16 v[44:47], v[32:35], a[92:95], v[44:47]
  ds_read_b64_tr_b16 v[26:27], v11 offset:26880
  v_mul_f32 v111, v111, v207
  v_mfma_f32_16x16x32_bf16 v[48:51], v[32:35], a[164:167], v[48:51]
  v_cvt_pk_bf16_f32 v216, v104, v105
  buffer_load_dwordx4 v2, s[12:15], s59 offen offset:2048 lds
  v_mfma_f32_16x16x32_bf16 v[52:55], v[32:35], a[236:239], v[52:55]
  v_cvt_pk_bf16_f32 v217, v106, v107
  v_cvt_pk_bf16_f32 v218, v108, v109
  v_mfma_f32_16x16x32_bf16 v[56:59], v[36:39], a[20:23], v[56:59]
  ds_read_b64_tr_b16 v[28:29], v11 offset:32768
  v_cvt_pk_bf16_f32 v219, v110, v111
  v_mfma_f32_16x16x32_bf16 v[60:63], v[36:39], a[92:95], v[60:63]
  ds_read_b64_tr_b16 v[30:31], v11 offset:33024
  buffer_store_dwordx2 v[216:217], v13, s[16:19], s29 offen offset:0 sc1
  buffer_store_dwordx2 v[218:219], v13, s[16:19], s29 offen offset:256 sc1
  v_mfma_f32_16x16x32_bf16 v[64:67], v[36:39], a[164:167], v[64:67]
  v_exp_f32 v208, -v112
  v_mfma_f32_16x16x32_bf16 v[68:71], v[36:39], a[236:239], v[68:71]
  s_waitcnt lgkmcnt(4)
  v_exp_f32 v209, -v113
  v_mfma_f32_16x16x32_bf16 v[40:43], v[16:19], a[24:27], v[40:43]
  ds_read_b64_tr_b16 v[32:33], v11 offset:28672
  v_exp_f32 v210, -v114
  v_mfma_f32_16x16x32_bf16 v[44:47], v[16:19], a[96:99], v[44:47]
  ds_read_b64_tr_b16 v[34:35], v11 offset:28928
  s_add_u32 m0, s33, 122880
  v_mfma_f32_16x16x32_bf16 v[48:51], v[16:19], a[168:171], v[48:51]
  v_exp_f32 v211, -v115
  v_mfma_f32_16x16x32_bf16 v[52:55], v[16:19], a[240:243], v[52:55]
  v_exp_f32 v212, -v116
  v_mfma_f32_16x16x32_bf16 v[56:59], v[20:23], a[24:27], v[56:59]
  ds_read_b64_tr_b16 v[36:37], v11 offset:34816
  v_exp_f32 v213, -v117
  v_mfma_f32_16x16x32_bf16 v[60:63], v[20:23], a[96:99], v[60:63]
  ds_read_b64_tr_b16 v[38:39], v11 offset:35072
  v_mfma_f32_16x16x32_bf16 v[64:67], v[20:23], a[168:171], v[64:67]
  v_exp_f32 v214, -v118
  v_mfma_f32_16x16x32_bf16 v[68:71], v[20:23], a[240:243], v[68:71]
  s_waitcnt lgkmcnt(4)
  v_exp_f32 v215, -v119
  v_mfma_f32_16x16x32_bf16 v[40:43], v[24:27], a[28:31], v[40:43]
  v_add_u32 v11, 36864, v11
  ds_read_b64_tr_b16 v[16:17], v11 offset:0
  v_mul_f32 v112, v112, v128
  v_mfma_f32_16x16x32_bf16 v[44:47], v[24:27], a[100:103], v[44:47]
  ds_read_b64_tr_b16 v[18:19], v11 offset:256
  v_mul_f32 v113, v113, v129
  v_mul_f32 v114, v114, v130
  v_mfma_f32_16x16x32_bf16 v[48:51], v[24:27], a[172:175], v[48:51]
  buffer_load_dwordx4 v2, s[12:15], s60 offen offset:0 lds
  v_mul_f32 v115, v115, v131
  v_mfma_f32_16x16x32_bf16 v[52:55], v[24:27], a[244:247], v[52:55]
  v_mul_f32 v116, v116, v132
  v_mul_f32 v117, v117, v133
  v_mfma_f32_16x16x32_bf16 v[56:59], v[28:31], a[28:31], v[56:59]
  ds_read_b64_tr_b16 v[20:21], v11 offset:6144
  v_mul_f32 v118, v118, v134
  v_mfma_f32_16x16x32_bf16 v[60:63], v[28:31], a[100:103], v[60:63]
  ds_read_b64_tr_b16 v[22:23], v11 offset:6400
  v_mul_f32 v119, v119, v135
  v_add_f32 v208, 1.0, v208
  v_mfma_f32_16x16x32_bf16 v[64:67], v[28:31], a[172:175], v[64:67]
  v_add_f32 v209, 1.0, v209
  v_add_f32 v210, 1.0, v210
  v_mfma_f32_16x16x32_bf16 v[68:71], v[28:31], a[244:247], v[68:71]
  s_waitcnt lgkmcnt(4)
  buffer_load_dwordx4 v2, s[12:15], s61 offen offset:1024 lds
  v_mfma_f32_16x16x32_bf16 v[40:43], v[32:35], a[32:35], v[40:43]
  ds_read_b64_tr_b16 v[24:25], v11 offset:2048
  v_add_f32 v211, 1.0, v211
  v_add_f32 v212, 1.0, v212
  v_mfma_f32_16x16x32_bf16 v[44:47], v[32:35], a[104:107], v[44:47]
  ds_read_b64_tr_b16 v[26:27], v11 offset:2304
  v_add_f32 v213, 1.0, v213
  v_add_f32 v214, 1.0, v214
  v_mfma_f32_16x16x32_bf16 v[48:51], v[32:35], a[176:179], v[48:51]
  v_add_f32 v215, 1.0, v215
  v_mfma_f32_16x16x32_bf16 v[52:55], v[32:35], a[248:251], v[52:55]
  v_rcp_f32 v208, v208
  v_mfma_f32_16x16x32_bf16 v[56:59], v[36:39], a[32:35], v[56:59]
  ds_read_b64_tr_b16 v[28:29], v11 offset:8192
  v_rcp_f32 v209, v209
  v_mfma_f32_16x16x32_bf16 v[60:63], v[36:39], a[104:107], v[60:63]
  ds_read_b64_tr_b16 v[30:31], v11 offset:8448
  v_rcp_f32 v210, v210
  v_mfma_f32_16x16x32_bf16 v[64:67], v[36:39], a[176:179], v[64:67]
  buffer_load_dwordx4 v2, s[12:15], s62 offen offset:2048 lds
  v_mfma_f32_16x16x32_bf16 v[68:71], v[36:39], a[248:251], v[68:71]
  s_waitcnt lgkmcnt(4)
  v_rcp_f32 v211, v211
  v_mfma_f32_16x16x32_bf16 v[40:43], v[16:19], a[36:39], v[40:43]
  ds_read_b64_tr_b16 v[32:33], v11 offset:4096
  v_rcp_f32 v212, v212
  v_mfma_f32_16x16x32_bf16 v[44:47], v[16:19], a[108:111], v[44:47]
  ds_read_b64_tr_b16 v[34:35], v11 offset:4352
  v_rcp_f32 v213, v213
  v_mfma_f32_16x16x32_bf16 v[48:51], v[16:19], a[180:183], v[48:51]
  v_rcp_f32 v214, v214
  v_mfma_f32_16x16x32_bf16 v[52:55], v[16:19], a[252:255], v[52:55]
  v_rcp_f32 v215, v215
  v_mfma_f32_16x16x32_bf16 v[56:59], v[20:23], a[36:39], v[56:59]
  ds_read_b64_tr_b16 v[36:37], v11 offset:10240
  v_mul_f32 v112, v112, v208
  v_mfma_f32_16x16x32_bf16 v[60:63], v[20:23], a[108:111], v[60:63]
  ds_read_b64_tr_b16 v[38:39], v11 offset:10496
  v_mul_f32 v113, v113, v209
  v_mfma_f32_16x16x32_bf16 v[64:67], v[20:23], a[180:183], v[64:67]
  v_mul_f32 v114, v114, v210
  s_add_u32 m0, s33, 135168
  v_mfma_f32_16x16x32_bf16 v[68:71], v[20:23], a[252:255], v[68:71]
  s_waitcnt lgkmcnt(4)
  v_mul_f32 v115, v115, v211
  v_mfma_f32_16x16x32_bf16 v[40:43], v[24:27], a[40:43], v[40:43]
  ds_read_b64_tr_b16 v[16:17], v11 offset:12288
  v_mul_f32 v116, v116, v212
  v_mul_f32 v117, v117, v213
  v_mfma_f32_16x16x32_bf16 v[44:47], v[24:27], a[112:115], v[44:47]
  ds_read_b64_tr_b16 v[18:19], v11 offset:12544
  v_mul_f32 v118, v118, v214
  v_mfma_f32_16x16x32_bf16 v[48:51], v[24:27], a[184:187], v[48:51]
  v_mul_f32 v119, v119, v215
  v_cvt_pk_bf16_f32 v220, v112, v113
  v_mfma_f32_16x16x32_bf16 v[52:55], v[24:27], v[224:227], v[52:55]
  v_cvt_pk_bf16_f32 v221, v114, v115
  v_cvt_pk_bf16_f32 v222, v116, v117
  v_mfma_f32_16x16x32_bf16 v[56:59], v[28:31], a[40:43], v[56:59]
  ds_read_b64_tr_b16 v[20:21], v11 offset:18432
  buffer_load_dwordx4 v2, s[12:15], s63 offen offset:0 lds
  v_mfma_f32_16x16x32_bf16 v[60:63], v[28:31], a[112:115], v[60:63]
  ds_read_b64_tr_b16 v[22:23], v11 offset:18688
  v_cvt_pk_bf16_f32 v223, v118, v119
  s_add_u32 s30, s29, 294912
  v_mfma_f32_16x16x32_bf16 v[64:67], v[28:31], a[184:187], v[64:67]
  buffer_store_dwordx2 v[220:221], v13, s[16:19], s30 offen offset:0 sc1
  buffer_store_dwordx2 v[222:223], v13, s[16:19], s30 offen offset:256 sc1
  v_mfma_f32_16x16x32_bf16 v[68:71], v[28:31], v[224:227], v[68:71]
  s_waitcnt lgkmcnt(4)
  s_add_u32 s29, s29, 1024
  v_mfma_f32_16x16x32_bf16 v[40:43], v[32:35], a[44:47], v[40:43]
  ds_read_b64_tr_b16 v[24:25], v11 offset:14336
  v_exp_f32 v200, -v136
  v_mfma_f32_16x16x32_bf16 v[44:47], v[32:35], a[116:119], v[44:47]
  ds_read_b64_tr_b16 v[26:27], v11 offset:14592
  v_exp_f32 v201, -v137
  v_mfma_f32_16x16x32_bf16 v[48:51], v[32:35], a[188:191], v[48:51]
  v_exp_f32 v202, -v138
  v_mfma_f32_16x16x32_bf16 v[52:55], v[32:35], v[228:231], v[52:55]
  buffer_load_dwordx4 v2, s[12:15], s64 offen offset:1024 lds
  v_mfma_f32_16x16x32_bf16 v[56:59], v[36:39], a[44:47], v[56:59]
  ds_read_b64_tr_b16 v[28:29], v11 offset:20480
  v_exp_f32 v203, -v139
  v_mfma_f32_16x16x32_bf16 v[60:63], v[36:39], a[116:119], v[60:63]
  ds_read_b64_tr_b16 v[30:31], v11 offset:20736
  v_exp_f32 v204, -v140
  v_mfma_f32_16x16x32_bf16 v[64:67], v[36:39], a[188:191], v[64:67]
  v_exp_f32 v205, -v141
  v_mfma_f32_16x16x32_bf16 v[68:71], v[36:39], v[228:231], v[68:71]
  s_waitcnt lgkmcnt(4)
  v_exp_f32 v206, -v142
  v_mfma_f32_16x16x32_bf16 v[40:43], v[16:19], a[48:51], v[40:43]
  ds_read_b64_tr_b16 v[32:33], v11 offset:16384
  v_mfma_f32_16x16x32_bf16 v[44:47], v[16:19], a[120:123], v[44:47]
  ds_read_b64_tr_b16 v[34:35], v11 offset:16640
  v_exp_f32 v207, -v143
  v_mfma_f32_16x16x32_bf16 v[48:51], v[16:19], a[192:195], v[48:51]
  v_mul_f32 v136, v136, v152
  v_mul_f32 v137, v137, v153
  v_mfma_f32_16x16x32_bf16 v[52:55], v[16:19], v[232:235], v[52:55]
  v_mul_f32 v138, v138, v154
  buffer_load_dwordx4 v2, s[12:15], s65 offen offset:2048 lds
  v_mfma_f32_16x16x32_bf16 v[56:59], v[20:23], a[48:51], v[56:59]
  ds_read_b64_tr_b16 v[36:37], v11 offset:22528
  v_mul_f32 v139, v139, v155
  v_mfma_f32_16x16x32_bf16 v[60:63], v[20:23], a[120:123], v[60:63]
  ds_read_b64_tr_b16 v[38:39], v11 offset:22784
  v_mul_f32 v140, v140, v156
  v_mul_f32 v141, v141, v157
  v_mfma_f32_16x16x32_bf16 v[64:67], v[20:23], a[192:195], v[64:67]
  v_mul_f32 v142, v142, v158
  v_mul_f32 v143, v143, v159
  v_mfma_f32_16x16x32_bf16 v[68:71], v[20:23], v[232:235], v[68:71]
  s_waitcnt lgkmcnt(4)
  v_add_f32 v200, 1.0, v200
  v_mfma_f32_16x16x32_bf16 v[40:43], v[24:27], a[52:55], v[40:43]
  ds_read_b64_tr_b16 v[16:17], v11 offset:24576
  v_add_f32 v201, 1.0, v201
  v_add_f32 v202, 1.0, v202
  v_mfma_f32_16x16x32_bf16 v[44:47], v[24:27], a[124:127], v[44:47]
  ds_read_b64_tr_b16 v[18:19], v11 offset:24832
  v_add_f32 v203, 1.0, v203
  v_mfma_f32_16x16x32_bf16 v[48:51], v[24:27], a[196:199], v[48:51]
  v_add_f32 v204, 1.0, v204
  v_add_f32 v205, 1.0, v205
  v_mfma_f32_16x16x32_bf16 v[52:55], v[24:27], v[236:239], v[52:55]
  v_add_f32 v206, 1.0, v206
  v_add_f32 v207, 1.0, v207
  v_mfma_f32_16x16x32_bf16 v[56:59], v[28:31], a[52:55], v[56:59]
  ds_read_b64_tr_b16 v[20:21], v11 offset:30720
  v_rcp_f32 v200, v200
  v_mfma_f32_16x16x32_bf16 v[60:63], v[28:31], a[124:127], v[60:63]
  ds_read_b64_tr_b16 v[22:23], v11 offset:30976
  v_rcp_f32 v201, v201
  v_mfma_f32_16x16x32_bf16 v[64:67], v[28:31], a[196:199], v[64:67]
  v_rcp_f32 v202, v202
  v_mfma_f32_16x16x32_bf16 v[68:71], v[28:31], v[236:239], v[68:71]
  s_waitcnt lgkmcnt(4)
  v_mfma_f32_16x16x32_bf16 v[40:43], v[32:35], a[56:59], v[40:43]
  ds_read_b64_tr_b16 v[24:25], v11 offset:26624
  v_rcp_f32 v203, v203
  v_mfma_f32_16x16x32_bf16 v[44:47], v[32:35], a[128:131], v[44:47]
  ds_read_b64_tr_b16 v[26:27], v11 offset:26880
  v_rcp_f32 v204, v204
  v_mfma_f32_16x16x32_bf16 v[48:51], v[32:35], a[200:203], v[48:51]
  v_rcp_f32 v205, v205
  v_mfma_f32_16x16x32_bf16 v[52:55], v[32:35], v[240:243], v[52:55]
  v_rcp_f32 v206, v206
  v_mfma_f32_16x16x32_bf16 v[56:59], v[36:39], a[56:59], v[56:59]
  ds_read_b64_tr_b16 v[28:29], v11 offset:32768
  v_rcp_f32 v207, v207
  v_mfma_f32_16x16x32_bf16 v[60:63], v[36:39], a[128:131], v[60:63]
  ds_read_b64_tr_b16 v[30:31], v11 offset:33024
  v_mul_f32 v136, v136, v200
  v_mfma_f32_16x16x32_bf16 v[64:67], v[36:39], a[200:203], v[64:67]
  v_mul_f32 v137, v137, v201
  v_mul_f32 v138, v138, v202
  v_mfma_f32_16x16x32_bf16 v[68:71], v[36:39], v[240:243], v[68:71]
  s_waitcnt lgkmcnt(4)
  v_mul_f32 v139, v139, v203
  v_mfma_f32_16x16x32_bf16 v[40:43], v[16:19], a[60:63], v[40:43]
  ds_read_b64_tr_b16 v[32:33], v11 offset:28672
  v_mul_f32 v140, v140, v204
  v_mfma_f32_16x16x32_bf16 v[44:47], v[16:19], a[132:135], v[44:47]
  ds_read_b64_tr_b16 v[34:35], v11 offset:28928
  v_mul_f32 v141, v141, v205
  v_mul_f32 v142, v142, v206
  v_mfma_f32_16x16x32_bf16 v[48:51], v[16:19], a[204:207], v[48:51]
  v_mul_f32 v143, v143, v207
  v_cvt_pk_bf16_f32 v216, v136, v137
  v_mfma_f32_16x16x32_bf16 v[52:55], v[16:19], v[244:247], v[52:55]
  v_cvt_pk_bf16_f32 v217, v138, v139
  v_cvt_pk_bf16_f32 v218, v140, v141
  v_mfma_f32_16x16x32_bf16 v[56:59], v[20:23], a[60:63], v[56:59]
  ds_read_b64_tr_b16 v[36:37], v11 offset:34816
  v_mfma_f32_16x16x32_bf16 v[60:63], v[20:23], a[132:135], v[60:63]
  ds_read_b64_tr_b16 v[38:39], v11 offset:35072
  v_mfma_f32_16x16x32_bf16 v[64:67], v[20:23], a[204:207], v[64:67]
  v_mfma_f32_16x16x32_bf16 v[68:71], v[20:23], v[244:247], v[68:71]
  s_waitcnt lgkmcnt(4)
  v_mfma_f32_16x16x32_bf16 v[40:43], v[24:27], a[64:67], v[40:43]
  s_waitcnt vmcnt(0)
  s_waitcnt lgkmcnt(0)
  s_barrier
  ds_read_b64_tr_b16 v[16:17], v12 offset:0
  v_mfma_f32_16x16x32_bf16 v[44:47], v[24:27], a[136:139], v[44:47]
  ds_read_b64_tr_b16 v[18:19], v12 offset:256
  v_mfma_f32_16x16x32_bf16 v[48:51], v[24:27], a[208:211], v[48:51]
  v_mfma_f32_16x16x32_bf16 v[52:55], v[24:27], v[248:251], v[52:55]
  v_mfma_f32_16x16x32_bf16 v[56:59], v[28:31], a[64:67], v[56:59]
  ds_read_b64_tr_b16 v[20:21], v12 offset:6144
  v_mfma_f32_16x16x32_bf16 v[60:63], v[28:31], a[136:139], v[60:63]
  ds_read_b64_tr_b16 v[22:23], v12 offset:6400
  v_mfma_f32_16x16x32_bf16 v[64:67], v[28:31], a[208:211], v[64:67]
  v_mfma_f32_16x16x32_bf16 v[68:71], v[28:31], v[248:251], v[68:71]
  s_waitcnt lgkmcnt(4)
  v_mfma_f32_16x16x32_bf16 v[40:43], v[32:35], a[68:71], v[40:43]
  ds_read_b64_tr_b16 v[24:25], v12 offset:2048
  v_mfma_f32_16x16x32_bf16 v[44:47], v[32:35], a[140:143], v[44:47]
  ds_read_b64_tr_b16 v[26:27], v12 offset:2304
  v_mfma_f32_16x16x32_bf16 v[48:51], v[32:35], a[212:215], v[48:51]
  v_mfma_f32_16x16x32_bf16 v[52:55], v[32:35], v[252:255], v[52:55]
  v_mfma_f32_16x16x32_bf16 v[56:59], v[36:39], a[68:71], v[56:59]
  ds_read_b64_tr_b16 v[28:29], v12 offset:8192
  v_mfma_f32_16x16x32_bf16 v[60:63], v[36:39], a[140:143], v[60:63]
  ds_read_b64_tr_b16 v[30:31], v12 offset:8448
  v_mfma_f32_16x16x32_bf16 v[64:67], v[36:39], a[212:215], v[64:67]
  v_mfma_f32_16x16x32_bf16 v[68:71], v[36:39], v[252:255], v[68:71]
  s_waitcnt lgkmcnt(4)
  v_cvt_pk_bf16_f32 v219, v142, v143
  buffer_store_dwordx2 v[216:217], v13, s[16:19], s29 offen offset:0 sc1
  buffer_store_dwordx2 v[218:219], v13, s[16:19], s29 offen offset:256 sc1
  v_exp_f32 v208, -v144
  s_branch k1_ffn
k1_ffn:
  v_mov_b32 v11, v12
  v_add_u32 v12, 73728, v10
  v_mfma_f32_16x16x32_bf16 v[72:75], v[16:19], a[0:3], 0
  ds_read_b64_tr_b16 v[32:33], v11 offset:4096
  v_mfma_f32_16x16x32_bf16 v[76:79], v[16:19], a[72:75], 0
  ds_read_b64_tr_b16 v[34:35], v11 offset:4352
  v_mfma_f32_16x16x32_bf16 v[80:83], v[16:19], a[144:147], 0
  v_add_u32 v0, 128, v0
  v_mfma_f32_16x16x32_bf16 v[84:87], v[16:19], a[216:219], 0
  v_exp_f32 v209, -v145
  v_mfma_f32_16x16x32_bf16 v[88:91], v[20:23], a[0:3], 0
  ds_read_b64_tr_b16 v[36:37], v11 offset:10240
  v_mfma_f32_16x16x32_bf16 v[92:95], v[20:23], a[72:75], 0
  ds_read_b64_tr_b16 v[38:39], v11 offset:10496
  v_mfma_f32_16x16x32_bf16 v[96:99], v[20:23], a[144:147], 0
  v_exp_f32 v210, -v146
  v_mfma_f32_16x16x32_bf16 v[100:103], v[20:23], a[216:219], 0
  s_waitcnt lgkmcnt(4)
  v_mfma_f32_16x16x32_bf16 v[72:75], v[24:27], a[4:7], v[72:75]
  ds_read_b64_tr_b16 v[16:17], v11 offset:12288
  v_mfma_f32_16x16x32_bf16 v[76:79], v[24:27], a[76:79], v[76:79]
  ds_read_b64_tr_b16 v[18:19], v11 offset:12544
  v_exp_f32 v211, -v147
  v_mfma_f32_16x16x32_bf16 v[80:83], v[24:27], a[148:151], v[80:83]
  v_exp_f32 v212, -v148
  v_mfma_f32_16x16x32_bf16 v[84:87], v[24:27], a[220:223], v[84:87]
  v_exp_f32 v213, -v149
  v_mfma_f32_16x16x32_bf16 v[88:91], v[28:31], a[4:7], v[88:91]
  ds_read_b64_tr_b16 v[20:21], v11 offset:18432
  v_mfma_f32_16x16x32_bf16 v[92:95], v[28:31], a[76:79], v[92:95]
  ds_read_b64_tr_b16 v[22:23], v11 offset:18688
  v_exp_f32 v214, -v150
  v_mfma_f32_16x16x32_bf16 v[96:99], v[28:31], a[148:151], v[96:99]
  v_exp_f32 v215, -v151
  v_mfma_f32_16x16x32_bf16 v[100:103], v[28:31], a[220:223], v[100:103]
  s_waitcnt lgkmcnt(4)
  v_mul_f32 v144, v144, v160
  v_mfma_f32_16x16x32_bf16 v[72:75], v[32:35], a[8:11], v[72:75]
  ds_read_b64_tr_b16 v[24:25], v11 offset:14336
  s_add_u32 m0, s33, 0
  v_mfma_f32_16x16x32_bf16 v[76:79], v[32:35], a[80:83], v[76:79]
  ds_read_b64_tr_b16 v[26:27], v11 offset:14592
  v_mul_f32 v145, v145, v161
  v_mfma_f32_16x16x32_bf16 v[80:83], v[32:35], a[152:155], v[80:83]
  v_mul_f32 v146, v146, v162
  v_mul_f32 v147, v147, v163
  v_mfma_f32_16x16x32_bf16 v[84:87], v[32:35], a[224:227], v[84:87]
  v_mul_f32 v148, v148, v164
  v_mul_f32 v149, v149, v165
  v_mfma_f32_16x16x32_bf16 v[88:91], v[36:39], a[8:11], v[88:91]
  ds_read_b64_tr_b16 v[28:29], v11 offset:20480
  v_mul_f32 v150, v150, v166
  v_mfma_f32_16x16x32_bf16 v[92:95], v[36:39], a[80:83], v[92:95]
  ds_read_b64_tr_b16 v[30:31], v11 offset:20736
  v_mul_f32 v151, v151, v167
  v_mfma_f32_16x16x32_bf16 v[96:99], v[36:39], a[152:155], v[96:99]
  v_add_f32 v208, 1.0, v208
  buffer_load_dwordx4 v0, s[12:15], s48 offen offset:0 lds
  v_mfma_f32_16x16x32_bf16 v[100:103], v[36:39], a[224:227], v[100:103]
  s_waitcnt lgkmcnt(4)
  v_add_f32 v209, 1.0, v209
  v_mfma_f32_16x16x32_bf16 v[72:75], v[16:19], a[12:15], v[72:75]
  ds_read_b64_tr_b16 v[32:33], v11 offset:16384
  v_add_f32 v210, 1.0, v210
  v_add_f32 v211, 1.0, v211
  v_mfma_f32_16x16x32_bf16 v[76:79], v[16:19], a[84:87], v[76:79]
  ds_read_b64_tr_b16 v[34:35], v11 offset:16640
  v_add_f32 v212, 1.0, v212
  v_mfma_f32_16x16x32_bf16 v[80:83], v[16:19], a[156:159], v[80:83]
  v_add_f32 v213, 1.0, v213
  v_add_f32 v214, 1.0, v214
  v_mfma_f32_16x16x32_bf16 v[84:87], v[16:19], a[228:231], v[84:87]
  v_add_f32 v215, 1.0, v215
  buffer_load_dwordx4 v0, s[12:15], s49 offen offset:1024 lds
  v_mfma_f32_16x16x32_bf16 v[88:91], v[20:23], a[12:15], v[88:91]
  ds_read_b64_tr_b16 v[36:37], v11 offset:22528
  v_rcp_f32 v208, v208
  v_mfma_f32_16x16x32_bf16 v[92:95], v[20:23], a[84:87], v[92:95]
  ds_read_b64_tr_b16 v[38:39], v11 offset:22784
  v_mfma_f32_16x16x32_bf16 v[96:99], v[20:23], a[156:159], v[96:99]
  v_rcp_f32 v209, v209
  v_mfma_f32_16x16x32_bf16 v[100:103], v[20:23], a[228:231], v[100:103]
  s_waitcnt lgkmcnt(4)
  v_rcp_f32 v210, v210
  v_mfma_f32_16x16x32_bf16 v[72:75], v[24:27], a[16:19], v[72:75]
  ds_read_b64_tr_b16 v[16:17], v11 offset:24576
  v_rcp_f32 v211, v211
  v_mfma_f32_16x16x32_bf16 v[76:79], v[24:27], a[88:91], v[76:79]
  ds_read_b64_tr_b16 v[18:19], v11 offset:24832
  v_mfma_f32_16x16x32_bf16 v[80:83], v[24:27], a[160:163], v[80:83]
  v_rcp_f32 v212, v212
  v_mfma_f32_16x16x32_bf16 v[84:87], v[24:27], a[232:235], v[84:87]
  v_rcp_f32 v213, v213
  v_mfma_f32_16x16x32_bf16 v[88:91], v[28:31], a[16:19], v[88:91]
  ds_read_b64_tr_b16 v[20:21], v11 offset:30720
  v_mfma_f32_16x16x32_bf16 v[92:95], v[28:31], a[88:91], v[92:95]
  ds_read_b64_tr_b16 v[22:23], v11 offset:30976
  v_rcp_f32 v214, v214
  v_mfma_f32_16x16x32_bf16 v[96:99], v[28:31], a[160:163], v[96:99]
  v_rcp_f32 v215, v215
  v_mfma_f32_16x16x32_bf16 v[100:103], v[28:31], a[232:235], v[100:103]
  s_waitcnt lgkmcnt(4)
  buffer_load_dwordx4 v0, s[12:15], s50 offen offset:2048 lds
  v_mfma_f32_16x16x32_bf16 v[72:75], v[32:35], a[20:23], v[72:75]
  ds_read_b64_tr_b16 v[24:25], v11 offset:26624
  v_mul_f32 v144, v144, v208
  v_mfma_f32_16x16x32_bf16 v[76:79], v[32:35], a[92:95], v[76:79]
  ds_read_b64_tr_b16 v[26:27], v11 offset:26880
  v_mul_f32 v145, v145, v209
  v_mul_f32 v146, v146, v210
  v_mfma_f32_16x16x32_bf16 v[80:83], v[32:35], a[164:167], v[80:83]
  v_mul_f32 v147, v147, v211
  v_mul_f32 v148, v148, v212
  v_mfma_f32_16x16x32_bf16 v[84:87], v[32:35], a[236:239], v[84:87]
  v_mul_f32 v149, v149, v213
  v_mul_f32 v150, v150, v214
  v_mfma_f32_16x16x32_bf16 v[88:91], v[36:39], a[20:23], v[88:91]
  ds_read_b64_tr_b16 v[28:29], v11 offset:32768
  s_add_u32 m0, s33, 12288
  v_mfma_f32_16x16x32_bf16 v[92:95], v[36:39], a[92:95], v[92:95]
  ds_read_b64_tr_b16 v[30:31], v11 offset:33024
  v_mul_f32 v151, v151, v215
  v_mfma_f32_16x16x32_bf16 v[96:99], v[36:39], a[164:167], v[96:99]
  v_cvt_pk_bf16_f32 v220, v144, v145
  v_cvt_pk_bf16_f32 v221, v146, v147
  v_mfma_f32_16x16x32_bf16 v[100:103], v[36:39], a[236:239], v[100:103]
  s_waitcnt lgkmcnt(4)
  v_cvt_pk_bf16_f32 v222, v148, v149
  v_mfma_f32_16x16x32_bf16 v[72:75], v[16:19], a[24:27], v[72:75]
  ds_read_b64_tr_b16 v[32:33], v11 offset:28672
  v_cvt_pk_bf16_f32 v223, v150, v151
  v_mfma_f32_16x16x32_bf16 v[76:79], v[16:19], a[96:99], v[76:79]
  ds_read_b64_tr_b16 v[34:35], v11 offset:28928
  s_add_u32 s30, s29, 294912
  buffer_store_dwordx2 v[220:221], v13, s[16:19], s30 offen offset:0 sc1
  v_mfma_f32_16x16x32_bf16 v[80:83], v[16:19], a[168:171], v[80:83]
  buffer_store_dwordx2 v[222:223], v13, s[16:19], s30 offen offset:256 sc1
  buffer_load_dwordx4 v0, s[12:15], s51 offen offset:0 lds
  v_mfma_f32_16x16x32_bf16 v[84:87], v[16:19], a[240:243], v[84:87]
  s_add_u32 s29, s29, 1024
  v_mfma_f32_16x16x32_bf16 v[88:91], v[20:23], a[24:27], v[88:91]
  ds_read_b64_tr_b16 v[36:37], v11 offset:34816
  v_exp_f32 v200, -v168
  v_mfma_f32_16x16x32_bf16 v[92:95], v[20:23], a[96:99], v[92:95]
  ds_read_b64_tr_b16 v[38:39], v11 offset:35072
  v_exp_f32 v201, -v169
  v_mfma_f32_16x16x32_bf16 v[96:99], v[20:23], a[168:171], v[96:99]
  v_exp_f32 v202, -v170
  v_mfma_f32_16x16x32_bf16 v[100:103], v[20:23], a[240:243], v[100:103]
  s_waitcnt lgkmcnt(4)
  v_mfma_f32_16x16x32_bf16 v[72:75], v[24:27], a[28:31], v[72:75]
  v_add_u32 v11, 36864, v11
  ds_read_b64_tr_b16 v[16:17], v11 offset:0
  v_exp_f32 v203, -v171
  v_mfma_f32_16x16x32_bf16 v[76:79], v[24:27], a[100:103], v[76:79]
  ds_read_b64_tr_b16 v[18:19], v11 offset:256
  v_exp_f32 v204, -v172
  v_mfma_f32_16x16x32_bf16 v[80:83], v[24:27], a[172:175], v[80:83]
  v_exp_f32 v205, -v173
  v_mfma_f32_16x16x32_bf16 v[84:87], v[24:27], a[244:247], v[84:87]
  v_exp_f32 v206, -v174
  v_mfma_f32_16x16x32_bf16 v[88:91], v[28:31], a[28:31], v[88:91]
  ds_read_b64_tr_b16 v[20:21], v11 offset:6144
  buffer_load_dwordx4 v0, s[12:15], s52 offen offset:1024 lds
  v_mfma_f32_16x16x32_bf16 v[92:95], v[28:31], a[100:103], v[92:95]
  ds_read_b64_tr_b16 v[22:23], v11 offset:6400
  v_mfma_f32_16x16x32_bf16 v[96:99], v[28:31], a[172:175], v[96:99]
  v_exp_f32 v207, -v175
  v_mfma_f32_16x16x32_bf16 v[100:103], v[28:31], a[244:247], v[100:103]
  s_waitcnt lgkmcnt(4)
  v_mul_f32 v168, v168, v184
  v_mfma_f32_16x16x32_bf16 v[72:75], v[32:35], a[32:35], v[72:75]
  ds_read_b64_tr_b16 v[24:25], v11 offset:2048
  v_mul_f32 v169, v169, v185
  v_mfma_f32_16x16x32_bf16 v[76:79], v[32:35], a[104:107], v[76:79]
  ds_read_b64_tr_b16 v[26:27], v11 offset:2304
  v_mul_f32 v170, v170, v186
  v_mul_f32 v171, v171, v187
  v_mfma_f32_16x16x32_bf16 v[80:83], v[32:35], a[176:179], v[80:83]
  v_mul_f32 v172, v172, v188
  v_mul_f32 v173, v173, v189
  v_mfma_f32_16x16x32_bf16 v[84:87], v[32:35], a[248:251], v[84:87]
  buffer_load_dwordx4 v0, s[12:15], s53 offen offset:2048 lds
  v_mul_f32 v174, v174, v190
  v_mfma_f32_16x16x32_bf16 v[88:91], v[36:39], a[32:35], v[88:91]
  ds_read_b64_tr_b16 v[28:29], v11 offset:8192
  v_mul_f32 v175, v175, v191
  v_mfma_f32_16x16x32_bf16 v[92:95], v[36:39], a[104:107], v[92:95]
  ds_read_b64_tr_b16 v[30:31], v11 offset:8448
  v_add_f32 v200, 1.0, v200
  v_mfma_f32_16x16x32_bf16 v[96:99], v[36:39], a[176:179], v[96:99]
  v_add_f32 v201, 1.0, v201
  v_add_f32 v202, 1.0, v202
  v_mfma_f32_16x16x32_bf16 v[100:103], v[36:39], a[248:251], v[100:103]
  s_waitcnt lgkmcnt(4)
  v_add_f32 v203, 1.0, v203
  v_mfma_f32_16x16x32_bf16 v[72:75], v[16:19], a[36:39], v[72:75]
  ds_read_b64_tr_b16 v[32:33], v11 offset:4096
  v_add_f32 v204, 1.0, v204
  v_mfma_f32_16x16x32_bf16 v[76:79], v[16:19], a[108:111], v[76:79]
  ds_read_b64_tr_b16 v[34:35], v11 offset:4352
  v_add_f32 v205, 1.0, v205
  v_mfma_f32_16x16x32_bf16 v[80:83], v[16:19], a[180:183], v[80:83]
  s_add_u32 m0, s33, 24576
  v_add_f32 v206, 1.0, v206
  v_mfma_f32_16x16x32_bf16 v[84:87], v[16:19], a[252:255], v[84:87]
  v_add_f32 v207, 1.0, v207
  v_mfma_f32_16x16x32_bf16 v[88:91], v[20:23], a[36:39], v[88:91]
  ds_read_b64_tr_b16 v[36:37], v11 offset:10240
  v_rcp_f32 v200, v200
  v_mfma_f32_16x16x32_bf16 v[92:95], v[20:23], a[108:111], v[92:95]
  ds_read_b64_tr_b16 v[38:39], v11 offset:10496
  v_rcp_f32 v201, v201
  v_mfma_f32_16x16x32_bf16 v[96:99], v[20:23], a[180:183], v[96:99]
  v_rcp_f32 v202, v202
  v_mfma_f32_16x16x32_bf16 v[100:103], v[20:23], a[252:255], v[100:103]
  s_waitcnt lgkmcnt(4)
  v_mfma_f32_16x16x32_bf16 v[72:75], v[24:27], a[40:43], v[72:75]
  ds_read_b64_tr_b16 v[16:17], v11 offset:12288
  v_rcp_f32 v203, v203
  v_mfma_f32_16x16x32_bf16 v[76:79], v[24:27], a[112:115], v[76:79]
  ds_read_b64_tr_b16 v[18:19], v11 offset:12544
  v_rcp_f32 v204, v204
  v_mfma_f32_16x16x32_bf16 v[80:83], v[24:27], a[184:187], v[80:83]
  buffer_load_dwordx4 v0, s[12:15], s54 offen offset:0 lds
  v_mfma_f32_16x16x32_bf16 v[84:87], v[24:27], v[224:227], v[84:87]
  v_rcp_f32 v205, v205
  v_mfma_f32_16x16x32_bf16 v[88:91], v[28:31], a[40:43], v[88:91]
  ds_read_b64_tr_b16 v[20:21], v11 offset:18432
  v_rcp_f32 v206, v206
  v_mfma_f32_16x16x32_bf16 v[92:95], v[28:31], a[112:115], v[92:95]
  ds_read_b64_tr_b16 v[22:23], v11 offset:18688
  v_mfma_f32_16x16x32_bf16 v[96:99], v[28:31], a[184:187], v[96:99]
  v_rcp_f32 v207, v207
  v_mfma_f32_16x16x32_bf16 v[100:103], v[28:31], v[224:227], v[100:103]
  s_waitcnt lgkmcnt(4)
  v_mul_f32 v168, v168, v200
  v_mfma_f32_16x16x32_bf16 v[72:75], v[32:35], a[44:47], v[72:75]
  ds_read_b64_tr_b16 v[24:25], v11 offset:14336
  v_mul_f32 v169, v169, v201
  v_mul_f32 v170, v170, v202
  v_mfma_f32_16x16x32_bf16 v[76:79], v[32:35], a[116:119], v[76:79]
  ds_read_b64_tr_b16 v[26:27], v11 offset:14592
  v_mul_f32 v171, v171, v203
  v_mfma_f32_16x16x32_bf16 v[80:83], v[32:35], a[188:191], v[80:83]
  v_mul_f32 v172, v172, v204
  buffer_load_dwordx4 v0, s[12:15], s55 offen offset:1024 lds
  v_mfma_f32_16x16x32_bf16 v[84:87], v[32:35], v[228:231], v[84:87]
  v_mul_f32 v173, v173, v205
  v_mul_f32 v174, v174, v206
  v_mfma_f32_16x16x32_bf16 v[88:91], v[36:39], a[44:47], v[88:91]
  ds_read_b64_tr_b16 v[28:29], v11 offset:20480
  v_mul_f32 v175, v175, v207
  v_mfma_f32_16x16x32_bf16 v[92:95], v[36:39], a[116:119], v[92:95]
  ds_read_b64_tr_b16 v[30:31], v11 offset:20736
  v_cvt_pk_bf16_f32 v216, v168, v169
  v_mfma_f32_16x16x32_bf16 v[96:99], v[36:39], a[188:191], v[96:99]
  v_cvt_pk_bf16_f32 v217, v170, v171
  v_cvt_pk_bf16_f32 v218, v172, v173
  v_mfma_f32_16x16x32_bf16 v[100:103], v[36:39], v[228:231], v[100:103]
  s_waitcnt lgkmcnt(4)
  v_cvt_pk_bf16_f32 v219, v174, v175
  v_mfma_f32_16x16x32_bf16 v[72:75], v[16:19], a[48:51], v[72:75]
  ds_read_b64_tr_b16 v[32:33], v11 offset:16384
  buffer_load_dwordx4 v0, s[12:15], s56 offen offset:2048 lds
  buffer_store_dwordx2 v[216:217], v13, s[16:19], s29 offen offset:0 sc1
  v_mfma_f32_16x16x32_bf16 v[76:79], v[16:19], a[120:123], v[76:79]
  ds_read_b64_tr_b16 v[34:35], v11 offset:16640
  buffer_store_dwordx2 v[218:219], v13, s[16:19], s29 offen offset:256 sc1
  v_mfma_f32_16x16x32_bf16 v[80:83], v[16:19], a[192:195], v[80:83]
  v_exp_f32 v208, -v176
  v_mfma_f32_16x16x32_bf16 v[84:87], v[16:19], v[232:235], v[84:87]
  v_exp_f32 v209, -v177
  v_mfma_f32_16x16x32_bf16 v[88:91], v[20:23], a[48:51], v[88:91]
  ds_read_b64_tr_b16 v[36:37], v11 offset:22528
  v_exp_f32 v210, -v178
  v_mfma_f32_16x16x32_bf16 v[92:95], v[20:23], a[120:123], v[92:95]
  ds_read_b64_tr_b16 v[38:39], v11 offset:22784
  v_mfma_f32_16x16x32_bf16 v[96:99], v[20:23], a[192:195], v[96:99]
  v_exp_f32 v211, -v179
  v_mfma_f32_16x16x32_bf16 v[100:103], v[20:23], v[232:235], v[100:103]
  s_waitcnt lgkmcnt(4)
  v_exp_f32 v212, -v180
  v_mfma_f32_16x16x32_bf16 v[72:75], v[24:27], a[52:55], v[72:75]
  ds_read_b64_tr_b16 v[16:17], v11 offset:24576
  v_exp_f32 v213, -v181
  v_mfma_f32_16x16x32_bf16 v[76:79], v[24:27], a[124:127], v[76:79]
  ds_read_b64_tr_b16 v[18:19], v11 offset:24832
  s_add_u32 m0, s33, 36864
  v_mfma_f32_16x16x32_bf16 v[80:83], v[24:27], a[196:199], v[80:83]
  v_exp_f32 v214, -v182
  v_mfma_f32_16x16x32_bf16 v[84:87], v[24:27], v[236:239], v[84:87]
  v_exp_f32 v215, -v183
  v_mfma_f32_16x16x32_bf16 v[88:91], v[28:31], a[52:55], v[88:91]
  ds_read_b64_tr_b16 v[20:21], v11 offset:30720
  v_mul_f32 v176, v176, v192
  v_mfma_f32_16x16x32_bf16 v[92:95], v[28:31], a[124:127], v[92:95]
  ds_read_b64_tr_b16 v[22:23], v11 offset:30976
  v_mul_f32 v177, v177, v193
  v_mfma_f32_16x16x32_bf16 v[96:99], v[28:31], a[196:199], v[96:99]
  v_mul_f32 v178, v178, v194
  v_mul_f32 v179, v179, v195
  v_mfma_f32_16x16x32_bf16 v[100:103], v[28:31], v[236:239], v[100:103]
  s_waitcnt lgkmcnt(4)
  v_mul_f32 v180, v180, v196
  v_mfma_f32_16x16x32_bf16 v[72:75], v[32:35], a[56:59], v[72:75]
  ds_read_b64_tr_b16 v[24:25], v11 offset:26624
  v_mul_f32 v181, v181, v197
  v_mfma_f32_16x16x32_bf16 v[76:79], v[32:35], a[128:131], v[76:79]
  ds_read_b64_tr_b16 v[26:27], v11 offset:26880
  buffer_load_dwordx4 v0, s[12:15], s57 offen offset:0 lds
  v_mfma_f32_16x16x32_bf16 v[80:83], v[32:35], a[200:203], v[80:83]
  v_mul_f32 v182, v182, v198
  v_mul_f32 v183, v183, v199
  v_mfma_f32_16x16x32_bf16 v[84:87], v[32:35], v[240:243], v[84:87]
  v_add_f32 v208, 1.0, v208
  v_add_f32 v209, 1.0, v209
  v_mfma_f32_16x16x32_bf16 v[88:91], v[36:39], a[56:59], v[88:91]
  ds_read_b64_tr_b16 v[28:29], v11 offset:32768
  v_add_f32 v210, 1.0, v210
  v_mfma_f32_16x16x32_bf16 v[92:95], v[36:39], a[128:131], v[92:95]
  ds_read_b64_tr_b16 v[30:31], v11 offset:33024
  v_add_f32 v211, 1.0, v211
  v_mfma_f32_16x16x32_bf16 v[96:99], v[36:39], a[200:203], v[96:99]
  v_add_f32 v212, 1.0, v212
  v_add_f32 v213, 1.0, v213
  v_mfma_f32_16x16x32_bf16 v[100:103], v[36:39], v[240:243], v[100:103]
  s_waitcnt lgkmcnt(4)
  v_add_f32 v214, 1.0, v214
  v_mfma_f32_16x16x32_bf16 v[72:75], v[16:19], a[60:63], v[72:75]
  ds_read_b64_tr_b16 v[32:33], v11 offset:28672
  v_add_f32 v215, 1.0, v215
  v_mfma_f32_16x16x32_bf16 v[76:79], v[16:19], a[132:135], v[76:79]
  ds_read_b64_tr_b16 v[34:35], v11 offset:28928
  v_rcp_f32 v208, v208
  v_mfma_f32_16x16x32_bf16 v[80:83], v[16:19], a[204:207], v[80:83]
  v_rcp_f32 v209, v209
  v_mfma_f32_16x16x32_bf16 v[84:87], v[16:19], v[244:247], v[84:87]
  v_rcp_f32 v210, v210
  v_mfma_f32_16x16x32_bf16 v[88:91], v[20:23], a[60:63], v[88:91]
  ds_read_b64_tr_b16 v[36:37], v11 offset:34816
  v_mfma_f32_16x16x32_bf16 v[92:95], v[20:23], a[132:135], v[92:95]
  ds_read_b64_tr_b16 v[38:39], v11 offset:35072
  v_rcp_f32 v211, v211
  v_mfma_f32_16x16x32_bf16 v[96:99], v[20:23], a[204:207], v[96:99]
  v_rcp_f32 v212, v212
  v_mfma_f32_16x16x32_bf16 v[100:103], v[20:23], v[244:247], v[100:103]
  s_waitcnt lgkmcnt(4)
  v_rcp_f32 v213, v213
  v_mfma_f32_16x16x32_bf16 v[72:75], v[24:27], a[64:67], v[72:75]
  ds_read_b64_tr_b16 v[16:17], v12 offset:0
  v_mfma_f32_16x16x32_bf16 v[76:79], v[24:27], a[136:139], v[76:79]
  ds_read_b64_tr_b16 v[18:19], v12 offset:256
  v_rcp_f32 v214, v214
  v_mfma_f32_16x16x32_bf16 v[80:83], v[24:27], a[208:211], v[80:83]
  v_rcp_f32 v215, v215
  v_mfma_f32_16x16x32_bf16 v[84:87], v[24:27], v[248:251], v[84:87]
  v_mul_f32 v176, v176, v208
  v_mul_f32 v177, v177, v209
  v_mfma_f32_16x16x32_bf16 v[88:91], v[28:31], a[64:67], v[88:91]
  ds_read_b64_tr_b16 v[20:21], v12 offset:6144
  v_mul_f32 v178, v178, v210
  v_mfma_f32_16x16x32_bf16 v[92:95], v[28:31], a[136:139], v[92:95]
  ds_read_b64_tr_b16 v[22:23], v12 offset:6400
  v_mul_f32 v179, v179, v211
  v_mfma_f32_16x16x32_bf16 v[96:99], v[28:31], a[208:211], v[96:99]
  v_mul_f32 v180, v180, v212
  v_mul_f32 v181, v181, v213
  v_mfma_f32_16x16x32_bf16 v[100:103], v[28:31], v[248:251], v[100:103]
  s_waitcnt lgkmcnt(4)
  v_mul_f32 v182, v182, v214
  v_mfma_f32_16x16x32_bf16 v[72:75], v[32:35], a[68:71], v[72:75]
  ds_read_b64_tr_b16 v[24:25], v12 offset:2048
  v_mul_f32 v183, v183, v215
  v_mfma_f32_16x16x32_bf16 v[76:79], v[32:35], a[140:143], v[76:79]
  ds_read_b64_tr_b16 v[26:27], v12 offset:2304
  v_cvt_pk_bf16_f32 v220, v176, v177
  v_cvt_pk_bf16_f32 v221, v178, v179
  v_mfma_f32_16x16x32_bf16 v[80:83], v[32:35], a[212:215], v[80:83]
  v_cvt_pk_bf16_f32 v222, v180, v181
  v_cvt_pk_bf16_f32 v223, v182, v183
  v_mfma_f32_16x16x32_bf16 v[84:87], v[32:35], v[252:255], v[84:87]
  s_add_u32 s30, s29, 294912
  buffer_store_dwordx2 v[220:221], v13, s[16:19], s30 offen offset:0 sc1
  v_mfma_f32_16x16x32_bf16 v[88:91], v[36:39], a[68:71], v[88:91]
  ds_read_b64_tr_b16 v[28:29], v12 offset:8192
  v_mfma_f32_16x16x32_bf16 v[92:95], v[36:39], a[140:143], v[92:95]
  ds_read_b64_tr_b16 v[30:31], v12 offset:8448
  v_mfma_f32_16x16x32_bf16 v[96:99], v[36:39], a[212:215], v[96:99]
  v_mfma_f32_16x16x32_bf16 v[100:103], v[36:39], v[252:255], v[100:103]
  s_waitcnt lgkmcnt(4)
  buffer_store_dwordx2 v[222:223], v13, s[16:19], s30 offen offset:256 sc1
  s_add_u32 s29, s29, 1024
  v_exp_f32 v200, -v40
  v_mov_b32 v11, v12
  v_mov_b32 v12, v9
  v_mfma_f32_16x16x32_bf16 v[104:107], v[16:19], a[0:3], 0
  ds_read_b64_tr_b16 v[32:33], v11 offset:4096
  v_mfma_f32_16x16x32_bf16 v[108:111], v[16:19], a[72:75], 0
  ds_read_b64_tr_b16 v[34:35], v11 offset:4352
  v_mfma_f32_16x16x32_bf16 v[112:115], v[16:19], a[144:147], 0
  buffer_load_dwordx4 v0, s[12:15], s58 offen offset:1024 lds
  v_mfma_f32_16x16x32_bf16 v[116:119], v[16:19], a[216:219], 0
  v_exp_f32 v201, -v41
  v_mfma_f32_16x16x32_bf16 v[120:123], v[20:23], a[0:3], 0
  ds_read_b64_tr_b16 v[36:37], v11 offset:10240
  v_mfma_f32_16x16x32_bf16 v[124:127], v[20:23], a[72:75], 0
  ds_read_b64_tr_b16 v[38:39], v11 offset:10496
  v_mfma_f32_16x16x32_bf16 v[128:131], v[20:23], a[144:147], 0
  v_exp_f32 v202, -v42
  v_mfma_f32_16x16x32_bf16 v[132:135], v[20:23], a[216:219], 0
  s_waitcnt lgkmcnt(4)
  v_mfma_f32_16x16x32_bf16 v[104:107], v[24:27], a[4:7], v[104:107]
  ds_read_b64_tr_b16 v[16:17], v11 offset:12288
  v_exp_f32 v203, -v43
  v_mfma_f32_16x16x32_bf16 v[108:111], v[24:27], a[76:79], v[108:111]
  ds_read_b64_tr_b16 v[18:19], v11 offset:12544
  v_exp_f32 v204, -v44
  v_mfma_f32_16x16x32_bf16 v[112:115], v[24:27], a[148:151], v[112:115]
  v_exp_f32 v205, -v45
  v_mfma_f32_16x16x32_bf16 v[116:119], v[24:27], a[220:223], v[116:119]
  v_exp_f32 v206, -v46
  v_mfma_f32_16x16x32_bf16 v[120:123], v[28:31], a[4:7], v[120:123]
  ds_read_b64_tr_b16 v[20:21], v11 offset:18432
  v_mfma_f32_16x16x32_bf16 v[124:127], v[28:31], a[76:79], v[124:127]
  ds_read_b64_tr_b16 v[22:23], v11 offset:18688
  v_exp_f32 v207, -v47
  v_mfma_f32_16x16x32_bf16 v[128:131], v[28:31], a[148:151], v[128:131]
  v_mul_f32 v40, v40, v56
  v_mul_f32 v41, v41, v57
  v_mfma_f32_16x16x32_bf16 v[132:135], v[28:31], a[220:223], v[132:135]
  s_waitcnt lgkmcnt(4)
  v_mul_f32 v42, v42, v58
  v_mfma_f32_16x16x32_bf16 v[104:107], v[32:35], a[8:11], v[104:107]
  ds_read_b64_tr_b16 v[24:25], v11 offset:14336
  v_mul_f32 v43, v43, v59
  v_mfma_f32_16x16x32_bf16 v[108:111], v[32:35], a[80:83], v[108:111]
  ds_read_b64_tr_b16 v[26:27], v11 offset:14592
  v_mul_f32 v44, v44, v60
  buffer_load_dwordx4 v0, s[12:15], s59 offen offset:2048 lds
  v_mfma_f32_16x16x32_bf16 v[112:115], v[32:35], a[152:155], v[112:115]
  v_mul_f32 v45, v45, v61
  v_mul_f32 v46, v46, v62
  v_mfma_f32_16x16x32_bf16 v[116:119], v[32:35], a[224:227], v[116:119]
  v_mul_f32 v47, v47, v63
  v_add_f32 v200, 1.0, v200
  v_mfma_f32_16x16x32_bf16 v[120:123], v[36:39], a[8:11], v[120:123]
  ds_read_b64_tr_b16 v[28:29], v11 offset:20480
  v_add_f32 v201, 1.0, v201
  v_mfma_f32_16x16x32_bf16 v[124:127], v[36:39], a[80:83], v[124:127]
  ds_read_b64_tr_b16 v[30:31], v11 offset:20736
  v_add_f32 v202, 1.0, v202
  v_mfma_f32_16x16x32_bf16 v[128:131], v[36:39], a[152:155], v[128:131]
  v_add_f32 v203, 1.0, v203
  v_add_f32 v204, 1.0, v204
  v_mfma_f32_16x16x32_bf16 v[132:135], v[36:39], a[224:227], v[132:135]
  s_waitcnt lgkmcnt(4)
  v_add_f32 v205, 1.0, v205
  v_add_f32 v206, 1.0, v206
  v_mfma_f32_16x16x32_bf16 v[104:107], v[16:19], a[12:15], v[104:107]
  ds_read_b64_tr_b16 v[32:33], v11 offset:16384
  v_add_f32 v207, 1.0, v207
  v_mfma_f32_16x16x32_bf16 v[108:111], v[16:19], a[84:87], v[108:111]
  ds_read_b64_tr_b16 v[34:35], v11 offset:16640
  s_add_u32 m0, s33, 49152
  v_rcp_f32 v200, v200
  v_mfma_f32_16x16x32_bf16 v[112:115], v[16:19], a[156:159], v[112:115]
  v_rcp_f32 v201, v201
  v_mfma_f32_16x16x32_bf16 v[116:119], v[16:19], a[228:231], v[116:119]
  v_rcp_f32 v202, v202
  v_mfma_f32_16x16x32_bf16 v[120:123], v[20:23], a[12:15], v[120:123]
  ds_read_b64_tr_b16 v[36:37], v11 offset:22528
  v_mfma_f32_16x16x32_bf16 v[124:127], v[20:23], a[84:87], v[124:127]
  ds_read_b64_tr_b16 v[38:39], v11 offset:22784
  v_rcp_f32 v203, v203
  v_mfma_f32_16x16x32_bf16 v[128:131], v[20:23], a[156:159], v[128:131]
  v_rcp_f32 v204, v204
  v_mfma_f32_16x16x32_bf16 v[132:135], v[20:23], a[228:231], v[132:135]
  s_waitcnt lgkmcnt(4)
  v_rcp_f32 v205, v205
  v_mfma_f32_16x16x32_bf16 v[104:107], v[24:27], a[16:19], v[104:107]
  ds_read_b64_tr_b16 v[16:17], v11 offset:24576
  v_mfma_f32_16x16x32_bf16 v[108:111], v[24:27], a[88:91], v[108:111]
  ds_read_b64_tr_b16 v[18:19], v11 offset:24832
  v_rcp_f32 v206, v206
  v_mfma_f32_16x16x32_bf16 v[112:115], v[24:27], a[160:163], v[112:115]
  v_rcp_f32 v207, v207
  v_mfma_f32_16x16x32_bf16 v[116:119], v[24:27], a[232:235], v[116:119]
  v_mul_f32 v40, v40, v200
  v_mul_f32 v41, v41, v201
  v_mfma_f32_16x16x32_bf16 v[120:123], v[28:31], a[16:19], v[120:123]
  ds_read_b64_tr_b16 v[20:21], v11 offset:30720
  v_mul_f32 v42, v42, v202
  v_mfma_f32_16x16x32_bf16 v[124:127], v[28:31], a[88:91], v[124:127]
  ds_read_b64_tr_b16 v[22:23], v11 offset:30976
  buffer_load_dwordx4 v0, s[12:15], s60 offen offset:0 lds
  v_mul_f32 v43, v43, v203
  v_mfma_f32_16x16x32_bf16 v[128:131], v[28:31], a[160:163], v[128:131]
  v_mul_f32 v44, v44, v204
  v_mul_f32 v45, v45, v205
  v_mfma_f32_16x16x32_bf16 v[132:135], v[28:31], a[232:235], v[132:135]
  s_waitcnt lgkmcnt(4)
  v_mul_f32 v46, v46, v206
  v_mfma_f32_16x16x32_bf16 v[104:107], v[32:35], a[20:23], v[104:107]
  ds_read_b64_tr_b16 v[24:25], v11 offset:26624
  v_mul_f32 v47, v47, v207
  v_mfma_f32_16x16x32_bf16 v[108:111], v[32:35], a[92:95], v[108:111]
  ds_read_b64_tr_b16 v[26:27], v11 offset:26880
  v_cvt_pk_bf16_f32 v216, v40, v41
  v_cvt_pk_bf16_f32 v217, v42, v43
  v_mfma_f32_16x16x32_bf16 v[112:115], v[32:35], a[164:167], v[112:115]
  v_cvt_pk_bf16_f32 v218, v44, v45
  v_cvt_pk_bf16_f32 v219, v46, v47
  v_mfma_f32_16x16x32_bf16 v[116:119], v[32:35], a[236:239], v[116:119]
  buffer_store_dwordx2 v[216:217], v13, s[16:19], s29 offen offset:0 sc1
  buffer_store_dwordx2 v[218:219], v13, s[16:19], s29 offen offset:256 sc1
  v_mfma_f32_16x16x32_bf16 v[120:123], v[36:39], a[20:23], v[120:123]
  ds_read_b64_tr_b16 v[28:29], v11 offset:32768
  v_exp_f32 v208, -v48
  v_mfma_f32_16x16x32_bf16 v[124:127], v[36:39], a[92:95], v[124:127]
  ds_read_b64_tr_b16 v[30:31], v11 offset:33024
  buffer_load_dwordx4 v0, s[12:15], s61 offen offset:1024 lds
  v_mfma_f32_16x16x32_bf16 v[128:131], v[36:39], a[164:167], v[128:131]
  v_exp_f32 v209, -v49
  v_mfma_f32_16x16x32_bf16 v[132:135], v[36:39], a[236:239], v[132:135]
  s_waitcnt lgkmcnt(4)
  v_exp_f32 v210, -v50
  v_mfma_f32_16x16x32_bf16 v[104:107], v[16:19], a[24:27], v[104:107]
  ds_read_b64_tr_b16 v[32:33], v11 offset:28672
  v_exp_f32 v211, -v51
  v_mfma_f32_16x16x32_bf16 v[108:111], v[16:19], a[96:99], v[108:111]
  ds_read_b64_tr_b16 v[34:35], v11 offset:28928
  v_mfma_f32_16x16x32_bf16 v[112:115], v[16:19], a[168:171], v[112:115]
  v_exp_f32 v212, -v52
  v_mfma_f32_16x16x32_bf16 v[116:119], v[16:19], a[240:243], v[116:119]
  v_exp_f32 v213, -v53
  v_mfma_f32_16x16x32_bf16 v[120:123], v[20:23], a[24:27], v[120:123]
  ds_read_b64_tr_b16 v[36:37], v11 offset:34816
  v_exp_f32 v214, -v54
  v_mfma_f32_16x16x32_bf16 v[124:127], v[20:23], a[96:99], v[124:127]
  ds_read_b64_tr_b16 v[38:39], v11 offset:35072
  v_exp_f32 v215, -v55
  v_mfma_f32_16x16x32_bf16 v[128:131], v[20:23], a[168:171], v[128:131]
  v_mul_f32 v48, v48, v64
  v_mul_f32 v49, v49, v65
  v_mfma_f32_16x16x32_bf16 v[132:135], v[20:23], a[240:243], v[132:135]
  s_waitcnt lgkmcnt(4)
  v_mul_f32 v50, v50, v66
  v_mfma_f32_16x16x32_bf16 v[104:107], v[24:27], a[28:31], v[104:107]
  v_add_u32 v11, 36864, v11
  ds_read_b64_tr_b16 v[16:17], v11 offset:0
  v_mul_f32 v51, v51, v67
  v_mfma_f32_16x16x32_bf16 v[108:111], v[24:27], a[100:103], v[108:111]
  ds_read_b64_tr_b16 v[18:19], v11 offset:256
  buffer_load_dwordx4 v0, s[12:15], s62 offen offset:2048 lds
  v_mfma_f32_16x16x32_bf16 v[112:115], v[24:27], a[172:175], v[112:115]
  v_mul_f32 v52, v52, v68
  v_mul_f32 v53, v53, v69
  v_mfma_f32_16x16x32_bf16 v[116:119], v[24:27], a[244:247], v[116:119]
  v_mul_f32 v54, v54, v70
  v_mul_f32 v55, v55, v71
  v_mfma_f32_16x16x32_bf16 v[120:123], v[28:31], a[28:31], v[120:123]
  ds_read_b64_tr_b16 v[20:21], v11 offset:6144
  v_add_f32 v208, 1.0, v208
  v_mfma_f32_16x16x32_bf16 v[124:127], v[28:31], a[100:103], v[124:127]
  ds_read_b64_tr_b16 v[22:23], v11 offset:6400
  v_add_f32 v209, 1.0, v209
  v_add_f32 v210, 1.0, v210
  v_mfma_f32_16x16x32_bf16 v[128:131], v[28:31], a[172:175], v[128:131]
  v_add_f32 v211, 1.0, v211
  v_add_f32 v212, 1.0, v212
  v_mfma_f32_16x16x32_bf16 v[132:135], v[28:31], a[244:247], v[132:135]
  s_waitcnt lgkmcnt(4)
  v_add_f32 v213, 1.0, v213
  v_mfma_f32_16x16x32_bf16 v[104:107], v[32:35], a[32:35], v[104:107]
  ds_read_b64_tr_b16 v[24:25], v11 offset:2048
  v_add_f32 v214, 1.0, v214
  s_add_u32 m0, s33, 61440
  v_mfma_f32_16x16x32_bf16 v[108:111], v[32:35], a[104:107], v[108:111]
  ds_read_b64_tr_b16 v[26:27], v11 offset:2304
  v_add_f32 v215, 1.0, v215
  v_mfma_f32_16x16x32_bf16 v[112:115], v[32:35], a[176:179], v[112:115]
  v_rcp_f32 v208, v208
  v_mfma_f32_16x16x32_bf16 v[116:119], v[32:35], a[248:251], v[116:119]
  v_rcp_f32 v209, v209
  v_mfma_f32_16x16x32_bf16 v[120:123], v[36:39], a[32:35], v[120:123]
  ds_read_b64_tr_b16 v[28:29], v11 offset:8192
  v_rcp_f32 v210, v210
  v_mfma_f32_16x16x32_bf16 v[124:127], v[36:39], a[104:107], v[124:127]
  ds_read_b64_tr_b16 v[30:31], v11 offset:8448
  v_rcp_f32 v211, v211
  v_mfma_f32_16x16x32_bf16 v[128:131], v[36:39], a[176:179], v[128:131]
  v_rcp_f32 v212, v212
  v_mfma_f32_16x16x32_bf16 v[132:135], v[36:39], a[248:251], v[132:135]
  s_waitcnt lgkmcnt(4)
  v_mfma_f32_16x16x32_bf16 v[104:107], v[16:19], a[36:39], v[104:107]
  ds_read_b64_tr_b16 v[32:33], v11 offset:4096
  v_rcp_f32 v213, v213
  v_mfma_f32_16x16x32_bf16 v[108:111], v[16:19], a[108:111], v[108:111]
  ds_read_b64_tr_b16 v[34:35], v11 offset:4352
  v_rcp_f32 v214, v214
  v_mfma_f32_16x16x32_bf16 v[112:115], v[16:19], a[180:183], v[112:115]
  v_rcp_f32 v215, v215
  v_mfma_f32_16x16x32_bf16 v[116:119], v[16:19], a[252:255], v[116:119]
  v_mul_f32 v48, v48, v208
  v_mul_f32 v49, v49, v209
  v_mfma_f32_16x16x32_bf16 v[120:123], v[20:23], a[36:39], v[120:123]
  ds_read_b64_tr_b16 v[36:37], v11 offset:10240
  buffer_load_dwordx4 v0, s[12:15], s63 offen offset:0 lds
  v_mfma_f32_16x16x32_bf16 v[124:127], v[20:23], a[108:111], v[124:127]
  ds_read_b64_tr_b16 v[38:39], v11 offset:10496
  v_mul_f32 v50, v50, v210
  v_mfma_f32_16x16x32_bf16 v[128:131], v[20:23], a[180:183], v[128:131]
  v_mul_f32 v51, v51, v211
  v_mul_f32 v52, v52, v212
  v_mfma_f32_16x16x32_bf16 v[132:135], v[20:23], a[252:255], v[132:135]
  s_waitcnt lgkmcnt(4)
  v_mul_f32 v53, v53, v213
  v_mfma_f32_16x16x32_bf16 v[104:107], v[24:27], a[40:43], v[104:107]
  ds_read_b64_tr_b16 v[16:17], v11 offset:12288
  v_mul_f32 v54, v54, v214
  v_mul_f32 v55, v55, v215
  v_mfma_f32_16x16x32_bf16 v[108:111], v[24:27], a[112:115], v[108:111]
  ds_read_b64_tr_b16 v[18:19], v11 offset:12544
  v_cvt_pk_bf16_f32 v220, v48, v49
  v_cvt_pk_bf16_f32 v221, v50, v51
  v_mfma_f32_16x16x32_bf16 v[112:115], v[24:27], a[184:187], v[112:115]
  v_cvt_pk_bf16_f32 v222, v52, v53
  v_cvt_pk_bf16_f32 v223, v54, v55
  v_mfma_f32_16x16x32_bf16 v[116:119], v[24:27], v[224:227], v[116:119]
  s_add_u32 s30, s29, 294912
  buffer_store_dwordx2 v[220:221], v13, s[16:19], s30 offen offset:0 sc1
  v_mfma_f32_16x16x32_bf16 v[120:123], v[28:31], a[40:43], v[120:123]
  ds_read_b64_tr_b16 v[20:21], v11 offset:18432
  buffer_load_dwordx4 v0, s[12:15], s64 offen offset:1024 lds
  v_mfma_f32_16x16x32_bf16 v[124:127], v[28:31], a[112:115], v[124:127]
  ds_read_b64_tr_b16 v[22:23], v11 offset:18688
  buffer_store_dwordx2 v[222:223], v13, s[16:19], s30 offen offset:256 sc1
  v_mfma_f32_16x16x32_bf16 v[128:131], v[28:31], a[184:187], v[128:131]
  s_add_u32 s29, s29, 1024
  v_exp_f32 v200, -v72
  v_mfma_f32_16x16x32_bf16 v[132:135], v[28:31], v[224:227], v[132:135]
  s_waitcnt lgkmcnt(4)
  v_mfma_f32_16x16x32_bf16 v[104:107], v[32:35], a[44:47], v[104:107]
  ds_read_b64_tr_b16 v[24:25], v11 offset:14336
  v_exp_f32 v201, -v73
  v_mfma_f32_16x16x32_bf16 v[108:111], v[32:35], a[116:119], v[108:111]
  ds_read_b64_tr_b16 v[26:27], v11 offset:14592
  v_exp_f32 v202, -v74
  v_mfma_f32_16x16x32_bf16 v[112:115], v[32:35], a[188:191], v[112:115]
  v_exp_f32 v203, -v75
  v_mfma_f32_16x16x32_bf16 v[116:119], v[32:35], v[228:231], v[116:119]
  v_exp_f32 v204, -v76
  v_mfma_f32_16x16x32_bf16 v[120:123], v[36:39], a[44:47], v[120:123]
  ds_read_b64_tr_b16 v[28:29], v11 offset:20480
  v_exp_f32 v205, -v77
  v_mfma_f32_16x16x32_bf16 v[124:127], v[36:39], a[116:119], v[124:127]
  ds_read_b64_tr_b16 v[30:31], v11 offset:20736
  v_mfma_f32_16x16x32_bf16 v[128:131], v[36:39], a[188:191], v[128:131]
  v_exp_f32 v206, -v78
  v_mfma_f32_16x16x32_bf16 v[132:135], v[36:39], v[228:231], v[132:135]
  s_waitcnt lgkmcnt(4)
  v_exp_f32 v207, -v79
  v_mfma_f32_16x16x32_bf16 v[104:107], v[16:19], a[48:51], v[104:107]
  ds_read_b64_tr_b16 v[32:33], v11 offset:16384
  v_mul_f32 v72, v72, v88
  v_mfma_f32_16x16x32_bf16 v[108:111], v[16:19], a[120:123], v[108:111]
  ds_read_b64_tr_b16 v[34:35], v11 offset:16640
  buffer_load_dwordx4 v0, s[12:15], s65 offen offset:2048 lds
  v_mul_f32 v73, v73, v89
  v_mfma_f32_16x16x32_bf16 v[112:115], v[16:19], a[192:195], v[112:115]
  v_mul_f32 v74, v74, v90
  v_mul_f32 v75, v75, v91
  v_mfma_f32_16x16x32_bf16 v[116:119], v[16:19], v[232:235], v[116:119]
  v_mul_f32 v76, v76, v92
  v_mul_f32 v77, v77, v93
  v_mfma_f32_16x16x32_bf16 v[120:123], v[20:23], a[48:51], v[120:123]
  ds_read_b64_tr_b16 v[36:37], v11 offset:22528
  v_mul_f32 v78, v78, v94
  v_mfma_f32_16x16x32_bf16 v[124:127], v[20:23], a[120:123], v[124:127]
  ds_read_b64_tr_b16 v[38:39], v11 offset:22784
  v_mul_f32 v79, v79, v95
  v_mfma_f32_16x16x32_bf16 v[128:131], v[20:23], a[192:195], v[128:131]
  v_add_f32 v200, 1.0, v200
  v_add_f32 v201, 1.0, v201
  v_mfma_f32_16x16x32_bf16 v[132:135], v[20:23], v[232:235], v[132:135]
  s_waitcnt lgkmcnt(4)
  v_add_f32 v202, 1.0, v202
  v_add_f32 v203, 1.0, v203
  v_mfma_f32_16x16x32_bf16 v[104:107], v[24:27], a[52:55], v[104:107]
  ds_read_b64_tr_b16 v[16:17], v11 offset:24576
  v_add_f32 v204, 1.0, v204
  v_mfma_f32_16x16x32_bf16 v[108:111], v[24:27], a[124:127], v[108:111]
  ds_read_b64_tr_b16 v[18:19], v11 offset:24832
  v_add_f32 v205, 1.0, v205
  v_add_f32 v206, 1.0, v206
  v_mfma_f32_16x16x32_bf16 v[112:115], v[24:27], a[196:199], v[112:115]
  v_add_f32 v207, 1.0, v207
  v_rcp_f32 v200, v200
  v_mfma_f32_16x16x32_bf16 v[116:119], v[24:27], v[236:239], v[116:119]
  v_rcp_f32 v201, v201
  v_mfma_f32_16x16x32_bf16 v[120:123], v[28:31], a[52:55], v[120:123]
  ds_read_b64_tr_b16 v[20:21], v11 offset:30720
  v_mfma_f32_16x16x32_bf16 v[124:127], v[28:31], a[124:127], v[124:127]
  ds_read_b64_tr_b16 v[22:23], v11 offset:30976
  v_rcp_f32 v202, v202
  v_mfma_f32_16x16x32_bf16 v[128:131], v[28:31], a[196:199], v[128:131]
  v_rcp_f32 v203, v203
  v_mfma_f32_16x16x32_bf16 v[132:135], v[28:31], v[236:239], v[132:135]
  s_waitcnt lgkmcnt(4)
  v_rcp_f32 v204, v204
  v_mfma_f32_16x16x32_bf16 v[104:107], v[32:35], a[56:59], v[104:107]
  ds_read_b64_tr_b16 v[24:25], v11 offset:26624
  v_mfma_f32_16x16x32_bf16 v[108:111], v[32:35], a[128:131], v[108:111]
  ds_read_b64_tr_b16 v[26:27], v11 offset:26880
  v_rcp_f32 v205, v205
  v_mfma_f32_16x16x32_bf16 v[112:115], v[32:35], a[200:203], v[112:115]
  v_rcp_f32 v206, v206
  v_mfma_f32_16x16x32_bf16 v[116:119], v[32:35], v[240:243], v[116:119]
  v_rcp_f32 v207, v207
  v_mfma_f32_16x16x32_bf16 v[120:123], v[36:39], a[56:59], v[120:123]
  ds_read_b64_tr_b16 v[28:29], v11 offset:32768
  v_mul_f32 v72, v72, v200
  v_mfma_f32_16x16x32_bf16 v[124:127], v[36:39], a[128:131], v[124:127]
  ds_read_b64_tr_b16 v[30:31], v11 offset:33024
  v_mul_f32 v73, v73, v201
  v_mul_f32 v74, v74, v202
  v_mfma_f32_16x16x32_bf16 v[128:131], v[36:39], a[200:203], v[128:131]
  v_mul_f32 v75, v75, v203
  v_mul_f32 v76, v76, v204
  v_mfma_f32_16x16x32_bf16 v[132:135], v[36:39], v[240:243], v[132:135]
  s_waitcnt lgkmcnt(4)
  v_mul_f32 v77, v77, v205
  v_mfma_f32_16x16x32_bf16 v[104:107], v[16:19], a[60:63], v[104:107]
  ds_read_b64_tr_b16 v[32:33], v11 offset:28672
  v_mul_f32 v78, v78, v206
  v_mul_f32 v79, v79, v207
  v_mfma_f32_16x16x32_bf16 v[108:111], v[16:19], a[132:135], v[108:111]
  ds_read_b64_tr_b16 v[34:35], v11 offset:28928
  v_cvt_pk_bf16_f32 v216, v72, v73
  v_mfma_f32_16x16x32_bf16 v[112:115], v[16:19], a[204:207], v[112:115]
  v_cvt_pk_bf16_f32 v217, v74, v75
  v_cvt_pk_bf16_f32 v218, v76, v77
  v_mfma_f32_16x16x32_bf16 v[116:119], v[16:19], v[244:247], v[116:119]
  v_cvt_pk_bf16_f32 v219, v78, v79
  buffer_store_dwordx2 v[216:217], v13, s[16:19], s29 offen offset:0 sc1
  v_mfma_f32_16x16x32_bf16 v[120:123], v[20:23], a[60:63], v[120:123]
  ds_read_b64_tr_b16 v[36:37], v11 offset:34816
  v_mfma_f32_16x16x32_bf16 v[124:127], v[20:23], a[132:135], v[124:127]
  ds_read_b64_tr_b16 v[38:39], v11 offset:35072
  v_mfma_f32_16x16x32_bf16 v[128:131], v[20:23], a[204:207], v[128:131]
  v_mfma_f32_16x16x32_bf16 v[132:135], v[20:23], v[244:247], v[132:135]
  s_waitcnt lgkmcnt(4)
  v_mfma_f32_16x16x32_bf16 v[104:107], v[24:27], a[64:67], v[104:107]
  s_waitcnt vmcnt(1)
  s_waitcnt lgkmcnt(0)
  s_barrier
  ds_read_b64_tr_b16 v[16:17], v12 offset:0
  v_mfma_f32_16x16x32_bf16 v[108:111], v[24:27], a[136:139], v[108:111]
  ds_read_b64_tr_b16 v[18:19], v12 offset:256
  v_mfma_f32_16x16x32_bf16 v[112:115], v[24:27], a[208:211], v[112:115]
  v_mfma_f32_16x16x32_bf16 v[116:119], v[24:27], v[248:251], v[116:119]
  v_mfma_f32_16x16x32_bf16 v[120:123], v[28:31], a[64:67], v[120:123]
  ds_read_b64_tr_b16 v[20:21], v12 offset:6144
  v_mfma_f32_16x16x32_bf16 v[124:127], v[28:31], a[136:139], v[124:127]
  ds_read_b64_tr_b16 v[22:23], v12 offset:6400
  v_mfma_f32_16x16x32_bf16 v[128:131], v[28:31], a[208:211], v[128:131]
  v_mfma_f32_16x16x32_bf16 v[132:135], v[28:31], v[248:251], v[132:135]
  s_waitcnt lgkmcnt(4)
  v_mfma_f32_16x16x32_bf16 v[104:107], v[32:35], a[68:71], v[104:107]
  ds_read_b64_tr_b16 v[24:25], v12 offset:2048
  v_mfma_f32_16x16x32_bf16 v[108:111], v[32:35], a[140:143], v[108:111]
  ds_read_b64_tr_b16 v[26:27], v12 offset:2304
  v_mfma_f32_16x16x32_bf16 v[112:115], v[32:35], a[212:215], v[112:115]
  v_mfma_f32_16x16x32_bf16 v[116:119], v[32:35], v[252:255], v[116:119]
  v_mfma_f32_16x16x32_bf16 v[120:123], v[36:39], a[68:71], v[120:123]
  ds_read_b64_tr_b16 v[28:29], v12 offset:8192
  v_mfma_f32_16x16x32_bf16 v[124:127], v[36:39], a[140:143], v[124:127]
  ds_read_b64_tr_b16 v[30:31], v12 offset:8448
  v_mfma_f32_16x16x32_bf16 v[128:131], v[36:39], a[212:215], v[128:131]
  v_mfma_f32_16x16x32_bf16 v[132:135], v[36:39], v[252:255], v[132:135]
  s_waitcnt lgkmcnt(4)
  buffer_store_dwordx2 v[218:219], v13, s[16:19], s29 offen offset:256 sc1
  v_exp_f32 v208, -v80
  v_exp_f32 v209, -v81
  v_mov_b32 v11, v12
  v_mov_b32 v12, v10
  v_mfma_f32_16x16x32_bf16 v[136:139], v[16:19], a[0:3], 0
  ds_read_b64_tr_b16 v[32:33], v11 offset:4096
  v_mfma_f32_16x16x32_bf16 v[140:143], v[16:19], a[72:75], 0
  ds_read_b64_tr_b16 v[34:35], v11 offset:4352
  v_mfma_f32_16x16x32_bf16 v[144:147], v[16:19], a[144:147], 0
  v_add_u32 v2, s45, v2
  v_mfma_f32_16x16x32_bf16 v[148:151], v[16:19], a[216:219], 0
  v_exp_f32 v210, -v82
  v_mfma_f32_16x16x32_bf16 v[152:155], v[20:23], a[0:3], 0
  ds_read_b64_tr_b16 v[36:37], v11 offset:10240
  v_mfma_f32_16x16x32_bf16 v[156:159], v[20:23], a[72:75], 0
  ds_read_b64_tr_b16 v[38:39], v11 offset:10496
  v_mfma_f32_16x16x32_bf16 v[160:163], v[20:23], a[144:147], 0
  v_exp_f32 v211, -v83
  v_mfma_f32_16x16x32_bf16 v[164:167], v[20:23], a[216:219], 0
  s_waitcnt lgkmcnt(4)
  v_mfma_f32_16x16x32_bf16 v[136:139], v[24:27], a[4:7], v[136:139]
  ds_read_b64_tr_b16 v[16:17], v11 offset:12288
  v_mfma_f32_16x16x32_bf16 v[140:143], v[24:27], a[76:79], v[140:143]
  ds_read_b64_tr_b16 v[18:19], v11 offset:12544
  v_exp_f32 v212, -v84
  v_mfma_f32_16x16x32_bf16 v[144:147], v[24:27], a[148:151], v[144:147]
  v_exp_f32 v213, -v85
  v_mfma_f32_16x16x32_bf16 v[148:151], v[24:27], a[220:223], v[148:151]
  v_exp_f32 v214, -v86
  v_mfma_f32_16x16x32_bf16 v[152:155], v[28:31], a[4:7], v[152:155]
  ds_read_b64_tr_b16 v[20:21], v11 offset:18432
  v_mfma_f32_16x16x32_bf16 v[156:159], v[28:31], a[76:79], v[156:159]
  ds_read_b64_tr_b16 v[22:23], v11 offset:18688
  v_exp_f32 v215, -v87
  v_mfma_f32_16x16x32_bf16 v[160:163], v[28:31], a[148:151], v[160:163]
  v_mul_f32 v80, v80, v96
  v_mul_f32 v81, v81, v97
  v_mfma_f32_16x16x32_bf16 v[164:167], v[28:31], a[220:223], v[164:167]
  s_waitcnt lgkmcnt(4)
  s_add_u32 m0, s33, 73728
  v_mfma_f32_16x16x32_bf16 v[136:139], v[32:35], a[8:11], v[136:139]
  ds_read_b64_tr_b16 v[24:25], v11 offset:14336
  v_mul_f32 v82, v82, v98
  v_mfma_f32_16x16x32_bf16 v[140:143], v[32:35], a[80:83], v[140:143]
  ds_read_b64_tr_b16 v[26:27], v11 offset:14592
  v_mul_f32 v83, v83, v99
  v_mfma_f32_16x16x32_bf16 v[144:147], v[32:35], a[152:155], v[144:147]
  v_mul_f32 v84, v84, v100
  v_mul_f32 v85, v85, v101
  v_mfma_f32_16x16x32_bf16 v[148:151], v[32:35], a[224:227], v[148:151]
  v_mul_f32 v86, v86, v102
  v_mul_f32 v87, v87, v103
  v_mfma_f32_16x16x32_bf16 v[152:155], v[36:39], a[8:11], v[152:155]
  ds_read_b64_tr_b16 v[28:29], v11 offset:20480
  v_add_f32 v208, 1.0, v208
  v_mfma_f32_16x16x32_bf16 v[156:159], v[36:39], a[80:83], v[156:159]
  ds_read_b64_tr_b16 v[30:31], v11 offset:20736
  buffer_load_dwordx4 v2, s[12:15], s48 offen offset:0 lds
  v_mfma_f32_16x16x32_bf16 v[160:163], v[36:39], a[152:155], v[160:163]
  v_add_f32 v209, 1.0, v209
  v_add_f32 v210, 1.0, v210
  v_mfma_f32_16x16x32_bf16 v[164:167], v[36:39], a[224:227], v[164:167]
  s_waitcnt lgkmcnt(4)
  v_add_f32 v211, 1.0, v211
  v_mfma_f32_16x16x32_bf16 v[136:139], v[16:19], a[12:15], v[136:139]
  ds_read_b64_tr_b16 v[32:33], v11 offset:16384
  v_add_f32 v212, 1.0, v212
  v_mfma_f32_16x16x32_bf16 v[140:143], v[16:19], a[84:87], v[140:143]
  ds_read_b64_tr_b16 v[34:35], v11 offset:16640
  v_add_f32 v213, 1.0, v213
  v_mfma_f32_16x16x32_bf16 v[144:147], v[16:19], a[156:159], v[144:147]
  v_add_f32 v214, 1.0, v214
  v_add_f32 v215, 1.0, v215
  v_mfma_f32_16x16x32_bf16 v[148:151], v[16:19], a[228:231], v[148:151]
  v_rcp_f32 v208, v208
  v_mfma_f32_16x16x32_bf16 v[152:155], v[20:23], a[12:15], v[152:155]
  ds_read_b64_tr_b16 v[36:37], v11 offset:22528
  buffer_load_dwordx4 v2, s[12:15], s49 offen offset:1024 lds
  v_mfma_f32_16x16x32_bf16 v[156:159], v[20:23], a[84:87], v[156:159]
  ds_read_b64_tr_b16 v[38:39], v11 offset:22784
  v_rcp_f32 v209, v209
  v_mfma_f32_16x16x32_bf16 v[160:163], v[20:23], a[156:159], v[160:163]
  v_rcp_f32 v210, v210
  v_mfma_f32_16x16x32_bf16 v[164:167], v[20:23], a[228:231], v[164:167]
  s_waitcnt lgkmcnt(4)
  v_mfma_f32_16x16x32_bf16 v[136:139], v[24:27], a[16:19], v[136:139]
  ds_read_b64_tr_b16 v[16:17], v11 offset:24576
  v_rcp_f32 v211, v211
  v_mfma_f32_16x16x32_bf16 v[140:143], v[24:27], a[88:91], v[140:143]
  ds_read_b64_tr_b16 v[18:19], v11 offset:24832
  v_rcp_f32 v212, v212
  v_mfma_f32_16x16x32_bf16 v[144:147], v[24:27], a[160:163], v[144:147]
  v_rcp_f32 v213, v213
  v_mfma_f32_16x16x32_bf16 v[148:151], v[24:27], a[232:235], v[148:151]
  v_rcp_f32 v214, v214
  v_mfma_f32_16x16x32_bf16 v[152:155], v[28:31], a[16:19], v[152:155]
  ds_read_b64_tr_b16 v[20:21], v11 offset:30720
  v_mfma_f32_16x16x32_bf16 v[156:159], v[28:31], a[88:91], v[156:159]
  ds_read_b64_tr_b16 v[22:23], v11 offset:30976
  v_rcp_f32 v215, v215
  v_mfma_f32_16x16x32_bf16 v[160:163], v[28:31], a[160:163], v[160:163]
  buffer_load_dwordx4 v2, s[12:15], s50 offen offset:2048 lds
  v_mul_f32 v80, v80, v208
  v_mfma_f32_16x16x32_bf16 v[164:167], v[28:31], a[232:235], v[164:167]
  s_waitcnt lgkmcnt(4)
  v_mul_f32 v81, v81, v209
  v_mfma_f32_16x16x32_bf16 v[136:139], v[32:35], a[20:23], v[136:139]
  ds_read_b64_tr_b16 v[24:25], v11 offset:26624
  v_mul_f32 v82, v82, v210
  v_mfma_f32_16x16x32_bf16 v[140:143], v[32:35], a[92:95], v[140:143]
  ds_read_b64_tr_b16 v[26:27], v11 offset:26880
  v_mul_f32 v83, v83, v211
  v_mfma_f32_16x16x32_bf16 v[144:147], v[32:35], a[164:167], v[144:147]
  v_mul_f32 v84, v84, v212
  v_mul_f32 v85, v85, v213
  v_mfma_f32_16x16x32_bf16 v[148:151], v[32:35], a[236:239], v[148:151]
  v_mul_f32 v86, v86, v214
  v_mul_f32 v87, v87, v215
  v_mfma_f32_16x16x32_bf16 v[152:155], v[36:39], a[20:23], v[152:155]
  ds_read_b64_tr_b16 v[28:29], v11 offset:32768
  s_add_u32 m0, s33, 86016
  v_mfma_f32_16x16x32_bf16 v[156:159], v[36:39], a[92:95], v[156:159]
  ds_read_b64_tr_b16 v[30:31], v11 offset:33024
  v_cvt_pk_bf16_f32 v220, v80, v81
  v_mfma_f32_16x16x32_bf16 v[160:163], v[36:39], a[164:167], v[160:163]
  v_cvt_pk_bf16_f32 v221, v82, v83
  v_cvt_pk_bf16_f32 v222, v84, v85
  v_mfma_f32_16x16x32_bf16 v[164:167], v[36:39], a[236:239], v[164:167]
  s_waitcnt lgkmcnt(4)
  v_cvt_pk_bf16_f32 v223, v86, v87
  v_mfma_f32_16x16x32_bf16 v[136:139], v[16:19], a[24:27], v[136:139]
  ds_read_b64_tr_b16 v[32:33], v11 offset:28672
  s_add_u32 s30, s29, 294912
  v_mfma_f32_16x16x32_bf16 v[140:143], v[16:19], a[96:99], v[140:143]
  ds_read_b64_tr_b16 v[34:35], v11 offset:28928
  buffer_store_dwordx2 v[220:221], v13, s[16:19], s30 offen offset:0 sc1
  v_mfma_f32_16x16x32_bf16 v[144:147], v[16:19], a[168:171], v[144:147]
  buffer_store_dwordx2 v[222:223], v13, s[16:19], s30 offen offset:256 sc1
  buffer_load_dwordx4 v2, s[12:15], s51 offen offset:0 lds
  v_mfma_f32_16x16x32_bf16 v[148:151], v[16:19], a[240:243], v[148:151]
  s_add_u32 s29, s29, 1024
  v_mfma_f32_16x16x32_bf16 v[152:155], v[20:23], a[24:27], v[152:155]
  ds_read_b64_tr_b16 v[36:37], v11 offset:34816
  v_exp_f32 v200, -v104
  v_mfma_f32_16x16x32_bf16 v[156:159], v[20:23], a[96:99], v[156:159]
  ds_read_b64_tr_b16 v[38:39], v11 offset:35072
  v_exp_f32 v201, -v105
  v_mfma_f32_16x16x32_bf16 v[160:163], v[20:23], a[168:171], v[160:163]
  v_exp_f32 v202, -v106
  v_mfma_f32_16x16x32_bf16 v[164:167], v[20:23], a[240:243], v[164:167]
  s_waitcnt lgkmcnt(4)
  v_mfma_f32_16x16x32_bf16 v[136:139], v[24:27], a[28:31], v[136:139]
  v_add_u32 v11, 36864, v11
  ds_read_b64_tr_b16 v[16:17], v11 offset:0
  v_exp_f32 v203, -v107
  v_mfma_f32_16x16x32_bf16 v[140:143], v[24:27], a[100:103], v[140:143]
  ds_read_b64_tr_b16 v[18:19], v11 offset:256
  v_exp_f32 v204, -v108
  v_mfma_f32_16x16x32_bf16 v[144:147], v[24:27], a[172:175], v[144:147]
  v_exp_f32 v205, -v109
  v_mfma_f32_16x16x32_bf16 v[148:151], v[24:27], a[244:247], v[148:151]
  v_exp_f32 v206, -v110
  v_mfma_f32_16x16x32_bf16 v[152:155], v[28:31], a[28:31], v[152:155]
  ds_read_b64_tr_b16 v[20:21], v11 offset:6144
  buffer_load_dwordx4 v2, s[12:15], s52 offen offset:1024 lds
  v_mfma_f32_16x16x32_bf16 v[156:159], v[28:31], a[100:103], v[156:159]
  ds_read_b64_tr_b16 v[22:23], v11 offset:6400
  v_mfma_f32_16x16x32_bf16 v[160:163], v[28:31], a[172:175], v[160:163]
  v_exp_f32 v207, -v111
  v_mfma_f32_16x16x32_bf16 v[164:167], v[28:31], a[244:247], v[164:167]
  s_waitcnt lgkmcnt(4)
  v_mul_f32 v104, v104, v120
  v_mfma_f32_16x16x32_bf16 v[136:139], v[32:35], a[32:35], v[136:139]
  ds_read_b64_tr_b16 v[24:25], v11 offset:2048
  v_mul_f32 v105, v105, v121
  v_mfma_f32_16x16x32_bf16 v[140:143], v[32:35], a[104:107], v[140:143]
  ds_read_b64_tr_b16 v[26:27], v11 offset:2304
  v_mul_f32 v106, v106, v122
  v_mul_f32 v107, v107, v123
  v_mfma_f32_16x16x32_bf16 v[144:147], v[32:35], a[176:179], v[144:147]
  v_mul_f32 v108, v108, v124
  v_mul_f32 v109, v109, v125
  v_mfma_f32_16x16x32_bf16 v[148:151], v[32:35], a[248:251], v[148:151]
  buffer_load_dwordx4 v2, s[12:15], s53 offen offset:2048 lds
  v_mul_f32 v110, v110, v126
  v_mfma_f32_16x16x32_bf16 v[152:155], v[36:39], a[32:35], v[152:155]
  ds_read_b64_tr_b16 v[28:29], v11 offset:8192
  v_mul_f32 v111, v111, v127
  v_mfma_f32_16x16x32_bf16 v[156:159], v[36:39], a[104:107], v[156:159]
  ds_read_b64_tr_b16 v[30:31], v11 offset:8448
  v_add_f32 v200, 1.0, v200
  v_mfma_f32_16x16x32_bf16 v[160:163], v[36:39], a[176:179], v[160:163]
  v_add_f32 v201, 1.0, v201
  v_add_f32 v202, 1.0, v202
  v_mfma_f32_16x16x32_bf16 v[164:167], v[36:39], a[248:251], v[164:167]
  s_waitcnt lgkmcnt(4)
  v_add_f32 v203, 1.0, v203
  v_mfma_f32_16x16x32_bf16 v[136:139], v[16:19], a[36:39], v[136:139]
  ds_read_b64_tr_b16 v[32:33], v11 offset:4096
  v_add_f32 v204, 1.0, v204
  v_mfma_f32_16x16x32_bf16 v[140:143], v[16:19], a[108:111], v[140:143]
  ds_read_b64_tr_b16 v[34:35], v11 offset:4352
  v_add_f32 v205, 1.0, v205
  v_mfma_f32_16x16x32_bf16 v[144:147], v[16:19], a[180:183], v[144:147]
  s_add_u32 m0, s33, 98304
  v_add_f32 v206, 1.0, v206
  v_mfma_f32_16x16x32_bf16 v[148:151], v[16:19], a[252:255], v[148:151]
  v_add_f32 v207, 1.0, v207
  v_mfma_f32_16x16x32_bf16 v[152:155], v[20:23], a[36:39], v[152:155]
  ds_read_b64_tr_b16 v[36:37], v11 offset:10240
  v_rcp_f32 v200, v200
  v_mfma_f32_16x16x32_bf16 v[156:159], v[20:23], a[108:111], v[156:159]
  ds_read_b64_tr_b16 v[38:39], v11 offset:10496
  v_rcp_f32 v201, v201
  v_mfma_f32_16x16x32_bf16 v[160:163], v[20:23], a[180:183], v[160:163]
  v_rcp_f32 v202, v202
  v_mfma_f32_16x16x32_bf16 v[164:167], v[20:23], a[252:255], v[164:167]
  s_waitcnt lgkmcnt(4)
  v_mfma_f32_16x16x32_bf16 v[136:139], v[24:27], a[40:43], v[136:139]
  ds_read_b64_tr_b16 v[16:17], v11 offset:12288
  v_rcp_f32 v203, v203
  v_mfma_f32_16x16x32_bf16 v[140:143], v[24:27], a[112:115], v[140:143]
  ds_read_b64_tr_b16 v[18:19], v11 offset:12544
  v_rcp_f32 v204, v204
  v_mfma_f32_16x16x32_bf16 v[144:147], v[24:27], a[184:187], v[144:147]
  buffer_load_dwordx4 v2, s[12:15], s54 offen offset:0 lds
  v_mfma_f32_16x16x32_bf16 v[148:151], v[24:27], v[224:227], v[148:151]
  v_rcp_f32 v205, v205
  v_mfma_f32_16x16x32_bf16 v[152:155], v[28:31], a[40:43], v[152:155]
  ds_read_b64_tr_b16 v[20:21], v11 offset:18432
  v_mfma_f32_16x16x32_bf16 v[156:159], v[28:31], a[112:115], v[156:159]
  ds_read_b64_tr_b16 v[22:23], v11 offset:18688
  v_rcp_f32 v206, v206
  v_mfma_f32_16x16x32_bf16 v[160:163], v[28:31], a[184:187], v[160:163]
  v_rcp_f32 v207, v207
  v_mfma_f32_16x16x32_bf16 v[164:167], v[28:31], v[224:227], v[164:167]
  s_waitcnt lgkmcnt(4)
  v_mul_f32 v104, v104, v200
  v_mfma_f32_16x16x32_bf16 v[136:139], v[32:35], a[44:47], v[136:139]
  ds_read_b64_tr_b16 v[24:25], v11 offset:14336
  v_mul_f32 v105, v105, v201
  v_mfma_f32_16x16x32_bf16 v[140:143], v[32:35], a[116:119], v[140:143]
  ds_read_b64_tr_b16 v[26:27], v11 offset:14592
  v_mul_f32 v106, v106, v202
  v_mul_f32 v107, v107, v203
  v_mfma_f32_16x16x32_bf16 v[144:147], v[32:35], a[188:191], v[144:147]
  v_mul_f32 v108, v108, v204
  buffer_load_dwordx4 v2, s[12:15], s55 offen offset:1024 lds
  v_mfma_f32_16x16x32_bf16 v[148:151], v[32:35], v[228:231], v[148:151]
  v_mul_f32 v109, v109, v205
  v_mul_f32 v110, v110, v206
  v_mfma_f32_16x16x32_bf16 v[152:155], v[36:39], a[44:47], v[152:155]
  ds_read_b64_tr_b16 v[28:29], v11 offset:20480
  v_mul_f32 v111, v111, v207
  v_mfma_f32_16x16x32_bf16 v[156:159], v[36:39], a[116:119], v[156:159]
  ds_read_b64_tr_b16 v[30:31], v11 offset:20736
  v_cvt_pk_bf16_f32 v216, v104, v105
  v_mfma_f32_16x16x32_bf16 v[160:163], v[36:39], a[188:191], v[160:163]
  v_cvt_pk_bf16_f32 v217, v106, v107
  v_cvt_pk_bf16_f32 v218, v108, v109
  v_mfma_f32_16x16x32_bf16 v[164:167], v[36:39], v[228:231], v[164:167]
  s_waitcnt lgkmcnt(4)
  v_cvt_pk_bf16_f32 v219, v110, v111
  v_mfma_f32_16x16x32_bf16 v[136:139], v[16:19], a[48:51], v[136:139]
  ds_read_b64_tr_b16 v[32:33], v11 offset:16384
  buffer_load_dwordx4 v2, s[12:15], s56 offen offset:2048 lds
  v_mfma_f32_16x16x32_bf16 v[140:143], v[16:19], a[120:123], v[140:143]
  ds_read_b64_tr_b16 v[34:35], v11 offset:16640
  buffer_store_dwordx2 v[216:217], v13, s[16:19], s29 offen offset:0 sc1
  v_mfma_f32_16x16x32_bf16 v[144:147], v[16:19], a[192:195], v[144:147]
  buffer_store_dwordx2 v[218:219], v13, s[16:19], s29 offen offset:256 sc1
  v_exp_f32 v208, -v112
  v_mfma_f32_16x16x32_bf16 v[148:151], v[16:19], v[232:235], v[148:151]
  v_exp_f32 v209, -v113
  v_mfma_f32_16x16x32_bf16 v[152:155], v[20:23], a[48:51], v[152:155]
  ds_read_b64_tr_b16 v[36:37], v11 offset:22528
  v_mfma_f32_16x16x32_bf16 v[156:159], v[20:23], a[120:123], v[156:159]
  ds_read_b64_tr_b16 v[38:39], v11 offset:22784
  v_exp_f32 v210, -v114
  v_mfma_f32_16x16x32_bf16 v[160:163], v[20:23], a[192:195], v[160:163]
  v_exp_f32 v211, -v115
  v_mfma_f32_16x16x32_bf16 v[164:167], v[20:23], v[232:235], v[164:167]
  s_waitcnt lgkmcnt(4)
  v_mfma_f32_16x16x32_bf16 v[136:139], v[24:27], a[52:55], v[136:139]
  ds_read_b64_tr_b16 v[16:17], v11 offset:24576
  v_exp_f32 v212, -v116
  v_mfma_f32_16x16x32_bf16 v[140:143], v[24:27], a[124:127], v[140:143]
  ds_read_b64_tr_b16 v[18:19], v11 offset:24832
  v_exp_f32 v213, -v117
  v_mfma_f32_16x16x32_bf16 v[144:147], v[24:27], a[196:199], v[144:147]
  s_add_u32 m0, s33, 110592
  v_mfma_f32_16x16x32_bf16 v[148:151], v[24:27], v[236:239], v[148:151]
  v_exp_f32 v214, -v118
  v_mfma_f32_16x16x32_bf16 v[152:155], v[28:31], a[52:55], v[152:155]
  ds_read_b64_tr_b16 v[20:21], v11 offset:30720
  v_mfma_f32_16x16x32_bf16 v[156:159], v[28:31], a[124:127], v[156:159]
  ds_read_b64_tr_b16 v[22:23], v11 offset:30976
  v_exp_f32 v215, -v119
  v_mfma_f32_16x16x32_bf16 v[160:163], v[28:31], a[196:199], v[160:163]
  v_mul_f32 v112, v112, v128
  v_mul_f32 v113, v113, v129
  v_mfma_f32_16x16x32_bf16 v[164:167], v[28:31], v[236:239], v[164:167]
  s_waitcnt lgkmcnt(4)
  v_mul_f32 v114, v114, v130
  v_mfma_f32_16x16x32_bf16 v[136:139], v[32:35], a[56:59], v[136:139]
  ds_read_b64_tr_b16 v[24:25], v11 offset:26624
  v_mul_f32 v115, v115, v131
  v_mfma_f32_16x16x32_bf16 v[140:143], v[32:35], a[128:131], v[140:143]
  ds_read_b64_tr_b16 v[26:27], v11 offset:26880
  v_mul_f32 v116, v116, v132
  buffer_load_dwordx4 v2, s[12:15], s57 offen offset:0 lds
  v_mfma_f32_16x16x32_bf16 v[144:147], v[32:35], a[200:203], v[144:147]
  v_mul_f32 v117, v117, v133
  v_mul_f32 v118, v118, v134
  v_mfma_f32_16x16x32_bf16 v[148:151], v[32:35], v[240:243], v[148:151]
  v_mul_f32 v119, v119, v135
  v_add_f32 v208, 1.0, v208
  v_mfma_f32_16x16x32_bf16 v[152:155], v[36:39], a[56:59], v[152:155]
  ds_read_b64_tr_b16 v[28:29], v11 offset:32768
  v_add_f32 v209, 1.0, v209
  v_mfma_f32_16x16x32_bf16 v[156:159], v[36:39], a[128:131], v[156:159]
  ds_read_b64_tr_b16 v[30:31], v11 offset:33024
  v_add_f32 v210, 1.0, v210
  v_mfma_f32_16x16x32_bf16 v[160:163], v[36:39], a[200:203], v[160:163]
  v_add_f32 v211, 1.0, v211
  v_add_f32 v212, 1.0, v212
  v_mfma_f32_16x16x32_bf16 v[164:167], v[36:39], v[240:243], v[164:167]
  s_waitcnt lgkmcnt(4)
  v_add_f32 v213, 1.0, v213
  v_mfma_f32_16x16x32_bf16 v[136:139], v[16:19], a[60:63], v[136:139]
  ds_read_b64_tr_b16 v[32:33], v11 offset:28672
  v_add_f32 v214, 1.0, v214
  v_mfma_f32_16x16x32_bf16 v[140:143], v[16:19], a[132:135], v[140:143]
  ds_read_b64_tr_b16 v[34:35], v11 offset:28928
  v_add_f32 v215, 1.0, v215
  v_mfma_f32_16x16x32_bf16 v[144:147], v[16:19], a[204:207], v[144:147]
  v_rcp_f32 v208, v208
  v_mfma_f32_16x16x32_bf16 v[148:151], v[16:19], v[244:247], v[148:151]
  v_rcp_f32 v209, v209
  v_mfma_f32_16x16x32_bf16 v[152:155], v[20:23], a[60:63], v[152:155]
  ds_read_b64_tr_b16 v[36:37], v11 offset:34816
  v_rcp_f32 v210, v210
  v_mfma_f32_16x16x32_bf16 v[156:159], v[20:23], a[132:135], v[156:159]
  ds_read_b64_tr_b16 v[38:39], v11 offset:35072
  v_mfma_f32_16x16x32_bf16 v[160:163], v[20:23], a[204:207], v[160:163]
  v_rcp_f32 v211, v211
  v_mfma_f32_16x16x32_bf16 v[164:167], v[20:23], v[244:247], v[164:167]
  s_waitcnt lgkmcnt(4)
  v_rcp_f32 v212, v212
  v_mfma_f32_16x16x32_bf16 v[136:139], v[24:27], a[64:67], v[136:139]
  ds_read_b64_tr_b16 v[16:17], v12 offset:0
  v_mfma_f32_16x16x32_bf16 v[140:143], v[24:27], a[136:139], v[140:143]
  ds_read_b64_tr_b16 v[18:19], v12 offset:256
  v_rcp_f32 v213, v213
  v_mfma_f32_16x16x32_bf16 v[144:147], v[24:27], a[208:211], v[144:147]
  v_rcp_f32 v214, v214
  v_mfma_f32_16x16x32_bf16 v[148:151], v[24:27], v[248:251], v[148:151]
  v_rcp_f32 v215, v215
  v_mfma_f32_16x16x32_bf16 v[152:155], v[28:31], a[64:67], v[152:155]
  ds_read_b64_tr_b16 v[20:21], v12 offset:6144
  v_mul_f32 v112, v112, v208
  v_mfma_f32_16x16x32_bf16 v[156:159], v[28:31], a[136:139], v[156:159]
  ds_read_b64_tr_b16 v[22:23], v12 offset:6400
  v_mul_f32 v113, v113, v209
  v_mfma_f32_16x16x32_bf16 v[160:163], v[28:31], a[208:211], v[160:163]
  v_mul_f32 v114, v114, v210
  v_mul_f32 v115, v115, v211
  v_mfma_f32_16x16x32_bf16 v[164:167], v[28:31], v[248:251], v[164:167]
  s_waitcnt lgkmcnt(4)
  v_mul_f32 v116, v116, v212
  v_mfma_f32_16x16x32_bf16 v[136:139], v[32:35], a[68:71], v[136:139]
  ds_read_b64_tr_b16 v[24:25], v12 offset:2048
  v_mul_f32 v117, v117, v213
  v_mfma_f32_16x16x32_bf16 v[140:143], v[32:35], a[140:143], v[140:143]
  ds_read_b64_tr_b16 v[26:27], v12 offset:2304
  v_mul_f32 v118, v118, v214
  v_mul_f32 v119, v119, v215
  v_mfma_f32_16x16x32_bf16 v[144:147], v[32:35], a[212:215], v[144:147]
  v_cvt_pk_bf16_f32 v220, v112, v113
  v_cvt_pk_bf16_f32 v221, v114, v115
  v_mfma_f32_16x16x32_bf16 v[148:151], v[32:35], v[252:255], v[148:151]
  v_cvt_pk_bf16_f32 v222, v116, v117
  v_cvt_pk_bf16_f32 v223, v118, v119
  v_mfma_f32_16x16x32_bf16 v[152:155], v[36:39], a[68:71], v[152:155]
  ds_read_b64_tr_b16 v[28:29], v12 offset:8192
  v_mfma_f32_16x16x32_bf16 v[156:159], v[36:39], a[140:143], v[156:159]
  ds_read_b64_tr_b16 v[30:31], v12 offset:8448
  v_mfma_f32_16x16x32_bf16 v[160:163], v[36:39], a[212:215], v[160:163]
  v_mfma_f32_16x16x32_bf16 v[164:167], v[36:39], v[252:255], v[164:167]
  s_waitcnt lgkmcnt(4)
  s_add_u32 s30, s29, 294912
  buffer_store_dwordx2 v[220:221], v13, s[16:19], s30 offen offset:0 sc1
  buffer_store_dwordx2 v[222:223], v13, s[16:19], s30 offen offset:256 sc1
  s_add_u32 s29, s29, 1024
  s_and_b32 s26, s21, 1
  s_cmp_eq_u32 s26, 1
  s_cselect_b64 vcc, -1, 0
  v_mov_b32 v11, v12
  s_nop 1
  v_cndmask_b32 v14, v9, v10, vcc
  v_add_u32 v12, 73728, v14
  v_mfma_f32_16x16x32_bf16 v[168:171], v[16:19], a[0:3], 0
  ds_read_b64_tr_b16 v[32:33], v11 offset:4096
  v_mfma_f32_16x16x32_bf16 v[172:175], v[16:19], a[72:75], 0
  ds_read_b64_tr_b16 v[34:35], v11 offset:4352
  v_mfma_f32_16x16x32_bf16 v[176:179], v[16:19], a[144:147], 0
  buffer_load_dwordx4 v2, s[12:15], s58 offen offset:1024 lds
  v_mfma_f32_16x16x32_bf16 v[180:183], v[16:19], a[216:219], 0
  v_exp_f32 v200, -v136
  v_mfma_f32_16x16x32_bf16 v[184:187], v[20:23], a[0:3], 0
  ds_read_b64_tr_b16 v[36:37], v11 offset:10240
  v_mfma_f32_16x16x32_bf16 v[188:191], v[20:23], a[72:75], 0
  ds_read_b64_tr_b16 v[38:39], v11 offset:10496
  v_mfma_f32_16x16x32_bf16 v[192:195], v[20:23], a[144:147], 0
  v_exp_f32 v201, -v137
  v_mfma_f32_16x16x32_bf16 v[196:199], v[20:23], a[216:219], 0
  s_waitcnt lgkmcnt(4)
  v_mfma_f32_16x16x32_bf16 v[168:171], v[24:27], a[4:7], v[168:171]
  ds_read_b64_tr_b16 v[16:17], v11 offset:12288
  v_mfma_f32_16x16x32_bf16 v[172:175], v[24:27], a[76:79], v[172:175]
  ds_read_b64_tr_b16 v[18:19], v11 offset:12544
  v_mfma_f32_16x16x32_bf16 v[176:179], v[24:27], a[148:151], v[176:179]
  v_exp_f32 v202, -v138
  v_mfma_f32_16x16x32_bf16 v[180:183], v[24:27], a[220:223], v[180:183]
  v_exp_f32 v203, -v139
  v_mfma_f32_16x16x32_bf16 v[184:187], v[28:31], a[4:7], v[184:187]
  ds_read_b64_tr_b16 v[20:21], v11 offset:18432
  v_mfma_f32_16x16x32_bf16 v[188:191], v[28:31], a[76:79], v[188:191]
  ds_read_b64_tr_b16 v[22:23], v11 offset:18688
  v_mfma_f32_16x16x32_bf16 v[192:195], v[28:31], a[148:151], v[192:195]
  v_exp_f32 v204, -v140
  v_mfma_f32_16x16x32_bf16 v[196:199], v[28:31], a[220:223], v[196:199]
  s_waitcnt lgkmcnt(4)
  v_mfma_f32_16x16x32_bf16 v[168:171], v[32:35], a[8:11], v[168:171]
  ds_read_b64_tr_b16 v[24:25], v11 offset:14336
  v_mfma_f32_16x16x32_bf16 v[172:175], v[32:35], a[80:83], v[172:175]
  ds_read_b64_tr_b16 v[26:27], v11 offset:14592
  v_exp_f32 v205, -v141
  v_mfma_f32_16x16x32_bf16 v[176:179], v[32:35], a[152:155], v[176:179]
  v_exp_f32 v206, -v142
  v_mfma_f32_16x16x32_bf16 v[180:183], v[32:35], a[224:227], v[180:183]
  v_exp_f32 v207, -v143
  v_mfma_f32_16x16x32_bf16 v[184:187], v[36:39], a[8:11], v[184:187]
  ds_read_b64_tr_b16 v[28:29], v11 offset:20480
  buffer_load_dwordx4 v2, s[12:15], s59 offen offset:2048 lds
  v_mfma_f32_16x16x32_bf16 v[188:191], v[36:39], a[80:83], v[188:191]
  ds_read_b64_tr_b16 v[30:31], v11 offset:20736
  v_mul_f32 v136, v136, v152
  v_mfma_f32_16x16x32_bf16 v[192:195], v[36:39], a[152:155], v[192:195]
  v_mul_f32 v137, v137, v153
  v_mul_f32 v138, v138, v154
  v_mfma_f32_16x16x32_bf16 v[196:199], v[36:39], a[224:227], v[196:199]
  s_waitcnt lgkmcnt(4)
  v_mul_f32 v139, v139, v155
  v_mfma_f32_16x16x32_bf16 v[168:171], v[16:19], a[12:15], v[168:171]
  ds_read_b64_tr_b16 v[32:33], v11 offset:16384
  v_mul_f32 v140, v140, v156
  v_mfma_f32_16x16x32_bf16 v[172:175], v[16:19], a[84:87], v[172:175]
  ds_read_b64_tr_b16 v[34:35], v11 offset:16640
  v_mul_f32 v141, v141, v157
  v_mfma_f32_16x16x32_bf16 v[176:179], v[16:19], a[156:159], v[176:179]
  v_mul_f32 v142, v142, v158
  v_mul_f32 v143, v143, v159
  v_mfma_f32_16x16x32_bf16 v[180:183], v[16:19], a[228:231], v[180:183]
  s_add_u32 m0, s33, 122880
  v_add_f32 v200, 1.0, v200
  v_mfma_f32_16x16x32_bf16 v[184:187], v[20:23], a[12:15], v[184:187]
  ds_read_b64_tr_b16 v[36:37], v11 offset:22528
  v_add_f32 v201, 1.0, v201
  v_mfma_f32_16x16x32_bf16 v[188:191], v[20:23], a[84:87], v[188:191]
  ds_read_b64_tr_b16 v[38:39], v11 offset:22784
  v_add_f32 v202, 1.0, v202
  v_mfma_f32_16x16x32_bf16 v[192:195], v[20:23], a[156:159], v[192:195]
  v_add_f32 v203, 1.0, v203
  v_add_f32 v204, 1.0, v204
  v_mfma_f32_16x16x32_bf16 v[196:199], v[20:23], a[228:231], v[196:199]
  s_waitcnt lgkmcnt(4)
  v_add_f32 v205, 1.0, v205
  v_mfma_f32_16x16x32_bf16 v[168:171], v[24:27], a[16:19], v[168:171]
  ds_read_b64_tr_b16 v[16:17], v11 offset:24576
  v_add_f32 v206, 1.0, v206
  v_mfma_f32_16x16x32_bf16 v[172:175], v[24:27], a[88:91], v[172:175]
  ds_read_b64_tr_b16 v[18:19], v11 offset:24832
  buffer_load_dwordx4 v2, s[12:15], s60 offen offset:0 lds
  v_mfma_f32_16x16x32_bf16 v[176:179], v[24:27], a[160:163], v[176:179]
  v_add_f32 v207, 1.0, v207
  v_mfma_f32_16x16x32_bf16 v[180:183], v[24:27], a[232:235], v[180:183]
  v_rcp_f32 v200, v200
  v_mfma_f32_16x16x32_bf16 v[184:187], v[28:31], a[16:19], v[184:187]
  ds_read_b64_tr_b16 v[20:21], v11 offset:30720
  v_mfma_f32_16x16x32_bf16 v[188:191], v[28:31], a[88:91], v[188:191]
  ds_read_b64_tr_b16 v[22:23], v11 offset:30976
  v_mfma_f32_16x16x32_bf16 v[192:195], v[28:31], a[160:163], v[192:195]
  v_rcp_f32 v201, v201
  v_mfma_f32_16x16x32_bf16 v[196:199], v[28:31], a[232:235], v[196:199]
  s_waitcnt lgkmcnt(4)
  v_mfma_f32_16x16x32_bf16 v[168:171], v[32:35], a[20:23], v[168:171]
  ds_read_b64_tr_b16 v[24:25], v11 offset:26624
  v_mfma_f32_16x16x32_bf16 v[172:175], v[32:35], a[92:95], v[172:175]
  ds_read_b64_tr_b16 v[26:27], v11 offset:26880
  v_mfma_f32_16x16x32_bf16 v[176:179], v[32:35], a[164:167], v[176:179]
  v_rcp_f32 v202, v202
  v_mfma_f32_16x16x32_bf16 v[180:183], v[32:35], a[236:239], v[180:183]
  v_rcp_f32 v203, v203
  v_mfma_f32_16x16x32_bf16 v[184:187], v[36:39], a[20:23], v[184:187]
  ds_read_b64_tr_b16 v[28:29], v11 offset:32768
  v_mfma_f32_16x16x32_bf16 v[188:191], v[36:39], a[92:95], v[188:191]
  ds_read_b64_tr_b16 v[30:31], v11 offset:33024
  v_mfma_f32_16x16x32_bf16 v[192:195], v[36:39], a[164:167], v[192:195]
  v_rcp_f32 v204, v204
  v_mfma_f32_16x16x32_bf16 v[196:199], v[36:39], a[236:239], v[196:199]
  s_waitcnt lgkmcnt(4)
  v_mfma_f32_16x16x32_bf16 v[168:171], v[16:19], a[24:27], v[168:171]
  ds_read_b64_tr_b16 v[32:33], v11 offset:28672
  v_rcp_f32 v205, v205
  v_mfma_f32_16x16x32_bf16 v[172:175], v[16:19], a[96:99], v[172:175]
  ds_read_b64_tr_b16 v[34:35], v11 offset:28928
  v_mfma_f32_16x16x32_bf16 v[176:179], v[16:19], a[168:171], v[176:179]
  v_rcp_f32 v206, v206
  v_mfma_f32_16x16x32_bf16 v[180:183], v[16:19], a[240:243], v[180:183]
  buffer_load_dwordx4 v2, s[12:15], s61 offen offset:1024 lds
  v_mfma_f32_16x16x32_bf16 v[184:187], v[20:23], a[24:27], v[184:187]
  ds_read_b64_tr_b16 v[36:37], v11 offset:34816
  v_mfma_f32_16x16x32_bf16 v[188:191], v[20:23], a[96:99], v[188:191]
  ds_read_b64_tr_b16 v[38:39], v11 offset:35072
  v_rcp_f32 v207, v207
  v_mfma_f32_16x16x32_bf16 v[192:195], v[20:23], a[168:171], v[192:195]
  v_mul_f32 v136, v136, v200
  v_mul_f32 v137, v137, v201
  v_mfma_f32_16x16x32_bf16 v[196:199], v[20:23], a[240:243], v[196:199]
  s_waitcnt lgkmcnt(4)
  v_mul_f32 v138, v138, v202
  v_mfma_f32_16x16x32_bf16 v[168:171], v[24:27], a[28:31], v[168:171]
  v_add_u32 v11, 36864, v11
  ds_read_b64_tr_b16 v[16:17], v11 offset:0
  v_mfma_f32_16x16x32_bf16 v[172:175], v[24:27], a[100:103], v[172:175]
  ds_read_b64_tr_b16 v[18:19], v11 offset:256
  v_mul_f32 v139, v139, v203
  v_mfma_f32_16x16x32_bf16 v[176:179], v[24:27], a[172:175], v[176:179]
  v_mul_f32 v140, v140, v204
  v_mul_f32 v141, v141, v205
  v_mfma_f32_16x16x32_bf16 v[180:183], v[24:27], a[244:247], v[180:183]
  buffer_load_dwordx4 v2, s[12:15], s62 offen offset:2048 lds
  v_mul_f32 v142, v142, v206
  v_mfma_f32_16x16x32_bf16 v[184:187], v[28:31], a[28:31], v[184:187]
  ds_read_b64_tr_b16 v[20:21], v11 offset:6144
  v_mul_f32 v143, v143, v207
  v_mfma_f32_16x16x32_bf16 v[188:191], v[28:31], a[100:103], v[188:191]
  ds_read_b64_tr_b16 v[22:23], v11 offset:6400
  v_cvt_pk_bf16_f32 v216, v136, v137
  v_mfma_f32_16x16x32_bf16 v[192:195], v[28:31], a[172:175], v[192:195]
  v_cvt_pk_bf16_f32 v217, v138, v139
  v_cvt_pk_bf16_f32 v218, v140, v141
  v_mfma_f32_16x16x32_bf16 v[196:199], v[28:31], a[244:247], v[196:199]
  s_waitcnt lgkmcnt(4)
  v_cvt_pk_bf16_f32 v219, v142, v143
  v_mfma_f32_16x16x32_bf16 v[168:171], v[32:35], a[32:35], v[168:171]
  ds_read_b64_tr_b16 v[24:25], v11 offset:2048
  buffer_store_dwordx2 v[216:217], v13, s[16:19], s29 offen offset:0 sc1
  v_mfma_f32_16x16x32_bf16 v[172:175], v[32:35], a[104:107], v[172:175]
  ds_read_b64_tr_b16 v[26:27], v11 offset:2304
  buffer_store_dwordx2 v[218:219], v13, s[16:19], s29 offen offset:256 sc1
  v_mfma_f32_16x16x32_bf16 v[176:179], v[32:35], a[176:179], v[176:179]
  s_add_u32 m0, s33, 135168
  v_mfma_f32_16x16x32_bf16 v[180:183], v[32:35], a[248:251], v[180:183]
  v_exp_f32 v208, -v144
  v_mfma_f32_16x16x32_bf16 v[184:187], v[36:39], a[32:35], v[184:187]
  ds_read_b64_tr_b16 v[28:29], v11 offset:8192
  v_mfma_f32_16x16x32_bf16 v[188:191], v[36:39], a[104:107], v[188:191]
  ds_read_b64_tr_b16 v[30:31], v11 offset:8448
  v_mfma_f32_16x16x32_bf16 v[192:195], v[36:39], a[176:179], v[192:195]
  v_exp_f32 v209, -v145
  v_mfma_f32_16x16x32_bf16 v[196:199], v[36:39], a[248:251], v[196:199]
  s_waitcnt lgkmcnt(4)
  v_mfma_f32_16x16x32_bf16 v[168:171], v[16:19], a[36:39], v[168:171]
  ds_read_b64_tr_b16 v[32:33], v11 offset:4096
  v_exp_f32 v210, -v146
  v_mfma_f32_16x16x32_bf16 v[172:175], v[16:19], a[108:111], v[172:175]
  ds_read_b64_tr_b16 v[34:35], v11 offset:4352
  v_mfma_f32_16x16x32_bf16 v[176:179], v[16:19], a[180:183], v[176:179]
  v_exp_f32 v211, -v147
  v_mfma_f32_16x16x32_bf16 v[180:183], v[16:19], a[252:255], v[180:183]
  v_exp_f32 v212, -v148
  v_mfma_f32_16x16x32_bf16 v[184:187], v[20:23], a[36:39], v[184:187]
  ds_read_b64_tr_b16 v[36:37], v11 offset:10240
  v_mfma_f32_16x16x32_bf16 v[188:191], v[20:23], a[108:111], v[188:191]
  ds_read_b64_tr_b16 v[38:39], v11 offset:10496
  v_mfma_f32_16x16x32_bf16 v[192:195], v[20:23], a[180:183], v[192:195]
  v_exp_f32 v213, -v149
  v_mfma_f32_16x16x32_bf16 v[196:199], v[20:23], a[252:255], v[196:199]
  s_waitcnt lgkmcnt(4)
  v_mfma_f32_16x16x32_bf16 v[168:171], v[24:27], a[40:43], v[168:171]
  ds_read_b64_tr_b16 v[16:17], v11 offset:12288
  v_exp_f32 v214, -v150
  v_mfma_f32_16x16x32_bf16 v[172:175], v[24:27], a[112:115], v[172:175]
  ds_read_b64_tr_b16 v[18:19], v11 offset:12544
  buffer_load_dwordx4 v2, s[12:15], s63 offen offset:0 lds
  v_mfma_f32_16x16x32_bf16 v[176:179], v[24:27], a[184:187], v[176:179]
  v_exp_f32 v215, -v151
  v_mfma_f32_16x16x32_bf16 v[180:183], v[24:27], v[224:227], v[180:183]
  v_mul_f32 v144, v144, v160
  v_mul_f32 v145, v145, v161
  v_mfma_f32_16x16x32_bf16 v[184:187], v[28:31], a[40:43], v[184:187]
  ds_read_b64_tr_b16 v[20:21], v11 offset:18432
  v_mul_f32 v146, v146, v162
  v_mfma_f32_16x16x32_bf16 v[188:191], v[28:31], a[112:115], v[188:191]
  ds_read_b64_tr_b16 v[22:23], v11 offset:18688
  v_mul_f32 v147, v147, v163
  v_mfma_f32_16x16x32_bf16 v[192:195], v[28:31], a[184:187], v[192:195]
  v_mul_f32 v148, v148, v164
  v_mul_f32 v149, v149, v165
  v_mfma_f32_16x16x32_bf16 v[196:199], v[28:31], v[224:227], v[196:199]
  s_waitcnt lgkmcnt(4)
  v_mul_f32 v150, v150, v166
  v_mfma_f32_16x16x32_bf16 v[168:171], v[32:35], a[44:47], v[168:171]
  ds_read_b64_tr_b16 v[24:25], v11 offset:14336
  buffer_load_dwordx4 v2, s[12:15], s64 offen offset:1024 lds
  v_mfma_f32_16x16x32_bf16 v[172:175], v[32:35], a[116:119], v[172:175]
  ds_read_b64_tr_b16 v[26:27], v11 offset:14592
  v_mul_f32 v151, v151, v167
  v_mfma_f32_16x16x32_bf16 v[176:179], v[32:35], a[188:191], v[176:179]
  v_add_f32 v208, 1.0, v208
  v_add_f32 v209, 1.0, v209
  v_mfma_f32_16x16x32_bf16 v[180:183], v[32:35], v[228:231], v[180:183]
  v_add_f32 v210, 1.0, v210
  v_add_f32 v211, 1.0, v211
  v_mfma_f32_16x16x32_bf16 v[184:187], v[36:39], a[44:47], v[184:187]
  ds_read_b64_tr_b16 v[28:29], v11 offset:20480
  v_add_f32 v212, 1.0, v212
  v_mfma_f32_16x16x32_bf16 v[188:191], v[36:39], a[116:119], v[188:191]
  ds_read_b64_tr_b16 v[30:31], v11 offset:20736
  v_add_f32 v213, 1.0, v213
  v_mfma_f32_16x16x32_bf16 v[192:195], v[36:39], a[188:191], v[192:195]
  buffer_load_dwordx4 v2, s[12:15], s65 offen offset:2048 lds
  v_add_f32 v214, 1.0, v214
  v_mfma_f32_16x16x32_bf16 v[196:199], v[36:39], v[228:231], v[196:199]
  s_waitcnt lgkmcnt(4)
  v_add_f32 v215, 1.0, v215
  v_mfma_f32_16x16x32_bf16 v[168:171], v[16:19], a[48:51], v[168:171]
  ds_read_b64_tr_b16 v[32:33], v11 offset:16384
  v_mfma_f32_16x16x32_bf16 v[172:175], v[16:19], a[120:123], v[172:175]
  ds_read_b64_tr_b16 v[34:35], v11 offset:16640
  v_mfma_f32_16x16x32_bf16 v[176:179], v[16:19], a[192:195], v[176:179]
  v_rcp_f32 v208, v208
  v_mfma_f32_16x16x32_bf16 v[180:183], v[16:19], v[232:235], v[180:183]
  v_rcp_f32 v209, v209
  v_mfma_f32_16x16x32_bf16 v[184:187], v[20:23], a[48:51], v[184:187]
  ds_read_b64_tr_b16 v[36:37], v11 offset:22528
  v_mfma_f32_16x16x32_bf16 v[188:191], v[20:23], a[120:123], v[188:191]
  ds_read_b64_tr_b16 v[38:39], v11 offset:22784
  v_mfma_f32_16x16x32_bf16 v[192:195], v[20:23], a[192:195], v[192:195]
  v_rcp_f32 v210, v210
  v_mfma_f32_16x16x32_bf16 v[196:199], v[20:23], v[232:235], v[196:199]
  s_waitcnt lgkmcnt(4)
  v_mfma_f32_16x16x32_bf16 v[168:171], v[24:27], a[52:55], v[168:171]
  ds_read_b64_tr_b16 v[16:17], v11 offset:24576
  v_mfma_f32_16x16x32_bf16 v[172:175], v[24:27], a[124:127], v[172:175]
  ds_read_b64_tr_b16 v[18:19], v11 offset:24832
  v_mfma_f32_16x16x32_bf16 v[176:179], v[24:27], a[196:199], v[176:179]
  v_rcp_f32 v211, v211
  v_mfma_f32_16x16x32_bf16 v[180:183], v[24:27], v[236:239], v[180:183]
  v_rcp_f32 v212, v212
  v_mfma_f32_16x16x32_bf16 v[184:187], v[28:31], a[52:55], v[184:187]
  ds_read_b64_tr_b16 v[20:21], v11 offset:30720
  v_mfma_f32_16x16x32_bf16 v[188:191], v[28:31], a[124:127], v[188:191]
  ds_read_b64_tr_b16 v[22:23], v11 offset:30976
  v_rcp_f32 v213, v213
  v_mfma_f32_16x16x32_bf16 v[192:195], v[28:31], a[196:199], v[192:195]
  v_rcp_f32 v214, v214
  v_mfma_f32_16x16x32_bf16 v[196:199], v[28:31], v[236:239], v[196:199]
  s_waitcnt lgkmcnt(4)
  v_mfma_f32_16x16x32_bf16 v[168:171], v[32:35], a[56:59], v[168:171]
  ds_read_b64_tr_b16 v[24:25], v11 offset:26624
  v_mfma_f32_16x16x32_bf16 v[172:175], v[32:35], a[128:131], v[172:175]
  ds_read_b64_tr_b16 v[26:27], v11 offset:26880
  v_rcp_f32 v215, v215
  v_mfma_f32_16x16x32_bf16 v[176:179], v[32:35], a[200:203], v[176:179]
  v_mul_f32 v144, v144, v208
  v_mul_f32 v145, v145, v209
  v_mfma_f32_16x16x32_bf16 v[180:183], v[32:35], v[240:243], v[180:183]
  v_mul_f32 v146, v146, v210
  v_mul_f32 v147, v147, v211
  v_mfma_f32_16x16x32_bf16 v[184:187], v[36:39], a[56:59], v[184:187]
  ds_read_b64_tr_b16 v[28:29], v11 offset:32768
  v_mul_f32 v148, v148, v212
  v_mfma_f32_16x16x32_bf16 v[188:191], v[36:39], a[128:131], v[188:191]
  ds_read_b64_tr_b16 v[30:31], v11 offset:33024
  v_mul_f32 v149, v149, v213
  v_mfma_f32_16x16x32_bf16 v[192:195], v[36:39], a[200:203], v[192:195]
  v_mul_f32 v150, v150, v214
  v_mul_f32 v151, v151, v215
  v_mfma_f32_16x16x32_bf16 v[196:199], v[36:39], v[240:243], v[196:199]
  s_waitcnt lgkmcnt(4)
  v_cvt_pk_bf16_f32 v220, v144, v145
  v_mfma_f32_16x16x32_bf16 v[168:171], v[16:19], a[60:63], v[168:171]
  ds_read_b64_tr_b16 v[32:33], v11 offset:28672
  v_cvt_pk_bf16_f32 v221, v146, v147
  v_mfma_f32_16x16x32_bf16 v[172:175], v[16:19], a[132:135], v[172:175]
  ds_read_b64_tr_b16 v[34:35], v11 offset:28928
  v_cvt_pk_bf16_f32 v222, v148, v149
  v_mfma_f32_16x16x32_bf16 v[176:179], v[16:19], a[204:207], v[176:179]
  v_cvt_pk_bf16_f32 v223, v150, v151
  s_add_u32 s30, s29, 294912
  v_mfma_f32_16x16x32_bf16 v[180:183], v[16:19], v[244:247], v[180:183]
  buffer_store_dwordx2 v[220:221], v13, s[16:19], s30 offen offset:0 sc1
  buffer_store_dwordx2 v[222:223], v13, s[16:19], s30 offen offset:256 sc1
  v_mfma_f32_16x16x32_bf16 v[184:187], v[20:23], a[60:63], v[184:187]
  ds_read_b64_tr_b16 v[36:37], v11 offset:34816
  v_mfma_f32_16x16x32_bf16 v[188:191], v[20:23], a[132:135], v[188:191]
  ds_read_b64_tr_b16 v[38:39], v11 offset:35072
  v_mfma_f32_16x16x32_bf16 v[192:195], v[20:23], a[204:207], v[192:195]
  v_mfma_f32_16x16x32_bf16 v[196:199], v[20:23], v[244:247], v[196:199]
  s_waitcnt lgkmcnt(4)
  v_mfma_f32_16x16x32_bf16 v[168:171], v[24:27], a[64:67], v[168:171]
  s_waitcnt vmcnt(2)
  s_waitcnt lgkmcnt(0)
  s_barrier
  ds_read_b64_tr_b16 v[16:17], v12 offset:0
  v_mfma_f32_16x16x32_bf16 v[172:175], v[24:27], a[136:139], v[172:175]
  ds_read_b64_tr_b16 v[18:19], v12 offset:256
  v_mfma_f32_16x16x32_bf16 v[176:179], v[24:27], a[208:211], v[176:179]
  v_mfma_f32_16x16x32_bf16 v[180:183], v[24:27], v[248:251], v[180:183]
  v_mfma_f32_16x16x32_bf16 v[184:187], v[28:31], a[64:67], v[184:187]
  ds_read_b64_tr_b16 v[20:21], v12 offset:6144
  v_mfma_f32_16x16x32_bf16 v[188:191], v[28:31], a[136:139], v[188:191]
  ds_read_b64_tr_b16 v[22:23], v12 offset:6400
  v_mfma_f32_16x16x32_bf16 v[192:195], v[28:31], a[208:211], v[192:195]
  v_mfma_f32_16x16x32_bf16 v[196:199], v[28:31], v[248:251], v[196:199]
  s_waitcnt lgkmcnt(4)
  v_mfma_f32_16x16x32_bf16 v[168:171], v[32:35], a[68:71], v[168:171]
  ds_read_b64_tr_b16 v[24:25], v12 offset:2048
  v_mfma_f32_16x16x32_bf16 v[172:175], v[32:35], a[140:143], v[172:175]
  ds_read_b64_tr_b16 v[26:27], v12 offset:2304
  v_mfma_f32_16x16x32_bf16 v[176:179], v[32:35], a[212:215], v[176:179]
  v_mfma_f32_16x16x32_bf16 v[180:183], v[32:35], v[252:255], v[180:183]
  v_mfma_f32_16x16x32_bf16 v[184:187], v[36:39], a[68:71], v[184:187]
  ds_read_b64_tr_b16 v[28:29], v12 offset:8192
  v_mfma_f32_16x16x32_bf16 v[188:191], v[36:39], a[140:143], v[188:191]
  ds_read_b64_tr_b16 v[30:31], v12 offset:8448
  v_mfma_f32_16x16x32_bf16 v[192:195], v[36:39], a[212:215], v[192:195]
  v_mfma_f32_16x16x32_bf16 v[196:199], v[36:39], v[252:255], v[196:199]
  s_waitcnt lgkmcnt(4)
  s_add_u32 s29, s29, 1024
  v_mov_b32 v11, v12
  v_mfma_f32_16x16x32_bf16 v[40:43], v[16:19], a[0:3], 0
  ds_read_b64_tr_b16 v[32:33], v11 offset:4096
  v_mfma_f32_16x16x32_bf16 v[44:47], v[16:19], a[72:75], 0
  ds_read_b64_tr_b16 v[34:35], v11 offset:4352
  v_mfma_f32_16x16x32_bf16 v[48:51], v[16:19], a[144:147], 0
  s_mov_b32 s8, s6
  s_and_b32 s9, s7, 0xffff
  v_mfma_f32_16x16x32_bf16 v[52:55], v[16:19], a[216:219], 0
  s_mov_b32 s10, 5308416
  s_and_b32 s26, s2, 7
  v_mfma_f32_16x16x32_bf16 v[56:59], v[20:23], a[0:3], 0
  ds_read_b64_tr_b16 v[36:37], v11 offset:10240
  s_lshr_b32 s27, s26, 1
  v_mfma_f32_16x16x32_bf16 v[60:63], v[20:23], a[72:75], 0
  ds_read_b64_tr_b16 v[38:39], v11 offset:10496
  s_mul_i32 s27, s27, 1152
  v_mfma_f32_16x16x32_bf16 v[64:67], v[20:23], a[144:147], 0
  s_lshr_b32 s28, s2, 3
  s_mul_i32 s28, s28, 36
  v_mfma_f32_16x16x32_bf16 v[68:71], v[20:23], a[216:219], 0
  s_waitcnt lgkmcnt(4)
  s_add_u32 s27, s27, s28
  v_mfma_f32_16x16x32_bf16 v[40:43], v[24:27], a[4:7], v[40:43]
  ds_read_b64_tr_b16 v[16:17], v11 offset:12288
  s_mul_i32 s27, s27, 1152
  v_mfma_f32_16x16x32_bf16 v[44:47], v[24:27], a[76:79], v[44:47]
  ds_read_b64_tr_b16 v[18:19], v11 offset:12544
  s_and_b32 s26, s26, 1
  v_mfma_f32_16x16x32_bf16 v[48:51], v[24:27], a[148:151], v[48:51]
  s_mul_i32 s26, s26, 576
  s_add_u32 s39, s27, s26
  v_mfma_f32_16x16x32_bf16 v[52:55], v[24:27], a[220:223], v[52:55]
  s_mul_i32 s26, s20, 81
  v_mfma_f32_16x16x32_bf16 v[56:59], v[28:31], a[4:7], v[56:59]
  ds_read_b64_tr_b16 v[20:21], v11 offset:18432
  v_add_u32 v5, 0, v1
  v_mfma_f32_16x16x32_bf16 v[60:63], v[28:31], a[76:79], v[60:63]
  ds_read_b64_tr_b16 v[22:23], v11 offset:18688
  v_add_u32 v5, s26, v5
  v_mfma_f32_16x16x32_bf16 v[64:67], v[28:31], a[148:151], v[64:67]
  v_mul_u32_u24 v6, 7282, v5
  v_mfma_f32_16x16x32_bf16 v[68:71], v[28:31], a[220:223], v[68:71]
  s_waitcnt lgkmcnt(4)
  v_lshrrev_b32 v6, 16, v6
  v_mfma_f32_16x16x32_bf16 v[40:43], v[32:35], a[8:11], v[40:43]
  ds_read_b64_tr_b16 v[24:25], v11 offset:14336
  v_mul_u32_u24 v7, 9, v6
  v_mfma_f32_16x16x32_bf16 v[44:47], v[32:35], a[80:83], v[44:47]
  ds_read_b64_tr_b16 v[26:27], v11 offset:14592
  v_sub_u32 v5, v5, v7
  v_mfma_f32_16x16x32_bf16 v[48:51], v[32:35], a[152:155], v[48:51]
  v_mul_u32_u24 v6, 1152, v6
  v_lshl_add_u32 v5, v5, 6, v6
  v_mfma_f32_16x16x32_bf16 v[52:55], v[32:35], a[224:227], v[52:55]
  buffer_load_dword v8, v5, s[8:11], s39 offen
  v_add_u32 v5, 64, v1
  v_mfma_f32_16x16x32_bf16 v[56:59], v[36:39], a[8:11], v[56:59]
  ds_read_b64_tr_b16 v[28:29], v11 offset:20480
  v_min_u32 v5, 80, v5
  v_mfma_f32_16x16x32_bf16 v[60:63], v[36:39], a[80:83], v[60:63]
  ds_read_b64_tr_b16 v[30:31], v11 offset:20736
  v_add_u32 v5, s26, v5
  v_mfma_f32_16x16x32_bf16 v[64:67], v[36:39], a[152:155], v[64:67]
  v_mul_u32_u24 v6, 7282, v5
  v_mfma_f32_16x16x32_bf16 v[68:71], v[36:39], a[224:227], v[68:71]
  s_waitcnt lgkmcnt(4)
  v_lshrrev_b32 v6, 16, v6
  v_mfma_f32_16x16x32_bf16 v[40:43], v[16:19], a[12:15], v[40:43]
  ds_read_b64_tr_b16 v[32:33], v11 offset:16384
  v_mul_u32_u24 v7, 9, v6
  v_mfma_f32_16x16x32_bf16 v[44:47], v[16:19], a[84:87], v[44:47]
  ds_read_b64_tr_b16 v[34:35], v11 offset:16640
  v_sub_u32 v5, v5, v7
  v_mfma_f32_16x16x32_bf16 v[48:51], v[16:19], a[156:159], v[48:51]
  v_mul_u32_u24 v6, 1152, v6
  v_lshl_add_u32 v5, v5, 6, v6
  v_mfma_f32_16x16x32_bf16 v[52:55], v[16:19], a[228:231], v[52:55]
  buffer_load_dword v8, v5, s[8:11], s39 offen
  v_mfma_f32_16x16x32_bf16 v[56:59], v[20:23], a[12:15], v[56:59]
  ds_read_b64_tr_b16 v[36:37], v11 offset:22528
  s_getpc_b64 s[84:85]
  v_mfma_f32_16x16x32_bf16 v[60:63], v[20:23], a[84:87], v[60:63]
  ds_read_b64_tr_b16 v[38:39], v11 offset:22784
cpf_k1:
  v_mfma_f32_16x16x32_bf16 v[64:67], v[20:23], a[156:159], v[64:67]
  s_add_u32 s84, s84, k2_attn_kernel-cpf_k1
  s_addc_u32 s85, s85, 0
  v_mfma_f32_16x16x32_bf16 v[68:71], v[20:23], a[228:231], v[68:71]
  s_waitcnt lgkmcnt(4)
  s_lshr_b32 s86, s2, 3
  v_mfma_f32_16x16x32_bf16 v[40:43], v[24:27], a[16:19], v[40:43]
  ds_read_b64_tr_b16 v[16:17], v11 offset:24576
  s_lshl_b32 s86, s86, 12
  v_mfma_f32_16x16x32_bf16 v[44:47], v[24:27], a[88:91], v[44:47]
  ds_read_b64_tr_b16 v[18:19], v11 offset:24832
  v_lshlrev_b32 v5, 6, v1
  v_mfma_f32_16x16x32_bf16 v[48:51], v[24:27], a[160:163], v[48:51]
  v_add_u32 v5, s86, v5
  v_min_u32 v5, k3_out_kernel-k2_attn_kernel-4, v5
  v_mfma_f32_16x16x32_bf16 v[52:55], v[24:27], a[232:235], v[52:55]
  global_load_dword v8, v5, s[84:85]
  v_mfma_f32_16x16x32_bf16 v[56:59], v[28:31], a[16:19], v[56:59]
  ds_read_b64_tr_b16 v[20:21], v11 offset:30720
  v_mfma_f32_16x16x32_bf16 v[60:63], v[28:31], a[88:91], v[60:63]
  ds_read_b64_tr_b16 v[22:23], v11 offset:30976
  v_mfma_f32_16x16x32_bf16 v[64:67], v[28:31], a[160:163], v[64:67]
  v_exp_f32 v200, -v168
  v_mfma_f32_16x16x32_bf16 v[68:71], v[28:31], a[232:235], v[68:71]
  s_waitcnt lgkmcnt(4)
  v_mfma_f32_16x16x32_bf16 v[40:43], v[32:35], a[20:23], v[40:43]
  ds_read_b64_tr_b16 v[24:25], v11 offset:26624
  v_mfma_f32_16x16x32_bf16 v[44:47], v[32:35], a[92:95], v[44:47]
  ds_read_b64_tr_b16 v[26:27], v11 offset:26880
  v_mfma_f32_16x16x32_bf16 v[48:51], v[32:35], a[164:167], v[48:51]
  v_exp_f32 v201, -v169
  v_mfma_f32_16x16x32_bf16 v[52:55], v[32:35], a[236:239], v[52:55]
  v_exp_f32 v202, -v170
  v_mfma_f32_16x16x32_bf16 v[56:59], v[36:39], a[20:23], v[56:59]
  ds_read_b64_tr_b16 v[28:29], v11 offset:32768
  v_mfma_f32_16x16x32_bf16 v[60:63], v[36:39], a[92:95], v[60:63]
  ds_read_b64_tr_b16 v[30:31], v11 offset:33024
  v_mfma_f32_16x16x32_bf16 v[64:67], v[36:39], a[164:167], v[64:67]
  v_exp_f32 v203, -v171
  v_mfma_f32_16x16x32_bf16 v[68:71], v[36:39], a[236:239], v[68:71]
  s_waitcnt lgkmcnt(4)
  v_mfma_f32_16x16x32_bf16 v[40:43], v[16:19], a[24:27], v[40:43]
  ds_read_b64_tr_b16 v[32:33], v11 offset:28672
  v_exp_f32 v204, -v172
  v_mfma_f32_16x16x32_bf16 v[44:47], v[16:19], a[96:99], v[44:47]
  ds_read_b64_tr_b16 v[34:35], v11 offset:28928
  v_mfma_f32_16x16x32_bf16 v[48:51], v[16:19], a[168:171], v[48:51]
  v_exp_f32 v205, -v173
  v_mfma_f32_16x16x32_bf16 v[52:55], v[16:19], a[240:243], v[52:55]
  v_exp_f32 v206, -v174
  v_mfma_f32_16x16x32_bf16 v[56:59], v[20:23], a[24:27], v[56:59]
  ds_read_b64_tr_b16 v[36:37], v11 offset:34816
  v_mfma_f32_16x16x32_bf16 v[60:63], v[20:23], a[96:99], v[60:63]
  ds_read_b64_tr_b16 v[38:39], v11 offset:35072
  v_exp_f32 v207, -v175
  v_mfma_f32_16x16x32_bf16 v[64:67], v[20:23], a[168:171], v[64:67]
  v_mul_f32 v168, v168, v184
  v_mul_f32 v169, v169, v185
  v_mfma_f32_16x16x32_bf16 v[68:71], v[20:23], a[240:243], v[68:71]
  s_waitcnt lgkmcnt(4)
  v_mul_f32 v170, v170, v186
  v_mfma_f32_16x16x32_bf16 v[40:43], v[24:27], a[28:31], v[40:43]
  v_add_u32 v11, 36864, v11
  ds_read_b64_tr_b16 v[16:17], v11 offset:0
  v_mfma_f32_16x16x32_bf16 v[44:47], v[24:27], a[100:103], v[44:47]
  ds_read_b64_tr_b16 v[18:19], v11 offset:256
  v_mul_f32 v171, v171, v187
  v_mfma_f32_16x16x32_bf16 v[48:51], v[24:27], a[172:175], v[48:51]
  v_mul_f32 v172, v172, v188
  v_mul_f32 v173, v173, v189
  v_mfma_f32_16x16x32_bf16 v[52:55], v[24:27], a[244:247], v[52:55]
  v_mul_f32 v174, v174, v190
  v_mul_f32 v175, v175, v191
  v_mfma_f32_16x16x32_bf16 v[56:59], v[28:31], a[28:31], v[56:59]
  ds_read_b64_tr_b16 v[20:21], v11 offset:6144
  v_add_f32 v200, 1.0, v200
  v_mfma_f32_16x16x32_bf16 v[60:63], v[28:31], a[100:103], v[60:63]
  ds_read_b64_tr_b16 v[22:23], v11 offset:6400
  v_add_f32 v201, 1.0, v201
  v_mfma_f32_16x16x32_bf16 v[64:67], v[28:31], a[172:175], v[64:67]
  v_add_f32 v202, 1.0, v202
  v_add_f32 v203, 1.0, v203
  v_mfma_f32_16x16x32_bf16 v[68:71], v[28:31], a[244:247], v[68:71]
  s_waitcnt lgkmcnt(4)
  v_add_f32 v204, 1.0, v204
  v_mfma_f32_16x16x32_bf16 v[40:43], v[32:35], a[32:35], v[40:43]
  ds_read_b64_tr_b16 v[24:25], v11 offset:2048
  v_add_f32 v205, 1.0, v205
  v_mfma_f32_16x16x32_bf16 v[44:47], v[32:35], a[104:107], v[44:47]
  ds_read_b64_tr_b16 v[26:27], v11 offset:2304
  v_add_f32 v206, 1.0, v206
  v_mfma_f32_16x16x32_bf16 v[48:51], v[32:35], a[176:179], v[48:51]
  v_add_f32 v207, 1.0, v207
  v_mfma_f32_16x16x32_bf16 v[52:55], v[32:35], a[248:251], v[52:55]
  v_rcp_f32 v200, v200
  v_mfma_f32_16x16x32_bf16 v[56:59], v[36:39], a[32:35], v[56:59]
  ds_read_b64_tr_b16 v[28:29], v11 offset:8192
  v_mfma_f32_16x16x32_bf16 v[60:63], v[36:39], a[104:107], v[60:63]
  ds_read_b64_tr_b16 v[30:31], v11 offset:8448
  v_rcp_f32 v201, v201
  v_mfma_f32_16x16x32_bf16 v[64:67], v[36:39], a[176:179], v[64:67]
  v_rcp_f32 v202, v202
  v_mfma_f32_16x16x32_bf16 v[68:71], v[36:39], a[248:251], v[68:71]
  s_waitcnt lgkmcnt(4)
  v_mfma_f32_16x16x32_bf16 v[40:43], v[16:19], a[36:39], v[40:43]
  ds_read_b64_tr_b16 v[32:33], v11 offset:4096
  v_mfma_f32_16x16x32_bf16 v[44:47], v[16:19], a[108:111], v[44:47]
  ds_read_b64_tr_b16 v[34:35], v11 offset:4352
  v_rcp_f32 v203, v203
  v_mfma_f32_16x16x32_bf16 v[48:51], v[16:19], a[180:183], v[48:51]
  v_rcp_f32 v204, v204
  v_mfma_f32_16x16x32_bf16 v[52:55], v[16:19], a[252:255], v[52:55]
  v_rcp_f32 v205, v205
  v_mfma_f32_16x16x32_bf16 v[56:59], v[20:23], a[36:39], v[56:59]
  ds_read_b64_tr_b16 v[36:37], v11 offset:10240
  v_mfma_f32_16x16x32_bf16 v[60:63], v[20:23], a[108:111], v[60:63]
  ds_read_b64_tr_b16 v[38:39], v11 offset:10496
  v_rcp_f32 v206, v206
  v_mfma_f32_16x16x32_bf16 v[64:67], v[20:23], a[180:183], v[64:67]
  v_rcp_f32 v207, v207
  v_mfma_f32_16x16x32_bf16 v[68:71], v[20:23], a[252:255], v[68:71]
  s_waitcnt lgkmcnt(4)
  v_mul_f32 v168, v168, v200
  v_mfma_f32_16x16x32_bf16 v[40:43], v[24:27], a[40:43], v[40:43]
  ds_read_b64_tr_b16 v[16:17], v11 offset:12288
  v_mul_f32 v169, v169, v201
  v_mfma_f32_16x16x32_bf16 v[44:47], v[24:27], a[112:115], v[44:47]
  ds_read_b64_tr_b16 v[18:19], v11 offset:12544
  v_mul_f32 v170, v170, v202
  v_mfma_f32_16x16x32_bf16 v[48:51], v[24:27], a[184:187], v[48:51]
  v_mul_f32 v171, v171, v203
  v_mul_f32 v172, v172, v204
  v_mfma_f32_16x16x32_bf16 v[52:55], v[24:27], v[224:227], v[52:55]
  v_mul_f32 v173, v173, v205
  v_mul_f32 v174, v174, v206
  v_mfma_f32_16x16x32_bf16 v[56:59], v[28:31], a[40:43], v[56:59]
  ds_read_b64_tr_b16 v[20:21], v11 offset:18432
  v_mul_f32 v175, v175, v207
  v_mfma_f32_16x16x32_bf16 v[60:63], v[28:31], a[112:115], v[60:63]
  ds_read_b64_tr_b16 v[22:23], v11 offset:18688
  v_cvt_pk_bf16_f32 v216, v168, v169
  v_mfma_f32_16x16x32_bf16 v[64:67], v[28:31], a[184:187], v[64:67]
  v_cvt_pk_bf16_f32 v217, v170, v171
  v_cvt_pk_bf16_f32 v218, v172, v173
  v_mfma_f32_16x16x32_bf16 v[68:71], v[28:31], v[224:227], v[68:71]
  s_waitcnt lgkmcnt(4)
  v_cvt_pk_bf16_f32 v219, v174, v175
  v_mfma_f32_16x16x32_bf16 v[40:43], v[32:35], a[44:47], v[40:43]
  ds_read_b64_tr_b16 v[24:25], v11 offset:14336
  buffer_store_dwordx2 v[216:217], v13, s[16:19], s29 offen offset:0 sc1
  v_mfma_f32_16x16x32_bf16 v[44:47], v[32:35], a[116:119], v[44:47]
  ds_read_b64_tr_b16 v[26:27], v11 offset:14592
  buffer_store_dwordx2 v[218:219], v13, s[16:19], s29 offen offset:256 sc1
  v_mfma_f32_16x16x32_bf16 v[48:51], v[32:35], a[188:191], v[48:51]
  v_exp_f32 v208, -v176
  v_mfma_f32_16x16x32_bf16 v[52:55], v[32:35], v[228:231], v[52:55]
  v_exp_f32 v209, -v177
  v_mfma_f32_16x16x32_bf16 v[56:59], v[36:39], a[44:47], v[56:59]
  ds_read_b64_tr_b16 v[28:29], v11 offset:20480
  v_mfma_f32_16x16x32_bf16 v[60:63], v[36:39], a[116:119], v[60:63]
  ds_read_b64_tr_b16 v[30:31], v11 offset:20736
  v_mfma_f32_16x16x32_bf16 v[64:67], v[36:39], a[188:191], v[64:67]
  v_exp_f32 v210, -v178
  v_mfma_f32_16x16x32_bf16 v[68:71], v[36:39], v[228:231], v[68:71]
  s_waitcnt lgkmcnt(4)
  v_mfma_f32_16x16x32_bf16 v[40:43], v[16:19], a[48:51], v[40:43]
  ds_read_b64_tr_b16 v[32:33], v11 offset:16384
  v_mfma_f32_16x16x32_bf16 v[44:47], v[16:19], a[120:123], v[44:47]
  ds_read_b64_tr_b16 v[34:35], v11 offset:16640
  v_exp_f32 v211, -v179
  v_mfma_f32_16x16x32_bf16 v[48:51], v[16:19], a[192:195], v[48:51]
  v_exp_f32 v212, -v180
  v_mfma_f32_16x16x32_bf16 v[52:55], v[16:19], v[232:235], v[52:55]
  v_exp_f32 v213, -v181
  v_mfma_f32_16x16x32_bf16 v[56:59], v[20:23], a[48:51], v[56:59]
  ds_read_b64_tr_b16 v[36:37], v11 offset:22528
  v_mfma_f32_16x16x32_bf16 v[60:63], v[20:23], a[120:123], v[60:63]
  ds_read_b64_tr_b16 v[38:39], v11 offset:22784
  v_mfma_f32_16x16x32_bf16 v[64:67], v[20:23], a[192:195], v[64:67]
  v_exp_f32 v214, -v182
  v_mfma_f32_16x16x32_bf16 v[68:71], v[20:23], v[232:235], v[68:71]
  s_waitcnt lgkmcnt(4)
  v_mfma_f32_16x16x32_bf16 v[40:43], v[24:27], a[52:55], v[40:43]
  ds_read_b64_tr_b16 v[16:17], v11 offset:24576
  v_exp_f32 v215, -v183
  v_mfma_f32_16x16x32_bf16 v[44:47], v[24:27], a[124:127], v[44:47]
  ds_read_b64_tr_b16 v[18:19], v11 offset:24832
  v_mul_f32 v176, v176, v192
  v_mfma_f32_16x16x32_bf16 v[48:51], v[24:27], a[196:199], v[48:51]
  v_mul_f32 v177, v177, v193
  v_mul_f32 v178, v178, v194
  v_mfma_f32_16x16x32_bf16 v[52:55], v[24:27], v[236:239], v[52:55]
  v_mul_f32 v179, v179, v195
  v_mul_f32 v180, v180, v196
  v_mfma_f32_16x16x32_bf16 v[56:59], v[28:31], a[52:55], v[56:59]
  ds_read_b64_tr_b16 v[20:21], v11 offset:30720
  v_mul_f32 v181, v181, v197
  v_mfma_f32_16x16x32_bf16 v[60:63], v[28:31], a[124:127], v[60:63]
  ds_read_b64_tr_b16 v[22:23], v11 offset:30976
  v_mul_f32 v182, v182, v198
  v_mfma_f32_16x16x32_bf16 v[64:67], v[28:31], a[196:199], v[64:67]
  v_mul_f32 v183, v183, v199
  v_add_f32 v208, 1.0, v208
  v_mfma_f32_16x16x32_bf16 v[68:71], v[28:31], v[236:239], v[68:71]
  s_waitcnt lgkmcnt(4)
  v_add_f32 v209, 1.0, v209
  v_mfma_f32_16x16x32_bf16 v[40:43], v[32:35], a[56:59], v[40:43]
  ds_read_b64_tr_b16 v[24:25], v11 offset:26624
  v_add_f32 v210, 1.0, v210
  v_mfma_f32_16x16x32_bf16 v[44:47], v[32:35], a[128:131], v[44:47]
  ds_read_b64_tr_b16 v[26:27], v11 offset:26880
  v_add_f32 v211, 1.0, v211
  v_mfma_f32_16x16x32_bf16 v[48:51], v[32:35], a[200:203], v[48:51]
  v_add_f32 v212, 1.0, v212
  v_add_f32 v213, 1.0, v213
  v_mfma_f32_16x16x32_bf16 v[52:55], v[32:35], v[240:243], v[52:55]
  v_add_f32 v214, 1.0, v214
  v_add_f32 v215, 1.0, v215
  v_mfma_f32_16x16x32_bf16 v[56:59], v[36:39], a[56:59], v[56:59]
  ds_read_b64_tr_b16 v[28:29], v11 offset:32768
  v_mfma_f32_16x16x32_bf16 v[60:63], v[36:39], a[128:131], v[60:63]
  ds_read_b64_tr_b16 v[30:31], v11 offset:33024
  v_mfma_f32_16x16x32_bf16 v[64:67], v[36:39], a[200:203], v[64:67]
  v_rcp_f32 v208, v208
  v_mfma_f32_16x16x32_bf16 v[68:71], v[36:39], v[240:243], v[68:71]
  s_waitcnt lgkmcnt(4)
  v_mfma_f32_16x16x32_bf16 v[40:43], v[16:19], a[60:63], v[40:43]
  ds_read_b64_tr_b16 v[32:33], v11 offset:28672
  v_rcp_f32 v209, v209
  v_mfma_f32_16x16x32_bf16 v[44:47], v[16:19], a[132:135], v[44:47]
  ds_read_b64_tr_b16 v[34:35], v11 offset:28928
  v_mfma_f32_16x16x32_bf16 v[48:51], v[16:19], a[204:207], v[48:51]
  v_rcp_f32 v210, v210
  v_mfma_f32_16x16x32_bf16 v[52:55], v[16:19], v[244:247], v[52:55]
  v_rcp_f32 v211, v211
  v_mfma_f32_16x16x32_bf16 v[56:59], v[20:23], a[60:63], v[56:59]
  ds_read_b64_tr_b16 v[36:37], v11 offset:34816
  v_mfma_f32_16x16x32_bf16 v[60:63], v[20:23], a[132:135], v[60:63]
  ds_read_b64_tr_b16 v[38:39], v11 offset:35072
  v_rcp_f32 v212, v212
  v_mfma_f32_16x16x32_bf16 v[64:67], v[20:23], a[204:207], v[64:67]
  v_rcp_f32 v213, v213
  v_mfma_f32_16x16x32_bf16 v[68:71], v[20:23], v[244:247], v[68:71]
  s_waitcnt lgkmcnt(4)
  v_mfma_f32_16x16x32_bf16 v[40:43], v[24:27], a[64:67], v[40:43]
  v_rcp_f32 v214, v214
  v_mfma_f32_16x16x32_bf16 v[44:47], v[24:27], a[136:139], v[44:47]
  v_rcp_f32 v215, v215
  v_mfma_f32_16x16x32_bf16 v[48:51], v[24:27], a[208:211], v[48:51]
  v_mul_f32 v176, v176, v208
  v_mul_f32 v177, v177, v209
  v_mfma_f32_16x16x32_bf16 v[52:55], v[24:27], v[248:251], v[52:55]
  v_mul_f32 v178, v178, v210
  v_mul_f32 v179, v179, v211
  v_mfma_f32_16x16x32_bf16 v[56:59], v[28:31], a[64:67], v[56:59]
  v_mul_f32 v180, v180, v212
  v_mul_f32 v181, v181, v213
  v_mfma_f32_16x16x32_bf16 v[60:63], v[28:31], a[136:139], v[60:63]
  v_mul_f32 v182, v182, v214
  v_mul_f32 v183, v183, v215
  v_mfma_f32_16x16x32_bf16 v[64:67], v[28:31], a[208:211], v[64:67]
  v_cvt_pk_bf16_f32 v220, v176, v177
  v_cvt_pk_bf16_f32 v221, v178, v179
  v_mfma_f32_16x16x32_bf16 v[68:71], v[28:31], v[248:251], v[68:71]
  s_waitcnt lgkmcnt(0)
  v_cvt_pk_bf16_f32 v222, v180, v181
  v_mfma_f32_16x16x32_bf16 v[40:43], v[32:35], a[68:71], v[40:43]
  v_cvt_pk_bf16_f32 v223, v182, v183
  s_add_u32 s30, s29, 294912
  v_mfma_f32_16x16x32_bf16 v[44:47], v[32:35], a[140:143], v[44:47]
  buffer_store_dwordx2 v[220:221], v13, s[16:19], s30 offen offset:0 sc1
  buffer_store_dwordx2 v[222:223], v13, s[16:19], s30 offen offset:256 sc1
  v_mfma_f32_16x16x32_bf16 v[48:51], v[32:35], a[212:215], v[48:51]
  s_add_u32 s29, s29, 1024
  v_mfma_f32_16x16x32_bf16 v[52:55], v[32:35], v[252:255], v[52:55]
  v_mfma_f32_16x16x32_bf16 v[56:59], v[36:39], a[68:71], v[56:59]
  v_mfma_f32_16x16x32_bf16 v[60:63], v[36:39], a[140:143], v[60:63]
  v_mfma_f32_16x16x32_bf16 v[64:67], v[36:39], a[212:215], v[64:67]
  v_mfma_f32_16x16x32_bf16 v[68:71], v[36:39], v[252:255], v[68:71]
  s_nop 7
  s_mov_b32 s29, s44
  v_exp_f32 v200, -v40
  v_exp_f32 v201, -v41
  v_exp_f32 v202, -v42
  v_exp_f32 v203, -v43
  v_exp_f32 v204, -v44
  v_exp_f32 v205, -v45
  v_exp_f32 v206, -v46
  v_exp_f32 v207, -v47
  v_mul_f32 v40, v40, v56
  v_mul_f32 v41, v41, v57
  v_mul_f32 v42, v42, v58
  v_mul_f32 v43, v43, v59
  v_mul_f32 v44, v44, v60
  v_mul_f32 v45, v45, v61
  v_mul_f32 v46, v46, v62
  v_mul_f32 v47, v47, v63
  v_add_f32 v200, 1.0, v200
  v_add_f32 v201, 1.0, v201
  v_add_f32 v202, 1.0, v202
  v_add_f32 v203, 1.0, v203
  v_add_f32 v204, 1.0, v204
  v_add_f32 v205, 1.0, v205
  v_add_f32 v206, 1.0, v206
  v_add_f32 v207, 1.0, v207
  v_rcp_f32 v200, v200
  v_rcp_f32 v201, v201
  v_rcp_f32 v202, v202
  v_rcp_f32 v203, v203
  v_rcp_f32 v204, v204
  v_rcp_f32 v205, v205
  v_rcp_f32 v206, v206
  v_rcp_f32 v207, v207
  v_mul_f32 v40, v40, v200
  v_mul_f32 v41, v41, v201
  v_mul_f32 v42, v42, v202
  v_mul_f32 v43, v43, v203
  v_mul_f32 v44, v44, v204
  v_mul_f32 v45, v45, v205
  v_mul_f32 v46, v46, v206
  v_mul_f32 v47, v47, v207
  v_cvt_pk_bf16_f32 v216, v40, v41
  v_cvt_pk_bf16_f32 v217, v42, v43
  v_cvt_pk_bf16_f32 v218, v44, v45
  v_cvt_pk_bf16_f32 v219, v46, v47
  buffer_store_dwordx2 v[216:217], v13, s[16:19], s29 offen offset:0 sc1
  buffer_store_dwordx2 v[218:219], v13, s[16:19], s29 offen offset:256 sc1
  v_exp_f32 v208, -v48
  v_exp_f32 v209, -v49
  v_exp_f32 v210, -v50
  v_exp_f32 v211, -v51
  v_exp_f32 v212, -v52
  v_exp_f32 v213, -v53
  v_exp_f32 v214, -v54
  v_exp_f32 v215, -v55
  v_mul_f32 v48, v48, v64
  v_mul_f32 v49, v49, v65
  v_mul_f32 v50, v50, v66
  v_mul_f32 v51, v51, v67
  v_mul_f32 v52, v52, v68
  v_mul_f32 v53, v53, v69
  v_mul_f32 v54, v54, v70
  v_mul_f32 v55, v55, v71
  v_add_f32 v208, 1.0, v208
  v_add_f32 v209, 1.0, v209
  v_add_f32 v210, 1.0, v210
  v_add_f32 v211, 1.0, v211
  v_add_f32 v212, 1.0, v212
  v_add_f32 v213, 1.0, v213
  v_add_f32 v214, 1.0, v214
  v_add_f32 v215, 1.0, v215
  v_rcp_f32 v208, v208
  v_rcp_f32 v209, v209
  v_rcp_f32 v210, v210
  v_rcp_f32 v211, v211
  v_rcp_f32 v212, v212
  v_rcp_f32 v213, v213
  v_rcp_f32 v214, v214
  v_rcp_f32 v215, v215
  v_mul_f32 v48, v48, v208
  v_mul_f32 v49, v49, v209
  v_mul_f32 v50, v50, v210
  v_mul_f32 v51, v51, v211
  v_mul_f32 v52, v52, v212
  v_mul_f32 v53, v53, v213
  v_mul_f32 v54, v54, v214
  v_mul_f32 v55, v55, v215
  v_cvt_pk_bf16_f32 v220, v48, v49
  v_cvt_pk_bf16_f32 v221, v50, v51
  v_cvt_pk_bf16_f32 v222, v52, v53
  v_cvt_pk_bf16_f32 v223, v54, v55
  s_add_u32 s30, s29, 294912
  buffer_store_dwordx2 v[220:221], v13, s[16:19], s30 offen offset:0 sc1
  buffer_store_dwordx2 v[222:223], v13, s[16:19], s30 offen offset:256 sc1
  s_add_u32 s29, s29, 1024
  s_waitcnt vmcnt(0)
  s_waitcnt vmcnt(0)
k1_end:
  s_endpgm
.section .rodata,"a"
.p2align 6
.amdhsa_kernel k1_gemm1_kernel
  .amdhsa_next_free_vgpr 512
  .amdhsa_next_free_sgpr 100
  .amdhsa_accum_offset 256
  .amdhsa_group_segment_fixed_size 0
  .amdhsa_kernarg_size 80
  .amdhsa_user_sgpr_count 2
  .amdhsa_user_sgpr_kernarg_segment_ptr 1
  .amdhsa_system_sgpr_workgroup_id_x 1
  .amdhsa_float_denorm_mode_32 3
.end_amdhsa_kernel
.text
.globl k2_attn_kernel
.p2align 8
.type k2_attn_kernel,@function
k2_attn_kernel:
  s_cmp_ge_u32 s2, 256
  s_cbranch_scc1 k2_end
  s_load_dwordx2 s[4:5], s[0:1], 48
  s_load_dwordx2 s[6:7], s[0:1], 72
  v_and_b32 v1, 63, v0
  v_lshrrev_b32 v2, 6, v0
  s_and_b32 s17, s2, 7
  v_readfirstlane_b32 s16, v2
  s_lshr_b32 s18, s2, 3
  s_waitcnt lgkmcnt(0)
  s_mov_b32 s8, s6
  s_and_b32 s9, s7, 0xffff
  s_mov_b32 s10, 50331648
  s_mov_b32 s11, 0x20000
  s_mov_b32 s12, s4
  s_and_b32 s13, s5, 0xffff
  s_mov_b32 s14, 5308416
  s_mov_b32 s15, 0x20000
  s_mov_b32 s22, s16
  s_cmp_ge_u32 s16, 4
  s_cbranch_scc1 k2_gemm
  s_lshl_b32 s24, s17, 2
  s_and_b32 s19, s18, 3
  s_add_u32 s24, s24, s19
  s_lshr_b32 s19, s18, 2
  s_lshl_b32 s25, s19, 3
  s_lshl_b32 s19, s16, 1
  s_add_u32 s25, s25, s19
  v_and_b32 v2, 31, v1
  v_and_b32 v3, 15, v1
  v_lshlrev_b32 v3, 4, v3
  v_bfe_u32 v11, v1, 4, 1
  v_lshl_add_u32 v10, v11, 2, v3
  v_lshrrev_b32 v3, 5, v1
  v_lshl_add_u32 v11, v3, 15, v10
  s_mul_i32 s19, s24, 73728
  s_add_u32 s19, s19, 2359296
  v_and_b32 v12, 15, v1
  v_lshlrev_b32 v12, 4, v12
  v_lshl_add_u32 v13, v3, 15, v12
  s_add_u32 s21, s19, 2359296
  s_add_u32 s20, s21, 0
  buffer_load_dwordx4 v[64:67], v13, s[8:11], s20 offen
  s_add_u32 s20, s21, 8192
  buffer_load_dwordx4 v[68:71], v13, s[8:11], s20 offen
  s_add_u32 s20, s21, 16384
  buffer_load_dwordx4 v[72:75], v13, s[8:11], s20 offen
  s_add_u32 s20, s21, 24576
  buffer_load_dwordx4 v[76:79], v13, s[8:11], s20 offen
  s_add_u32 s20, s21, 65536
  buffer_load_dwordx4 v[80:83], v12, s[8:11], s20 offen
  s_add_u32 s20, s21, 256
  buffer_load_dwordx4 v[84:87], v13, s[8:11], s20 offen
  s_add_u32 s20, s21, 8448
  buffer_load_dwordx4 v[88:91], v13, s[8:11], s20 offen
  s_add_u32 s20, s21, 16640
  buffer_load_dwordx4 v[92:95], v13, s[8:11], s20 offen
  s_add_u32 s20, s21, 24832
  buffer_load_dwordx4 v[96:99], v13, s[8:11], s20 offen
  s_add_u32 s20, s21, 65792
  buffer_load_dwordx4 v[100:103], v12, s[8:11], s20 offen
  s_lshl_b32 s20, s25, 7
  s_add_u32 s19, s19, s20
  s_add_u32 s20, s19, 0
  buffer_load_dwordx4 v[104:107], v13, s[8:11], s20 offen
  s_add_u32 s20, s19, 8192
  buffer_load_dwordx4 v[108:111], v13, s[8:11], s20 offen
  s_add_u32 s20, s19, 16384
  buffer_load_dwordx4 v[112:115], v13, s[8:11], s20 offen
  s_add_u32 s20, s19, 24576
  buffer_load_dwordx4 v[116:119], v13, s[8:11], s20 offen
  s_add_u32 s20, s19, 65536
  buffer_load_dwordx4 v[120:123], v12, s[8:11], s20 offen
  s_setprio 2
  v_lshlrev_b32 v9, 4, v1
  v_mov_b32 v177, 0x3f803f80
  v_cmp_eq_u32 vcc, 18, v2
  s_nop 1
  v_cndmask_b32 v180, 0, v177, vcc
  v_mov_b32 v181, v180
  v_mov_b32 v182, v180
  v_mov_b32 v183, v180
  s_mul_i32 s20, s16, 12800
  s_add_u32 s20, s20, 115200
  v_add_u32 v178, s20, v9
  v_cmp_le_u32 vcc, 18, v2
  s_and_saveexec_b64 s[28:29], vcc
  ds_write_b128 v178, v[180:183] offset:0
  ds_write_b128 v178, v[180:183] offset:1024
  ds_write_b128 v178, v[180:183] offset:2048
  ds_write_b128 v178, v[180:183] offset:3072
  ds_write_b128 v178, v[180:183] offset:4096
  ds_write_b128 v178, v[180:183] offset:5120
  ds_write_b128 v178, v[180:183] offset:6144
  ds_write_b128 v178, v[180:183] offset:7168
  s_mov_b64 exec, s[28:29]
  v_add_u32 v4, 110592, v9
  v_lshlrev_b32 v5, 4, v2
  v_add_u32 v5, 114688, v5
  v_and_b32 v12, 16, v1
  v_cmp_eq_u32 s[30:31], 0, v12
  v_cmp_gt_u32 vcc, 32, v1
  s_waitcnt vmcnt(0)
  v_cndmask_b32 v184, v65, v64, s[30:31]
  v_cndmask_b32 v185, v69, v68, s[30:31]
  v_cndmask_b32 v186, v73, v72, s[30:31]
  v_cndmask_b32 v187, v77, v76, s[30:31]
  v_cndmask_b32 v40, v81, v80, s[30:31]
  v_cndmask_b32 v188, v67, v66, s[30:31]
  v_cndmask_b32 v189, v71, v70, s[30:31]
  v_cndmask_b32 v190, v75, v74, s[30:31]
  v_cndmask_b32 v191, v79, v78, s[30:31]
  v_cndmask_b32 v41, v83, v82, s[30:31]
  v_cndmask_b32 v192, v85, v84, s[30:31]
  v_cndmask_b32 v193, v89, v88, s[30:31]
  v_cndmask_b32 v194, v93, v92, s[30:31]
  v_cndmask_b32 v195, v97, v96, s[30:31]
  v_cndmask_b32 v42, v101, v100, s[30:31]
  v_cndmask_b32 v196, v87, v86, s[30:31]
  v_cndmask_b32 v197, v91, v90, s[30:31]
  v_cndmask_b32 v198, v95, v94, s[30:31]
  v_cndmask_b32 v199, v99, v98, s[30:31]
  v_cndmask_b32 v43, v103, v102, s[30:31]
  v_cndmask_b32 v16, v105, v104, s[30:31]
  v_cndmask_b32 v17, v109, v108, s[30:31]
  v_cndmask_b32 v18, v113, v112, s[30:31]
  v_cndmask_b32 v19, v117, v116, s[30:31]
  v_cndmask_b32 v24, v121, v120, s[30:31]
  v_cndmask_b32 v20, v107, v106, s[30:31]
  v_cndmask_b32 v21, v111, v110, s[30:31]
  v_cndmask_b32 v22, v115, v114, s[30:31]
  v_cndmask_b32 v23, v119, v118, s[30:31]
  v_cndmask_b32 v26, v123, v122, s[30:31]
  v_cndmask_b32 v24, 0, v24, vcc
  v_mov_b32 v25, 0
  v_mov_b32 v28, 0
  v_mov_b32 v29, v24
  v_cndmask_b32 v26, 0, v26, vcc
  v_mov_b32 v27, 0
  v_mov_b32 v30, 0
  v_mov_b32 v31, v26
  v_mov_b32 v112, 0
  v_mov_b32 v113, 0
  v_mov_b32 v114, 0
  v_mov_b32 v115, 0
  v_mov_b32 v116, 0
  v_mov_b32 v117, 0
  v_mov_b32 v118, 0
  v_mov_b32 v119, 0
  v_mov_b32 v120, 0
  v_mov_b32 v121, 0
  v_mov_b32 v122, 0
  v_mov_b32 v123, 0
  v_mov_b32 v124, 0
  v_mov_b32 v125, 0
  v_mov_b32 v126, 0
  v_mov_b32 v127, 0
  v_mov_b32 v128, 0
  v_mov_b32 v129, 0
  v_mov_b32 v130, 0
  v_mov_b32 v131, 0
  v_mov_b32 v132, 0
  v_mov_b32 v133, 0
  v_mov_b32 v134, 0
  v_mov_b32 v135, 0
  v_mov_b32 v136, 0
  v_mov_b32 v137, 0
  v_mov_b32 v138, 0
  v_mov_b32 v139, 0
  v_mov_b32 v140, 0
  v_mov_b32 v141, 0
  v_mov_b32 v142, 0
  v_mov_b32 v143, 0
  v_mov_b32 v176, 0xff800000
  v_mov_b32 v177, 0xff800000
  v_mfma_f32_32x32x8_bf16 v[64:79], v[40:41], v[24:25], 0
  v_mfma_f32_32x32x16_bf16 v[64:79], v[184:187], v[16:19], v[64:79]
  v_mfma_f32_32x32x8_bf16 v[80:95], v[40:41], v[26:27], 0
  v_mfma_f32_32x32x16_bf16 v[80:95], v[184:187], v[20:23], v[80:95]
  s_nop 7
  s_nop 3
  v_max3_f32 v176, v64, v65, v176
  v_max3_f32 v176, v66, v67, v176
  v_max3_f32 v176, v68, v69, v176
  v_max3_f32 v176, v70, v71, v176
  v_max3_f32 v176, v72, v73, v176
  v_max3_f32 v176, v74, v75, v176
  v_max3_f32 v176, v76, v77, v176
  v_max3_f32 v176, v78, v79, v176
  v_mfma_f32_32x32x8_bf16 v[64:79], v[40:41], v[28:29], 0
  v_mfma_f32_32x32x16_bf16 v[64:79], v[188:191], v[16:19], v[64:79]
  s_nop 1
  v_max3_f32 v177, v80, v81, v177
  v_max3_f32 v177, v82, v83, v177
  v_max3_f32 v177, v84, v85, v177
  v_max3_f32 v177, v86, v87, v177
  v_max3_f32 v177, v88, v89, v177
  v_max3_f32 v177, v90, v91, v177
  v_max3_f32 v177, v92, v93, v177
  v_max3_f32 v177, v94, v95, v177
  v_mfma_f32_32x32x8_bf16 v[80:95], v[40:41], v[30:31], 0
  v_mfma_f32_32x32x16_bf16 v[80:95], v[188:191], v[20:23], v[80:95]
  s_nop 1
  v_max3_f32 v176, v64, v65, v176
  v_max3_f32 v176, v66, v67, v176
  v_max3_f32 v176, v68, v69, v176
  v_max3_f32 v176, v70, v71, v176
  v_max3_f32 v176, v72, v73, v176
  v_max3_f32 v176, v74, v75, v176
  v_max3_f32 v176, v76, v77, v176
  v_max3_f32 v176, v78, v79, v176
  v_mfma_f32_32x32x8_bf16 v[64:79], v[42:43], v[24:25], 0
  v_mfma_f32_32x32x16_bf16 v[64:79], v[192:195], v[16:19], v[64:79]
  s_nop 1
  v_max3_f32 v177, v80, v81, v177
  v_max3_f32 v177, v82, v83, v177
  v_max3_f32 v177, v84, v85, v177
  v_max3_f32 v177, v86, v87, v177
  v_max3_f32 v177, v88, v89, v177
  v_max3_f32 v177, v90, v91, v177
  v_max3_f32 v177, v92, v93, v177
  v_max3_f32 v177, v94, v95, v177
  v_mfma_f32_32x32x8_bf16 v[80:95], v[42:43], v[26:27], 0
  v_mfma_f32_32x32x16_bf16 v[80:95], v[192:195], v[20:23], v[80:95]
  s_nop 1
  v_max3_f32 v176, v64, v65, v176
  v_max3_f32 v176, v66, v67, v176
  v_max3_f32 v176, v68, v69, v176
  v_max3_f32 v176, v70, v71, v176
  v_max3_f32 v176, v72, v73, v176
  v_max3_f32 v176, v74, v75, v176
  v_max3_f32 v176, v76, v77, v176
  v_max3_f32 v176, v78, v79, v176
  v_mfma_f32_32x32x8_bf16 v[64:79], v[42:43], v[28:29], 0
  v_mfma_f32_32x32x16_bf16 v[64:79], v[196:199], v[16:19], v[64:79]
  s_nop 1
  v_max3_f32 v177, v80, v81, v177
  v_max3_f32 v177, v82, v83, v177
  v_max3_f32 v177, v84, v85, v177
  v_max3_f32 v177, v86, v87, v177
  v_max3_f32 v177, v88, v89, v177
  v_max3_f32 v177, v90, v91, v177
  v_max3_f32 v177, v92, v93, v177
  v_max3_f32 v177, v94, v95, v177
  v_mfma_f32_32x32x8_bf16 v[80:95], v[42:43], v[30:31], 0
  v_mfma_f32_32x32x16_bf16 v[80:95], v[196:199], v[20:23], v[80:95]
  s_nop 1
  v_max3_f32 v176, v64, v65, v176
  v_max3_f32 v176, v66, v67, v176
  v_max3_f32 v176, v68, v69, v176
  v_max3_f32 v176, v70, v71, v176
  v_max3_f32 v176, v72, v73, v176
  v_max3_f32 v176, v74, v75, v176
  v_max3_f32 v176, v76, v77, v176
  v_max3_f32 v176, v78, v79, v176
  s_nop 3
  v_max3_f32 v177, v80, v81, v177
  v_max3_f32 v177, v82, v83, v177
  v_max3_f32 v177, v84, v85, v177
  v_max3_f32 v177, v86, v87, v177
  v_max3_f32 v177, v88, v89, v177
  v_max3_f32 v177, v90, v91, v177
  v_max3_f32 v177, v92, v93, v177
  v_max3_f32 v177, v94, v95, v177
  v_mov_b32 v178, v176
  s_nop 1
  v_permlane32_swap_b32 v178, v176
  s_nop 1
  v_max_f32 v176, v176, v178
  v_add_f32 v176, 0x42b40000, v176
  v_sub_f32 v144, 0, v176
  v_sub_f32 v145, 0, v176
  v_sub_f32 v146, 0, v176
  v_sub_f32 v147, 0, v176
  v_sub_f32 v148, 0, v176
  v_sub_f32 v149, 0, v176
  v_sub_f32 v150, 0, v176
  v_sub_f32 v151, 0, v176
  v_sub_f32 v152, 0, v176
  v_sub_f32 v153, 0, v176
  v_sub_f32 v154, 0, v176
  v_sub_f32 v155, 0, v176
  v_sub_f32 v156, 0, v176
  v_sub_f32 v157, 0, v176
  v_sub_f32 v158, 0, v176
  v_sub_f32 v159, 0, v176
  v_mov_b32 v178, v177
  s_nop 1
  v_permlane32_swap_b32 v178, v177
  s_nop 1
  v_max_f32 v177, v177, v178
  v_add_f32 v177, 0x42b40000, v177
  v_sub_f32 v160, 0, v177
  v_sub_f32 v161, 0, v177
  v_sub_f32 v162, 0, v177
  v_sub_f32 v163, 0, v177
  v_sub_f32 v164, 0, v177
  v_sub_f32 v165, 0, v177
  v_sub_f32 v166, 0, v177
  v_sub_f32 v167, 0, v177
  v_sub_f32 v168, 0, v177
  v_sub_f32 v169, 0, v177
  v_sub_f32 v170, 0, v177
  v_sub_f32 v171, 0, v177
  v_sub_f32 v172, 0, v177
  v_sub_f32 v173, 0, v177
  v_sub_f32 v174, 0, v177
  v_sub_f32 v175, 0, v177
  s_waitcnt lgkmcnt(0)
  s_barrier
  ds_read_b128 v[32:35], v4 offset:0
  ds_read_b128 v[40:43], v5 offset:0
  s_waitcnt lgkmcnt(0)
  v_mfma_f32_32x32x8_bf16 v[64:79], v[40:41], v[24:25], v[144:159]
  v_mfma_f32_32x32x16_bf16 v[64:79], v[32:35], v[16:19], v[64:79]
  s_nop 7
  v_mfma_f32_32x32x8_bf16 v[80:95], v[40:41], v[26:27], v[160:175]
  ds_read_b128 v[48:51], v4 offset:4608
  ds_read_b128 v[52:55], v4 offset:5632
  ds_read_b128 v[36:39], v4 offset:1024
  v_exp_f32 v64, v64
  v_exp_f32 v65, v65
  v_exp_f32 v66, v66
  v_exp_f32 v67, v67
  v_mfma_f32_32x32x16_bf16 v[80:95], v[32:35], v[20:23], v[80:95]
  v_exp_f32 v68, v68
  v_exp_f32 v69, v69
  v_exp_f32 v70, v70
  v_exp_f32 v71, v71
  v_cvt_pk_bf16_f32 v96, v64, v65
  v_cvt_pk_bf16_f32 v97, v66, v67
  v_exp_f32 v72, v72
  v_exp_f32 v73, v73
  v_exp_f32 v74, v74
  v_exp_f32 v75, v75
  v_cvt_pk_bf16_f32 v98, v68, v69
  v_cvt_pk_bf16_f32 v99, v70, v71
  v_exp_f32 v76, v76
  v_exp_f32 v77, v77
  v_exp_f32 v78, v78
  v_exp_f32 v79, v79
  v_cvt_pk_bf16_f32 v100, v72, v73
  v_cvt_pk_bf16_f32 v101, v74, v75
  v_cvt_pk_bf16_f32 v102, v76, v77
  v_cvt_pk_bf16_f32 v103, v78, v79
  s_waitcnt lgkmcnt(0)
  v_mfma_f32_32x32x8_bf16 v[64:79], v[40:41], v[28:29], v[144:159]
  v_exp_f32 v80, v80
  v_exp_f32 v81, v81
  v_exp_f32 v82, v82
  v_exp_f32 v83, v83
  v_mfma_f32_32x32x16_bf16 v[112:127], v[48:51], v[96:99], v[112:127]
  v_exp_f32 v84, v84
  v_exp_f32 v85, v85
  v_exp_f32 v86, v86
  v_exp_f32 v87, v87
  v_cvt_pk_bf16_f32 v104, v80, v81
  v_cvt_pk_bf16_f32 v105, v82, v83
  v_mfma_f32_32x32x16_bf16 v[64:79], v[36:39], v[16:19], v[64:79]
  v_exp_f32 v88, v88
  v_exp_f32 v89, v89
  v_exp_f32 v90, v90
  v_exp_f32 v91, v91
  v_cvt_pk_bf16_f32 v106, v84, v85
  v_cvt_pk_bf16_f32 v107, v86, v87
  v_mfma_f32_32x32x16_bf16 v[112:127], v[52:55], v[100:103], v[112:127]
  v_exp_f32 v92, v92
  v_exp_f32 v93, v93
  v_exp_f32 v94, v94
  v_exp_f32 v95, v95
  v_cvt_pk_bf16_f32 v108, v88, v89
  v_cvt_pk_bf16_f32 v109, v90, v91
  v_cvt_pk_bf16_f32 v110, v92, v93
  v_cvt_pk_bf16_f32 v111, v94, v95
  s_barrier
  v_mfma_f32_32x32x8_bf16 v[80:95], v[40:41], v[30:31], v[160:175]
  ds_read_b128 v[56:59], v4 offset:6656
  ds_read_b128 v[60:63], v4 offset:7680
  ds_read_b128 v[32:35], v4 offset:2048
  v_exp_f32 v64, v64
  v_exp_f32 v65, v65
  v_exp_f32 v66, v66
  v_exp_f32 v67, v67
  v_mfma_f32_32x32x16_bf16 v[128:143], v[48:51], v[104:107], v[128:143]
  v_exp_f32 v68, v68
  v_exp_f32 v69, v69
  v_exp_f32 v70, v70
  v_exp_f32 v71, v71
  v_cvt_pk_bf16_f32 v96, v64, v65
  v_cvt_pk_bf16_f32 v97, v66, v67
  v_mfma_f32_32x32x16_bf16 v[80:95], v[36:39], v[20:23], v[80:95]
  v_exp_f32 v72, v72
  v_exp_f32 v73, v73
  v_exp_f32 v74, v74
  v_exp_f32 v75, v75
  v_cvt_pk_bf16_f32 v98, v68, v69
  v_cvt_pk_bf16_f32 v99, v70, v71
  v_mfma_f32_32x32x16_bf16 v[128:143], v[52:55], v[108:111], v[128:143]
  v_exp_f32 v76, v76
  v_exp_f32 v77, v77
  v_exp_f32 v78, v78
  v_exp_f32 v79, v79
  v_cvt_pk_bf16_f32 v100, v72, v73
  v_cvt_pk_bf16_f32 v101, v74, v75
  v_cvt_pk_bf16_f32 v102, v76, v77
  v_cvt_pk_bf16_f32 v103, v78, v79
  s_waitcnt lgkmcnt(0)
  v_mfma_f32_32x32x8_bf16 v[64:79], v[42:43], v[24:25], v[144:159]
  v_exp_f32 v80, v80
  v_exp_f32 v81, v81
  v_exp_f32 v82, v82
  v_exp_f32 v83, v83
  v_mfma_f32_32x32x16_bf16 v[112:127], v[56:59], v[96:99], v[112:127]
  v_exp_f32 v84, v84
  v_exp_f32 v85, v85
  v_exp_f32 v86, v86
  v_exp_f32 v87, v87
  v_cvt_pk_bf16_f32 v104, v80, v81
  v_cvt_pk_bf16_f32 v105, v82, v83
  v_mfma_f32_32x32x16_bf16 v[64:79], v[32:35], v[16:19], v[64:79]
  v_exp_f32 v88, v88
  v_exp_f32 v89, v89
  v_exp_f32 v90, v90
  v_exp_f32 v91, v91
  v_cvt_pk_bf16_f32 v106, v84, v85
  v_cvt_pk_bf16_f32 v107, v86, v87
  v_mfma_f32_32x32x16_bf16 v[112:127], v[60:63], v[100:103], v[112:127]
  v_exp_f32 v92, v92
  v_exp_f32 v93, v93
  v_exp_f32 v94, v94
  v_exp_f32 v95, v95
  v_cvt_pk_bf16_f32 v108, v88, v89
  v_cvt_pk_bf16_f32 v109, v90, v91
  v_cvt_pk_bf16_f32 v110, v92, v93
  v_cvt_pk_bf16_f32 v111, v94, v95
  v_mfma_f32_32x32x8_bf16 v[80:95], v[42:43], v[26:27], v[160:175]
  ds_read_b128 v[48:51], v4 offset:8704
  ds_read_b128 v[52:55], v4 offset:9728
  ds_read_b128 v[36:39], v4 offset:3072
  v_exp_f32 v64, v64
  v_exp_f32 v65, v65
  v_exp_f32 v66, v66
  v_exp_f32 v67, v67
  v_mfma_f32_32x32x16_bf16 v[128:143], v[56:59], v[104:107], v[128:143]
  v_exp_f32 v68, v68
  v_exp_f32 v69, v69
  v_exp_f32 v70, v70
  v_exp_f32 v71, v71
  v_cvt_pk_bf16_f32 v96, v64, v65
  v_cvt_pk_bf16_f32 v97, v66, v67
  v_mfma_f32_32x32x16_bf16 v[80:95], v[32:35], v[20:23], v[80:95]
  v_exp_f32 v72, v72
  v_exp_f32 v73, v73
  v_exp_f32 v74, v74
  v_exp_f32 v75, v75
  v_cvt_pk_bf16_f32 v98, v68, v69
  v_cvt_pk_bf16_f32 v99, v70, v71
  v_mfma_f32_32x32x16_bf16 v[128:143], v[60:63], v[108:111], v[128:143]
  v_exp_f32 v76, v76
  v_exp_f32 v77, v77
  v_exp_f32 v78, v78
  v_exp_f32 v79, v79
  v_cvt_pk_bf16_f32 v100, v72, v73
  v_cvt_pk_bf16_f32 v101, v74, v75
  v_cvt_pk_bf16_f32 v102, v76, v77
  v_cvt_pk_bf16_f32 v103, v78, v79
  s_waitcnt lgkmcnt(0)
  v_mfma_f32_32x32x8_bf16 v[64:79], v[42:43], v[28:29], v[144:159]
  v_exp_f32 v80, v80
  v_exp_f32 v81, v81
  v_exp_f32 v82, v82
  v_exp_f32 v83, v83
  v_mfma_f32_32x32x16_bf16 v[112:127], v[48:51], v[96:99], v[112:127]
  v_exp_f32 v84, v84
  v_exp_f32 v85, v85
  v_exp_f32 v86, v86
  v_exp_f32 v87, v87
  v_cvt_pk_bf16_f32 v104, v80, v81
  v_cvt_pk_bf16_f32 v105, v82, v83
  v_mfma_f32_32x32x16_bf16 v[64:79], v[36:39], v[16:19], v[64:79]
  v_exp_f32 v88, v88
  v_exp_f32 v89, v89
  v_exp_f32 v90, v90
  v_exp_f32 v91, v91
  v_cvt_pk_bf16_f32 v106, v84, v85
  v_cvt_pk_bf16_f32 v107, v86, v87
  v_mfma_f32_32x32x16_bf16 v[112:127], v[52:55], v[100:103], v[112:127]
  v_exp_f32 v92, v92
  v_exp_f32 v93, v93
  v_exp_f32 v94, v94
  v_exp_f32 v95, v95
  v_cvt_pk_bf16_f32 v108, v88, v89
  v_cvt_pk_bf16_f32 v109, v90, v91
  v_cvt_pk_bf16_f32 v110, v92, v93
  v_cvt_pk_bf16_f32 v111, v94, v95
  v_mfma_f32_32x32x8_bf16 v[80:95], v[42:43], v[30:31], v[160:175]
  ds_read_b128 v[56:59], v4 offset:10752
  ds_read_b128 v[60:63], v4 offset:11776
  ds_read_b128 v[32:35], v4 offset:12800
  ds_read_b128 v[44:47], v5 offset:12800
  v_exp_f32 v64, v64
  v_exp_f32 v65, v65
  v_exp_f32 v66, v66
  v_exp_f32 v67, v67
  v_mfma_f32_32x32x16_bf16 v[128:143], v[48:51], v[104:107], v[128:143]
  v_exp_f32 v68, v68
  v_exp_f32 v69, v69
  v_exp_f32 v70, v70
  v_exp_f32 v71, v71
  v_cvt_pk_bf16_f32 v96, v64, v65
  v_cvt_pk_bf16_f32 v97, v66, v67
  v_mfma_f32_32x32x16_bf16 v[80:95], v[36:39], v[20:23], v[80:95]
  v_exp_f32 v72, v72
  v_exp_f32 v73, v73
  v_exp_f32 v74, v74
  v_exp_f32 v75, v75
  v_cvt_pk_bf16_f32 v98, v68, v69
  v_cvt_pk_bf16_f32 v99, v70, v71
  v_mfma_f32_32x32x16_bf16 v[128:143], v[52:55], v[108:111], v[128:143]
  v_exp_f32 v76, v76
  v_exp_f32 v77, v77
  v_exp_f32 v78, v78
  v_exp_f32 v79, v79
  v_cvt_pk_bf16_f32 v100, v72, v73
  v_cvt_pk_bf16_f32 v101, v74, v75
  v_cvt_pk_bf16_f32 v102, v76, v77
  v_cvt_pk_bf16_f32 v103, v78, v79
  s_waitcnt lgkmcnt(0)
  v_mfma_f32_32x32x8_bf16 v[64:79], v[44:45], v[24:25], v[144:159]
  v_exp_f32 v80, v80
  v_exp_f32 v81, v81
  v_exp_f32 v82, v82
  v_exp_f32 v83, v83
  v_mfma_f32_32x32x16_bf16 v[112:127], v[56:59], v[96:99], v[112:127]
  v_exp_f32 v84, v84
  v_exp_f32 v85, v85
  v_exp_f32 v86, v86
  v_exp_f32 v87, v87
  v_cvt_pk_bf16_f32 v104, v80, v81
  v_cvt_pk_bf16_f32 v105, v82, v83
  v_mfma_f32_32x32x16_bf16 v[64:79], v[32:35], v[16:19], v[64:79]
  v_exp_f32 v88, v88
  v_exp_f32 v89, v89
  v_exp_f32 v90, v90
  v_exp_f32 v91, v91
  v_cvt_pk_bf16_f32 v106, v84, v85
  v_cvt_pk_bf16_f32 v107, v86, v87
  v_mfma_f32_32x32x16_bf16 v[112:127], v[60:63], v[100:103], v[112:127]
  v_exp_f32 v92, v92
  v_exp_f32 v93, v93
  v_exp_f32 v94, v94
  v_exp_f32 v95, v95
  v_cvt_pk_bf16_f32 v108, v88, v89
  v_cvt_pk_bf16_f32 v109, v90, v91
  v_cvt_pk_bf16_f32 v110, v92, v93
  v_cvt_pk_bf16_f32 v111, v94, v95
  v_mfma_f32_32x32x8_bf16 v[80:95], v[44:45], v[26:27], v[160:175]
  ds_read_b128 v[48:51], v4 offset:17408
  ds_read_b128 v[52:55], v4 offset:18432
  ds_read_b128 v[36:39], v4 offset:13824
  v_exp_f32 v64, v64
  v_exp_f32 v65, v65
  v_exp_f32 v66, v66
  v_exp_f32 v67, v67
  v_mfma_f32_32x32x16_bf16 v[128:143], v[56:59], v[104:107], v[128:143]
  v_exp_f32 v68, v68
  v_exp_f32 v69, v69
  v_exp_f32 v70, v70
  v_exp_f32 v71, v71
  v_cvt_pk_bf16_f32 v96, v64, v65
  v_cvt_pk_bf16_f32 v97, v66, v67
  v_mfma_f32_32x32x16_bf16 v[80:95], v[32:35], v[20:23], v[80:95]
  v_exp_f32 v72, v72
  v_exp_f32 v73, v73
  v_exp_f32 v74, v74
  v_exp_f32 v75, v75
  v_cvt_pk_bf16_f32 v98, v68, v69
  v_cvt_pk_bf16_f32 v99, v70, v71
  v_mfma_f32_32x32x16_bf16 v[128:143], v[60:63], v[108:111], v[128:143]
  v_exp_f32 v76, v76
  v_exp_f32 v77, v77
  v_exp_f32 v78, v78
  v_exp_f32 v79, v79
  v_cvt_pk_bf16_f32 v100, v72, v73
  v_cvt_pk_bf16_f32 v101, v74, v75
  v_cvt_pk_bf16_f32 v102, v76, v77
  v_cvt_pk_bf16_f32 v103, v78, v79
  s_waitcnt lgkmcnt(0)
  v_mfma_f32_32x32x8_bf16 v[64:79], v[44:45], v[28:29], v[144:159]
  v_exp_f32 v80, v80
  v_exp_f32 v81, v81
  v_exp_f32 v82, v82
  v_exp_f32 v83, v83
  v_mfma_f32_32x32x16_bf16 v[112:127], v[48:51], v[96:99], v[112:127]
  v_exp_f32 v84, v84
  v_exp_f32 v85, v85
  v_exp_f32 v86, v86
  v_exp_f32 v87, v87
  v_cvt_pk_bf16_f32 v104, v80, v81
  v_cvt_pk_bf16_f32 v105, v82, v83
  v_mfma_f32_32x32x16_bf16 v[64:79], v[36:39], v[16:19], v[64:79]
  v_exp_f32 v88, v88
  v_exp_f32 v89, v89
  v_exp_f32 v90, v90
  v_exp_f32 v91, v91
  v_cvt_pk_bf16_f32 v106, v84, v85
  v_cvt_pk_bf16_f32 v107, v86, v87
  v_mfma_f32_32x32x16_bf16 v[112:127], v[52:55], v[100:103], v[112:127]
  v_exp_f32 v92, v92
  v_exp_f32 v93, v93
  v_exp_f32 v94, v94
  v_exp_f32 v95, v95
  v_cvt_pk_bf16_f32 v108, v88, v89
  v_cvt_pk_bf16_f32 v109, v90, v91
  v_cvt_pk_bf16_f32 v110, v92, v93
  v_cvt_pk_bf16_f32 v111, v94, v95
  s_barrier
  v_mfma_f32_32x32x8_bf16 v[80:95], v[44:45], v[30:31], v[160:175]
  ds_read_b128 v[56:59], v4 offset:19456
  ds_read_b128 v[60:63], v4 offset:20480
  ds_read_b128 v[32:35], v4 offset:14848
  v_exp_f32 v64, v64
  v_exp_f32 v65, v65
  v_exp_f32 v66, v66
  v_exp_f32 v67, v67
  v_mfma_f32_32x32x16_bf16 v[128:143], v[48:51], v[104:107], v[128:143]
  v_exp_f32 v68, v68
  v_exp_f32 v69, v69
  v_exp_f32 v70, v70
  v_exp_f32 v71, v71
  v_cvt_pk_bf16_f32 v96, v64, v65
  v_cvt_pk_bf16_f32 v97, v66, v67
  v_mfma_f32_32x32x16_bf16 v[80:95], v[36:39], v[20:23], v[80:95]
  v_exp_f32 v72, v72
  v_exp_f32 v73, v73
  v_exp_f32 v74, v74
  v_exp_f32 v75, v75
  v_cvt_pk_bf16_f32 v98, v68, v69
  v_cvt_pk_bf16_f32 v99, v70, v71
  v_mfma_f32_32x32x16_bf16 v[128:143], v[52:55], v[108:111], v[128:143]
  v_exp_f32 v76, v76
  v_exp_f32 v77, v77
  v_exp_f32 v78, v78
  v_exp_f32 v79, v79
  v_cvt_pk_bf16_f32 v100, v72, v73
  v_cvt_pk_bf16_f32 v101, v74, v75
  v_cvt_pk_bf16_f32 v102, v76, v77
  v_cvt_pk_bf16_f32 v103, v78, v79
  s_waitcnt lgkmcnt(0)
  v_mfma_f32_32x32x8_bf16 v[64:79], v[46:47], v[24:25], v[144:159]
  v_exp_f32 v80, v80
  v_exp_f32 v81, v81
  v_exp_f32 v82, v82
  v_exp_f32 v83, v83
  v_mfma_f32_32x32x16_bf16 v[112:127], v[56:59], v[96:99], v[112:127]
  v_exp_f32 v84, v84
  v_exp_f32 v85, v85
  v_exp_f32 v86, v86
  v_exp_f32 v87, v87
  v_cvt_pk_bf16_f32 v104, v80, v81
  v_cvt_pk_bf16_f32 v105, v82, v83
  v_mfma_f32_32x32x16_bf16 v[64:79], v[32:35], v[16:19], v[64:79]
  v_exp_f32 v88, v88
  v_exp_f32 v89, v89
  v_exp_f32 v90, v90
  v_exp_f32 v91, v91
  v_cvt_pk_bf16_f32 v106, v84, v85
  v_cvt_pk_bf16_f32 v107, v86, v87
  v_mfma_f32_32x32x16_bf16 v[112:127], v[60:63], v[100:103], v[112:127]
  v_exp_f32 v92, v92
  v_exp_f32 v93, v93
  v_exp_f32 v94, v94
  v_exp_f32 v95, v95
  v_cvt_pk_bf16_f32 v108, v88, v89
  v_cvt_pk_bf16_f32 v109, v90, v91
  v_cvt_pk_bf16_f32 v110, v92, v93
  v_cvt_pk_bf16_f32 v111, v94, v95
  v_mfma_f32_32x32x8_bf16 v[80:95], v[46:47], v[26:27], v[160:175]
  ds_read_b128 v[48:51], v4 offset:21504
  ds_read_b128 v[52:55], v4 offset:22528
  ds_read_b128 v[36:39], v4 offset:15872
  v_exp_f32 v64, v64
  v_exp_f32 v65, v65
  v_exp_f32 v66, v66
  v_exp_f32 v67, v67
  v_mfma_f32_32x32x16_bf16 v[128:143], v[56:59], v[104:107], v[128:143]
  v_exp_f32 v68, v68
  v_exp_f32 v69, v69
  v_exp_f32 v70, v70
  v_exp_f32 v71, v71
  v_cvt_pk_bf16_f32 v96, v64, v65
  v_cvt_pk_bf16_f32 v97, v66, v67
  v_mfma_f32_32x32x16_bf16 v[80:95], v[32:35], v[20:23], v[80:95]
  v_exp_f32 v72, v72
  v_exp_f32 v73, v73
  v_exp_f32 v74, v74
  v_exp_f32 v75, v75
  v_cvt_pk_bf16_f32 v98, v68, v69
  v_cvt_pk_bf16_f32 v99, v70, v71
  v_mfma_f32_32x32x16_bf16 v[128:143], v[60:63], v[108:111], v[128:143]
  v_exp_f32 v76, v76
  v_exp_f32 v77, v77
  v_exp_f32 v78, v78
  v_exp_f32 v79, v79
  v_cvt_pk_bf16_f32 v100, v72, v73
  v_cvt_pk_bf16_f32 v101, v74, v75
  v_cvt_pk_bf16_f32 v102, v76, v77
  v_cvt_pk_bf16_f32 v103, v78, v79
  s_waitcnt lgkmcnt(0)
  v_mfma_f32_32x32x8_bf16 v[64:79], v[46:47], v[28:29], v[144:159]
  v_exp_f32 v80, v80
  v_exp_f32 v81, v81
  v_exp_f32 v82, v82
  v_exp_f32 v83, v83
  v_mfma_f32_32x32x16_bf16 v[112:127], v[48:51], v[96:99], v[112:127]
  v_exp_f32 v84, v84
  v_exp_f32 v85, v85
  v_exp_f32 v86, v86
  v_exp_f32 v87, v87
  v_cvt_pk_bf16_f32 v104, v80, v81
  v_cvt_pk_bf16_f32 v105, v82, v83
  v_mfma_f32_32x32x16_bf16 v[64:79], v[36:39], v[16:19], v[64:79]
  v_exp_f32 v88, v88
  v_exp_f32 v89, v89
  v_exp_f32 v90, v90
  v_exp_f32 v91, v91
  v_cvt_pk_bf16_f32 v106, v84, v85
  v_cvt_pk_bf16_f32 v107, v86, v87
  v_mfma_f32_32x32x16_bf16 v[112:127], v[52:55], v[100:103], v[112:127]
  v_exp_f32 v92, v92
  v_exp_f32 v93, v93
  v_exp_f32 v94, v94
  v_exp_f32 v95, v95
  v_cvt_pk_bf16_f32 v108, v88, v89
  v_cvt_pk_bf16_f32 v109, v90, v91
  v_cvt_pk_bf16_f32 v110, v92, v93
  v_cvt_pk_bf16_f32 v111, v94, v95
  v_mfma_f32_32x32x8_bf16 v[80:95], v[46:47], v[30:31], v[160:175]
  ds_read_b128 v[56:59], v4 offset:23552
  ds_read_b128 v[60:63], v4 offset:24576
  ds_read_b128 v[32:35], v4 offset:25600
  ds_read_b128 v[40:43], v5 offset:25600
  v_exp_f32 v64, v64
  v_exp_f32 v65, v65
  v_exp_f32 v66, v66
  v_exp_f32 v67, v67
  v_mfma_f32_32x32x16_bf16 v[128:143], v[48:51], v[104:107], v[128:143]
  v_exp_f32 v68, v68
  v_exp_f32 v69, v69
  v_exp_f32 v70, v70
  v_exp_f32 v71, v71
  v_cvt_pk_bf16_f32 v96, v64, v65
  v_cvt_pk_bf16_f32 v97, v66, v67
  v_mfma_f32_32x32x16_bf16 v[80:95], v[36:39], v[20:23], v[80:95]
  v_exp_f32 v72, v72
  v_exp_f32 v73, v73
  v_exp_f32 v74, v74
  v_exp_f32 v75, v75
  v_cvt_pk_bf16_f32 v98, v68, v69
  v_cvt_pk_bf16_f32 v99, v70, v71
  v_mfma_f32_32x32x16_bf16 v[128:143], v[52:55], v[108:111], v[128:143]
  v_exp_f32 v76, v76
  v_exp_f32 v77, v77
  v_exp_f32 v78, v78
  v_exp_f32 v79, v79
  v_cvt_pk_bf16_f32 v100, v72, v73
  v_cvt_pk_bf16_f32 v101, v74, v75
  v_cvt_pk_bf16_f32 v102, v76, v77
  v_cvt_pk_bf16_f32 v103, v78, v79
  s_waitcnt lgkmcnt(0)
  v_mfma_f32_32x32x8_bf16 v[64:79], v[40:41], v[24:25], v[144:159]
  v_exp_f32 v80, v80
  v_exp_f32 v81, v81
  v_exp_f32 v82, v82
  v_exp_f32 v83, v83
  v_mfma_f32_32x32x16_bf16 v[112:127], v[56:59], v[96:99], v[112:127]
  v_exp_f32 v84, v84
  v_exp_f32 v85, v85
  v_exp_f32 v86, v86
  v_exp_f32 v87, v87
  v_cvt_pk_bf16_f32 v104, v80, v81
  v_cvt_pk_bf16_f32 v105, v82, v83
  v_mfma_f32_32x32x16_bf16 v[64:79], v[32:35], v[16:19], v[64:79]
  v_exp_f32 v88, v88
  v_exp_f32 v89, v89
  v_exp_f32 v90, v90
  v_exp_f32 v91, v91
  v_cvt_pk_bf16_f32 v106, v84, v85
  v_cvt_pk_bf16_f32 v107, v86, v87
  v_mfma_f32_32x32x16_bf16 v[112:127], v[60:63], v[100:103], v[112:127]
  v_exp_f32 v92, v92
  v_exp_f32 v93, v93
  v_exp_f32 v94, v94
  v_exp_f32 v95, v95
  v_cvt_pk_bf16_f32 v108, v88, v89
  v_cvt_pk_bf16_f32 v109, v90, v91
  v_cvt_pk_bf16_f32 v110, v92, v93
  v_cvt_pk_bf16_f32 v111, v94, v95
  v_mfma_f32_32x32x8_bf16 v[80:95], v[40:41], v[26:27], v[160:175]
  ds_read_b128 v[48:51], v4 offset:30208
  ds_read_b128 v[52:55], v4 offset:31232
  ds_read_b128 v[36:39], v4 offset:26624
  v_exp_f32 v64, v64
  v_exp_f32 v65, v65
  v_exp_f32 v66, v66
  v_exp_f32 v67, v67
  v_mfma_f32_32x32x16_bf16 v[128:143], v[56:59], v[104:107], v[128:143]
  v_exp_f32 v68, v68
  v_exp_f32 v69, v69
  v_exp_f32 v70, v70
  v_exp_f32 v71, v71
  v_cvt_pk_bf16_f32 v96, v64, v65
  v_cvt_pk_bf16_f32 v97, v66, v67
  v_mfma_f32_32x32x16_bf16 v[80:95], v[32:35], v[20:23], v[80:95]
  v_exp_f32 v72, v72
  v_exp_f32 v73, v73
  v_exp_f32 v74, v74
  v_exp_f32 v75, v75
  v_cvt_pk_bf16_f32 v98, v68, v69
  v_cvt_pk_bf16_f32 v99, v70, v71
  v_mfma_f32_32x32x16_bf16 v[128:143], v[60:63], v[108:111], v[128:143]
  v_exp_f32 v76, v76
  v_exp_f32 v77, v77
  v_exp_f32 v78, v78
  v_exp_f32 v79, v79
  v_cvt_pk_bf16_f32 v100, v72, v73
  v_cvt_pk_bf16_f32 v101, v74, v75
  v_cvt_pk_bf16_f32 v102, v76, v77
  v_cvt_pk_bf16_f32 v103, v78, v79
  s_waitcnt lgkmcnt(0)
  v_mfma_f32_32x32x8_bf16 v[64:79], v[40:41], v[28:29], v[144:159]
  v_exp_f32 v80, v80
  v_exp_f32 v81, v81
  v_exp_f32 v82, v82
  v_exp_f32 v83, v83
  v_mfma_f32_32x32x16_bf16 v[112:127], v[48:51], v[96:99], v[112:127]
  v_exp_f32 v84, v84
  v_exp_f32 v85, v85
  v_exp_f32 v86, v86
  v_exp_f32 v87, v87
  v_cvt_pk_bf16_f32 v104, v80, v81
  v_cvt_pk_bf16_f32 v105, v82, v83
  v_mfma_f32_32x32x16_bf16 v[64:79], v[36:39], v[16:19], v[64:79]
  v_exp_f32 v88, v88
  v_exp_f32 v89, v89
  v_exp_f32 v90, v90
  v_exp_f32 v91, v91
  v_cvt_pk_bf16_f32 v106, v84, v85
  v_cvt_pk_bf16_f32 v107, v86, v87
  v_mfma_f32_32x32x16_bf16 v[112:127], v[52:55], v[100:103], v[112:127]
  v_exp_f32 v92, v92
  v_exp_f32 v93, v93
  v_exp_f32 v94, v94
  v_exp_f32 v95, v95
  v_cvt_pk_bf16_f32 v108, v88, v89
  v_cvt_pk_bf16_f32 v109, v90, v91
  v_cvt_pk_bf16_f32 v110, v92, v93
  v_cvt_pk_bf16_f32 v111, v94, v95
  s_barrier
  v_mfma_f32_32x32x8_bf16 v[80:95], v[40:41], v[30:31], v[160:175]
  ds_read_b128 v[56:59], v4 offset:32256
  ds_read_b128 v[60:63], v4 offset:33280
  ds_read_b128 v[32:35], v4 offset:27648
  v_exp_f32 v64, v64
  v_exp_f32 v65, v65
  v_exp_f32 v66, v66
  v_exp_f32 v67, v67
  v_mfma_f32_32x32x16_bf16 v[128:143], v[48:51], v[104:107], v[128:143]
  v_exp_f32 v68, v68
  v_exp_f32 v69, v69
  v_exp_f32 v70, v70
  v_exp_f32 v71, v71
  v_cvt_pk_bf16_f32 v96, v64, v65
  v_cvt_pk_bf16_f32 v97, v66, v67
  v_mfma_f32_32x32x16_bf16 v[80:95], v[36:39], v[20:23], v[80:95]
  v_exp_f32 v72, v72
  v_exp_f32 v73, v73
  v_exp_f32 v74, v74
  v_exp_f32 v75, v75
  v_cvt_pk_bf16_f32 v98, v68, v69
  v_cvt_pk_bf16_f32 v99, v70, v71
  v_mfma_f32_32x32x16_bf16 v[128:143], v[52:55], v[108:111], v[128:143]
  v_exp_f32 v76, v76
  v_exp_f32 v77, v77
  v_exp_f32 v78, v78
  v_exp_f32 v79, v79
  v_cvt_pk_bf16_f32 v100, v72, v73
  v_cvt_pk_bf16_f32 v101, v74, v75
  v_cvt_pk_bf16_f32 v102, v76, v77
  v_cvt_pk_bf16_f32 v103, v78, v79
  s_waitcnt lgkmcnt(0)
  v_mfma_f32_32x32x8_bf16 v[64:79], v[42:43], v[24:25], v[144:159]
  v_exp_f32 v80, v80
  v_exp_f32 v81, v81
  v_exp_f32 v82, v82
  v_exp_f32 v83, v83
  v_mfma_f32_32x32x16_bf16 v[112:127], v[56:59], v[96:99], v[112:127]
  v_exp_f32 v84, v84
  v_exp_f32 v85, v85
  v_exp_f32 v86, v86
  v_exp_f32 v87, v87
  v_cvt_pk_bf16_f32 v104, v80, v81
  v_cvt_pk_bf16_f32 v105, v82, v83
  v_mfma_f32_32x32x16_bf16 v[64:79], v[32:35], v[16:19], v[64:79]
  v_exp_f32 v88, v88
  v_exp_f32 v89, v89
  v_exp_f32 v90, v90
  v_exp_f32 v91, v91
  v_cvt_pk_bf16_f32 v106, v84, v85
  v_cvt_pk_bf16_f32 v107, v86, v87
  v_mfma_f32_32x32x16_bf16 v[112:127], v[60:63], v[100:103], v[112:127]
  v_exp_f32 v92, v92
  v_exp_f32 v93, v93
  v_exp_f32 v94, v94
  v_exp_f32 v95, v95
  v_cvt_pk_bf16_f32 v108, v88, v89
  v_cvt_pk_bf16_f32 v109, v90, v91
  v_cvt_pk_bf16_f32 v110, v92, v93
  v_cvt_pk_bf16_f32 v111, v94, v95
  v_mfma_f32_32x32x8_bf16 v[80:95], v[42:43], v[26:27], v[160:175]
  ds_read_b128 v[48:51], v4 offset:34304
  ds_read_b128 v[52:55], v4 offset:35328
  ds_read_b128 v[36:39], v4 offset:28672
  v_exp_f32 v64, v64
  v_exp_f32 v65, v65
  v_exp_f32 v66, v66
  v_exp_f32 v67, v67
  v_mfma_f32_32x32x16_bf16 v[128:143], v[56:59], v[104:107], v[128:143]
  v_exp_f32 v68, v68
  v_exp_f32 v69, v69
  v_exp_f32 v70, v70
  v_exp_f32 v71, v71
  v_cvt_pk_bf16_f32 v96, v64, v65
  v_cvt_pk_bf16_f32 v97, v66, v67
  v_mfma_f32_32x32x16_bf16 v[80:95], v[32:35], v[20:23], v[80:95]
  v_exp_f32 v72, v72
  v_exp_f32 v73, v73
  v_exp_f32 v74, v74
  v_exp_f32 v75, v75
  v_cvt_pk_bf16_f32 v98, v68, v69
  v_cvt_pk_bf16_f32 v99, v70, v71
  v_mfma_f32_32x32x16_bf16 v[128:143], v[60:63], v[108:111], v[128:143]
  v_exp_f32 v76, v76
  v_exp_f32 v77, v77
  v_exp_f32 v78, v78
  v_exp_f32 v79, v79
  v_cvt_pk_bf16_f32 v100, v72, v73
  v_cvt_pk_bf16_f32 v101, v74, v75
  v_cvt_pk_bf16_f32 v102, v76, v77
  v_cvt_pk_bf16_f32 v103, v78, v79
  s_waitcnt lgkmcnt(0)
  v_mfma_f32_32x32x8_bf16 v[64:79], v[42:43], v[28:29], v[144:159]
  v_exp_f32 v80, v80
  v_exp_f32 v81, v81
  v_exp_f32 v82, v82
  v_exp_f32 v83, v83
  v_mfma_f32_32x32x16_bf16 v[112:127], v[48:51], v[96:99], v[112:127]
  v_exp_f32 v84, v84
  v_exp_f32 v85, v85
  v_exp_f32 v86, v86
  v_exp_f32 v87, v87
  v_cvt_pk_bf16_f32 v104, v80, v81
  v_cvt_pk_bf16_f32 v105, v82, v83
  v_mfma_f32_32x32x16_bf16 v[64:79], v[36:39], v[16:19], v[64:79]
  v_exp_f32 v88, v88
  v_exp_f32 v89, v89
  v_exp_f32 v90, v90
  v_exp_f32 v91, v91
  v_cvt_pk_bf16_f32 v106, v84, v85
  v_cvt_pk_bf16_f32 v107, v86, v87
  v_mfma_f32_32x32x16_bf16 v[112:127], v[52:55], v[100:103], v[112:127]
  v_exp_f32 v92, v92
  v_exp_f32 v93, v93
  v_exp_f32 v94, v94
  v_exp_f32 v95, v95
  v_cvt_pk_bf16_f32 v108, v88, v89
  v_cvt_pk_bf16_f32 v109, v90, v91
  v_cvt_pk_bf16_f32 v110, v92, v93
  v_cvt_pk_bf16_f32 v111, v94, v95
  v_mfma_f32_32x32x8_bf16 v[80:95], v[42:43], v[30:31], v[160:175]
  ds_read_b128 v[56:59], v4 offset:36352
  ds_read_b128 v[60:63], v4 offset:37376
  ds_read_b128 v[32:35], v4 offset:38400
  ds_read_b128 v[44:47], v5 offset:38400
  v_exp_f32 v64, v64
  v_exp_f32 v65, v65
  v_exp_f32 v66, v66
  v_exp_f32 v67, v67
  v_mfma_f32_32x32x16_bf16 v[128:143], v[48:51], v[104:107], v[128:143]
  v_exp_f32 v68, v68
  v_exp_f32 v69, v69
  v_exp_f32 v70, v70
  v_exp_f32 v71, v71
  v_cvt_pk_bf16_f32 v96, v64, v65
  v_cvt_pk_bf16_f32 v97, v66, v67
  v_mfma_f32_32x32x16_bf16 v[80:95], v[36:39], v[20:23], v[80:95]
  v_exp_f32 v72, v72
  v_exp_f32 v73, v73
  v_exp_f32 v74, v74
  v_exp_f32 v75, v75
  v_cvt_pk_bf16_f32 v98, v68, v69
  v_cvt_pk_bf16_f32 v99, v70, v71
  v_mfma_f32_32x32x16_bf16 v[128:143], v[52:55], v[108:111], v[128:143]
  v_exp_f32 v76, v76
  v_exp_f32 v77, v77
  v_exp_f32 v78, v78
  v_exp_f32 v79, v79
  v_cvt_pk_bf16_f32 v100, v72, v73
  v_cvt_pk_bf16_f32 v101, v74, v75
  v_cvt_pk_bf16_f32 v102, v76, v77
  v_cvt_pk_bf16_f32 v103, v78, v79
  s_waitcnt lgkmcnt(0)
  v_mfma_f32_32x32x8_bf16 v[64:79], v[44:45], v[24:25], v[144:159]
  v_exp_f32 v80, v80
  v_exp_f32 v81, v81
  v_exp_f32 v82, v82
  v_exp_f32 v83, v83
  v_mfma_f32_32x32x16_bf16 v[112:127], v[56:59], v[96:99], v[112:127]
  v_exp_f32 v84, v84
  v_exp_f32 v85, v85
  v_exp_f32 v86, v86
  v_exp_f32 v87, v87
  v_cvt_pk_bf16_f32 v104, v80, v81
  v_cvt_pk_bf16_f32 v105, v82, v83
  v_mfma_f32_32x32x16_bf16 v[64:79], v[32:35], v[16:19], v[64:79]
  v_exp_f32 v88, v88
  v_exp_f32 v89, v89
  v_exp_f32 v90, v90
  v_exp_f32 v91, v91
  v_cvt_pk_bf16_f32 v106, v84, v85
  v_cvt_pk_bf16_f32 v107, v86, v87
  v_mfma_f32_32x32x16_bf16 v[112:127], v[60:63], v[100:103], v[112:127]
  v_exp_f32 v92, v92
  v_exp_f32 v93, v93
  v_exp_f32 v94, v94
  v_exp_f32 v95, v95
  v_cvt_pk_bf16_f32 v108, v88, v89
  v_cvt_pk_bf16_f32 v109, v90, v91
  v_cvt_pk_bf16_f32 v110, v92, v93
  v_cvt_pk_bf16_f32 v111, v94, v95
  v_mfma_f32_32x32x8_bf16 v[80:95], v[44:45], v[26:27], v[160:175]
  ds_read_b128 v[48:51], v4 offset:43008
  ds_read_b128 v[52:55], v4 offset:44032
  ds_read_b128 v[36:39], v4 offset:39424
  v_exp_f32 v64, v64
  v_exp_f32 v65, v65
  v_exp_f32 v66, v66
  v_exp_f32 v67, v67
  v_mfma_f32_32x32x16_bf16 v[128:143], v[56:59], v[104:107], v[128:143]
  v_exp_f32 v68, v68
  v_exp_f32 v69, v69
  v_exp_f32 v70, v70
  v_exp_f32 v71, v71
  v_cvt_pk_bf16_f32 v96, v64, v65
  v_cvt_pk_bf16_f32 v97, v66, v67
  v_mfma_f32_32x32x16_bf16 v[80:95], v[32:35], v[20:23], v[80:95]
  v_exp_f32 v72, v72
  v_exp_f32 v73, v73
  v_exp_f32 v74, v74
  v_exp_f32 v75, v75
  v_cvt_pk_bf16_f32 v98, v68, v69
  v_cvt_pk_bf16_f32 v99, v70, v71
  v_mfma_f32_32x32x16_bf16 v[128:143], v[60:63], v[108:111], v[128:143]
  v_exp_f32 v76, v76
  v_exp_f32 v77, v77
  v_exp_f32 v78, v78
  v_exp_f32 v79, v79
  v_cvt_pk_bf16_f32 v100, v72, v73
  v_cvt_pk_bf16_f32 v101, v74, v75
  v_cvt_pk_bf16_f32 v102, v76, v77
  v_cvt_pk_bf16_f32 v103, v78, v79
  s_waitcnt lgkmcnt(0)
  v_mfma_f32_32x32x8_bf16 v[64:79], v[44:45], v[28:29], v[144:159]
  v_exp_f32 v80, v80
  v_exp_f32 v81, v81
  v_exp_f32 v82, v82
  v_exp_f32 v83, v83
  v_mfma_f32_32x32x16_bf16 v[112:127], v[48:51], v[96:99], v[112:127]
  v_exp_f32 v84, v84
  v_exp_f32 v85, v85
  v_exp_f32 v86, v86
  v_exp_f32 v87, v87
  v_cvt_pk_bf16_f32 v104, v80, v81
  v_cvt_pk_bf16_f32 v105, v82, v83
  v_mfma_f32_32x32x16_bf16 v[64:79], v[36:39], v[16:19], v[64:79]
  v_exp_f32 v88, v88
  v_exp_f32 v89, v89
  v_exp_f32 v90, v90
  v_exp_f32 v91, v91
  v_cvt_pk_bf16_f32 v106, v84, v85
  v_cvt_pk_bf16_f32 v107, v86, v87
  v_mfma_f32_32x32x16_bf16 v[112:127], v[52:55], v[100:103], v[112:127]
  v_exp_f32 v92, v92
  v_exp_f32 v93, v93
  v_exp_f32 v94, v94
  v_exp_f32 v95, v95
  v_cvt_pk_bf16_f32 v108, v88, v89
  v_cvt_pk_bf16_f32 v109, v90, v91
  v_cvt_pk_bf16_f32 v110, v92, v93
  v_cvt_pk_bf16_f32 v111, v94, v95
  s_barrier
  v_mfma_f32_32x32x8_bf16 v[80:95], v[44:45], v[30:31], v[160:175]
  ds_read_b128 v[56:59], v4 offset:45056
  ds_read_b128 v[60:63], v4 offset:46080
  ds_read_b128 v[32:35], v4 offset:40448
  v_exp_f32 v64, v64
  v_exp_f32 v65, v65
  v_exp_f32 v66, v66
  v_exp_f32 v67, v67
  v_mfma_f32_32x32x16_bf16 v[128:143], v[48:51], v[104:107], v[128:143]
  v_exp_f32 v68, v68
  v_exp_f32 v69, v69
  v_exp_f32 v70, v70
  v_exp_f32 v71, v71
  v_cvt_pk_bf16_f32 v96, v64, v65
  v_cvt_pk_bf16_f32 v97, v66, v67
  v_mfma_f32_32x32x16_bf16 v[80:95], v[36:39], v[20:23], v[80:95]
  v_exp_f32 v72, v72
  v_exp_f32 v73, v73
  v_exp_f32 v74, v74
  v_exp_f32 v75, v75
  v_cvt_pk_bf16_f32 v98, v68, v69
  v_cvt_pk_bf16_f32 v99, v70, v71
  v_mfma_f32_32x32x16_bf16 v[128:143], v[52:55], v[108:111], v[128:143]
  v_exp_f32 v76, v76
  v_exp_f32 v77, v77
  v_exp_f32 v78, v78
  v_exp_f32 v79, v79
  v_cvt_pk_bf16_f32 v100, v72, v73
  v_cvt_pk_bf16_f32 v101, v74, v75
  v_cvt_pk_bf16_f32 v102, v76, v77
  v_cvt_pk_bf16_f32 v103, v78, v79
  s_waitcnt lgkmcnt(0)
  v_mfma_f32_32x32x8_bf16 v[64:79], v[46:47], v[24:25], v[144:159]
  v_exp_f32 v80, v80
  v_exp_f32 v81, v81
  v_exp_f32 v82, v82
  v_exp_f32 v83, v83
  v_mfma_f32_32x32x16_bf16 v[112:127], v[56:59], v[96:99], v[112:127]
  v_exp_f32 v84, v84
  v_exp_f32 v85, v85
  v_exp_f32 v86, v86
  v_exp_f32 v87, v87
  v_cvt_pk_bf16_f32 v104, v80, v81
  v_cvt_pk_bf16_f32 v105, v82, v83
  v_mfma_f32_32x32x16_bf16 v[64:79], v[32:35], v[16:19], v[64:79]
  v_exp_f32 v88, v88
  v_exp_f32 v89, v89
  v_exp_f32 v90, v90
  v_exp_f32 v91, v91
  v_cvt_pk_bf16_f32 v106, v84, v85
  v_cvt_pk_bf16_f32 v107, v86, v87
  v_mfma_f32_32x32x16_bf16 v[112:127], v[60:63], v[100:103], v[112:127]
  v_exp_f32 v92, v92
  v_exp_f32 v93, v93
  v_exp_f32 v94, v94
  v_exp_f32 v95, v95
  v_cvt_pk_bf16_f32 v108, v88, v89
  v_cvt_pk_bf16_f32 v109, v90, v91
  v_cvt_pk_bf16_f32 v110, v92, v93
  v_cvt_pk_bf16_f32 v111, v94, v95
  v_mfma_f32_32x32x8_bf16 v[80:95], v[46:47], v[26:27], v[160:175]
  ds_read_b128 v[48:51], v4 offset:47104
  ds_read_b128 v[52:55], v4 offset:48128
  ds_read_b128 v[36:39], v4 offset:41472
  v_exp_f32 v64, v64
  v_exp_f32 v65, v65
  v_exp_f32 v66, v66
  v_exp_f32 v67, v67
  v_mfma_f32_32x32x16_bf16 v[128:143], v[56:59], v[104:107], v[128:143]
  v_exp_f32 v68, v68
  v_exp_f32 v69, v69
  v_exp_f32 v70, v70
  v_exp_f32 v71, v71
  v_cvt_pk_bf16_f32 v96, v64, v65
  v_cvt_pk_bf16_f32 v97, v66, v67
  v_mfma_f32_32x32x16_bf16 v[80:95], v[32:35], v[20:23], v[80:95]
  v_exp_f32 v72, v72
  v_exp_f32 v73, v73
  v_exp_f32 v74, v74
  v_exp_f32 v75, v75
  v_cvt_pk_bf16_f32 v98, v68, v69
  v_cvt_pk_bf16_f32 v99, v70, v71
  v_mfma_f32_32x32x16_bf16 v[128:143], v[60:63], v[108:111], v[128:143]
  v_exp_f32 v76, v76
  v_exp_f32 v77, v77
  v_exp_f32 v78, v78
  v_exp_f32 v79, v79
  v_cvt_pk_bf16_f32 v100, v72, v73
  v_cvt_pk_bf16_f32 v101, v74, v75
  v_cvt_pk_bf16_f32 v102, v76, v77
  v_cvt_pk_bf16_f32 v103, v78, v79
  s_waitcnt lgkmcnt(0)
  v_mfma_f32_32x32x8_bf16 v[64:79], v[46:47], v[28:29], v[144:159]
  v_exp_f32 v80, v80
  v_exp_f32 v81, v81
  v_exp_f32 v82, v82
  v_exp_f32 v83, v83
  v_mfma_f32_32x32x16_bf16 v[112:127], v[48:51], v[96:99], v[112:127]
  v_exp_f32 v84, v84
  v_exp_f32 v85, v85
  v_exp_f32 v86, v86
  v_exp_f32 v87, v87
  v_cvt_pk_bf16_f32 v104, v80, v81
  v_cvt_pk_bf16_f32 v105, v82, v83
  v_mfma_f32_32x32x16_bf16 v[64:79], v[36:39], v[16:19], v[64:79]
  v_exp_f32 v88, v88
  v_exp_f32 v89, v89
  v_exp_f32 v90, v90
  v_exp_f32 v91, v91
  v_cvt_pk_bf16_f32 v106, v84, v85
  v_cvt_pk_bf16_f32 v107, v86, v87
  v_mfma_f32_32x32x16_bf16 v[112:127], v[52:55], v[100:103], v[112:127]
  v_exp_f32 v92, v92
  v_exp_f32 v93, v93
  v_exp_f32 v94, v94
  v_exp_f32 v95, v95
  v_cvt_pk_bf16_f32 v108, v88, v89
  v_cvt_pk_bf16_f32 v109, v90, v91
  v_cvt_pk_bf16_f32 v110, v92, v93
  v_cvt_pk_bf16_f32 v111, v94, v95
  v_mfma_f32_32x32x8_bf16 v[80:95], v[46:47], v[30:31], v[160:175]
  ds_read_b128 v[56:59], v4 offset:49152
  ds_read_b128 v[60:63], v4 offset:50176
  ds_read_b128 v[32:35], v4 offset:0
  ds_read_b128 v[40:43], v5 offset:0
  v_exp_f32 v64, v64
  v_exp_f32 v65, v65
  v_exp_f32 v66, v66
  v_exp_f32 v67, v67
  v_mfma_f32_32x32x16_bf16 v[128:143], v[48:51], v[104:107], v[128:143]
  v_exp_f32 v68, v68
  v_exp_f32 v69, v69
  v_exp_f32 v70, v70
  v_exp_f32 v71, v71
  v_cvt_pk_bf16_f32 v96, v64, v65
  v_cvt_pk_bf16_f32 v97, v66, v67
  v_mfma_f32_32x32x16_bf16 v[80:95], v[36:39], v[20:23], v[80:95]
  v_exp_f32 v72, v72
  v_exp_f32 v73, v73
  v_exp_f32 v74, v74
  v_exp_f32 v75, v75
  v_cvt_pk_bf16_f32 v98, v68, v69
  v_cvt_pk_bf16_f32 v99, v70, v71
  v_mfma_f32_32x32x16_bf16 v[128:143], v[52:55], v[108:111], v[128:143]
  v_exp_f32 v76, v76
  v_exp_f32 v77, v77
  v_exp_f32 v78, v78
  v_exp_f32 v79, v79
  v_cvt_pk_bf16_f32 v100, v72, v73
  v_cvt_pk_bf16_f32 v101, v74, v75
  v_cvt_pk_bf16_f32 v102, v76, v77
  v_cvt_pk_bf16_f32 v103, v78, v79
  s_waitcnt lgkmcnt(0)
  v_mfma_f32_32x32x8_bf16 v[64:79], v[40:41], v[24:25], v[144:159]
  v_exp_f32 v80, v80
  v_exp_f32 v81, v81
  v_exp_f32 v82, v82
  v_exp_f32 v83, v83
  v_mfma_f32_32x32x16_bf16 v[112:127], v[56:59], v[96:99], v[112:127]
  v_exp_f32 v84, v84
  v_exp_f32 v85, v85
  v_exp_f32 v86, v86
  v_exp_f32 v87, v87
  v_cvt_pk_bf16_f32 v104, v80, v81
  v_cvt_pk_bf16_f32 v105, v82, v83
  v_mfma_f32_32x32x16_bf16 v[64:79], v[32:35], v[16:19], v[64:79]
  v_exp_f32 v88, v88
  v_exp_f32 v89, v89
  v_exp_f32 v90, v90
  v_exp_f32 v91, v91
  v_cvt_pk_bf16_f32 v106, v84, v85
  v_cvt_pk_bf16_f32 v107, v86, v87
  v_mfma_f32_32x32x16_bf16 v[112:127], v[60:63], v[100:103], v[112:127]
  v_exp_f32 v92, v92
  v_exp_f32 v93, v93
  v_exp_f32 v94, v94
  v_exp_f32 v95, v95
  v_cvt_pk_bf16_f32 v108, v88, v89
  v_cvt_pk_bf16_f32 v109, v90, v91
  v_cvt_pk_bf16_f32 v110, v92, v93
  v_cvt_pk_bf16_f32 v111, v94, v95
  s_mov_b32 s27, 0
k2_aloop:
  v_mfma_f32_32x32x8_bf16 v[80:95], v[40:41], v[26:27], v[160:175]
  ds_read_b128 v[48:51], v4 offset:4608
  ds_read_b128 v[52:55], v4 offset:5632
  ds_read_b128 v[36:39], v4 offset:1024
  v_exp_f32 v64, v64
  v_exp_f32 v65, v65
  v_exp_f32 v66, v66
  v_exp_f32 v67, v67
  v_mfma_f32_32x32x16_bf16 v[128:143], v[56:59], v[104:107], v[128:143]
  v_exp_f32 v68, v68
  v_exp_f32 v69, v69
  v_exp_f32 v70, v70
  v_exp_f32 v71, v71
  v_cvt_pk_bf16_f32 v96, v64, v65
  v_cvt_pk_bf16_f32 v97, v66, v67
  v_mfma_f32_32x32x16_bf16 v[80:95], v[32:35], v[20:23], v[80:95]
  v_exp_f32 v72, v72
  v_exp_f32 v73, v73
  v_exp_f32 v74, v74
  v_exp_f32 v75, v75
  v_cvt_pk_bf16_f32 v98, v68, v69
  v_cvt_pk_bf16_f32 v99, v70, v71
  v_mfma_f32_32x32x16_bf16 v[128:143], v[60:63], v[108:111], v[128:143]
  v_exp_f32 v76, v76
  v_exp_f32 v77, v77
  v_exp_f32 v78, v78
  v_exp_f32 v79, v79
  v_cvt_pk_bf16_f32 v100, v72, v73
  v_cvt_pk_bf16_f32 v101, v74, v75
  v_cvt_pk_bf16_f32 v102, v76, v77
  v_cvt_pk_bf16_f32 v103, v78, v79
  s_waitcnt lgkmcnt(0)
  v_mfma_f32_32x32x8_bf16 v[64:79], v[40:41], v[28:29], v[144:159]
  v_exp_f32 v80, v80
  v_exp_f32 v81, v81
  v_exp_f32 v82, v82
  v_exp_f32 v83, v83
  v_mfma_f32_32x32x16_bf16 v[112:127], v[48:51], v[96:99], v[112:127]
  v_exp_f32 v84, v84
  v_exp_f32 v85, v85
  v_exp_f32 v86, v86
  v_exp_f32 v87, v87
  v_cvt_pk_bf16_f32 v104, v80, v81
  v_cvt_pk_bf16_f32 v105, v82, v83
  v_mfma_f32_32x32x16_bf16 v[64:79], v[36:39], v[16:19], v[64:79]
  v_exp_f32 v88, v88
  v_exp_f32 v89, v89
  v_exp_f32 v90, v90
  v_exp_f32 v91, v91
  v_cvt_pk_bf16_f32 v106, v84, v85
  v_cvt_pk_bf16_f32 v107, v86, v87
  v_mfma_f32_32x32x16_bf16 v[112:127], v[52:55], v[100:103], v[112:127]
  v_exp_f32 v92, v92
  v_exp_f32 v93, v93
  v_exp_f32 v94, v94
  v_exp_f32 v95, v95
  v_cvt_pk_bf16_f32 v108, v88, v89
  v_cvt_pk_bf16_f32 v109, v90, v91
  v_cvt_pk_bf16_f32 v110, v92, v93
  v_cvt_pk_bf16_f32 v111, v94, v95
  s_barrier
  v_mfma_f32_32x32x8_bf16 v[80:95], v[40:41], v[30:31], v[160:175]
  ds_read_b128 v[56:59], v4 offset:6656
  ds_read_b128 v[60:63], v4 offset:7680
  ds_read_b128 v[32:35], v4 offset:2048
  v_exp_f32 v64, v64
  v_exp_f32 v65, v65
  v_exp_f32 v66, v66
  v_exp_f32 v67, v67
  v_mfma_f32_32x32x16_bf16 v[128:143], v[48:51], v[104:107], v[128:143]
  v_exp_f32 v68, v68
  v_exp_f32 v69, v69
  v_exp_f32 v70, v70
  v_exp_f32 v71, v71
  v_cvt_pk_bf16_f32 v96, v64, v65
  v_cvt_pk_bf16_f32 v97, v66, v67
  v_mfma_f32_32x32x16_bf16 v[80:95], v[36:39], v[20:23], v[80:95]
  v_exp_f32 v72, v72
  v_exp_f32 v73, v73
  v_exp_f32 v74, v74
  v_exp_f32 v75, v75
  v_cvt_pk_bf16_f32 v98, v68, v69
  v_cvt_pk_bf16_f32 v99, v70, v71
  v_mfma_f32_32x32x16_bf16 v[128:143], v[52:55], v[108:111], v[128:143]
  v_exp_f32 v76, v76
  v_exp_f32 v77, v77
  v_exp_f32 v78, v78
  v_exp_f32 v79, v79
  v_cvt_pk_bf16_f32 v100, v72, v73
  v_cvt_pk_bf16_f32 v101, v74, v75
  v_cvt_pk_bf16_f32 v102, v76, v77
  v_cvt_pk_bf16_f32 v103, v78, v79
  s_waitcnt lgkmcnt(0)
  v_mfma_f32_32x32x8_bf16 v[64:79], v[42:43], v[24:25], v[144:159]
  v_exp_f32 v80, v80
  v_exp_f32 v81, v81
  v_exp_f32 v82, v82
  v_exp_f32 v83, v83
  v_mfma_f32_32x32x16_bf16 v[112:127], v[56:59], v[96:99], v[112:127]
  v_exp_f32 v84, v84
  v_exp_f32 v85, v85
  v_exp_f32 v86, v86
  v_exp_f32 v87, v87
  v_cvt_pk_bf16_f32 v104, v80, v81
  v_cvt_pk_bf16_f32 v105, v82, v83
  v_mfma_f32_32x32x16_bf16 v[64:79], v[32:35], v[16:19], v[64:79]
  v_exp_f32 v88, v88
  v_exp_f32 v89, v89
  v_exp_f32 v90, v90
  v_exp_f32 v91, v91
  v_cvt_pk_bf16_f32 v106, v84, v85
  v_cvt_pk_bf16_f32 v107, v86, v87
  v_mfma_f32_32x32x16_bf16 v[112:127], v[60:63], v[100:103], v[112:127]
  v_exp_f32 v92, v92
  v_exp_f32 v93, v93
  v_exp_f32 v94, v94
  v_exp_f32 v95, v95
  v_cvt_pk_bf16_f32 v108, v88, v89
  v_cvt_pk_bf16_f32 v109, v90, v91
  v_cvt_pk_bf16_f32 v110, v92, v93
  v_cvt_pk_bf16_f32 v111, v94, v95
  v_mfma_f32_32x32x8_bf16 v[80:95], v[42:43], v[26:27], v[160:175]
  ds_read_b128 v[48:51], v4 offset:8704
  ds_read_b128 v[52:55], v4 offset:9728
  ds_read_b128 v[36:39], v4 offset:3072
  v_exp_f32 v64, v64
  v_exp_f32 v65, v65
  v_exp_f32 v66, v66
  v_exp_f32 v67, v67
  v_mfma_f32_32x32x16_bf16 v[128:143], v[56:59], v[104:107], v[128:143]
  v_exp_f32 v68, v68
  v_exp_f32 v69, v69
  v_exp_f32 v70, v70
  v_exp_f32 v71, v71
  v_cvt_pk_bf16_f32 v96, v64, v65
  v_cvt_pk_bf16_f32 v97, v66, v67
  v_mfma_f32_32x32x16_bf16 v[80:95], v[32:35], v[20:23], v[80:95]
  v_exp_f32 v72, v72
  v_exp_f32 v73, v73
  v_exp_f32 v74, v74
  v_exp_f32 v75, v75
  v_cvt_pk_bf16_f32 v98, v68, v69
  v_cvt_pk_bf16_f32 v99, v70, v71
  v_mfma_f32_32x32x16_bf16 v[128:143], v[60:63], v[108:111], v[128:143]
  v_exp_f32 v76, v76
  v_exp_f32 v77, v77
  v_exp_f32 v78, v78
  v_exp_f32 v79, v79
  v_cvt_pk_bf16_f32 v100, v72, v73
  v_cvt_pk_bf16_f32 v101, v74, v75
  v_cvt_pk_bf16_f32 v102, v76, v77
  v_cvt_pk_bf16_f32 v103, v78, v79
  s_waitcnt lgkmcnt(0)
  v_mfma_f32_32x32x8_bf16 v[64:79], v[42:43], v[28:29], v[144:159]
  v_exp_f32 v80, v80
  v_exp_f32 v81, v81
  v_exp_f32 v82, v82
  v_exp_f32 v83, v83
  v_mfma_f32_32x32x16_bf16 v[112:127], v[48:51], v[96:99], v[112:127]
  v_exp_f32 v84, v84
  v_exp_f32 v85, v85
  v_exp_f32 v86, v86
  v_exp_f32 v87, v87
  v_cvt_pk_bf16_f32 v104, v80, v81
  v_cvt_pk_bf16_f32 v105, v82, v83
  v_mfma_f32_32x32x16_bf16 v[64:79], v[36:39], v[16:19], v[64:79]
  v_exp_f32 v88, v88
  v_exp_f32 v89, v89
  v_exp_f32 v90, v90
  v_exp_f32 v91, v91
  v_cvt_pk_bf16_f32 v106, v84, v85
  v_cvt_pk_bf16_f32 v107, v86, v87
  v_mfma_f32_32x32x16_bf16 v[112:127], v[52:55], v[100:103], v[112:127]
  v_exp_f32 v92, v92
  v_exp_f32 v93, v93
  v_exp_f32 v94, v94
  v_exp_f32 v95, v95
  v_cvt_pk_bf16_f32 v108, v88, v89
  v_cvt_pk_bf16_f32 v109, v90, v91
  v_cvt_pk_bf16_f32 v110, v92, v93
  v_cvt_pk_bf16_f32 v111, v94, v95
  v_mfma_f32_32x32x8_bf16 v[80:95], v[42:43], v[30:31], v[160:175]
  ds_read_b128 v[56:59], v4 offset:10752
  ds_read_b128 v[60:63], v4 offset:11776
  ds_read_b128 v[32:35], v4 offset:12800
  ds_read_b128 v[44:47], v5 offset:12800
  v_exp_f32 v64, v64
  v_exp_f32 v65, v65
  v_exp_f32 v66, v66
  v_exp_f32 v67, v67
  v_mfma_f32_32x32x16_bf16 v[128:143], v[48:51], v[104:107], v[128:143]
  v_exp_f32 v68, v68
  v_exp_f32 v69, v69
  v_exp_f32 v70, v70
  v_exp_f32 v71, v71
  v_cvt_pk_bf16_f32 v96, v64, v65
  v_cvt_pk_bf16_f32 v97, v66, v67
  v_mfma_f32_32x32x16_bf16 v[80:95], v[36:39], v[20:23], v[80:95]
  v_exp_f32 v72, v72
  v_exp_f32 v73, v73
  v_exp_f32 v74, v74
  v_exp_f32 v75, v75
  v_cvt_pk_bf16_f32 v98, v68, v69
  v_cvt_pk_bf16_f32 v99, v70, v71
  v_mfma_f32_32x32x16_bf16 v[128:143], v[52:55], v[108:111], v[128:143]
  v_exp_f32 v76, v76
  v_exp_f32 v77, v77
  v_exp_f32 v78, v78
  v_exp_f32 v79, v79
  v_cvt_pk_bf16_f32 v100, v72, v73
  v_cvt_pk_bf16_f32 v101, v74, v75
  v_cvt_pk_bf16_f32 v102, v76, v77
  v_cvt_pk_bf16_f32 v103, v78, v79
  s_waitcnt lgkmcnt(0)
  v_mfma_f32_32x32x8_bf16 v[64:79], v[44:45], v[24:25], v[144:159]
  v_exp_f32 v80, v80
  v_exp_f32 v81, v81
  v_exp_f32 v82, v82
  v_exp_f32 v83, v83
  v_mfma_f32_32x32x16_bf16 v[112:127], v[56:59], v[96:99], v[112:127]
  v_exp_f32 v84, v84
  v_exp_f32 v85, v85
  v_exp_f32 v86, v86
  v_exp_f32 v87, v87
  v_cvt_pk_bf16_f32 v104, v80, v81
  v_cvt_pk_bf16_f32 v105, v82, v83
  v_mfma_f32_32x32x16_bf16 v[64:79], v[32:35], v[16:19], v[64:79]
  v_exp_f32 v88, v88
  v_exp_f32 v89, v89
  v_exp_f32 v90, v90
  v_exp_f32 v91, v91
  v_cvt_pk_bf16_f32 v106, v84, v85
  v_cvt_pk_bf16_f32 v107, v86, v87
  v_mfma_f32_32x32x16_bf16 v[112:127], v[60:63], v[100:103], v[112:127]
  v_exp_f32 v92, v92
  v_exp_f32 v93, v93
  v_exp_f32 v94, v94
  v_exp_f32 v95, v95
  v_cvt_pk_bf16_f32 v108, v88, v89
  v_cvt_pk_bf16_f32 v109, v90, v91
  v_cvt_pk_bf16_f32 v110, v92, v93
  v_cvt_pk_bf16_f32 v111, v94, v95
  v_mfma_f32_32x32x8_bf16 v[80:95], v[44:45], v[26:27], v[160:175]
  ds_read_b128 v[48:51], v4 offset:17408
  ds_read_b128 v[52:55], v4 offset:18432
  ds_read_b128 v[36:39], v4 offset:13824
  v_exp_f32 v64, v64
  v_exp_f32 v65, v65
  v_exp_f32 v66, v66
  v_exp_f32 v67, v67
  v_mfma_f32_32x32x16_bf16 v[128:143], v[56:59], v[104:107], v[128:143]
  v_exp_f32 v68, v68
  v_exp_f32 v69, v69
  v_exp_f32 v70, v70
  v_exp_f32 v71, v71
  v_cvt_pk_bf16_f32 v96, v64, v65
  v_cvt_pk_bf16_f32 v97, v66, v67
  v_mfma_f32_32x32x16_bf16 v[80:95], v[32:35], v[20:23], v[80:95]
  v_exp_f32 v72, v72
  v_exp_f32 v73, v73
  v_exp_f32 v74, v74
  v_exp_f32 v75, v75
  v_cvt_pk_bf16_f32 v98, v68, v69
  v_cvt_pk_bf16_f32 v99, v70, v71
  v_mfma_f32_32x32x16_bf16 v[128:143], v[60:63], v[108:111], v[128:143]
  v_exp_f32 v76, v76
  v_exp_f32 v77, v77
  v_exp_f32 v78, v78
  v_exp_f32 v79, v79
  v_cvt_pk_bf16_f32 v100, v72, v73
  v_cvt_pk_bf16_f32 v101, v74, v75
  v_cvt_pk_bf16_f32 v102, v76, v77
  v_cvt_pk_bf16_f32 v103, v78, v79
  s_waitcnt lgkmcnt(0)
  v_mfma_f32_32x32x8_bf16 v[64:79], v[44:45], v[28:29], v[144:159]
  v_exp_f32 v80, v80
  v_exp_f32 v81, v81
  v_exp_f32 v82, v82
  v_exp_f32 v83, v83
  v_mfma_f32_32x32x16_bf16 v[112:127], v[48:51], v[96:99], v[112:127]
  v_exp_f32 v84, v84
  v_exp_f32 v85, v85
  v_exp_f32 v86, v86
  v_exp_f32 v87, v87
  v_cvt_pk_bf16_f32 v104, v80, v81
  v_cvt_pk_bf16_f32 v105, v82, v83
  v_mfma_f32_32x32x16_bf16 v[64:79], v[36:39], v[16:19], v[64:79]
  v_exp_f32 v88, v88
  v_exp_f32 v89, v89
  v_exp_f32 v90, v90
  v_exp_f32 v91, v91
  v_cvt_pk_bf16_f32 v106, v84, v85
  v_cvt_pk_bf16_f32 v107, v86, v87
  v_mfma_f32_32x32x16_bf16 v[112:127], v[52:55], v[100:103], v[112:127]
  v_exp_f32 v92, v92
  v_exp_f32 v93, v93
  v_exp_f32 v94, v94
  v_exp_f32 v95, v95
  v_cvt_pk_bf16_f32 v108, v88, v89
  v_cvt_pk_bf16_f32 v109, v90, v91
  v_cvt_pk_bf16_f32 v110, v92, v93
  v_cvt_pk_bf16_f32 v111, v94, v95
  s_barrier
  v_mfma_f32_32x32x8_bf16 v[80:95], v[44:45], v[30:31], v[160:175]
  ds_read_b128 v[56:59], v4 offset:19456
  ds_read_b128 v[60:63], v4 offset:20480
  ds_read_b128 v[32:35], v4 offset:14848
  v_exp_f32 v64, v64
  v_exp_f32 v65, v65
  v_exp_f32 v66, v66
  v_exp_f32 v67, v67
  v_mfma_f32_32x32x16_bf16 v[128:143], v[48:51], v[104:107], v[128:143]
  v_exp_f32 v68, v68
  v_exp_f32 v69, v69
  v_exp_f32 v70, v70
  v_exp_f32 v71, v71
  v_cvt_pk_bf16_f32 v96, v64, v65
  v_cvt_pk_bf16_f32 v97, v66, v67
  v_mfma_f32_32x32x16_bf16 v[80:95], v[36:39], v[20:23], v[80:95]
  v_exp_f32 v72, v72
  v_exp_f32 v73, v73
  v_exp_f32 v74, v74
  v_exp_f32 v75, v75
  v_cvt_pk_bf16_f32 v98, v68, v69
  v_cvt_pk_bf16_f32 v99, v70, v71
  v_mfma_f32_32x32x16_bf16 v[128:143], v[52:55], v[108:111], v[128:143]
  v_exp_f32 v76, v76
  v_exp_f32 v77, v77
  v_exp_f32 v78, v78
  v_exp_f32 v79, v79
  v_cvt_pk_bf16_f32 v100, v72, v73
  v_cvt_pk_bf16_f32 v101, v74, v75
  v_cvt_pk_bf16_f32 v102, v76, v77
  v_cvt_pk_bf16_f32 v103, v78, v79
  s_waitcnt lgkmcnt(0)
  v_mfma_f32_32x32x8_bf16 v[64:79], v[46:47], v[24:25], v[144:159]
  v_exp_f32 v80, v80
  v_exp_f32 v81, v81
  v_exp_f32 v82, v82
  v_exp_f32 v83, v83
  v_mfma_f32_32x32x16_bf16 v[112:127], v[56:59], v[96:99], v[112:127]
  v_exp_f32 v84, v84
  v_exp_f32 v85, v85
  v_exp_f32 v86, v86
  v_exp_f32 v87, v87
  v_cvt_pk_bf16_f32 v104, v80, v81
  v_cvt_pk_bf16_f32 v105, v82, v83
  v_mfma_f32_32x32x16_bf16 v[64:79], v[32:35], v[16:19], v[64:79]
  v_exp_f32 v88, v88
  v_exp_f32 v89, v89
  v_exp_f32 v90, v90
  v_exp_f32 v91, v91
  v_cvt_pk_bf16_f32 v106, v84, v85
  v_cvt_pk_bf16_f32 v107, v86, v87
  v_mfma_f32_32x32x16_bf16 v[112:127], v[60:63], v[100:103], v[112:127]
  v_exp_f32 v92, v92
  v_exp_f32 v93, v93
  v_exp_f32 v94, v94
  v_exp_f32 v95, v95
  v_cvt_pk_bf16_f32 v108, v88, v89
  v_cvt_pk_bf16_f32 v109, v90, v91
  v_cvt_pk_bf16_f32 v110, v92, v93
  v_cvt_pk_bf16_f32 v111, v94, v95
  v_mfma_f32_32x32x8_bf16 v[80:95], v[46:47], v[26:27], v[160:175]
  ds_read_b128 v[48:51], v4 offset:21504
  ds_read_b128 v[52:55], v4 offset:22528
  ds_read_b128 v[36:39], v4 offset:15872
  v_exp_f32 v64, v64
  v_exp_f32 v65, v65
  v_exp_f32 v66, v66
  v_exp_f32 v67, v67
  v_mfma_f32_32x32x16_bf16 v[128:143], v[56:59], v[104:107], v[128:143]
  v_exp_f32 v68, v68
  v_exp_f32 v69, v69
  v_exp_f32 v70, v70
  v_exp_f32 v71, v71
  v_cvt_pk_bf16_f32 v96, v64, v65
  v_cvt_pk_bf16_f32 v97, v66, v67
  v_mfma_f32_32x32x16_bf16 v[80:95], v[32:35], v[20:23], v[80:95]
  v_exp_f32 v72, v72
  v_exp_f32 v73, v73
  v_exp_f32 v74, v74
  v_exp_f32 v75, v75
  v_cvt_pk_bf16_f32 v98, v68, v69
  v_cvt_pk_bf16_f32 v99, v70, v71
  v_mfma_f32_32x32x16_bf16 v[128:143], v[60:63], v[108:111], v[128:143]
  v_exp_f32 v76, v76
  v_exp_f32 v77, v77
  v_exp_f32 v78, v78
  v_exp_f32 v79, v79
  v_cvt_pk_bf16_f32 v100, v72, v73
  v_cvt_pk_bf16_f32 v101, v74, v75
  v_cvt_pk_bf16_f32 v102, v76, v77
  v_cvt_pk_bf16_f32 v103, v78, v79
  s_waitcnt lgkmcnt(0)
  v_mfma_f32_32x32x8_bf16 v[64:79], v[46:47], v[28:29], v[144:159]
  v_exp_f32 v80, v80
  v_exp_f32 v81, v81
  v_exp_f32 v82, v82
  v_exp_f32 v83, v83
  v_mfma_f32_32x32x16_bf16 v[112:127], v[48:51], v[96:99], v[112:127]
  v_exp_f32 v84, v84
  v_exp_f32 v85, v85
  v_exp_f32 v86, v86
  v_exp_f32 v87, v87
  v_cvt_pk_bf16_f32 v104, v80, v81
  v_cvt_pk_bf16_f32 v105, v82, v83
  v_mfma_f32_32x32x16_bf16 v[64:79], v[36:39], v[16:19], v[64:79]
  v_exp_f32 v88, v88
  v_exp_f32 v89, v89
  v_exp_f32 v90, v90
  v_exp_f32 v91, v91
  v_cvt_pk_bf16_f32 v106, v84, v85
  v_cvt_pk_bf16_f32 v107, v86, v87
  v_mfma_f32_32x32x16_bf16 v[112:127], v[52:55], v[100:103], v[112:127]
  v_exp_f32 v92, v92
  v_exp_f32 v93, v93
  v_exp_f32 v94, v94
  v_exp_f32 v95, v95
  v_cvt_pk_bf16_f32 v108, v88, v89
  v_cvt_pk_bf16_f32 v109, v90, v91
  v_cvt_pk_bf16_f32 v110, v92, v93
  v_cvt_pk_bf16_f32 v111, v94, v95
  v_mfma_f32_32x32x8_bf16 v[80:95], v[46:47], v[30:31], v[160:175]
  ds_read_b128 v[56:59], v4 offset:23552
  ds_read_b128 v[60:63], v4 offset:24576
  ds_read_b128 v[32:35], v4 offset:25600
  ds_read_b128 v[40:43], v5 offset:25600
  v_exp_f32 v64, v64
  v_exp_f32 v65, v65
  v_exp_f32 v66, v66
  v_exp_f32 v67, v67
  v_mfma_f32_32x32x16_bf16 v[128:143], v[48:51], v[104:107], v[128:143]
  v_exp_f32 v68, v68
  v_exp_f32 v69, v69
  v_exp_f32 v70, v70
  v_exp_f32 v71, v71
  v_cvt_pk_bf16_f32 v96, v64, v65
  v_cvt_pk_bf16_f32 v97, v66, v67
  v_mfma_f32_32x32x16_bf16 v[80:95], v[36:39], v[20:23], v[80:95]
  v_exp_f32 v72, v72
  v_exp_f32 v73, v73
  v_exp_f32 v74, v74
  v_exp_f32 v75, v75
  v_cvt_pk_bf16_f32 v98, v68, v69
  v_cvt_pk_bf16_f32 v99, v70, v71
  v_mfma_f32_32x32x16_bf16 v[128:143], v[52:55], v[108:111], v[128:143]
  v_exp_f32 v76, v76
  v_exp_f32 v77, v77
  v_exp_f32 v78, v78
  v_exp_f32 v79, v79
  v_cvt_pk_bf16_f32 v100, v72, v73
  v_cvt_pk_bf16_f32 v101, v74, v75
  v_cvt_pk_bf16_f32 v102, v76, v77
  v_cvt_pk_bf16_f32 v103, v78, v79
  s_waitcnt lgkmcnt(0)
  v_mfma_f32_32x32x8_bf16 v[64:79], v[40:41], v[24:25], v[144:159]
  v_exp_f32 v80, v80
  v_exp_f32 v81, v81
  v_exp_f32 v82, v82
  v_exp_f32 v83, v83
  v_mfma_f32_32x32x16_bf16 v[112:127], v[56:59], v[96:99], v[112:127]
  v_exp_f32 v84, v84
  v_exp_f32 v85, v85
  v_exp_f32 v86, v86
  v_exp_f32 v87, v87
  v_cvt_pk_bf16_f32 v104, v80, v81
  v_cvt_pk_bf16_f32 v105, v82, v83
  v_mfma_f32_32x32x16_bf16 v[64:79], v[32:35], v[16:19], v[64:79]
  v_exp_f32 v88, v88
  v_exp_f32 v89, v89
  v_exp_f32 v90, v90
  v_exp_f32 v91, v91
  v_cvt_pk_bf16_f32 v106, v84, v85
  v_cvt_pk_bf16_f32 v107, v86, v87
  v_mfma_f32_32x32x16_bf16 v[112:127], v[60:63], v[100:103], v[112:127]
  v_exp_f32 v92, v92
  v_exp_f32 v93, v93
  v_exp_f32 v94, v94
  v_exp_f32 v95, v95
  v_cvt_pk_bf16_f32 v108, v88, v89
  v_cvt_pk_bf16_f32 v109, v90, v91
  v_cvt_pk_bf16_f32 v110, v92, v93
  v_cvt_pk_bf16_f32 v111, v94, v95
  v_mfma_f32_32x32x8_bf16 v[80:95], v[40:41], v[26:27], v[160:175]
  ds_read_b128 v[48:51], v4 offset:30208
  ds_read_b128 v[52:55], v4 offset:31232
  ds_read_b128 v[36:39], v4 offset:26624
  v_exp_f32 v64, v64
  v_exp_f32 v65, v65
  v_exp_f32 v66, v66
  v_exp_f32 v67, v67
  v_mfma_f32_32x32x16_bf16 v[128:143], v[56:59], v[104:107], v[128:143]
  v_exp_f32 v68, v68
  v_exp_f32 v69, v69
  v_exp_f32 v70, v70
  v_exp_f32 v71, v71
  v_cvt_pk_bf16_f32 v96, v64, v65
  v_cvt_pk_bf16_f32 v97, v66, v67
  v_mfma_f32_32x32x16_bf16 v[80:95], v[32:35], v[20:23], v[80:95]
  v_exp_f32 v72, v72
  v_exp_f32 v73, v73
  v_exp_f32 v74, v74
  v_exp_f32 v75, v75
  v_cvt_pk_bf16_f32 v98, v68, v69
  v_cvt_pk_bf16_f32 v99, v70, v71
  v_mfma_f32_32x32x16_bf16 v[128:143], v[60:63], v[108:111], v[128:143]
  v_exp_f32 v76, v76
  v_exp_f32 v77, v77
  v_exp_f32 v78, v78
  v_exp_f32 v79, v79
  v_cvt_pk_bf16_f32 v100, v72, v73
  v_cvt_pk_bf16_f32 v101, v74, v75
  v_cvt_pk_bf16_f32 v102, v76, v77
  v_cvt_pk_bf16_f32 v103, v78, v79
  s_waitcnt lgkmcnt(0)
  v_mfma_f32_32x32x8_bf16 v[64:79], v[40:41], v[28:29], v[144:159]
  v_exp_f32 v80, v80
  v_exp_f32 v81, v81
  v_exp_f32 v82, v82
  v_exp_f32 v83, v83
  v_mfma_f32_32x32x16_bf16 v[112:127], v[48:51], v[96:99], v[112:127]
  v_exp_f32 v84, v84
  v_exp_f32 v85, v85
  v_exp_f32 v86, v86
  v_exp_f32 v87, v87
  v_cvt_pk_bf16_f32 v104, v80, v81
  v_cvt_pk_bf16_f32 v105, v82, v83
  v_mfma_f32_32x32x16_bf16 v[64:79], v[36:39], v[16:19], v[64:79]
  v_exp_f32 v88, v88
  v_exp_f32 v89, v89
  v_exp_f32 v90, v90
  v_exp_f32 v91, v91
  v_cvt_pk_bf16_f32 v106, v84, v85
  v_cvt_pk_bf16_f32 v107, v86, v87
  v_mfma_f32_32x32x16_bf16 v[112:127], v[52:55], v[100:103], v[112:127]
  v_exp_f32 v92, v92
  v_exp_f32 v93, v93
  v_exp_f32 v94, v94
  v_exp_f32 v95, v95
  v_cvt_pk_bf16_f32 v108, v88, v89
  v_cvt_pk_bf16_f32 v109, v90, v91
  v_cvt_pk_bf16_f32 v110, v92, v93
  v_cvt_pk_bf16_f32 v111, v94, v95
  s_barrier
  v_mfma_f32_32x32x8_bf16 v[80:95], v[40:41], v[30:31], v[160:175]
  ds_read_b128 v[56:59], v4 offset:32256
  ds_read_b128 v[60:63], v4 offset:33280
  ds_read_b128 v[32:35], v4 offset:27648
  v_exp_f32 v64, v64
  v_exp_f32 v65, v65
  v_exp_f32 v66, v66
  v_exp_f32 v67, v67
  v_mfma_f32_32x32x16_bf16 v[128:143], v[48:51], v[104:107], v[128:143]
  v_exp_f32 v68, v68
  v_exp_f32 v69, v69
  v_exp_f32 v70, v70
  v_exp_f32 v71, v71
  v_cvt_pk_bf16_f32 v96, v64, v65
  v_cvt_pk_bf16_f32 v97, v66, v67
  v_mfma_f32_32x32x16_bf16 v[80:95], v[36:39], v[20:23], v[80:95]
  v_exp_f32 v72, v72
  v_exp_f32 v73, v73
  v_exp_f32 v74, v74
  v_exp_f32 v75, v75
  v_cvt_pk_bf16_f32 v98, v68, v69
  v_cvt_pk_bf16_f32 v99, v70, v71
  v_mfma_f32_32x32x16_bf16 v[128:143], v[52:55], v[108:111], v[128:143]
  v_exp_f32 v76, v76
  v_exp_f32 v77, v77
  v_exp_f32 v78, v78
  v_exp_f32 v79, v79
  v_cvt_pk_bf16_f32 v100, v72, v73
  v_cvt_pk_bf16_f32 v101, v74, v75
  v_cvt_pk_bf16_f32 v102, v76, v77
  v_cvt_pk_bf16_f32 v103, v78, v79
  s_waitcnt lgkmcnt(0)
  v_mfma_f32_32x32x8_bf16 v[64:79], v[42:43], v[24:25], v[144:159]
  v_exp_f32 v80, v80
  v_exp_f32 v81, v81
  v_exp_f32 v82, v82
  v_exp_f32 v83, v83
  v_mfma_f32_32x32x16_bf16 v[112:127], v[56:59], v[96:99], v[112:127]
  v_exp_f32 v84, v84
  v_exp_f32 v85, v85
  v_exp_f32 v86, v86
  v_exp_f32 v87, v87
  v_cvt_pk_bf16_f32 v104, v80, v81
  v_cvt_pk_bf16_f32 v105, v82, v83
  v_mfma_f32_32x32x16_bf16 v[64:79], v[32:35], v[16:19], v[64:79]
  v_exp_f32 v88, v88
  v_exp_f32 v89, v89
  v_exp_f32 v90, v90
  v_exp_f32 v91, v91
  v_cvt_pk_bf16_f32 v106, v84, v85
  v_cvt_pk_bf16_f32 v107, v86, v87
  v_mfma_f32_32x32x16_bf16 v[112:127], v[60:63], v[100:103], v[112:127]
  v_exp_f32 v92, v92
  v_exp_f32 v93, v93
  v_exp_f32 v94, v94
  v_exp_f32 v95, v95
  v_cvt_pk_bf16_f32 v108, v88, v89
  v_cvt_pk_bf16_f32 v109, v90, v91
  v_cvt_pk_bf16_f32 v110, v92, v93
  v_cvt_pk_bf16_f32 v111, v94, v95
  v_mfma_f32_32x32x8_bf16 v[80:95], v[42:43], v[26:27], v[160:175]
  ds_read_b128 v[48:51], v4 offset:34304
  ds_read_b128 v[52:55], v4 offset:35328
  ds_read_b128 v[36:39], v4 offset:28672
  v_exp_f32 v64, v64
  v_exp_f32 v65, v65
  v_exp_f32 v66, v66
  v_exp_f32 v67, v67
  v_mfma_f32_32x32x16_bf16 v[128:143], v[56:59], v[104:107], v[128:143]
  v_exp_f32 v68, v68
  v_exp_f32 v69, v69
  v_exp_f32 v70, v70
  v_exp_f32 v71, v71
  v_cvt_pk_bf16_f32 v96, v64, v65
  v_cvt_pk_bf16_f32 v97, v66, v67
  v_mfma_f32_32x32x16_bf16 v[80:95], v[32:35], v[20:23], v[80:95]
  v_exp_f32 v72, v72
  v_exp_f32 v73, v73
  v_exp_f32 v74, v74
  v_exp_f32 v75, v75
  v_cvt_pk_bf16_f32 v98, v68, v69
  v_cvt_pk_bf16_f32 v99, v70, v71
  v_mfma_f32_32x32x16_bf16 v[128:143], v[60:63], v[108:111], v[128:143]
  v_exp_f32 v76, v76
  v_exp_f32 v77, v77
  v_exp_f32 v78, v78
  v_exp_f32 v79, v79
  v_cvt_pk_bf16_f32 v100, v72, v73
  v_cvt_pk_bf16_f32 v101, v74, v75
  v_cvt_pk_bf16_f32 v102, v76, v77
  v_cvt_pk_bf16_f32 v103, v78, v79
  s_waitcnt lgkmcnt(0)
  v_mfma_f32_32x32x8_bf16 v[64:79], v[42:43], v[28:29], v[144:159]
  v_exp_f32 v80, v80
  v_exp_f32 v81, v81
  v_exp_f32 v82, v82
  v_exp_f32 v83, v83
  v_mfma_f32_32x32x16_bf16 v[112:127], v[48:51], v[96:99], v[112:127]
  v_exp_f32 v84, v84
  v_exp_f32 v85, v85
  v_exp_f32 v86, v86
  v_exp_f32 v87, v87
  v_cvt_pk_bf16_f32 v104, v80, v81
  v_cvt_pk_bf16_f32 v105, v82, v83
  v_mfma_f32_32x32x16_bf16 v[64:79], v[36:39], v[16:19], v[64:79]
  v_exp_f32 v88, v88
  v_exp_f32 v89, v89
  v_exp_f32 v90, v90
  v_exp_f32 v91, v91
  v_cvt_pk_bf16_f32 v106, v84, v85
  v_cvt_pk_bf16_f32 v107, v86, v87
  v_mfma_f32_32x32x16_bf16 v[112:127], v[52:55], v[100:103], v[112:127]
  v_exp_f32 v92, v92
  v_exp_f32 v93, v93
  v_exp_f32 v94, v94
  v_exp_f32 v95, v95
  v_cvt_pk_bf16_f32 v108, v88, v89
  v_cvt_pk_bf16_f32 v109, v90, v91
  v_cvt_pk_bf16_f32 v110, v92, v93
  v_cvt_pk_bf16_f32 v111, v94, v95
  v_mfma_f32_32x32x8_bf16 v[80:95], v[42:43], v[30:31], v[160:175]
  ds_read_b128 v[56:59], v4 offset:36352
  ds_read_b128 v[60:63], v4 offset:37376
  ds_read_b128 v[32:35], v4 offset:38400
  ds_read_b128 v[44:47], v5 offset:38400
  v_exp_f32 v64, v64
  v_exp_f32 v65, v65
  v_exp_f32 v66, v66
  v_exp_f32 v67, v67
  v_mfma_f32_32x32x16_bf16 v[128:143], v[48:51], v[104:107], v[128:143]
  v_exp_f32 v68, v68
  v_exp_f32 v69, v69
  v_exp_f32 v70, v70
  v_exp_f32 v71, v71
  v_cvt_pk_bf16_f32 v96, v64, v65
  v_cvt_pk_bf16_f32 v97, v66, v67
  v_mfma_f32_32x32x16_bf16 v[80:95], v[36:39], v[20:23], v[80:95]
  v_exp_f32 v72, v72
  v_exp_f32 v73, v73
  v_exp_f32 v74, v74
  v_exp_f32 v75, v75
  v_cvt_pk_bf16_f32 v98, v68, v69
  v_cvt_pk_bf16_f32 v99, v70, v71
  v_mfma_f32_32x32x16_bf16 v[128:143], v[52:55], v[108:111], v[128:143]
  v_exp_f32 v76, v76
  v_exp_f32 v77, v77
  v_exp_f32 v78, v78
  v_exp_f32 v79, v79
  v_cvt_pk_bf16_f32 v100, v72, v73
  v_cvt_pk_bf16_f32 v101, v74, v75
  v_cvt_pk_bf16_f32 v102, v76, v77
  v_cvt_pk_bf16_f32 v103, v78, v79
  s_waitcnt lgkmcnt(0)
  v_mfma_f32_32x32x8_bf16 v[64:79], v[44:45], v[24:25], v[144:159]
  v_exp_f32 v80, v80
  v_exp_f32 v81, v81
  v_exp_f32 v82, v82
  v_exp_f32 v83, v83
  v_mfma_f32_32x32x16_bf16 v[112:127], v[56:59], v[96:99], v[112:127]
  v_exp_f32 v84, v84
  v_exp_f32 v85, v85
  v_exp_f32 v86, v86
  v_exp_f32 v87, v87
  v_cvt_pk_bf16_f32 v104, v80, v81
  v_cvt_pk_bf16_f32 v105, v82, v83
  v_mfma_f32_32x32x16_bf16 v[64:79], v[32:35], v[16:19], v[64:79]
  v_exp_f32 v88, v88
  v_exp_f32 v89, v89
  v_exp_f32 v90, v90
  v_exp_f32 v91, v91
  v_cvt_pk_bf16_f32 v106, v84, v85
  v_cvt_pk_bf16_f32 v107, v86, v87
  v_mfma_f32_32x32x16_bf16 v[112:127], v[60:63], v[100:103], v[112:127]
  v_exp_f32 v92, v92
  v_exp_f32 v93, v93
  v_exp_f32 v94, v94
  v_exp_f32 v95, v95
  v_cvt_pk_bf16_f32 v108, v88, v89
  v_cvt_pk_bf16_f32 v109, v90, v91
  v_cvt_pk_bf16_f32 v110, v92, v93
  v_cvt_pk_bf16_f32 v111, v94, v95
  v_mfma_f32_32x32x8_bf16 v[80:95], v[44:45], v[26:27], v[160:175]
  ds_read_b128 v[48:51], v4 offset:43008
  ds_read_b128 v[52:55], v4 offset:44032
  ds_read_b128 v[36:39], v4 offset:39424
  v_exp_f32 v64, v64
  v_exp_f32 v65, v65
  v_exp_f32 v66, v66
  v_exp_f32 v67, v67
  v_mfma_f32_32x32x16_bf16 v[128:143], v[56:59], v[104:107], v[128:143]
  v_exp_f32 v68, v68
  v_exp_f32 v69, v69
  v_exp_f32 v70, v70
  v_exp_f32 v71, v71
  v_cvt_pk_bf16_f32 v96, v64, v65
  v_cvt_pk_bf16_f32 v97, v66, v67
  v_mfma_f32_32x32x16_bf16 v[80:95], v[32:35], v[20:23], v[80:95]
  v_exp_f32 v72, v72
  v_exp_f32 v73, v73
  v_exp_f32 v74, v74
  v_exp_f32 v75, v75
  v_cvt_pk_bf16_f32 v98, v68, v69
  v_cvt_pk_bf16_f32 v99, v70, v71
  v_mfma_f32_32x32x16_bf16 v[128:143], v[60:63], v[108:111], v[128:143]
  v_exp_f32 v76, v76
  v_exp_f32 v77, v77
  v_exp_f32 v78, v78
  v_exp_f32 v79, v79
  v_cvt_pk_bf16_f32 v100, v72, v73
  v_cvt_pk_bf16_f32 v101, v74, v75
  v_cvt_pk_bf16_f32 v102, v76, v77
  v_cvt_pk_bf16_f32 v103, v78, v79
  s_waitcnt lgkmcnt(0)
  v_mfma_f32_32x32x8_bf16 v[64:79], v[44:45], v[28:29], v[144:159]
  v_exp_f32 v80, v80
  v_exp_f32 v81, v81
  v_exp_f32 v82, v82
  v_exp_f32 v83, v83
  v_mfma_f32_32x32x16_bf16 v[112:127], v[48:51], v[96:99], v[112:127]
  v_exp_f32 v84, v84
  v_exp_f32 v85, v85
  v_exp_f32 v86, v86
  v_exp_f32 v87, v87
  v_cvt_pk_bf16_f32 v104, v80, v81
  v_cvt_pk_bf16_f32 v105, v82, v83
  v_mfma_f32_32x32x16_bf16 v[64:79], v[36:39], v[16:19], v[64:79]
  v_exp_f32 v88, v88
  v_exp_f32 v89, v89
  v_exp_f32 v90, v90
  v_exp_f32 v91, v91
  v_cvt_pk_bf16_f32 v106, v84, v85
  v_cvt_pk_bf16_f32 v107, v86, v87
  v_mfma_f32_32x32x16_bf16 v[112:127], v[52:55], v[100:103], v[112:127]
  v_exp_f32 v92, v92
  v_exp_f32 v93, v93
  v_exp_f32 v94, v94
  v_exp_f32 v95, v95
  v_cvt_pk_bf16_f32 v108, v88, v89
  v_cvt_pk_bf16_f32 v109, v90, v91
  v_cvt_pk_bf16_f32 v110, v92, v93
  v_cvt_pk_bf16_f32 v111, v94, v95
  s_barrier
  v_mfma_f32_32x32x8_bf16 v[80:95], v[44:45], v[30:31], v[160:175]
  ds_read_b128 v[56:59], v4 offset:45056
  ds_read_b128 v[60:63], v4 offset:46080
  ds_read_b128 v[32:35], v4 offset:40448
  v_exp_f32 v64, v64
  v_exp_f32 v65, v65
  v_exp_f32 v66, v66
  v_exp_f32 v67, v67
  v_mfma_f32_32x32x16_bf16 v[128:143], v[48:51], v[104:107], v[128:143]
  v_exp_f32 v68, v68
  v_exp_f32 v69, v69
  v_exp_f32 v70, v70
  v_exp_f32 v71, v71
  v_cvt_pk_bf16_f32 v96, v64, v65
  v_cvt_pk_bf16_f32 v97, v66, v67
  v_mfma_f32_32x32x16_bf16 v[80:95], v[36:39], v[20:23], v[80:95]
  v_exp_f32 v72, v72
  v_exp_f32 v73, v73
  v_exp_f32 v74, v74
  v_exp_f32 v75, v75
  v_cvt_pk_bf16_f32 v98, v68, v69
  v_cvt_pk_bf16_f32 v99, v70, v71
  v_mfma_f32_32x32x16_bf16 v[128:143], v[52:55], v[108:111], v[128:143]
  v_exp_f32 v76, v76
  v_exp_f32 v77, v77
  v_exp_f32 v78, v78
  v_exp_f32 v79, v79
  v_cvt_pk_bf16_f32 v100, v72, v73
  v_cvt_pk_bf16_f32 v101, v74, v75
  v_cvt_pk_bf16_f32 v102, v76, v77
  v_cvt_pk_bf16_f32 v103, v78, v79
  s_waitcnt lgkmcnt(0)
  v_mfma_f32_32x32x8_bf16 v[64:79], v[46:47], v[24:25], v[144:159]
  v_exp_f32 v80, v80
  v_exp_f32 v81, v81
  v_exp_f32 v82, v82
  v_exp_f32 v83, v83
  v_mfma_f32_32x32x16_bf16 v[112:127], v[56:59], v[96:99], v[112:127]
  v_exp_f32 v84, v84
  v_exp_f32 v85, v85
  v_exp_f32 v86, v86
  v_exp_f32 v87, v87
  v_cvt_pk_bf16_f32 v104, v80, v81
  v_cvt_pk_bf16_f32 v105, v82, v83
  v_mfma_f32_32x32x16_bf16 v[64:79], v[32:35], v[16:19], v[64:79]
  v_exp_f32 v88, v88
  v_exp_f32 v89, v89
  v_exp_f32 v90, v90
  v_exp_f32 v91, v91
  v_cvt_pk_bf16_f32 v106, v84, v85
  v_cvt_pk_bf16_f32 v107, v86, v87
  v_mfma_f32_32x32x16_bf16 v[112:127], v[60:63], v[100:103], v[112:127]
  v_exp_f32 v92, v92
  v_exp_f32 v93, v93
  v_exp_f32 v94, v94
  v_exp_f32 v95, v95
  v_cvt_pk_bf16_f32 v108, v88, v89
  v_cvt_pk_bf16_f32 v109, v90, v91
  v_cvt_pk_bf16_f32 v110, v92, v93
  v_cvt_pk_bf16_f32 v111, v94, v95
  v_mfma_f32_32x32x8_bf16 v[80:95], v[46:47], v[26:27], v[160:175]
  ds_read_b128 v[48:51], v4 offset:47104
  ds_read_b128 v[52:55], v4 offset:48128
  ds_read_b128 v[36:39], v4 offset:41472
  v_exp_f32 v64, v64
  v_exp_f32 v65, v65
  v_exp_f32 v66, v66
  v_exp_f32 v67, v67
  v_mfma_f32_32x32x16_bf16 v[128:143], v[56:59], v[104:107], v[128:143]
  v_exp_f32 v68, v68
  v_exp_f32 v69, v69
  v_exp_f32 v70, v70
  v_exp_f32 v71, v71
  v_cvt_pk_bf16_f32 v96, v64, v65
  v_cvt_pk_bf16_f32 v97, v66, v67
  v_mfma_f32_32x32x16_bf16 v[80:95], v[32:35], v[20:23], v[80:95]
  v_exp_f32 v72, v72
  v_exp_f32 v73, v73
  v_exp_f32 v74, v74
  v_exp_f32 v75, v75
  v_cvt_pk_bf16_f32 v98, v68, v69
  v_cvt_pk_bf16_f32 v99, v70, v71
  v_mfma_f32_32x32x16_bf16 v[128:143], v[60:63], v[108:111], v[128:143]
  v_exp_f32 v76, v76
  v_exp_f32 v77, v77
  v_exp_f32 v78, v78
  v_exp_f32 v79, v79
  v_cvt_pk_bf16_f32 v100, v72, v73
  v_cvt_pk_bf16_f32 v101, v74, v75
  v_cvt_pk_bf16_f32 v102, v76, v77
  v_cvt_pk_bf16_f32 v103, v78, v79
  s_waitcnt lgkmcnt(0)
  v_mfma_f32_32x32x8_bf16 v[64:79], v[46:47], v[28:29], v[144:159]
  v_exp_f32 v80, v80
  v_exp_f32 v81, v81
  v_exp_f32 v82, v82
  v_exp_f32 v83, v83
  v_mfma_f32_32x32x16_bf16 v[112:127], v[48:51], v[96:99], v[112:127]
  v_exp_f32 v84, v84
  v_exp_f32 v85, v85
  v_exp_f32 v86, v86
  v_exp_f32 v87, v87
  v_cvt_pk_bf16_f32 v104, v80, v81
  v_cvt_pk_bf16_f32 v105, v82, v83
  v_mfma_f32_32x32x16_bf16 v[64:79], v[36:39], v[16:19], v[64:79]
  v_exp_f32 v88, v88
  v_exp_f32 v89, v89
  v_exp_f32 v90, v90
  v_exp_f32 v91, v91
  v_cvt_pk_bf16_f32 v106, v84, v85
  v_cvt_pk_bf16_f32 v107, v86, v87
  v_mfma_f32_32x32x16_bf16 v[112:127], v[52:55], v[100:103], v[112:127]
  v_exp_f32 v92, v92
  v_exp_f32 v93, v93
  v_exp_f32 v94, v94
  v_exp_f32 v95, v95
  v_cvt_pk_bf16_f32 v108, v88, v89
  v_cvt_pk_bf16_f32 v109, v90, v91
  v_cvt_pk_bf16_f32 v110, v92, v93
  v_cvt_pk_bf16_f32 v111, v94, v95
  v_mfma_f32_32x32x8_bf16 v[80:95], v[46:47], v[30:31], v[160:175]
  ds_read_b128 v[56:59], v4 offset:49152
  ds_read_b128 v[60:63], v4 offset:50176
  ds_read_b128 v[32:35], v4 offset:0
  ds_read_b128 v[40:43], v5 offset:0
  v_exp_f32 v64, v64
  v_exp_f32 v65, v65
  v_exp_f32 v66, v66
  v_exp_f32 v67, v67
  v_mfma_f32_32x32x16_bf16 v[128:143], v[48:51], v[104:107], v[128:143]
  v_exp_f32 v68, v68
  v_exp_f32 v69, v69
  v_exp_f32 v70, v70
  v_exp_f32 v71, v71
  v_cvt_pk_bf16_f32 v96, v64, v65
  v_cvt_pk_bf16_f32 v97, v66, v67
  v_mfma_f32_32x32x16_bf16 v[80:95], v[36:39], v[20:23], v[80:95]
  v_exp_f32 v72, v72
  v_exp_f32 v73, v73
  v_exp_f32 v74, v74
  v_exp_f32 v75, v75
  v_cvt_pk_bf16_f32 v98, v68, v69
  v_cvt_pk_bf16_f32 v99, v70, v71
  v_mfma_f32_32x32x16_bf16 v[128:143], v[52:55], v[108:111], v[128:143]
  v_exp_f32 v76, v76
  v_exp_f32 v77, v77
  v_exp_f32 v78, v78
  v_exp_f32 v79, v79
  v_cvt_pk_bf16_f32 v100, v72, v73
  v_cvt_pk_bf16_f32 v101, v74, v75
  v_cvt_pk_bf16_f32 v102, v76, v77
  v_cvt_pk_bf16_f32 v103, v78, v79
  s_waitcnt lgkmcnt(0)
  v_mfma_f32_32x32x8_bf16 v[64:79], v[40:41], v[24:25], v[144:159]
  v_exp_f32 v80, v80
  v_exp_f32 v81, v81
  v_exp_f32 v82, v82
  v_exp_f32 v83, v83
  v_mfma_f32_32x32x16_bf16 v[112:127], v[56:59], v[96:99], v[112:127]
  v_exp_f32 v84, v84
  v_exp_f32 v85, v85
  v_exp_f32 v86, v86
  v_exp_f32 v87, v87
  v_cvt_pk_bf16_f32 v104, v80, v81
  v_cvt_pk_bf16_f32 v105, v82, v83
  v_mfma_f32_32x32x16_bf16 v[64:79], v[32:35], v[16:19], v[64:79]
  v_exp_f32 v88, v88
  v_exp_f32 v89, v89
  v_exp_f32 v90, v90
  v_exp_f32 v91, v91
  v_cvt_pk_bf16_f32 v106, v84, v85
  v_cvt_pk_bf16_f32 v107, v86, v87
  v_mfma_f32_32x32x16_bf16 v[112:127], v[60:63], v[100:103], v[112:127]
  v_exp_f32 v92, v92
  v_exp_f32 v93, v93
  v_exp_f32 v94, v94
  v_exp_f32 v95, v95
  v_cvt_pk_bf16_f32 v108, v88, v89
  v_cvt_pk_bf16_f32 v109, v90, v91
  v_cvt_pk_bf16_f32 v110, v92, v93
  v_cvt_pk_bf16_f32 v111, v94, v95
  s_add_u32 s27, s27, 1
  s_cmp_lt_u32 s27, 2
  s_cbranch_scc1 k2_aloop
  s_load_dwordx2 s[30:31], s[0:1], 16
  s_mul_i32 s19, s16, 81
  s_mul_i32 s20, s18, 20736
  s_waitcnt lgkmcnt(0)
  s_mov_b32 s32, s30
  s_and_b32 s33, s31, 0xffff
  s_mov_b32 s34, 663552
  s_mov_b32 s35, 0x20000
  v_add_u32 v176, 0, v1
  v_add_u32 v176, s19, v176
  v_mul_u32_u24 v177, 3641, v176
  v_lshrrev_b32 v177, 16, v177
  v_mul_u32_u24 v178, 18, v177
  v_sub_u32 v176, v176, v178
  v_mul_u32_u24 v177, 1152, v177
  v_lshl_add_u32 v176, v176, 6, v177
  buffer_load_dword v179, v176, s[32:35], s20 offen
  v_add_u32 v176, 64, v1
  v_min_u32 v176, 80, v176
  v_add_u32 v176, s19, v176
  v_mul_u32_u24 v177, 3641, v176
  v_lshrrev_b32 v177, 16, v177
  v_mul_u32_u24 v178, 18, v177
  v_sub_u32 v176, v176, v178
  v_mul_u32_u24 v177, 1152, v177
  v_lshl_add_u32 v176, v176, 6, v177
  buffer_load_dword v179, v176, s[32:35], s20 offen
  s_getpc_b64 s[36:37]
cpf_k2:
  s_add_u32 s36, s36, k3_out_kernel-cpf_k2
  s_addc_u32 s37, s37, 0
  s_lshr_b32 s38, s2, 3
  s_lshl_b32 s38, s38, 12
  v_lshlrev_b32 v176, 6, v1
  v_add_u32 v176, s38, v176
  v_min_u32 v176, k3_code_end-k3_out_kernel-4, v176
  global_load_dword v179, v176, s[36:37]
  v_mfma_f32_32x32x8_bf16 v[80:95], v[40:41], v[26:27], v[160:175]
  ds_read_b128 v[48:51], v4 offset:4608
  ds_read_b128 v[52:55], v4 offset:5632
  ds_read_b128 v[36:39], v4 offset:1024
  v_exp_f32 v64, v64
  v_exp_f32 v65, v65
  v_exp_f32 v66, v66
  v_exp_f32 v67, v67
  v_mfma_f32_32x32x16_bf16 v[128:143], v[56:59], v[104:107], v[128:143]
  v_exp_f32 v68, v68
  v_exp_f32 v69, v69
  v_exp_f32 v70, v70
  v_exp_f32 v71, v71
  v_cvt_pk_bf16_f32 v96, v64, v65
  v_cvt_pk_bf16_f32 v97, v66, v67
  v_mfma_f32_32x32x16_bf16 v[80:95], v[32:35], v[20:23], v[80:95]
  v_exp_f32 v72, v72
  v_exp_f32 v73, v73
  v_exp_f32 v74, v74
  v_exp_f32 v75, v75
  v_cvt_pk_bf16_f32 v98, v68, v69
  v_cvt_pk_bf16_f32 v99, v70, v71
  v_mfma_f32_32x32x16_bf16 v[128:143], v[60:63], v[108:111], v[128:143]
  v_exp_f32 v76, v76
  v_exp_f32 v77, v77
  v_exp_f32 v78, v78
  v_exp_f32 v79, v79
  v_cvt_pk_bf16_f32 v100, v72, v73
  v_cvt_pk_bf16_f32 v101, v74, v75
  v_cvt_pk_bf16_f32 v102, v76, v77
  v_cvt_pk_bf16_f32 v103, v78, v79
  s_waitcnt lgkmcnt(0)
  v_mfma_f32_32x32x8_bf16 v[64:79], v[40:41], v[28:29], v[144:159]
  v_exp_f32 v80, v80
  v_exp_f32 v81, v81
  v_exp_f32 v82, v82
  v_exp_f32 v83, v83
  v_mfma_f32_32x32x16_bf16 v[112:127], v[48:51], v[96:99], v[112:127]
  v_exp_f32 v84, v84
  v_exp_f32 v85, v85
  v_exp_f32 v86, v86
  v_exp_f32 v87, v87
  v_cvt_pk_bf16_f32 v104, v80, v81
  v_cvt_pk_bf16_f32 v105, v82, v83
  v_mfma_f32_32x32x16_bf16 v[64:79], v[36:39], v[16:19], v[64:79]
  v_exp_f32 v88, v88
  v_exp_f32 v89, v89
  v_exp_f32 v90, v90
  v_exp_f32 v91, v91
  v_cvt_pk_bf16_f32 v106, v84, v85
  v_cvt_pk_bf16_f32 v107, v86, v87
  v_mfma_f32_32x32x16_bf16 v[112:127], v[52:55], v[100:103], v[112:127]
  v_exp_f32 v92, v92
  v_exp_f32 v93, v93
  v_exp_f32 v94, v94
  v_exp_f32 v95, v95
  v_cvt_pk_bf16_f32 v108, v88, v89
  v_cvt_pk_bf16_f32 v109, v90, v91
  v_cvt_pk_bf16_f32 v110, v92, v93
  v_cvt_pk_bf16_f32 v111, v94, v95
  s_barrier
  v_mfma_f32_32x32x8_bf16 v[80:95], v[40:41], v[30:31], v[160:175]
  ds_read_b128 v[56:59], v4 offset:6656
  ds_read_b128 v[60:63], v4 offset:7680
  ds_read_b128 v[32:35], v4 offset:2048
  v_exp_f32 v64, v64
  v_exp_f32 v65, v65
  v_exp_f32 v66, v66
  v_exp_f32 v67, v67
  v_mfma_f32_32x32x16_bf16 v[128:143], v[48:51], v[104:107], v[128:143]
  v_exp_f32 v68, v68
  v_exp_f32 v69, v69
  v_exp_f32 v70, v70
  v_exp_f32 v71, v71
  v_cvt_pk_bf16_f32 v96, v64, v65
  v_cvt_pk_bf16_f32 v97, v66, v67
  v_mfma_f32_32x32x16_bf16 v[80:95], v[36:39], v[20:23], v[80:95]
  v_exp_f32 v72, v72
  v_exp_f32 v73, v73
  v_exp_f32 v74, v74
  v_exp_f32 v75, v75
  v_cvt_pk_bf16_f32 v98, v68, v69
  v_cvt_pk_bf16_f32 v99, v70, v71
  v_mfma_f32_32x32x16_bf16 v[128:143], v[52:55], v[108:111], v[128:143]
  v_exp_f32 v76, v76
  v_exp_f32 v77, v77
  v_exp_f32 v78, v78
  v_exp_f32 v79, v79
  v_cvt_pk_bf16_f32 v100, v72, v73
  v_cvt_pk_bf16_f32 v101, v74, v75
  v_cvt_pk_bf16_f32 v102, v76, v77
  v_cvt_pk_bf16_f32 v103, v78, v79
  s_waitcnt lgkmcnt(0)
  v_mfma_f32_32x32x8_bf16 v[64:79], v[42:43], v[24:25], v[144:159]
  v_exp_f32 v80, v80
  v_exp_f32 v81, v81
  v_exp_f32 v82, v82
  v_exp_f32 v83, v83
  v_mfma_f32_32x32x16_bf16 v[112:127], v[56:59], v[96:99], v[112:127]
  v_exp_f32 v84, v84
  v_exp_f32 v85, v85
  v_exp_f32 v86, v86
  v_exp_f32 v87, v87
  v_cvt_pk_bf16_f32 v104, v80, v81
  v_cvt_pk_bf16_f32 v105, v82, v83
  v_mfma_f32_32x32x16_bf16 v[64:79], v[32:35], v[16:19], v[64:79]
  v_exp_f32 v88, v88
  v_exp_f32 v89, v89
  v_exp_f32 v90, v90
  v_exp_f32 v91, v91
  v_cvt_pk_bf16_f32 v106, v84, v85
  v_cvt_pk_bf16_f32 v107, v86, v87
  v_mfma_f32_32x32x16_bf16 v[112:127], v[60:63], v[100:103], v[112:127]
  v_exp_f32 v92, v92
  v_exp_f32 v93, v93
  v_exp_f32 v94, v94
  v_exp_f32 v95, v95
  v_cvt_pk_bf16_f32 v108, v88, v89
  v_cvt_pk_bf16_f32 v109, v90, v91
  v_cvt_pk_bf16_f32 v110, v92, v93
  v_cvt_pk_bf16_f32 v111, v94, v95
  v_mfma_f32_32x32x8_bf16 v[80:95], v[42:43], v[26:27], v[160:175]
  ds_read_b128 v[48:51], v4 offset:8704
  ds_read_b128 v[52:55], v4 offset:9728
  ds_read_b128 v[36:39], v4 offset:3072
  v_exp_f32 v64, v64
  v_exp_f32 v65, v65
  v_exp_f32 v66, v66
  v_exp_f32 v67, v67
  v_mfma_f32_32x32x16_bf16 v[128:143], v[56:59], v[104:107], v[128:143]
  v_exp_f32 v68, v68
  v_exp_f32 v69, v69
  v_exp_f32 v70, v70
  v_exp_f32 v71, v71
  v_cvt_pk_bf16_f32 v96, v64, v65
  v_cvt_pk_bf16_f32 v97, v66, v67
  v_mfma_f32_32x32x16_bf16 v[80:95], v[32:35], v[20:23], v[80:95]
  v_exp_f32 v72, v72
  v_exp_f32 v73, v73
  v_exp_f32 v74, v74
  v_exp_f32 v75, v75
  v_cvt_pk_bf16_f32 v98, v68, v69
  v_cvt_pk_bf16_f32 v99, v70, v71
  v_mfma_f32_32x32x16_bf16 v[128:143], v[60:63], v[108:111], v[128:143]
  v_exp_f32 v76, v76
  v_exp_f32 v77, v77
  v_exp_f32 v78, v78
  v_exp_f32 v79, v79
  v_cvt_pk_bf16_f32 v100, v72, v73
  v_cvt_pk_bf16_f32 v101, v74, v75
  v_cvt_pk_bf16_f32 v102, v76, v77
  v_cvt_pk_bf16_f32 v103, v78, v79
  s_waitcnt lgkmcnt(0)
  v_mfma_f32_32x32x8_bf16 v[64:79], v[42:43], v[28:29], v[144:159]
  v_exp_f32 v80, v80
  v_exp_f32 v81, v81
  v_exp_f32 v82, v82
  v_exp_f32 v83, v83
  v_mfma_f32_32x32x16_bf16 v[112:127], v[48:51], v[96:99], v[112:127]
  v_exp_f32 v84, v84
  v_exp_f32 v85, v85
  v_exp_f32 v86, v86
  v_exp_f32 v87, v87
  v_cvt_pk_bf16_f32 v104, v80, v81
  v_cvt_pk_bf16_f32 v105, v82, v83
  v_mfma_f32_32x32x16_bf16 v[64:79], v[36:39], v[16:19], v[64:79]
  v_exp_f32 v88, v88
  v_exp_f32 v89, v89
  v_exp_f32 v90, v90
  v_exp_f32 v91, v91
  v_cvt_pk_bf16_f32 v106, v84, v85
  v_cvt_pk_bf16_f32 v107, v86, v87
  v_mfma_f32_32x32x16_bf16 v[112:127], v[52:55], v[100:103], v[112:127]
  v_exp_f32 v92, v92
  v_exp_f32 v93, v93
  v_exp_f32 v94, v94
  v_exp_f32 v95, v95
  v_cvt_pk_bf16_f32 v108, v88, v89
  v_cvt_pk_bf16_f32 v109, v90, v91
  v_cvt_pk_bf16_f32 v110, v92, v93
  v_cvt_pk_bf16_f32 v111, v94, v95
  v_mfma_f32_32x32x8_bf16 v[80:95], v[42:43], v[30:31], v[160:175]
  ds_read_b128 v[56:59], v4 offset:10752
  ds_read_b128 v[60:63], v4 offset:11776
  ds_read_b128 v[32:35], v4 offset:12800
  ds_read_b128 v[44:47], v5 offset:12800
  v_exp_f32 v64, v64
  v_exp_f32 v65, v65
  v_exp_f32 v66, v66
  v_exp_f32 v67, v67
  v_mfma_f32_32x32x16_bf16 v[128:143], v[48:51], v[104:107], v[128:143]
  v_exp_f32 v68, v68
  v_exp_f32 v69, v69
  v_exp_f32 v70, v70
  v_exp_f32 v71, v71
  v_cvt_pk_bf16_f32 v96, v64, v65
  v_cvt_pk_bf16_f32 v97, v66, v67
  v_mfma_f32_32x32x16_bf16 v[80:95], v[36:39], v[20:23], v[80:95]
  v_exp_f32 v72, v72
  v_exp_f32 v73, v73
  v_exp_f32 v74, v74
  v_exp_f32 v75, v75
  v_cvt_pk_bf16_f32 v98, v68, v69
  v_cvt_pk_bf16_f32 v99, v70, v71
  v_mfma_f32_32x32x16_bf16 v[128:143], v[52:55], v[108:111], v[128:143]
  v_exp_f32 v76, v76
  v_exp_f32 v77, v77
  v_exp_f32 v78, v78
  v_exp_f32 v79, v79
  v_cvt_pk_bf16_f32 v100, v72, v73
  v_cvt_pk_bf16_f32 v101, v74, v75
  v_cvt_pk_bf16_f32 v102, v76, v77
  v_cvt_pk_bf16_f32 v103, v78, v79
  s_waitcnt lgkmcnt(0)
  v_mfma_f32_32x32x8_bf16 v[64:79], v[44:45], v[24:25], v[144:159]
  v_exp_f32 v80, v80
  v_exp_f32 v81, v81
  v_exp_f32 v82, v82
  v_exp_f32 v83, v83
  v_mfma_f32_32x32x16_bf16 v[112:127], v[56:59], v[96:99], v[112:127]
  v_exp_f32 v84, v84
  v_exp_f32 v85, v85
  v_exp_f32 v86, v86
  v_exp_f32 v87, v87
  v_cvt_pk_bf16_f32 v104, v80, v81
  v_cvt_pk_bf16_f32 v105, v82, v83
  v_mfma_f32_32x32x16_bf16 v[64:79], v[32:35], v[16:19], v[64:79]
  v_exp_f32 v88, v88
  v_exp_f32 v89, v89
  v_exp_f32 v90, v90
  v_exp_f32 v91, v91
  v_cvt_pk_bf16_f32 v106, v84, v85
  v_cvt_pk_bf16_f32 v107, v86, v87
  v_mfma_f32_32x32x16_bf16 v[112:127], v[60:63], v[100:103], v[112:127]
  v_exp_f32 v92, v92
  v_exp_f32 v93, v93
  v_exp_f32 v94, v94
  v_exp_f32 v95, v95
  v_cvt_pk_bf16_f32 v108, v88, v89
  v_cvt_pk_bf16_f32 v109, v90, v91
  v_cvt_pk_bf16_f32 v110, v92, v93
  v_cvt_pk_bf16_f32 v111, v94, v95
  v_mfma_f32_32x32x8_bf16 v[80:95], v[44:45], v[26:27], v[160:175]
  ds_read_b128 v[48:51], v4 offset:17408
  ds_read_b128 v[52:55], v4 offset:18432
  ds_read_b128 v[36:39], v4 offset:13824
  v_exp_f32 v64, v64
  v_exp_f32 v65, v65
  v_exp_f32 v66, v66
  v_exp_f32 v67, v67
  v_mfma_f32_32x32x16_bf16 v[128:143], v[56:59], v[104:107], v[128:143]
  v_exp_f32 v68, v68
  v_exp_f32 v69, v69
  v_exp_f32 v70, v70
  v_exp_f32 v71, v71
  v_cvt_pk_bf16_f32 v96, v64, v65
  v_cvt_pk_bf16_f32 v97, v66, v67
  v_mfma_f32_32x32x16_bf16 v[80:95], v[32:35], v[20:23], v[80:95]
  v_exp_f32 v72, v72
  v_exp_f32 v73, v73
  v_exp_f32 v74, v74
  v_exp_f32 v75, v75
  v_cvt_pk_bf16_f32 v98, v68, v69
  v_cvt_pk_bf16_f32 v99, v70, v71
  v_mfma_f32_32x32x16_bf16 v[128:143], v[60:63], v[108:111], v[128:143]
  v_exp_f32 v76, v76
  v_exp_f32 v77, v77
  v_exp_f32 v78, v78
  v_exp_f32 v79, v79
  v_cvt_pk_bf16_f32 v100, v72, v73
  v_cvt_pk_bf16_f32 v101, v74, v75
  v_cvt_pk_bf16_f32 v102, v76, v77
  v_cvt_pk_bf16_f32 v103, v78, v79
  s_waitcnt lgkmcnt(0)
  v_mfma_f32_32x32x8_bf16 v[64:79], v[44:45], v[28:29], v[144:159]
  v_exp_f32 v80, v80
  v_exp_f32 v81, v81
  v_exp_f32 v82, v82
  v_exp_f32 v83, v83
  v_mfma_f32_32x32x16_bf16 v[112:127], v[48:51], v[96:99], v[112:127]
  v_exp_f32 v84, v84
  v_exp_f32 v85, v85
  v_exp_f32 v86, v86
  v_exp_f32 v87, v87
  v_cvt_pk_bf16_f32 v104, v80, v81
  v_cvt_pk_bf16_f32 v105, v82, v83
  v_mfma_f32_32x32x16_bf16 v[64:79], v[36:39], v[16:19], v[64:79]
  v_exp_f32 v88, v88
  v_exp_f32 v89, v89
  v_exp_f32 v90, v90
  v_exp_f32 v91, v91
  v_cvt_pk_bf16_f32 v106, v84, v85
  v_cvt_pk_bf16_f32 v107, v86, v87
  v_mfma_f32_32x32x16_bf16 v[112:127], v[52:55], v[100:103], v[112:127]
  v_exp_f32 v92, v92
  v_exp_f32 v93, v93
  v_exp_f32 v94, v94
  v_exp_f32 v95, v95
  v_cvt_pk_bf16_f32 v108, v88, v89
  v_cvt_pk_bf16_f32 v109, v90, v91
  v_cvt_pk_bf16_f32 v110, v92, v93
  v_cvt_pk_bf16_f32 v111, v94, v95
  s_barrier
  v_mfma_f32_32x32x8_bf16 v[80:95], v[44:45], v[30:31], v[160:175]
  ds_read_b128 v[56:59], v4 offset:19456
  ds_read_b128 v[60:63], v4 offset:20480
  ds_read_b128 v[32:35], v4 offset:14848
  v_exp_f32 v64, v64
  v_exp_f32 v65, v65
  v_exp_f32 v66, v66
  v_exp_f32 v67, v67
  v_mfma_f32_32x32x16_bf16 v[128:143], v[48:51], v[104:107], v[128:143]
  v_exp_f32 v68, v68
  v_exp_f32 v69, v69
  v_exp_f32 v70, v70
  v_exp_f32 v71, v71
  v_cvt_pk_bf16_f32 v96, v64, v65
  v_cvt_pk_bf16_f32 v97, v66, v67
  v_mfma_f32_32x32x16_bf16 v[80:95], v[36:39], v[20:23], v[80:95]
  v_exp_f32 v72, v72
  v_exp_f32 v73, v73
  v_exp_f32 v74, v74
  v_exp_f32 v75, v75
  v_cvt_pk_bf16_f32 v98, v68, v69
  v_cvt_pk_bf16_f32 v99, v70, v71
  v_mfma_f32_32x32x16_bf16 v[128:143], v[52:55], v[108:111], v[128:143]
  v_exp_f32 v76, v76
  v_exp_f32 v77, v77
  v_exp_f32 v78, v78
  v_exp_f32 v79, v79
  v_cvt_pk_bf16_f32 v100, v72, v73
  v_cvt_pk_bf16_f32 v101, v74, v75
  v_cvt_pk_bf16_f32 v102, v76, v77
  v_cvt_pk_bf16_f32 v103, v78, v79
  s_waitcnt lgkmcnt(0)
  v_mfma_f32_32x32x8_bf16 v[64:79], v[46:47], v[24:25], v[144:159]
  v_exp_f32 v80, v80
  v_exp_f32 v81, v81
  v_exp_f32 v82, v82
  v_exp_f32 v83, v83
  v_mfma_f32_32x32x16_bf16 v[112:127], v[56:59], v[96:99], v[112:127]
  v_exp_f32 v84, v84
  v_exp_f32 v85, v85
  v_exp_f32 v86, v86
  v_exp_f32 v87, v87
  v_cvt_pk_bf16_f32 v104, v80, v81
  v_cvt_pk_bf16_f32 v105, v82, v83
  v_mfma_f32_32x32x16_bf16 v[64:79], v[32:35], v[16:19], v[64:79]
  v_exp_f32 v88, v88
  v_exp_f32 v89, v89
  v_exp_f32 v90, v90
  v_exp_f32 v91, v91
  v_cvt_pk_bf16_f32 v106, v84, v85
  v_cvt_pk_bf16_f32 v107, v86, v87
  v_mfma_f32_32x32x16_bf16 v[112:127], v[60:63], v[100:103], v[112:127]
  v_exp_f32 v92, v92
  v_exp_f32 v93, v93
  v_exp_f32 v94, v94
  v_exp_f32 v95, v95
  v_cvt_pk_bf16_f32 v108, v88, v89
  v_cvt_pk_bf16_f32 v109, v90, v91
  v_cvt_pk_bf16_f32 v110, v92, v93
  v_cvt_pk_bf16_f32 v111, v94, v95
  v_mfma_f32_32x32x8_bf16 v[80:95], v[46:47], v[26:27], v[160:175]
  ds_read_b128 v[48:51], v4 offset:21504
  ds_read_b128 v[52:55], v4 offset:22528
  ds_read_b128 v[36:39], v4 offset:15872
  v_exp_f32 v64, v64
  v_exp_f32 v65, v65
  v_exp_f32 v66, v66
  v_exp_f32 v67, v67
  v_mfma_f32_32x32x16_bf16 v[128:143], v[56:59], v[104:107], v[128:143]
  v_exp_f32 v68, v68
  v_exp_f32 v69, v69
  v_exp_f32 v70, v70
  v_exp_f32 v71, v71
  v_cvt_pk_bf16_f32 v96, v64, v65
  v_cvt_pk_bf16_f32 v97, v66, v67
  v_mfma_f32_32x32x16_bf16 v[80:95], v[32:35], v[20:23], v[80:95]
  v_exp_f32 v72, v72
  v_exp_f32 v73, v73
  v_exp_f32 v74, v74
  v_exp_f32 v75, v75
  v_cvt_pk_bf16_f32 v98, v68, v69
  v_cvt_pk_bf16_f32 v99, v70, v71
  v_mfma_f32_32x32x16_bf16 v[128:143], v[60:63], v[108:111], v[128:143]
  v_exp_f32 v76, v76
  v_exp_f32 v77, v77
  v_exp_f32 v78, v78
  v_exp_f32 v79, v79
  v_cvt_pk_bf16_f32 v100, v72, v73
  v_cvt_pk_bf16_f32 v101, v74, v75
  v_cvt_pk_bf16_f32 v102, v76, v77
  v_cvt_pk_bf16_f32 v103, v78, v79
  s_waitcnt lgkmcnt(0)
  v_mfma_f32_32x32x8_bf16 v[64:79], v[46:47], v[28:29], v[144:159]
  v_exp_f32 v80, v80
  v_exp_f32 v81, v81
  v_exp_f32 v82, v82
  v_exp_f32 v83, v83
  v_mfma_f32_32x32x16_bf16 v[112:127], v[48:51], v[96:99], v[112:127]
  v_exp_f32 v84, v84
  v_exp_f32 v85, v85
  v_exp_f32 v86, v86
  v_exp_f32 v87, v87
  v_cvt_pk_bf16_f32 v104, v80, v81
  v_cvt_pk_bf16_f32 v105, v82, v83
  v_mfma_f32_32x32x16_bf16 v[64:79], v[36:39], v[16:19], v[64:79]
  v_exp_f32 v88, v88
  v_exp_f32 v89, v89
  v_exp_f32 v90, v90
  v_exp_f32 v91, v91
  v_cvt_pk_bf16_f32 v106, v84, v85
  v_cvt_pk_bf16_f32 v107, v86, v87
  v_mfma_f32_32x32x16_bf16 v[112:127], v[52:55], v[100:103], v[112:127]
  v_exp_f32 v92, v92
  v_exp_f32 v93, v93
  v_exp_f32 v94, v94
  v_exp_f32 v95, v95
  v_cvt_pk_bf16_f32 v108, v88, v89
  v_cvt_pk_bf16_f32 v109, v90, v91
  v_cvt_pk_bf16_f32 v110, v92, v93
  v_cvt_pk_bf16_f32 v111, v94, v95
  v_mfma_f32_32x32x8_bf16 v[80:95], v[46:47], v[30:31], v[160:175]
  ds_read_b128 v[56:59], v4 offset:23552
  ds_read_b128 v[60:63], v4 offset:24576
  ds_read_b128 v[32:35], v4 offset:25600
  ds_read_b128 v[40:43], v5 offset:25600
  v_exp_f32 v64, v64
  v_exp_f32 v65, v65
  v_exp_f32 v66, v66
  v_exp_f32 v67, v67
  v_mfma_f32_32x32x16_bf16 v[128:143], v[48:51], v[104:107], v[128:143]
  v_exp_f32 v68, v68
  v_exp_f32 v69, v69
  v_exp_f32 v70, v70
  v_exp_f32 v71, v71
  v_cvt_pk_bf16_f32 v96, v64, v65
  v_cvt_pk_bf16_f32 v97, v66, v67
  v_mfma_f32_32x32x16_bf16 v[80:95], v[36:39], v[20:23], v[80:95]
  v_exp_f32 v72, v72
  v_exp_f32 v73, v73
  v_exp_f32 v74, v74
  v_exp_f32 v75, v75
  v_cvt_pk_bf16_f32 v98, v68, v69
  v_cvt_pk_bf16_f32 v99, v70, v71
  v_mfma_f32_32x32x16_bf16 v[128:143], v[52:55], v[108:111], v[128:143]
  v_exp_f32 v76, v76
  v_exp_f32 v77, v77
  v_exp_f32 v78, v78
  v_exp_f32 v79, v79
  v_cvt_pk_bf16_f32 v100, v72, v73
  v_cvt_pk_bf16_f32 v101, v74, v75
  v_cvt_pk_bf16_f32 v102, v76, v77
  v_cvt_pk_bf16_f32 v103, v78, v79
  s_waitcnt lgkmcnt(0)
  v_mfma_f32_32x32x8_bf16 v[64:79], v[40:41], v[24:25], v[144:159]
  v_exp_f32 v80, v80
  v_exp_f32 v81, v81
  v_exp_f32 v82, v82
  v_exp_f32 v83, v83
  v_mfma_f32_32x32x16_bf16 v[112:127], v[56:59], v[96:99], v[112:127]
  v_exp_f32 v84, v84
  v_exp_f32 v85, v85
  v_exp_f32 v86, v86
  v_exp_f32 v87, v87
  v_cvt_pk_bf16_f32 v104, v80, v81
  v_cvt_pk_bf16_f32 v105, v82, v83
  v_mfma_f32_32x32x16_bf16 v[64:79], v[32:35], v[16:19], v[64:79]
  v_exp_f32 v88, v88
  v_exp_f32 v89, v89
  v_exp_f32 v90, v90
  v_exp_f32 v91, v91
  v_cvt_pk_bf16_f32 v106, v84, v85
  v_cvt_pk_bf16_f32 v107, v86, v87
  v_mfma_f32_32x32x16_bf16 v[112:127], v[60:63], v[100:103], v[112:127]
  v_exp_f32 v92, v92
  v_exp_f32 v93, v93
  v_exp_f32 v94, v94
  v_exp_f32 v95, v95
  v_cvt_pk_bf16_f32 v108, v88, v89
  v_cvt_pk_bf16_f32 v109, v90, v91
  v_cvt_pk_bf16_f32 v110, v92, v93
  v_cvt_pk_bf16_f32 v111, v94, v95
  v_mfma_f32_32x32x8_bf16 v[80:95], v[40:41], v[26:27], v[160:175]
  ds_read_b128 v[48:51], v4 offset:30208
  ds_read_b128 v[52:55], v4 offset:31232
  ds_read_b128 v[36:39], v4 offset:26624
  v_exp_f32 v64, v64
  v_exp_f32 v65, v65
  v_exp_f32 v66, v66
  v_exp_f32 v67, v67
  v_mfma_f32_32x32x16_bf16 v[128:143], v[56:59], v[104:107], v[128:143]
  v_exp_f32 v68, v68
  v_exp_f32 v69, v69
  v_exp_f32 v70, v70
  v_exp_f32 v71, v71
  v_cvt_pk_bf16_f32 v96, v64, v65
  v_cvt_pk_bf16_f32 v97, v66, v67
  v_mfma_f32_32x32x16_bf16 v[80:95], v[32:35], v[20:23], v[80:95]
  v_exp_f32 v72, v72
  v_exp_f32 v73, v73
  v_exp_f32 v74, v74
  v_exp_f32 v75, v75
  v_cvt_pk_bf16_f32 v98, v68, v69
  v_cvt_pk_bf16_f32 v99, v70, v71
  v_mfma_f32_32x32x16_bf16 v[128:143], v[60:63], v[108:111], v[128:143]
  v_exp_f32 v76, v76
  v_exp_f32 v77, v77
  v_exp_f32 v78, v78
  v_exp_f32 v79, v79
  v_cvt_pk_bf16_f32 v100, v72, v73
  v_cvt_pk_bf16_f32 v101, v74, v75
  v_cvt_pk_bf16_f32 v102, v76, v77
  v_cvt_pk_bf16_f32 v103, v78, v79
  s_waitcnt lgkmcnt(0)
  v_mfma_f32_32x32x8_bf16 v[64:79], v[40:41], v[28:29], v[144:159]
  v_exp_f32 v80, v80
  v_exp_f32 v81, v81
  v_exp_f32 v82, v82
  v_exp_f32 v83, v83
  v_mfma_f32_32x32x16_bf16 v[112:127], v[48:51], v[96:99], v[112:127]
  v_exp_f32 v84, v84
  v_exp_f32 v85, v85
  v_exp_f32 v86, v86
  v_exp_f32 v87, v87
  v_cvt_pk_bf16_f32 v104, v80, v81
  v_cvt_pk_bf16_f32 v105, v82, v83
  v_mfma_f32_32x32x16_bf16 v[64:79], v[36:39], v[16:19], v[64:79]
  v_exp_f32 v88, v88
  v_exp_f32 v89, v89
  v_exp_f32 v90, v90
  v_exp_f32 v91, v91
  v_cvt_pk_bf16_f32 v106, v84, v85
  v_cvt_pk_bf16_f32 v107, v86, v87
  v_mfma_f32_32x32x16_bf16 v[112:127], v[52:55], v[100:103], v[112:127]
  v_exp_f32 v92, v92
  v_exp_f32 v93, v93
  v_exp_f32 v94, v94
  v_exp_f32 v95, v95
  v_cvt_pk_bf16_f32 v108, v88, v89
  v_cvt_pk_bf16_f32 v109, v90, v91
  v_cvt_pk_bf16_f32 v110, v92, v93
  v_cvt_pk_bf16_f32 v111, v94, v95
  s_barrier
  v_mfma_f32_32x32x8_bf16 v[80:95], v[40:41], v[30:31], v[160:175]
  ds_read_b128 v[56:59], v4 offset:32256
  ds_read_b128 v[60:63], v4 offset:33280
  ds_read_b128 v[32:35], v4 offset:27648
  v_exp_f32 v64, v64
  v_exp_f32 v65, v65
  v_exp_f32 v66, v66
  v_exp_f32 v67, v67
  v_mfma_f32_32x32x16_bf16 v[128:143], v[48:51], v[104:107], v[128:143]
  v_exp_f32 v68, v68
  v_exp_f32 v69, v69
  v_exp_f32 v70, v70
  v_exp_f32 v71, v71
  v_cvt_pk_bf16_f32 v96, v64, v65
  v_cvt_pk_bf16_f32 v97, v66, v67
  v_mfma_f32_32x32x16_bf16 v[80:95], v[36:39], v[20:23], v[80:95]
  v_exp_f32 v72, v72
  v_exp_f32 v73, v73
  v_exp_f32 v74, v74
  v_exp_f32 v75, v75
  v_cvt_pk_bf16_f32 v98, v68, v69
  v_cvt_pk_bf16_f32 v99, v70, v71
  v_mfma_f32_32x32x16_bf16 v[128:143], v[52:55], v[108:111], v[128:143]
  v_exp_f32 v76, v76
  v_exp_f32 v77, v77
  v_exp_f32 v78, v78
  v_exp_f32 v79, v79
  v_cvt_pk_bf16_f32 v100, v72, v73
  v_cvt_pk_bf16_f32 v101, v74, v75
  v_cvt_pk_bf16_f32 v102, v76, v77
  v_cvt_pk_bf16_f32 v103, v78, v79
  s_waitcnt lgkmcnt(0)
  v_mfma_f32_32x32x8_bf16 v[64:79], v[42:43], v[24:25], v[144:159]
  v_exp_f32 v80, v80
  v_exp_f32 v81, v81
  v_exp_f32 v82, v82
  v_exp_f32 v83, v83
  v_mfma_f32_32x32x16_bf16 v[112:127], v[56:59], v[96:99], v[112:127]
  v_exp_f32 v84, v84
  v_exp_f32 v85, v85
  v_exp_f32 v86, v86
  v_exp_f32 v87, v87
  v_cvt_pk_bf16_f32 v104, v80, v81
  v_cvt_pk_bf16_f32 v105, v82, v83
  v_mfma_f32_32x32x16_bf16 v[64:79], v[32:35], v[16:19], v[64:79]
  v_exp_f32 v88, v88
  v_exp_f32 v89, v89
  v_exp_f32 v90, v90
  v_exp_f32 v91, v91
  v_cvt_pk_bf16_f32 v106, v84, v85
  v_cvt_pk_bf16_f32 v107, v86, v87
  v_mfma_f32_32x32x16_bf16 v[112:127], v[60:63], v[100:103], v[112:127]
  v_exp_f32 v92, v92
  v_exp_f32 v93, v93
  v_exp_f32 v94, v94
  v_exp_f32 v95, v95
  v_cvt_pk_bf16_f32 v108, v88, v89
  v_cvt_pk_bf16_f32 v109, v90, v91
  v_cvt_pk_bf16_f32 v110, v92, v93
  v_cvt_pk_bf16_f32 v111, v94, v95
  v_mfma_f32_32x32x8_bf16 v[80:95], v[42:43], v[26:27], v[160:175]
  ds_read_b128 v[48:51], v4 offset:34304
  ds_read_b128 v[52:55], v4 offset:35328
  ds_read_b128 v[36:39], v4 offset:28672
  v_exp_f32 v64, v64
  v_exp_f32 v65, v65
  v_exp_f32 v66, v66
  v_exp_f32 v67, v67
  v_mfma_f32_32x32x16_bf16 v[128:143], v[56:59], v[104:107], v[128:143]
  v_exp_f32 v68, v68
  v_exp_f32 v69, v69
  v_exp_f32 v70, v70
  v_exp_f32 v71, v71
  v_cvt_pk_bf16_f32 v96, v64, v65
  v_cvt_pk_bf16_f32 v97, v66, v67
  v_mfma_f32_32x32x16_bf16 v[80:95], v[32:35], v[20:23], v[80:95]
  v_exp_f32 v72, v72
  v_exp_f32 v73, v73
  v_exp_f32 v74, v74
  v_exp_f32 v75, v75
  v_cvt_pk_bf16_f32 v98, v68, v69
  v_cvt_pk_bf16_f32 v99, v70, v71
  v_mfma_f32_32x32x16_bf16 v[128:143], v[60:63], v[108:111], v[128:143]
  v_exp_f32 v76, v76
  v_exp_f32 v77, v77
  v_exp_f32 v78, v78
  v_exp_f32 v79, v79
  v_cvt_pk_bf16_f32 v100, v72, v73
  v_cvt_pk_bf16_f32 v101, v74, v75
  v_cvt_pk_bf16_f32 v102, v76, v77
  v_cvt_pk_bf16_f32 v103, v78, v79
  s_waitcnt lgkmcnt(0)
  v_mfma_f32_32x32x8_bf16 v[64:79], v[42:43], v[28:29], v[144:159]
  v_exp_f32 v80, v80
  v_exp_f32 v81, v81
  v_exp_f32 v82, v82
  v_exp_f32 v83, v83
  v_mfma_f32_32x32x16_bf16 v[112:127], v[48:51], v[96:99], v[112:127]
  v_exp_f32 v84, v84
  v_exp_f32 v85, v85
  v_exp_f32 v86, v86
  v_exp_f32 v87, v87
  v_cvt_pk_bf16_f32 v104, v80, v81
  v_cvt_pk_bf16_f32 v105, v82, v83
  v_mfma_f32_32x32x16_bf16 v[64:79], v[36:39], v[16:19], v[64:79]
  v_exp_f32 v88, v88
  v_exp_f32 v89, v89
  v_exp_f32 v90, v90
  v_exp_f32 v91, v91
  v_cvt_pk_bf16_f32 v106, v84, v85
  v_cvt_pk_bf16_f32 v107, v86, v87
  v_mfma_f32_32x32x16_bf16 v[112:127], v[52:55], v[100:103], v[112:127]
  v_exp_f32 v92, v92
  v_exp_f32 v93, v93
  v_exp_f32 v94, v94
  v_exp_f32 v95, v95
  v_cvt_pk_bf16_f32 v108, v88, v89
  v_cvt_pk_bf16_f32 v109, v90, v91
  v_cvt_pk_bf16_f32 v110, v92, v93
  v_cvt_pk_bf16_f32 v111, v94, v95
  v_mfma_f32_32x32x8_bf16 v[80:95], v[42:43], v[30:31], v[160:175]
  ds_read_b128 v[56:59], v4 offset:36352
  ds_read_b128 v[60:63], v4 offset:37376
  ds_read_b128 v[32:35], v4 offset:38400
  ds_read_b128 v[44:47], v5 offset:38400
  v_exp_f32 v64, v64
  v_exp_f32 v65, v65
  v_exp_f32 v66, v66
  v_exp_f32 v67, v67
  v_mfma_f32_32x32x16_bf16 v[128:143], v[48:51], v[104:107], v[128:143]
  v_exp_f32 v68, v68
  v_exp_f32 v69, v69
  v_exp_f32 v70, v70
  v_exp_f32 v71, v71
  v_cvt_pk_bf16_f32 v96, v64, v65
  v_cvt_pk_bf16_f32 v97, v66, v67
  v_mfma_f32_32x32x16_bf16 v[80:95], v[36:39], v[20:23], v[80:95]
  v_exp_f32 v72, v72
  v_exp_f32 v73, v73
  v_exp_f32 v74, v74
  v_exp_f32 v75, v75
  v_cvt_pk_bf16_f32 v98, v68, v69
  v_cvt_pk_bf16_f32 v99, v70, v71
  v_mfma_f32_32x32x16_bf16 v[128:143], v[52:55], v[108:111], v[128:143]
  v_exp_f32 v76, v76
  v_exp_f32 v77, v77
  v_exp_f32 v78, v78
  v_exp_f32 v79, v79
  v_cvt_pk_bf16_f32 v100, v72, v73
  v_cvt_pk_bf16_f32 v101, v74, v75
  v_cvt_pk_bf16_f32 v102, v76, v77
  v_cvt_pk_bf16_f32 v103, v78, v79
  s_waitcnt lgkmcnt(0)
  v_mfma_f32_32x32x8_bf16 v[64:79], v[44:45], v[24:25], v[144:159]
  v_exp_f32 v80, v80
  v_exp_f32 v81, v81
  v_exp_f32 v82, v82
  v_exp_f32 v83, v83
  v_mfma_f32_32x32x16_bf16 v[112:127], v[56:59], v[96:99], v[112:127]
  v_exp_f32 v84, v84
  v_exp_f32 v85, v85
  v_exp_f32 v86, v86
  v_exp_f32 v87, v87
  v_cvt_pk_bf16_f32 v104, v80, v81
  v_cvt_pk_bf16_f32 v105, v82, v83
  v_mfma_f32_32x32x16_bf16 v[64:79], v[32:35], v[16:19], v[64:79]
  v_exp_f32 v88, v88
  v_exp_f32 v89, v89
  v_exp_f32 v90, v90
  v_exp_f32 v91, v91
  v_cvt_pk_bf16_f32 v106, v84, v85
  v_cvt_pk_bf16_f32 v107, v86, v87
  v_mfma_f32_32x32x16_bf16 v[112:127], v[60:63], v[100:103], v[112:127]
  v_exp_f32 v92, v92
  v_exp_f32 v93, v93
  v_exp_f32 v94, v94
  v_exp_f32 v95, v95
  v_cvt_pk_bf16_f32 v108, v88, v89
  v_cvt_pk_bf16_f32 v109, v90, v91
  v_cvt_pk_bf16_f32 v110, v92, v93
  v_cvt_pk_bf16_f32 v111, v94, v95
  v_mfma_f32_32x32x8_bf16 v[80:95], v[44:45], v[26:27], v[160:175]
  ds_read_b128 v[48:51], v4 offset:43008
  ds_read_b128 v[52:55], v4 offset:44032
  ds_read_b128 v[36:39], v4 offset:39424
  v_exp_f32 v64, v64
  v_exp_f32 v65, v65
  v_exp_f32 v66, v66
  v_exp_f32 v67, v67
  v_mfma_f32_32x32x16_bf16 v[128:143], v[56:59], v[104:107], v[128:143]
  v_exp_f32 v68, v68
  v_exp_f32 v69, v69
  v_exp_f32 v70, v70
  v_exp_f32 v71, v71
  v_cvt_pk_bf16_f32 v96, v64, v65
  v_cvt_pk_bf16_f32 v97, v66, v67
  v_mfma_f32_32x32x16_bf16 v[80:95], v[32:35], v[20:23], v[80:95]
  v_exp_f32 v72, v72
  v_exp_f32 v73, v73
  v_exp_f32 v74, v74
  v_exp_f32 v75, v75
  v_cvt_pk_bf16_f32 v98, v68, v69
  v_cvt_pk_bf16_f32 v99, v70, v71
  v_mfma_f32_32x32x16_bf16 v[128:143], v[60:63], v[108:111], v[128:143]
  v_exp_f32 v76, v76
  v_exp_f32 v77, v77
  v_exp_f32 v78, v78
  v_exp_f32 v79, v79
  v_cvt_pk_bf16_f32 v100, v72, v73
  v_cvt_pk_bf16_f32 v101, v74, v75
  v_cvt_pk_bf16_f32 v102, v76, v77
  v_cvt_pk_bf16_f32 v103, v78, v79
  s_waitcnt lgkmcnt(0)
  v_mfma_f32_32x32x8_bf16 v[64:79], v[44:45], v[28:29], v[144:159]
  v_exp_f32 v80, v80
  v_exp_f32 v81, v81
  v_exp_f32 v82, v82
  v_exp_f32 v83, v83
  v_mfma_f32_32x32x16_bf16 v[112:127], v[48:51], v[96:99], v[112:127]
  v_exp_f32 v84, v84
  v_exp_f32 v85, v85
  v_exp_f32 v86, v86
  v_exp_f32 v87, v87
  v_cvt_pk_bf16_f32 v104, v80, v81
  v_cvt_pk_bf16_f32 v105, v82, v83
  v_mfma_f32_32x32x16_bf16 v[64:79], v[36:39], v[16:19], v[64:79]
  v_exp_f32 v88, v88
  v_exp_f32 v89, v89
  v_exp_f32 v90, v90
  v_exp_f32 v91, v91
  v_cvt_pk_bf16_f32 v106, v84, v85
  v_cvt_pk_bf16_f32 v107, v86, v87
  v_mfma_f32_32x32x16_bf16 v[112:127], v[52:55], v[100:103], v[112:127]
  v_exp_f32 v92, v92
  v_exp_f32 v93, v93
  v_exp_f32 v94, v94
  v_exp_f32 v95, v95
  v_cvt_pk_bf16_f32 v108, v88, v89
  v_cvt_pk_bf16_f32 v109, v90, v91
  v_cvt_pk_bf16_f32 v110, v92, v93
  v_cvt_pk_bf16_f32 v111, v94, v95
  s_barrier
  v_mfma_f32_32x32x8_bf16 v[80:95], v[44:45], v[30:31], v[160:175]
  ds_read_b128 v[56:59], v4 offset:45056
  ds_read_b128 v[60:63], v4 offset:46080
  ds_read_b128 v[32:35], v4 offset:40448
  v_exp_f32 v64, v64
  v_exp_f32 v65, v65
  v_exp_f32 v66, v66
  v_exp_f32 v67, v67
  v_mfma_f32_32x32x16_bf16 v[128:143], v[48:51], v[104:107], v[128:143]
  v_exp_f32 v68, v68
  v_exp_f32 v69, v69
  v_exp_f32 v70, v70
  v_exp_f32 v71, v71
  v_cvt_pk_bf16_f32 v96, v64, v65
  v_cvt_pk_bf16_f32 v97, v66, v67
  v_mfma_f32_32x32x16_bf16 v[80:95], v[36:39], v[20:23], v[80:95]
  v_exp_f32 v72, v72
  v_exp_f32 v73, v73
  v_exp_f32 v74, v74
  v_exp_f32 v75, v75
  v_cvt_pk_bf16_f32 v98, v68, v69
  v_cvt_pk_bf16_f32 v99, v70, v71
  v_mfma_f32_32x32x16_bf16 v[128:143], v[52:55], v[108:111], v[128:143]
  v_exp_f32 v76, v76
  v_exp_f32 v77, v77
  v_exp_f32 v78, v78
  v_exp_f32 v79, v79
  v_cvt_pk_bf16_f32 v100, v72, v73
  v_cvt_pk_bf16_f32 v101, v74, v75
  v_cvt_pk_bf16_f32 v102, v76, v77
  v_cvt_pk_bf16_f32 v103, v78, v79
  s_waitcnt lgkmcnt(0)
  v_mfma_f32_32x32x8_bf16 v[64:79], v[46:47], v[24:25], v[144:159]
  v_exp_f32 v80, v80
  v_exp_f32 v81, v81
  v_exp_f32 v82, v82
  v_exp_f32 v83, v83
  v_mfma_f32_32x32x16_bf16 v[112:127], v[56:59], v[96:99], v[112:127]
  v_exp_f32 v84, v84
  v_exp_f32 v85, v85
  v_exp_f32 v86, v86
  v_exp_f32 v87, v87
  v_cvt_pk_bf16_f32 v104, v80, v81
  v_cvt_pk_bf16_f32 v105, v82, v83
  v_mfma_f32_32x32x16_bf16 v[64:79], v[32:35], v[16:19], v[64:79]
  v_exp_f32 v88, v88
  v_exp_f32 v89, v89
  v_exp_f32 v90, v90
  v_exp_f32 v91, v91
  v_cvt_pk_bf16_f32 v106, v84, v85
  v_cvt_pk_bf16_f32 v107, v86, v87
  v_mfma_f32_32x32x16_bf16 v[112:127], v[60:63], v[100:103], v[112:127]
  v_exp_f32 v92, v92
  v_exp_f32 v93, v93
  v_exp_f32 v94, v94
  v_exp_f32 v95, v95
  v_cvt_pk_bf16_f32 v108, v88, v89
  v_cvt_pk_bf16_f32 v109, v90, v91
  v_cvt_pk_bf16_f32 v110, v92, v93
  v_cvt_pk_bf16_f32 v111, v94, v95
  v_mfma_f32_32x32x8_bf16 v[80:95], v[46:47], v[26:27], v[160:175]
  ds_read_b128 v[48:51], v4 offset:47104
  ds_read_b128 v[52:55], v4 offset:48128
  ds_read_b128 v[36:39], v4 offset:41472
  v_exp_f32 v64, v64
  v_exp_f32 v65, v65
  v_exp_f32 v66, v66
  v_exp_f32 v67, v67
  v_mfma_f32_32x32x16_bf16 v[128:143], v[56:59], v[104:107], v[128:143]
  v_exp_f32 v68, v68
  v_exp_f32 v69, v69
  v_exp_f32 v70, v70
  v_exp_f32 v71, v71
  v_cvt_pk_bf16_f32 v96, v64, v65
  v_cvt_pk_bf16_f32 v97, v66, v67
  v_mfma_f32_32x32x16_bf16 v[80:95], v[32:35], v[20:23], v[80:95]
  v_exp_f32 v72, v72
  v_exp_f32 v73, v73
  v_exp_f32 v74, v74
  v_exp_f32 v75, v75
  v_cvt_pk_bf16_f32 v98, v68, v69
  v_cvt_pk_bf16_f32 v99, v70, v71
  v_mfma_f32_32x32x16_bf16 v[128:143], v[60:63], v[108:111], v[128:143]
  v_exp_f32 v76, v76
  v_exp_f32 v77, v77
  v_exp_f32 v78, v78
  v_exp_f32 v79, v79
  v_cvt_pk_bf16_f32 v100, v72, v73
  v_cvt_pk_bf16_f32 v101, v74, v75
  v_cvt_pk_bf16_f32 v102, v76, v77
  v_cvt_pk_bf16_f32 v103, v78, v79
  s_waitcnt lgkmcnt(0)
  v_mfma_f32_32x32x8_bf16 v[64:79], v[46:47], v[28:29], v[144:159]
  v_exp_f32 v80, v80
  v_exp_f32 v81, v81
  v_exp_f32 v82, v82
  v_exp_f32 v83, v83
  v_mfma_f32_32x32x16_bf16 v[112:127], v[48:51], v[96:99], v[112:127]
  v_exp_f32 v84, v84
  v_exp_f32 v85, v85
  v_exp_f32 v86, v86
  v_exp_f32 v87, v87
  v_cvt_pk_bf16_f32 v104, v80, v81
  v_cvt_pk_bf16_f32 v105, v82, v83
  v_mfma_f32_32x32x16_bf16 v[64:79], v[36:39], v[16:19], v[64:79]
  v_exp_f32 v88, v88
  v_exp_f32 v89, v89
  v_exp_f32 v90, v90
  v_exp_f32 v91, v91
  v_cvt_pk_bf16_f32 v106, v84, v85
  v_cvt_pk_bf16_f32 v107, v86, v87
  v_mfma_f32_32x32x16_bf16 v[112:127], v[52:55], v[100:103], v[112:127]
  v_exp_f32 v92, v92
  v_exp_f32 v93, v93
  v_exp_f32 v94, v94
  v_exp_f32 v95, v95
  v_cvt_pk_bf16_f32 v108, v88, v89
  v_cvt_pk_bf16_f32 v109, v90, v91
  v_cvt_pk_bf16_f32 v110, v92, v93
  v_cvt_pk_bf16_f32 v111, v94, v95
  v_mfma_f32_32x32x8_bf16 v[80:95], v[46:47], v[30:31], v[160:175]
  ds_read_b128 v[56:59], v4 offset:49152
  ds_read_b128 v[60:63], v4 offset:50176
  v_exp_f32 v64, v64
  v_exp_f32 v65, v65
  v_exp_f32 v66, v66
  v_exp_f32 v67, v67
  v_mfma_f32_32x32x16_bf16 v[128:143], v[48:51], v[104:107], v[128:143]
  v_exp_f32 v68, v68
  v_exp_f32 v69, v69
  v_exp_f32 v70, v70
  v_exp_f32 v71, v71
  v_cvt_pk_bf16_f32 v96, v64, v65
  v_cvt_pk_bf16_f32 v97, v66, v67
  v_mfma_f32_32x32x16_bf16 v[80:95], v[36:39], v[20:23], v[80:95]
  v_exp_f32 v72, v72
  v_exp_f32 v73, v73
  v_exp_f32 v74, v74
  v_exp_f32 v75, v75
  v_cvt_pk_bf16_f32 v98, v68, v69
  v_cvt_pk_bf16_f32 v99, v70, v71
  v_mfma_f32_32x32x16_bf16 v[128:143], v[52:55], v[108:111], v[128:143]
  v_exp_f32 v76, v76
  v_exp_f32 v77, v77
  v_exp_f32 v78, v78
  v_exp_f32 v79, v79
  v_cvt_pk_bf16_f32 v100, v72, v73
  v_cvt_pk_bf16_f32 v101, v74, v75
  v_cvt_pk_bf16_f32 v102, v76, v77
  v_cvt_pk_bf16_f32 v103, v78, v79
  s_waitcnt lgkmcnt(0)
  v_mfma_f32_32x32x16_bf16 v[112:127], v[56:59], v[96:99], v[112:127]
  v_exp_f32 v80, v80
  v_exp_f32 v81, v81
  v_exp_f32 v82, v82
  v_exp_f32 v83, v83
  v_mfma_f32_32x32x16_bf16 v[112:127], v[60:63], v[100:103], v[112:127]
  v_exp_f32 v84, v84
  v_exp_f32 v85, v85
  v_exp_f32 v86, v86
  v_exp_f32 v87, v87
  v_cvt_pk_bf16_f32 v104, v80, v81
  v_cvt_pk_bf16_f32 v105, v82, v83
  v_exp_f32 v88, v88
  v_exp_f32 v89, v89
  v_exp_f32 v90, v90
  v_exp_f32 v91, v91
  v_cvt_pk_bf16_f32 v106, v84, v85
  v_cvt_pk_bf16_f32 v107, v86, v87
  v_exp_f32 v92, v92
  v_exp_f32 v93, v93
  v_exp_f32 v94, v94
  v_exp_f32 v95, v95
  v_cvt_pk_bf16_f32 v108, v88, v89
  v_cvt_pk_bf16_f32 v109, v90, v91
  v_cvt_pk_bf16_f32 v110, v92, v93
  v_cvt_pk_bf16_f32 v111, v94, v95
  s_nop 1
  v_mfma_f32_32x32x16_bf16 v[128:143], v[56:59], v[104:107], v[128:143]
  v_mfma_f32_32x32x16_bf16 v[128:143], v[60:63], v[108:111], v[128:143]
  s_barrier
  s_nop 15
  s_mov_b32 s26, 0
k2_afin:
  s_mov_b64 s[28:29], 0
  v_mov_b32 v176, v122
  v_mov_b32 v186, v122
  s_nop 1
  v_permlane32_swap_b32 v186, v176
  s_nop 1
  v_mov_b32 v176, 0x7b800000
  v_cmp_nlt_f32 vcc, v186, v176
  v_rcp_f32 v186, v186
  s_or_b64 s[28:29], s[28:29], vcc
  v_mul_f32 v186, 0x3f317218, v186
  v_mul_f32 v188, v112, v186
  v_mul_f32 v189, v113, v186
  v_mul_f32 v190, v114, v186
  v_mul_f32 v191, v115, v186
  v_mul_f32 v192, v116, v186
  v_mul_f32 v193, v117, v186
  v_mul_f32 v194, v118, v186
  v_mul_f32 v195, v119, v186
  v_mul_f32 v196, v120, v186
  v_mul_f32 v197, v121, v186
  v_mul_f32 v176, 0, v188
  v_fmac_f32 v176, 0, v189
  v_fmac_f32 v176, 0, v190
  v_fmac_f32 v176, 0, v191
  v_fmac_f32 v176, 0, v192
  v_fmac_f32 v176, 0, v193
  v_fmac_f32 v176, 0, v194
  v_fmac_f32 v176, 0, v195
  v_fmac_f32 v176, 0, v196
  v_fmac_f32 v176, 0, v197
  v_mov_b32 v177, 0x207
  v_cmp_class_f32 vcc, v176, v177
  v_cvt_pk_bf16_f32 v96, v188, v189
  v_cvt_pk_bf16_f32 v97, v190, v191
  v_cvt_pk_bf16_f32 v98, v192, v193
  v_cvt_pk_bf16_f32 v99, v194, v195
  v_cvt_pk_bf16_f32 v100, v196, v197
  s_or_b64 s[28:29], s[28:29], vcc
  v_mov_b32 v176, v138
  v_mov_b32 v187, v138
  s_nop 1
  v_permlane32_swap_b32 v187, v176
  s_nop 1
  v_mov_b32 v176, 0x7b800000
  v_cmp_nlt_f32 vcc, v187, v176
  v_rcp_f32 v187, v187
  s_or_b64 s[28:29], s[28:29], vcc
  v_mul_f32 v187, 0x3f317218, v187
  v_mul_f32 v188, v128, v187
  v_mul_f32 v189, v129, v187
  v_mul_f32 v190, v130, v187
  v_mul_f32 v191, v131, v187
  v_mul_f32 v192, v132, v187
  v_mul_f32 v193, v133, v187
  v_mul_f32 v194, v134, v187
  v_mul_f32 v195, v135, v187
  v_mul_f32 v196, v136, v187
  v_mul_f32 v197, v137, v187
  v_mul_f32 v176, 0, v188
  v_fmac_f32 v176, 0, v189
  v_fmac_f32 v176, 0, v190
  v_fmac_f32 v176, 0, v191
  v_fmac_f32 v176, 0, v192
  v_fmac_f32 v176, 0, v193
  v_fmac_f32 v176, 0, v194
  v_fmac_f32 v176, 0, v195
  v_fmac_f32 v176, 0, v196
  v_fmac_f32 v176, 0, v197
  v_mov_b32 v177, 0x207
  v_cmp_class_f32 vcc, v176, v177
  v_cvt_pk_bf16_f32 v104, v188, v189
  v_cvt_pk_bf16_f32 v105, v190, v191
  v_cvt_pk_bf16_f32 v106, v192, v193
  v_cvt_pk_bf16_f32 v107, v194, v195
  v_cvt_pk_bf16_f32 v108, v196, v197
  s_or_b64 s[28:29], s[28:29], vcc
  s_cmp_eq_u32 s26, 0
  s_cselect_b64 s[30:31], s[28:29], 0
  s_cmp_lg_u64 s[30:31], 0
  s_cbranch_scc1 k2_aslow
  s_lshl_b32 s19, s24, 6
  s_add_u32 s19, s19, s25
  s_lshl_b32 s19, s19, 10
  s_add_u32 s19, s19, 9437184
  buffer_store_dwordx4 v[96:99], v9, s[8:11], s19 offen sc1
  s_lshr_b32 s19, s24, 3
  s_lshl_b32 s19, s19, 6
  s_add_u32 s19, s19, s25
  s_lshl_b32 s19, s19, 10
  s_bfe_u32 s20, s24, 65538
  s_lshl_b32 s20, s20, 9
  s_add_u32 s19, s19, s20
  s_and_b32 s20, s24, 3
  s_lshl_b32 s20, s20, 2
  s_add_u32 s19, s19, s20
  s_add_u32 s19, s19, 11534336
  v_mov_b32 v185, 0x7ffffff0
  v_cmp_gt_u32 vcc, 32, v1
  s_nop 1
  v_cndmask_b32 v185, v185, v9, vcc
  buffer_store_dword v100, v185, s[8:11], s19 offen sc1
  s_lshl_b32 s19, s24, 6
  s_add_u32 s19, s19, s25
  s_lshl_b32 s19, s19, 10
  s_add_u32 s19, s19, 9438208
  buffer_store_dwordx4 v[104:107], v9, s[8:11], s19 offen sc1
  s_lshr_b32 s19, s24, 3
  s_lshl_b32 s19, s19, 6
  s_add_u32 s19, s19, s25
  s_lshl_b32 s19, s19, 10
  s_bfe_u32 s20, s24, 65538
  s_lshl_b32 s20, s20, 9
  s_add_u32 s19, s19, s20
  s_and_b32 s20, s24, 3
  s_lshl_b32 s20, s20, 2
  s_add_u32 s19, s19, s20
  s_add_u32 s19, s19, 11535360
  v_mov_b32 v185, 0x7ffffff0
  v_cmp_gt_u32 vcc, 32, v1
  s_nop 1
  v_cndmask_b32 v185, v185, v9, vcc
  buffer_store_dword v108, v185, s[8:11], s19 offen sc1
  s_cmp_eq_u32 s26, 0
  s_cbranch_scc0 k2_anobar
  s_barrier
k2_anobar:
  s_endpgm
k2_aslow:
  s_barrier
  s_mov_b32 s26, 1
  v_lshrrev_b32 v3, 5, v1
  v_lshl_add_u32 v11, v3, 15, v10
  s_mul_i32 s36, s24, 73728
  s_add_u32 s36, s36, 4718592
  s_mul_i32 s37, s24, 73728
  s_add_u32 s37, s37, 7077888
  v_mov_b32 v41, 0
  v_mov_b32 v176, 0xff800000
  v_mov_b32 v177, 0xff800000
  s_mov_b32 s38, s36
  s_mov_b32 s39, 0
k2_slowA:
  s_add_u32 s20, s38, 0
  buffer_load_dword v32, v11, s[8:11], s20 offen
  s_add_u32 s20, s38, 8192
  buffer_load_dword v33, v11, s[8:11], s20 offen
  s_add_u32 s20, s38, 16384
  buffer_load_dword v34, v11, s[8:11], s20 offen
  s_add_u32 s20, s38, 24576
  buffer_load_dword v35, v11, s[8:11], s20 offen
  s_add_u32 s20, s38, 65536
  buffer_load_dword v40, v10, s[8:11], s20 offen
  s_waitcnt vmcnt(0)
  v_mfma_f32_32x32x8_bf16 v[64:79], v[40:41], v[24:25], 0
  v_mfma_f32_32x32x16_bf16 v[64:79], v[32:35], v[16:19], v[64:79]
  v_mfma_f32_32x32x8_bf16 v[80:95], v[40:41], v[26:27], 0
  v_mfma_f32_32x32x16_bf16 v[80:95], v[32:35], v[20:23], v[80:95]
  s_nop 15
  s_nop 3
  v_max3_f32 v176, v64, v65, v176
  v_max3_f32 v176, v66, v67, v176
  v_max3_f32 v176, v68, v69, v176
  v_max3_f32 v176, v70, v71, v176
  v_max3_f32 v176, v72, v73, v176
  v_max3_f32 v176, v74, v75, v176
  v_max3_f32 v176, v76, v77, v176
  v_max3_f32 v176, v78, v79, v176
  v_max3_f32 v177, v80, v81, v177
  v_max3_f32 v177, v82, v83, v177
  v_max3_f32 v177, v84, v85, v177
  v_max3_f32 v177, v86, v87, v177
  v_max3_f32 v177, v88, v89, v177
  v_max3_f32 v177, v90, v91, v177
  v_max3_f32 v177, v92, v93, v177
  v_max3_f32 v177, v94, v95, v177
  s_add_u32 s39, s39, 1
  s_lshr_b32 s42, s39, 1
  s_lshl_b32 s42, s42, 8
  s_and_b32 s43, s39, 1
  s_lshl_b32 s43, s43, 3
  s_add_u32 s42, s42, s43
  s_add_u32 s38, s36, s42
  s_cmp_lt_u32 s39, 64
  s_cbranch_scc1 k2_slowA
  v_mov_b32 v178, v176
  s_nop 1
  v_permlane32_swap_b32 v178, v176
  s_nop 1
  v_max_f32 v176, v176, v178
  v_sub_f32 v144, 0, v176
  v_sub_f32 v145, 0, v176
  v_sub_f32 v146, 0, v176
  v_sub_f32 v147, 0, v176
  v_sub_f32 v148, 0, v176
  v_sub_f32 v149, 0, v176
  v_sub_f32 v150, 0, v176
  v_sub_f32 v151, 0, v176
  v_sub_f32 v152, 0, v176
  v_sub_f32 v153, 0, v176
  v_sub_f32 v154, 0, v176
  v_sub_f32 v155, 0, v176
  v_sub_f32 v156, 0, v176
  v_sub_f32 v157, 0, v176
  v_sub_f32 v158, 0, v176
  v_sub_f32 v159, 0, v176
  v_mov_b32 v112, 0
  v_mov_b32 v113, 0
  v_mov_b32 v114, 0
  v_mov_b32 v115, 0
  v_mov_b32 v116, 0
  v_mov_b32 v117, 0
  v_mov_b32 v118, 0
  v_mov_b32 v119, 0
  v_mov_b32 v120, 0
  v_mov_b32 v121, 0
  v_mov_b32 v122, 0
  v_mov_b32 v123, 0
  v_mov_b32 v124, 0
  v_mov_b32 v125, 0
  v_mov_b32 v126, 0
  v_mov_b32 v127, 0
  v_mov_b32 v178, v177
  s_nop 1
  v_permlane32_swap_b32 v178, v177
  s_nop 1
  v_max_f32 v177, v177, v178
  v_sub_f32 v160, 0, v177
  v_sub_f32 v161, 0, v177
  v_sub_f32 v162, 0, v177
  v_sub_f32 v163, 0, v177
  v_sub_f32 v164, 0, v177
  v_sub_f32 v165, 0, v177
  v_sub_f32 v166, 0, v177
  v_sub_f32 v167, 0, v177
  v_sub_f32 v168, 0, v177
  v_sub_f32 v169, 0, v177
  v_sub_f32 v170, 0, v177
  v_sub_f32 v171, 0, v177
  v_sub_f32 v172, 0, v177
  v_sub_f32 v173, 0, v177
  v_sub_f32 v174, 0, v177
  v_sub_f32 v175, 0, v177
  v_mov_b32 v128, 0
  v_mov_b32 v129, 0
  v_mov_b32 v130, 0
  v_mov_b32 v131, 0
  v_mov_b32 v132, 0
  v_mov_b32 v133, 0
  v_mov_b32 v134, 0
  v_mov_b32 v135, 0
  v_mov_b32 v136, 0
  v_mov_b32 v137, 0
  v_mov_b32 v138, 0
  v_mov_b32 v139, 0
  v_mov_b32 v140, 0
  v_mov_b32 v141, 0
  v_mov_b32 v142, 0
  v_mov_b32 v143, 0
  v_and_b32 v2, 31, v1
  v_mov_b32 v178, 0x3f803f80
  v_cmp_eq_u32 vcc, 18, v2
  s_nop 1
  v_cndmask_b32 v48, 0, v178, vcc
  v_cndmask_b32 v49, 0, v178, vcc
  v_cndmask_b32 v50, 0, v178, vcc
  v_cndmask_b32 v51, 0, v178, vcc
  v_cndmask_b32 v52, 0, v178, vcc
  v_cndmask_b32 v53, 0, v178, vcc
  v_cndmask_b32 v54, 0, v178, vcc
  v_cndmask_b32 v55, 0, v178, vcc
  v_mul_u32_u24 v3, 18, v3
  v_add_u32 v3, v3, v2
  v_lshlrev_b32 v179, 4, v3
  v_cmp_gt_u32 vcc, 18, v2
  s_nop 1
  s_mov_b64 s[40:41], vcc
  s_mov_b32 s38, s36
  s_mov_b32 s39, 0
k2_slowB:
  s_add_u32 s20, s38, 0
  buffer_load_dword v32, v11, s[8:11], s20 offen
  s_add_u32 s20, s38, 8192
  buffer_load_dword v33, v11, s[8:11], s20 offen
  s_add_u32 s20, s38, 16384
  buffer_load_dword v34, v11, s[8:11], s20 offen
  s_add_u32 s20, s38, 24576
  buffer_load_dword v35, v11, s[8:11], s20 offen
  s_add_u32 s20, s38, 65536
  buffer_load_dword v40, v10, s[8:11], s20 offen
  s_mov_b64 exec, s[40:41]
  buffer_load_dwordx4 v[48:51], v179, s[8:11], s37 offen
  buffer_load_dwordx4 v[52:55], v179, s[8:11], s37 offen offset:576
  s_mov_b64 exec, -1
  s_waitcnt vmcnt(0)
  v_mfma_f32_32x32x8_bf16 v[64:79], v[40:41], v[24:25], v[144:159]
  v_mfma_f32_32x32x16_bf16 v[64:79], v[32:35], v[16:19], v[64:79]
  v_mfma_f32_32x32x8_bf16 v[80:95], v[40:41], v[26:27], v[160:175]
  v_mfma_f32_32x32x16_bf16 v[80:95], v[32:35], v[20:23], v[80:95]
  s_nop 15
  s_nop 3
  v_exp_f32 v64, v64
  v_exp_f32 v65, v65
  v_exp_f32 v66, v66
  v_exp_f32 v67, v67
  v_exp_f32 v68, v68
  v_exp_f32 v69, v69
  v_exp_f32 v70, v70
  v_exp_f32 v71, v71
  v_exp_f32 v72, v72
  v_exp_f32 v73, v73
  v_exp_f32 v74, v74
  v_exp_f32 v75, v75
  v_exp_f32 v76, v76
  v_exp_f32 v77, v77
  v_exp_f32 v78, v78
  v_exp_f32 v79, v79
  s_nop 0
  v_cvt_pk_bf16_f32 v96, v64, v65
  v_cvt_pk_bf16_f32 v97, v66, v67
  v_cvt_pk_bf16_f32 v98, v68, v69
  v_cvt_pk_bf16_f32 v99, v70, v71
  v_cvt_pk_bf16_f32 v100, v72, v73
  v_cvt_pk_bf16_f32 v101, v74, v75
  v_cvt_pk_bf16_f32 v102, v76, v77
  v_cvt_pk_bf16_f32 v103, v78, v79
  v_exp_f32 v80, v80
  v_exp_f32 v81, v81
  v_exp_f32 v82, v82
  v_exp_f32 v83, v83
  v_exp_f32 v84, v84
  v_exp_f32 v85, v85
  v_exp_f32 v86, v86
  v_exp_f32 v87, v87
  v_exp_f32 v88, v88
  v_exp_f32 v89, v89
  v_exp_f32 v90, v90
  v_exp_f32 v91, v91
  v_exp_f32 v92, v92
  v_exp_f32 v93, v93
  v_exp_f32 v94, v94
  v_exp_f32 v95, v95
  s_nop 0
  v_cvt_pk_bf16_f32 v104, v80, v81
  v_cvt_pk_bf16_f32 v105, v82, v83
  v_cvt_pk_bf16_f32 v106, v84, v85
  v_cvt_pk_bf16_f32 v107, v86, v87
  v_cvt_pk_bf16_f32 v108, v88, v89
  v_cvt_pk_bf16_f32 v109, v90, v91
  v_cvt_pk_bf16_f32 v110, v92, v93
  v_cvt_pk_bf16_f32 v111, v94, v95
  s_nop 1
  v_mfma_f32_32x32x16_bf16 v[112:127], v[48:51], v[96:99], v[112:127]
  v_mfma_f32_32x32x16_bf16 v[112:127], v[52:55], v[100:103], v[112:127]
  v_mfma_f32_32x32x16_bf16 v[128:143], v[48:51], v[104:107], v[128:143]
  v_mfma_f32_32x32x16_bf16 v[128:143], v[52:55], v[108:111], v[128:143]
  s_add_u32 s37, s37, 1152
  s_add_u32 s39, s39, 1
  s_lshr_b32 s42, s39, 1
  s_lshl_b32 s42, s42, 8
  s_and_b32 s43, s39, 1
  s_lshl_b32 s43, s43, 3
  s_add_u32 s42, s42, s43
  s_add_u32 s38, s36, s42
  s_cmp_lt_u32 s39, 64
  s_cbranch_scc1 k2_slowB
  s_nop 15
  s_nop 3
  s_branch k2_afin
k2_gemm:
  s_sub_u32 s16, s16, 4
  s_lshl_b32 s19, s17, 2
  s_and_b32 s20, s18, 3
  s_add_u32 s44, s19, s20
  v_and_b32 v17, 3, v1
  v_lshrrev_b32 v18, 2, v1
  v_lshlrev_b32 v18, 4, v18
  v_lshl_add_u32 v11, v17, 13, v18
  v_lshrrev_b32 v19, 1, v17
  v_lshl_add_u32 v18, v19, 8, v18
  v_and_b32 v17, 1, v17
  v_lshl_add_u32 v16, v17, 3, v18
  v_and_b32 v17, 31, v1
  v_lshrrev_b32 v18, 5, v1
  v_mul_u32_u24 v18, 18, v18
  v_add_u32 v18, v18, v17
  v_lshlrev_b32 v12, 4, v18
  v_cmp_gt_u32 vcc, 18, v17
  s_mul_i32 s30, s44, 73728
  s_add_u32 s30, s30, 4718592
  s_and_b32 s19, s16, 1
  s_lshl_b32 s20, s19, 2
  s_add_u32 s31, s30, s20
  s_add_u32 s31, s31, 65536
  s_lshr_b32 s20, s16, 1
  s_lshl_b32 s20, s20, 8
  s_add_u32 s30, s30, s20
  s_lshl_b32 s20, s19, 3
  s_add_u32 s30, s30, s20
  s_mov_b64 s[38:39], vcc
  s_lshl_b32 s32, s44, 7
  s_lshl_b32 s20, s16, 1
  s_add_u32 s32, s32, s20
  s_mul_i32 s32, s32, 576
  s_add_u32 s32, s32, 7077888
  s_lshl_b32 s47, s16, 10
  s_add_u32 s42, s47, 4608
  s_lshl_b32 s19, s19, 8
  s_add_u32 s43, s19, 4096
  s_sub_u32 s43, s43, s47
  s_mov_b32 s48, 0
  s_mov_b32 s49, 0
  s_mov_b32 s35, 0
  s_add_u32 s34, s49, s47
  s_add_u32 s34, s34, 110592
  s_add_u32 m0, s34, 0
  s_add_u32 s37, s30, 0
  buffer_load_dword v11, s[8:11], s37 offen lds
  s_add_u32 m0, s34, 256
  s_add_u32 s37, s30, 4
  buffer_load_dword v11, s[8:11], s37 offen lds
  s_add_u32 m0, s34, 512
  s_add_u32 s37, s30, 32768
  buffer_load_dword v11, s[8:11], s37 offen lds
  s_add_u32 m0, s34, 768
  s_add_u32 s37, s30, 32772
  buffer_load_dword v11, s[8:11], s37 offen lds
  s_add_u32 m0, s34, s43
  s_nop 0
  buffer_load_dword v16, s[8:11], s31 offen lds
  s_add_u32 m0, s34, s42
  s_mov_b64 exec, s[38:39]
  buffer_load_dwordx4 v12, s[8:11], s32 offen lds
  s_add_u32 m0, m0, 1024
  s_add_u32 s37, s32, 576
  buffer_load_dwordx4 v12, s[8:11], s37 offen lds
  s_mov_b64 exec, -1
  s_add_u32 s30, s30, 512
  s_add_u32 s31, s31, 512
  s_add_u32 s32, s32, 4608
  s_add_u32 s49, s49, 12800
  s_cmp_eq_u32 s49, 51200
  s_cselect_b32 s49, 0, s49
  s_and_b32 s24, s16, 1
  s_lshr_b32 s25, s16, 1
  s_lshr_b32 s26, s17, 1
  s_and_b32 s27, s17, 1
  v_lshlrev_b32 v15, 4, v1
  s_lshl_b32 s29, s18, 1
  s_add_u32 s29, s29, s24
  s_mov_b32 s46, s29
  s_mul_i32 s29, s29, 288
  s_mul_i32 s19, s26, 72
  s_add_u32 s29, s29, s19
  s_mul_i32 s19, s25, 36
  s_add_u32 s29, s29, s19
  s_lshl_b32 s29, s29, 10
  s_add_u32 s29, s29, 12582912
  buffer_load_dwordx4 v[224:227], v15, s[8:11], s29 offen
  buffer_load_dwordx4 v[228:231], v15, s[8:11], s29 offen offset:1024
  s_add_u32 s29, s29, 2048
  v_add_u32 v17, 0, v1
  v_mul_u32_u24 v18, 1821, v17
  v_lshrrev_b32 v18, 16, v18
  v_mul_u32_u24 v19, 36, v18
  v_sub_u32 v17, v17, v19
  v_mul_u32_u24 v18, 1152, v18
  v_lshl_add_u32 v2, v17, 4, v18
  v_add_u32 v17, 64, v1
  v_mul_u32_u24 v18, 1821, v17
  v_lshrrev_b32 v18, 16, v18
  v_mul_u32_u24 v19, 36, v18
  v_sub_u32 v17, v17, v19
  v_mul_u32_u24 v18, 1152, v18
  v_lshl_add_u32 v3, v17, 4, v18
  v_subrev_u32 v3, 1024, v3
  v_add_u32 v17, 128, v1
  v_mul_u32_u24 v18, 1821, v17
  v_lshrrev_b32 v18, 16, v18
  v_mul_u32_u24 v19, 36, v18
  v_sub_u32 v17, v17, v19
  v_mul_u32_u24 v18, 1152, v18
  v_lshl_add_u32 v4, v17, 4, v18
  v_subrev_u32 v4, 2048, v4
  v_add_u32 v17, 192, v1
  v_mul_u32_u24 v18, 1821, v17
  v_lshrrev_b32 v18, 16, v18
  v_mul_u32_u24 v19, 36, v18
  v_sub_u32 v17, v17, v19
  v_mul_u32_u24 v18, 1152, v18
  v_lshl_add_u32 v5, v17, 4, v18
  v_subrev_u32 v5, 3072, v5
  v_add_u32 v17, 256, v1
  v_mul_u32_u24 v18, 1821, v17
  v_lshrrev_b32 v18, 16, v18
  v_mul_u32_u24 v19, 36, v18
  v_sub_u32 v17, v17, v19
  v_mul_u32_u24 v18, 1152, v18
  v_lshl_add_u32 v6, v17, 4, v18
  v_add_u32 v17, 320, v1
  v_mul_u32_u24 v18, 1821, v17
  v_lshrrev_b32 v18, 16, v18
  v_mul_u32_u24 v19, 36, v18
  v_sub_u32 v17, v17, v19
  v_mul_u32_u24 v18, 1152, v18
  v_lshl_add_u32 v7, v17, 4, v18
  v_subrev_u32 v7, 1024, v7
  v_add_u32 v17, 384, v1
  v_mul_u32_u24 v18, 1821, v17
  v_lshrrev_b32 v18, 16, v18
  v_mul_u32_u24 v19, 36, v18
  v_sub_u32 v17, v17, v19
  v_mul_u32_u24 v18, 1152, v18
  v_lshl_add_u32 v8, v17, 4, v18
  v_subrev_u32 v8, 2048, v8
  v_add_u32 v17, 448, v1
  v_mul_u32_u24 v18, 1821, v17
  v_lshrrev_b32 v18, 16, v18
  v_mul_u32_u24 v19, 36, v18
  v_sub_u32 v17, v17, v19
  v_mul_u32_u24 v18, 1152, v18
  v_lshl_add_u32 v9, v17, 4, v18
  v_subrev_u32 v9, 3072, v9
  v_add_u32 v17, 512, v1
  v_mul_u32_u24 v18, 1821, v17
  v_lshrrev_b32 v18, 16, v18
  v_mul_u32_u24 v19, 36, v18
  v_sub_u32 v17, v17, v19
  v_mul_u32_u24 v18, 1152, v18
  v_lshl_add_u32 v10, v17, 4, v18
  s_mul_i32 s28, s26, 1152
  s_mul_i32 s19, s25, 576
  s_add_u32 s28, s28, s19
  s_lshl_b32 s19, s24, 4
  s_add_u32 s28, s28, s19
  s_mul_i32 s28, s28, 1152
  s_mul_i32 s19, s27, 576
  s_add_u32 s28, s28, s19
  s_mul_i32 s45, s25, 18432
  s_mul_i32 s19, s24, 9216
  s_add_u32 s45, s45, s19
  s_add_u32 m0, s48, s45
  s_nop 0
  buffer_load_dwordx4 v2, s[12:15], s28 offen offset:0 lds
  buffer_load_dwordx4 v3, s[12:15], s28 offen offset:1024 lds
  buffer_load_dwordx4 v4, s[12:15], s28 offen offset:2048 lds
  buffer_load_dwordx4 v5, s[12:15], s28 offen offset:3072 lds
  s_add_u32 m0, m0, 4096
  s_nop 0
  buffer_load_dwordx4 v6, s[12:15], s28 offen offset:0 lds
  buffer_load_dwordx4 v7, s[12:15], s28 offen offset:1024 lds
  buffer_load_dwordx4 v8, s[12:15], s28 offen offset:2048 lds
  buffer_load_dwordx4 v9, s[12:15], s28 offen offset:3072 lds
  s_add_u32 m0, m0, 4096
  s_nop 0
  buffer_load_dwordx4 v10, s[12:15], s28 offen offset:0 lds
  s_add_u32 s28, s28, 36864
  s_add_u32 s48, s48, 36864
  s_cmp_eq_u32 s48, 110592
  s_cselect_b32 s48, 0, s48
  s_add_u32 s34, s49, s47
  s_add_u32 s34, s34, 110592
  s_add_u32 m0, s34, 0
  s_add_u32 s37, s30, 0
  buffer_load_dword v11, s[8:11], s37 offen lds
  s_add_u32 m0, s34, 256
  s_add_u32 s37, s30, 4
  buffer_load_dword v11, s[8:11], s37 offen lds
  s_add_u32 m0, s34, 512
  s_add_u32 s37, s30, 32768
  buffer_load_dword v11, s[8:11], s37 offen lds
  s_add_u32 m0, s34, 768
  s_add_u32 s37, s30, 32772
  buffer_load_dword v11, s[8:11], s37 offen lds
  s_add_u32 m0, s34, s43
  s_nop 0
  buffer_load_dword v16, s[8:11], s31 offen lds
  s_add_u32 m0, s34, s42
  s_mov_b64 exec, s[38:39]
  buffer_load_dwordx4 v12, s[8:11], s32 offen lds
  s_add_u32 m0, m0, 1024
  s_add_u32 s37, s32, 576
  buffer_load_dwordx4 v12, s[8:11], s37 offen lds
  s_mov_b64 exec, -1
  s_add_u32 s30, s30, 512
  s_add_u32 s31, s31, 512
  s_add_u32 s32, s32, 4608
  s_add_u32 s49, s49, 12800
  s_cmp_eq_u32 s49, 51200
  s_cselect_b32 s49, 0, s49
  buffer_load_dwordx4 v[232:235], v15, s[8:11], s29 offen
  buffer_load_dwordx4 v[236:239], v15, s[8:11], s29 offen offset:1024
  s_add_u32 s29, s29, 2048
  s_add_u32 m0, s48, s45
  s_nop 0
  buffer_load_dwordx4 v2, s[12:15], s28 offen offset:0 lds
  buffer_load_dwordx4 v3, s[12:15], s28 offen offset:1024 lds
  buffer_load_dwordx4 v4, s[12:15], s28 offen offset:2048 lds
  buffer_load_dwordx4 v5, s[12:15], s28 offen offset:3072 lds
  s_add_u32 m0, m0, 4096
  s_nop 0
  buffer_load_dwordx4 v6, s[12:15], s28 offen offset:0 lds
  buffer_load_dwordx4 v7, s[12:15], s28 offen offset:1024 lds
  buffer_load_dwordx4 v8, s[12:15], s28 offen offset:2048 lds
  buffer_load_dwordx4 v9, s[12:15], s28 offen offset:3072 lds
  s_add_u32 m0, m0, 4096
  s_nop 0
  buffer_load_dwordx4 v10, s[12:15], s28 offen offset:0 lds
  s_add_u32 s28, s28, 36864
  s_add_u32 s48, s48, 36864
  s_cmp_eq_u32 s48, 110592
  s_cselect_b32 s48, 0, s48
  v_and_b32 v17, 15, v1
  v_lshrrev_b32 v18, 2, v17
  v_and_b32 v17, 3, v17
  v_lshlrev_b32 v17, 3, v17
  v_lshrrev_b32 v19, 5, v1
  v_lshl_add_u32 v18, v19, 2, v18
  v_mul_u32_u24 v18, 576, v18
  v_bfe_u32 v19, v1, 4, 1
  v_lshl_add_u32 v17, v19, 5, v17
  v_add_u32 v13, v18, v17
  s_mul_i32 s19, s25, 18432
  v_add_u32 v13, s19, v13
  s_waitcnt vmcnt(18)
  s_barrier
  v_add_u32 v14, s35, v13
  ds_read_b64_tr_b16 v[208:209], v14 offset:0
  ds_read_b64_tr_b16 v[210:211], v14 offset:4608
  ds_read_b64_tr_b16 v[212:213], v14 offset:64
  ds_read_b64_tr_b16 v[214:215], v14 offset:4672
  ds_read_b64_tr_b16 v[216:217], v14 offset:128
  ds_read_b64_tr_b16 v[218:219], v14 offset:4736
  s_waitcnt lgkmcnt(4)
  v_mfma_f32_32x32x16_bf16 v[64:79], v[208:211], v[224:227], 0
  ds_read_b64_tr_b16 v[220:221], v14 offset:192
  ds_read_b64_tr_b16 v[222:223], v14 offset:4800
  s_add_u32 s34, s49, s47
  s_add_u32 s34, s34, 110592
  s_add_u32 m0, s34, 0
  s_add_u32 s37, s30, 0
  buffer_load_dword v11, s[8:11], s37 offen lds
  s_waitcnt lgkmcnt(4)
  v_mfma_f32_32x32x16_bf16 v[80:95], v[212:215], v[224:227], 0
  ds_read_b64_tr_b16 v[208:209], v14 offset:256
  ds_read_b64_tr_b16 v[210:211], v14 offset:4864
  s_add_u32 m0, s34, 256
  s_add_u32 s37, s30, 4
  buffer_load_dword v11, s[8:11], s37 offen lds
  s_add_u32 m0, s34, 512
  s_add_u32 s37, s30, 32768
  buffer_load_dword v11, s[8:11], s37 offen lds
  s_waitcnt lgkmcnt(4)
  v_mfma_f32_32x32x16_bf16 v[96:111], v[216:219], v[224:227], 0
  ds_read_b64_tr_b16 v[212:213], v14 offset:320
  ds_read_b64_tr_b16 v[214:215], v14 offset:4928
  s_add_u32 m0, s34, 768
  s_add_u32 s37, s30, 32772
  buffer_load_dword v11, s[8:11], s37 offen lds
  s_add_u32 m0, s34, s43
  s_nop 0
  buffer_load_dword v16, s[8:11], s31 offen lds
  s_waitcnt lgkmcnt(4)
  v_mfma_f32_32x32x16_bf16 v[112:127], v[220:223], v[224:227], 0
  ds_read_b64_tr_b16 v[216:217], v14 offset:384
  ds_read_b64_tr_b16 v[218:219], v14 offset:4992
  s_add_u32 m0, s34, s42
  s_mov_b64 exec, s[38:39]
  buffer_load_dwordx4 v12, s[8:11], s32 offen lds
  s_add_u32 m0, m0, 1024
  s_add_u32 s37, s32, 576
  buffer_load_dwordx4 v12, s[8:11], s37 offen lds
  s_mov_b64 exec, -1
  s_add_u32 s30, s30, 512
  s_add_u32 s31, s31, 512
  s_add_u32 s32, s32, 4608
  s_add_u32 s49, s49, 12800
  s_cmp_eq_u32 s49, 51200
  s_cselect_b32 s49, 0, s49
  s_waitcnt lgkmcnt(4)
  v_mfma_f32_32x32x16_bf16 v[128:143], v[208:211], v[224:227], 0
  ds_read_b64_tr_b16 v[220:221], v14 offset:448
  ds_read_b64_tr_b16 v[222:223], v14 offset:5056
  buffer_load_dwordx4 v[240:243], v15, s[8:11], s29 offen
  buffer_load_dwordx4 v[244:247], v15, s[8:11], s29 offen offset:1024
  s_add_u32 s29, s29, 2048
  s_add_u32 m0, s48, s45
  s_waitcnt lgkmcnt(4)
  v_mfma_f32_32x32x16_bf16 v[144:159], v[212:215], v[224:227], 0
  ds_read_b64_tr_b16 v[208:209], v14 offset:512
  ds_read_b64_tr_b16 v[210:211], v14 offset:5120
  s_nop 0
  buffer_load_dwordx4 v2, s[12:15], s28 offen offset:0 lds
  buffer_load_dwordx4 v3, s[12:15], s28 offen offset:1024 lds
  s_waitcnt lgkmcnt(4)
  v_mfma_f32_32x32x16_bf16 v[160:175], v[216:219], v[224:227], 0
  ds_read_b64_tr_b16 v[212:213], v14 offset:9216
  ds_read_b64_tr_b16 v[214:215], v14 offset:13824
  buffer_load_dwordx4 v4, s[12:15], s28 offen offset:2048 lds
  buffer_load_dwordx4 v5, s[12:15], s28 offen offset:3072 lds
  s_waitcnt lgkmcnt(4)
  v_mfma_f32_32x32x16_bf16 v[176:191], v[220:223], v[224:227], 0
  ds_read_b64_tr_b16 v[216:217], v14 offset:9280
  ds_read_b64_tr_b16 v[218:219], v14 offset:13888
  s_add_u32 m0, m0, 4096
  s_nop 0
  buffer_load_dwordx4 v6, s[12:15], s28 offen offset:0 lds
  buffer_load_dwordx4 v7, s[12:15], s28 offen offset:1024 lds
  s_waitcnt lgkmcnt(4)
  v_mfma_f32_32x32x16_bf16 v[192:207], v[208:211], v[224:227], 0
  ds_read_b64_tr_b16 v[220:221], v14 offset:9344
  ds_read_b64_tr_b16 v[222:223], v14 offset:13952
  buffer_load_dwordx4 v8, s[12:15], s28 offen offset:2048 lds
  buffer_load_dwordx4 v9, s[12:15], s28 offen offset:3072 lds
  s_waitcnt lgkmcnt(4)
  v_mfma_f32_32x32x16_bf16 v[64:79], v[212:215], v[228:231], v[64:79]
  ds_read_b64_tr_b16 v[208:209], v14 offset:9408
  ds_read_b64_tr_b16 v[210:211], v14 offset:14016
  s_add_u32 m0, m0, 4096
  s_nop 0
  buffer_load_dwordx4 v10, s[12:15], s28 offen offset:0 lds
  s_add_u32 s28, s28, 36864
  s_add_u32 s48, s48, 36864
  s_cmp_eq_u32 s48, 110592
  s_cselect_b32 s48, 0, s48
  s_waitcnt lgkmcnt(4)
  v_mfma_f32_32x32x16_bf16 v[80:95], v[216:219], v[228:231], v[80:95]
  ds_read_b64_tr_b16 v[212:213], v14 offset:9472
  ds_read_b64_tr_b16 v[214:215], v14 offset:14080
  s_waitcnt lgkmcnt(4)
  v_mfma_f32_32x32x16_bf16 v[96:111], v[220:223], v[228:231], v[96:111]
  ds_read_b64_tr_b16 v[216:217], v14 offset:9536
  ds_read_b64_tr_b16 v[218:219], v14 offset:14144
  s_waitcnt lgkmcnt(4)
  v_mfma_f32_32x32x16_bf16 v[112:127], v[208:211], v[228:231], v[112:127]
  ds_read_b64_tr_b16 v[220:221], v14 offset:9600
  ds_read_b64_tr_b16 v[222:223], v14 offset:14208
  s_waitcnt lgkmcnt(4)
  v_mfma_f32_32x32x16_bf16 v[128:143], v[212:215], v[228:231], v[128:143]
  ds_read_b64_tr_b16 v[208:209], v14 offset:9664
  ds_read_b64_tr_b16 v[210:211], v14 offset:14272
  s_waitcnt lgkmcnt(4)
  v_mfma_f32_32x32x16_bf16 v[144:159], v[216:219], v[228:231], v[144:159]
  ds_read_b64_tr_b16 v[212:213], v14 offset:9728
  ds_read_b64_tr_b16 v[214:215], v14 offset:14336
  s_waitcnt lgkmcnt(4)
  v_mfma_f32_32x32x16_bf16 v[160:175], v[220:223], v[228:231], v[160:175]
  s_waitcnt lgkmcnt(2)
  v_mfma_f32_32x32x16_bf16 v[176:191], v[208:211], v[228:231], v[176:191]
  s_waitcnt lgkmcnt(0)
  v_mfma_f32_32x32x16_bf16 v[192:207], v[212:215], v[228:231], v[192:207]
  s_add_u32 s35, s35, 36864
  s_cmp_eq_u32 s35, 110592
  s_cselect_b32 s35, 0, s35
  s_waitcnt vmcnt(18)
  s_barrier
  s_mov_b32 s36, 0
k2_gloop:
  v_add_u32 v14, s35, v13
  ds_read_b64_tr_b16 v[208:209], v14 offset:0
  ds_read_b64_tr_b16 v[210:211], v14 offset:4608
  ds_read_b64_tr_b16 v[212:213], v14 offset:64
  ds_read_b64_tr_b16 v[214:215], v14 offset:4672
  ds_read_b64_tr_b16 v[216:217], v14 offset:128
  ds_read_b64_tr_b16 v[218:219], v14 offset:4736
  s_waitcnt lgkmcnt(4)
  v_mfma_f32_32x32x16_bf16 v[64:79], v[208:211], v[232:235], v[64:79]
  ds_read_b64_tr_b16 v[220:221], v14 offset:192
  ds_read_b64_tr_b16 v[222:223], v14 offset:4800
  s_add_u32 s34, s49, s47
  s_add_u32 s34, s34, 110592
  s_add_u32 m0, s34, 0
  s_add_u32 s37, s30, 0
  buffer_load_dword v11, s[8:11], s37 offen lds
  s_waitcnt lgkmcnt(4)
  v_mfma_f32_32x32x16_bf16 v[80:95], v[212:215], v[232:235], v[80:95]
  ds_read_b64_tr_b16 v[208:209], v14 offset:256
  ds_read_b64_tr_b16 v[210:211], v14 offset:4864
  s_add_u32 m0, s34, 256
  s_add_u32 s37, s30, 4
  buffer_load_dword v11, s[8:11], s37 offen lds
  s_add_u32 m0, s34, 512
  s_add_u32 s37, s30, 32768
  buffer_load_dword v11, s[8:11], s37 offen lds
  s_waitcnt lgkmcnt(4)
  v_mfma_f32_32x32x16_bf16 v[96:111], v[216:219], v[232:235], v[96:111]
  ds_read_b64_tr_b16 v[212:213], v14 offset:320
  ds_read_b64_tr_b16 v[214:215], v14 offset:4928
  s_add_u32 m0, s34, 768
  s_add_u32 s37, s30, 32772
  buffer_load_dword v11, s[8:11], s37 offen lds
  s_add_u32 m0, s34, s43
  s_nop 0
  buffer_load_dword v16, s[8:11], s31 offen lds
  s_waitcnt lgkmcnt(4)
  v_mfma_f32_32x32x16_bf16 v[112:127], v[220:223], v[232:235], v[112:127]
  ds_read_b64_tr_b16 v[216:217], v14 offset:384
  ds_read_b64_tr_b16 v[218:219], v14 offset:4992
  s_add_u32 m0, s34, s42
  s_mov_b64 exec, s[38:39]
  buffer_load_dwordx4 v12, s[8:11], s32 offen lds
  s_add_u32 m0, m0, 1024
  s_add_u32 s37, s32, 576
  buffer_load_dwordx4 v12, s[8:11], s37 offen lds
  s_mov_b64 exec, -1
  s_add_u32 s30, s30, 512
  s_add_u32 s31, s31, 512
  s_add_u32 s32, s32, 4608
  s_add_u32 s49, s49, 12800
  s_cmp_eq_u32 s49, 51200
  s_cselect_b32 s49, 0, s49
  s_waitcnt lgkmcnt(4)
  v_mfma_f32_32x32x16_bf16 v[128:143], v[208:211], v[232:235], v[128:143]
  ds_read_b64_tr_b16 v[220:221], v14 offset:448
  ds_read_b64_tr_b16 v[222:223], v14 offset:5056
  buffer_load_dwordx4 v[224:227], v15, s[8:11], s29 offen
  buffer_load_dwordx4 v[228:231], v15, s[8:11], s29 offen offset:1024
  s_add_u32 s29, s29, 2048
  s_add_u32 m0, s48, s45
  s_waitcnt lgkmcnt(4)
  v_mfma_f32_32x32x16_bf16 v[144:159], v[212:215], v[232:235], v[144:159]
  ds_read_b64_tr_b16 v[208:209], v14 offset:512
  ds_read_b64_tr_b16 v[210:211], v14 offset:5120
  s_nop 0
  buffer_load_dwordx4 v2, s[12:15], s28 offen offset:0 lds
  buffer_load_dwordx4 v3, s[12:15], s28 offen offset:1024 lds
  s_waitcnt lgkmcnt(4)
  v_mfma_f32_32x32x16_bf16 v[160:175], v[216:219], v[232:235], v[160:175]
  ds_read_b64_tr_b16 v[212:213], v14 offset:9216
  ds_read_b64_tr_b16 v[214:215], v14 offset:13824
  buffer_load_dwordx4 v4, s[12:15], s28 offen offset:2048 lds
  buffer_load_dwordx4 v5, s[12:15], s28 offen offset:3072 lds
  s_waitcnt lgkmcnt(4)
  v_mfma_f32_32x32x16_bf16 v[176:191], v[220:223], v[232:235], v[176:191]
  ds_read_b64_tr_b16 v[216:217], v14 offset:9280
  ds_read_b64_tr_b16 v[218:219], v14 offset:13888
  s_add_u32 m0, m0, 4096
  s_nop 0
  buffer_load_dwordx4 v6, s[12:15], s28 offen offset:0 lds
  buffer_load_dwordx4 v7, s[12:15], s28 offen offset:1024 lds
  s_waitcnt lgkmcnt(4)
  v_mfma_f32_32x32x16_bf16 v[192:207], v[208:211], v[232:235], v[192:207]
  ds_read_b64_tr_b16 v[220:221], v14 offset:9344
  ds_read_b64_tr_b16 v[222:223], v14 offset:13952
  buffer_load_dwordx4 v8, s[12:15], s28 offen offset:2048 lds
  buffer_load_dwordx4 v9, s[12:15], s28 offen offset:3072 lds
  s_waitcnt lgkmcnt(4)
  v_mfma_f32_32x32x16_bf16 v[64:79], v[212:215], v[236:239], v[64:79]
  ds_read_b64_tr_b16 v[208:209], v14 offset:9408
  ds_read_b64_tr_b16 v[210:211], v14 offset:14016
  s_add_u32 m0, m0, 4096
  s_nop 0
  buffer_load_dwordx4 v10, s[12:15], s28 offen offset:0 lds
  s_add_u32 s28, s28, 36864
  s_add_u32 s48, s48, 36864
  s_cmp_eq_u32 s48, 110592
  s_cselect_b32 s48, 0, s48
  s_waitcnt lgkmcnt(4)
  v_mfma_f32_32x32x16_bf16 v[80:95], v[216:219], v[236:239], v[80:95]
  ds_read_b64_tr_b16 v[212:213], v14 offset:9472
  ds_read_b64_tr_b16 v[214:215], v14 offset:14080
  s_waitcnt lgkmcnt(4)
  v_mfma_f32_32x32x16_bf16 v[96:111], v[220:223], v[236:239], v[96:111]
  ds_read_b64_tr_b16 v[216:217], v14 offset:9536
  ds_read_b64_tr_b16 v[218:219], v14 offset:14144
  s_waitcnt lgkmcnt(4)
  v_mfma_f32_32x32x16_bf16 v[112:127], v[208:211], v[236:239], v[112:127]
  ds_read_b64_tr_b16 v[220:221], v14 offset:9600
  ds_read_b64_tr_b16 v[222:223], v14 offset:14208
  s_waitcnt lgkmcnt(4)
  v_mfma_f32_32x32x16_bf16 v[128:143], v[212:215], v[236:239], v[128:143]
  ds_read_b64_tr_b16 v[208:209], v14 offset:9664
  ds_read_b64_tr_b16 v[210:211], v14 offset:14272
  s_waitcnt lgkmcnt(4)
  v_mfma_f32_32x32x16_bf16 v[144:159], v[216:219], v[236:239], v[144:159]
  ds_read_b64_tr_b16 v[212:213], v14 offset:9728
  ds_read_b64_tr_b16 v[214:215], v14 offset:14336
  s_waitcnt lgkmcnt(4)
  v_mfma_f32_32x32x16_bf16 v[160:175], v[220:223], v[236:239], v[160:175]
  s_waitcnt lgkmcnt(2)
  v_mfma_f32_32x32x16_bf16 v[176:191], v[208:211], v[236:239], v[176:191]
  s_waitcnt lgkmcnt(0)
  v_mfma_f32_32x32x16_bf16 v[192:207], v[212:215], v[236:239], v[192:207]
  s_add_u32 s35, s35, 36864
  s_cmp_eq_u32 s35, 110592
  s_cselect_b32 s35, 0, s35
  s_waitcnt vmcnt(18)
  s_barrier
  v_add_u32 v14, s35, v13
  ds_read_b64_tr_b16 v[208:209], v14 offset:0
  ds_read_b64_tr_b16 v[210:211], v14 offset:4608
  ds_read_b64_tr_b16 v[212:213], v14 offset:64
  ds_read_b64_tr_b16 v[214:215], v14 offset:4672
  ds_read_b64_tr_b16 v[216:217], v14 offset:128
  ds_read_b64_tr_b16 v[218:219], v14 offset:4736
  s_waitcnt lgkmcnt(4)
  v_mfma_f32_32x32x16_bf16 v[64:79], v[208:211], v[240:243], v[64:79]
  ds_read_b64_tr_b16 v[220:221], v14 offset:192
  ds_read_b64_tr_b16 v[222:223], v14 offset:4800
  s_add_u32 s34, s49, s47
  s_add_u32 s34, s34, 110592
  s_add_u32 m0, s34, 0
  s_add_u32 s37, s30, 0
  buffer_load_dword v11, s[8:11], s37 offen lds
  s_waitcnt lgkmcnt(4)
  v_mfma_f32_32x32x16_bf16 v[80:95], v[212:215], v[240:243], v[80:95]
  ds_read_b64_tr_b16 v[208:209], v14 offset:256
  ds_read_b64_tr_b16 v[210:211], v14 offset:4864
  s_add_u32 m0, s34, 256
  s_add_u32 s37, s30, 4
  buffer_load_dword v11, s[8:11], s37 offen lds
  s_add_u32 m0, s34, 512
  s_add_u32 s37, s30, 32768
  buffer_load_dword v11, s[8:11], s37 offen lds
  s_waitcnt lgkmcnt(4)
  v_mfma_f32_32x32x16_bf16 v[96:111], v[216:219], v[240:243], v[96:111]
  ds_read_b64_tr_b16 v[212:213], v14 offset:320
  ds_read_b64_tr_b16 v[214:215], v14 offset:4928
  s_add_u32 m0, s34, 768
  s_add_u32 s37, s30, 32772
  buffer_load_dword v11, s[8:11], s37 offen lds
  s_add_u32 m0, s34, s43
  s_nop 0
  buffer_load_dword v16, s[8:11], s31 offen lds
  s_waitcnt lgkmcnt(4)
  v_mfma_f32_32x32x16_bf16 v[112:127], v[220:223], v[240:243], v[112:127]
  ds_read_b64_tr_b16 v[216:217], v14 offset:384
  ds_read_b64_tr_b16 v[218:219], v14 offset:4992
  s_add_u32 m0, s34, s42
  s_mov_b64 exec, s[38:39]
  buffer_load_dwordx4 v12, s[8:11], s32 offen lds
  s_add_u32 m0, m0, 1024
  s_add_u32 s37, s32, 576
  buffer_load_dwordx4 v12, s[8:11], s37 offen lds
  s_mov_b64 exec, -1
  s_add_u32 s30, s30, 512
  s_add_u32 s31, s31, 512
  s_add_u32 s32, s32, 4608
  s_add_u32 s49, s49, 12800
  s_cmp_eq_u32 s49, 51200
  s_cselect_b32 s49, 0, s49
  s_waitcnt lgkmcnt(4)
  v_mfma_f32_32x32x16_bf16 v[128:143], v[208:211], v[240:243], v[128:143]
  ds_read_b64_tr_b16 v[220:221], v14 offset:448
  ds_read_b64_tr_b16 v[222:223], v14 offset:5056
  buffer_load_dwordx4 v[232:235], v15, s[8:11], s29 offen
  buffer_load_dwordx4 v[236:239], v15, s[8:11], s29 offen offset:1024
  s_add_u32 s29, s29, 2048
  s_add_u32 m0, s48, s45
  s_waitcnt lgkmcnt(4)
  v_mfma_f32_32x32x16_bf16 v[144:159], v[212:215], v[240:243], v[144:159]
  ds_read_b64_tr_b16 v[208:209], v14 offset:512
  ds_read_b64_tr_b16 v[210:211], v14 offset:5120
  s_nop 0
  buffer_load_dwordx4 v2, s[12:15], s28 offen offset:0 lds
  buffer_load_dwordx4 v3, s[12:15], s28 offen offset:1024 lds
  s_waitcnt lgkmcnt(4)
  v_mfma_f32_32x32x16_bf16 v[160:175], v[216:219], v[240:243], v[160:175]
  ds_read_b64_tr_b16 v[212:213], v14 offset:9216
  ds_read_b64_tr_b16 v[214:215], v14 offset:13824
  buffer_load_dwordx4 v4, s[12:15], s28 offen offset:2048 lds
  buffer_load_dwordx4 v5, s[12:15], s28 offen offset:3072 lds
  s_waitcnt lgkmcnt(4)
  v_mfma_f32_32x32x16_bf16 v[176:191], v[220:223], v[240:243], v[176:191]
  ds_read_b64_tr_b16 v[216:217], v14 offset:9280
  ds_read_b64_tr_b16 v[218:219], v14 offset:13888
  s_add_u32 m0, m0, 4096
  s_nop 0
  buffer_load_dwordx4 v6, s[12:15], s28 offen offset:0 lds
  buffer_load_dwordx4 v7, s[12:15], s28 offen offset:1024 lds
  s_waitcnt lgkmcnt(4)
  v_mfma_f32_32x32x16_bf16 v[192:207], v[208:211], v[240:243], v[192:207]
  ds_read_b64_tr_b16 v[220:221], v14 offset:9344
  ds_read_b64_tr_b16 v[222:223], v14 offset:13952
  buffer_load_dwordx4 v8, s[12:15], s28 offen offset:2048 lds
  buffer_load_dwordx4 v9, s[12:15], s28 offen offset:3072 lds
  s_waitcnt lgkmcnt(4)
  v_mfma_f32_32x32x16_bf16 v[64:79], v[212:215], v[244:247], v[64:79]
  ds_read_b64_tr_b16 v[208:209], v14 offset:9408
  ds_read_b64_tr_b16 v[210:211], v14 offset:14016
  s_add_u32 m0, m0, 4096
  s_nop 0
  buffer_load_dwordx4 v10, s[12:15], s28 offen offset:0 lds
  s_add_u32 s28, s28, 36864
  s_add_u32 s48, s48, 36864
  s_cmp_eq_u32 s48, 110592
  s_cselect_b32 s48, 0, s48
  s_waitcnt lgkmcnt(4)
  v_mfma_f32_32x32x16_bf16 v[80:95], v[216:219], v[244:247], v[80:95]
  ds_read_b64_tr_b16 v[212:213], v14 offset:9472
  ds_read_b64_tr_b16 v[214:215], v14 offset:14080
  s_waitcnt lgkmcnt(4)
  v_mfma_f32_32x32x16_bf16 v[96:111], v[220:223], v[244:247], v[96:111]
  ds_read_b64_tr_b16 v[216:217], v14 offset:9536
  ds_read_b64_tr_b16 v[218:219], v14 offset:14144
  s_waitcnt lgkmcnt(4)
  v_mfma_f32_32x32x16_bf16 v[112:127], v[208:211], v[244:247], v[112:127]
  ds_read_b64_tr_b16 v[220:221], v14 offset:9600
  ds_read_b64_tr_b16 v[222:223], v14 offset:14208
  s_waitcnt lgkmcnt(4)
  v_mfma_f32_32x32x16_bf16 v[128:143], v[212:215], v[244:247], v[128:143]
  ds_read_b64_tr_b16 v[208:209], v14 offset:9664
  ds_read_b64_tr_b16 v[210:211], v14 offset:14272
  s_waitcnt lgkmcnt(4)
  v_mfma_f32_32x32x16_bf16 v[144:159], v[216:219], v[244:247], v[144:159]
  ds_read_b64_tr_b16 v[212:213], v14 offset:9728
  ds_read_b64_tr_b16 v[214:215], v14 offset:14336
  s_waitcnt lgkmcnt(4)
  v_mfma_f32_32x32x16_bf16 v[160:175], v[220:223], v[244:247], v[160:175]
  s_waitcnt lgkmcnt(2)
  v_mfma_f32_32x32x16_bf16 v[176:191], v[208:211], v[244:247], v[176:191]
  s_waitcnt lgkmcnt(0)
  v_mfma_f32_32x32x16_bf16 v[192:207], v[212:215], v[244:247], v[192:207]
  s_add_u32 s35, s35, 36864
  s_cmp_eq_u32 s35, 110592
  s_cselect_b32 s35, 0, s35
  s_waitcnt vmcnt(18)
  s_barrier
  v_add_u32 v14, s35, v13
  ds_read_b64_tr_b16 v[208:209], v14 offset:0
  ds_read_b64_tr_b16 v[210:211], v14 offset:4608
  ds_read_b64_tr_b16 v[212:213], v14 offset:64
  ds_read_b64_tr_b16 v[214:215], v14 offset:4672
  ds_read_b64_tr_b16 v[216:217], v14 offset:128
  ds_read_b64_tr_b16 v[218:219], v14 offset:4736
  s_waitcnt lgkmcnt(4)
  v_mfma_f32_32x32x16_bf16 v[64:79], v[208:211], v[224:227], v[64:79]
  ds_read_b64_tr_b16 v[220:221], v14 offset:192
  ds_read_b64_tr_b16 v[222:223], v14 offset:4800
  s_add_u32 s34, s49, s47
  s_add_u32 s34, s34, 110592
  s_add_u32 m0, s34, 0
  s_add_u32 s37, s30, 0
  buffer_load_dword v11, s[8:11], s37 offen lds
  s_waitcnt lgkmcnt(4)
  v_mfma_f32_32x32x16_bf16 v[80:95], v[212:215], v[224:227], v[80:95]
  ds_read_b64_tr_b16 v[208:209], v14 offset:256
  ds_read_b64_tr_b16 v[210:211], v14 offset:4864
  s_add_u32 m0, s34, 256
  s_add_u32 s37, s30, 4
  buffer_load_dword v11, s[8:11], s37 offen lds
  s_add_u32 m0, s34, 512
  s_add_u32 s37, s30, 32768
  buffer_load_dword v11, s[8:11], s37 offen lds
  s_waitcnt lgkmcnt(4)
  v_mfma_f32_32x32x16_bf16 v[96:111], v[216:219], v[224:227], v[96:111]
  ds_read_b64_tr_b16 v[212:213], v14 offset:320
  ds_read_b64_tr_b16 v[214:215], v14 offset:4928
  s_add_u32 m0, s34, 768
  s_add_u32 s37, s30, 32772
  buffer_load_dword v11, s[8:11], s37 offen lds
  s_add_u32 m0, s34, s43
  s_nop 0
  buffer_load_dword v16, s[8:11], s31 offen lds
  s_waitcnt lgkmcnt(4)
  v_mfma_f32_32x32x16_bf16 v[112:127], v[220:223], v[224:227], v[112:127]
  ds_read_b64_tr_b16 v[216:217], v14 offset:384
  ds_read_b64_tr_b16 v[218:219], v14 offset:4992
  s_add_u32 m0, s34, s42
  s_mov_b64 exec, s[38:39]
  buffer_load_dwordx4 v12, s[8:11], s32 offen lds
  s_add_u32 m0, m0, 1024
  s_add_u32 s37, s32, 576
  buffer_load_dwordx4 v12, s[8:11], s37 offen lds
  s_mov_b64 exec, -1
  s_add_u32 s30, s30, 512
  s_add_u32 s31, s31, 512
  s_add_u32 s32, s32, 4608
  s_add_u32 s49, s49, 12800
  s_cmp_eq_u32 s49, 51200
  s_cselect_b32 s49, 0, s49
  s_waitcnt lgkmcnt(4)
  v_mfma_f32_32x32x16_bf16 v[128:143], v[208:211], v[224:227], v[128:143]
  ds_read_b64_tr_b16 v[220:221], v14 offset:448
  ds_read_b64_tr_b16 v[222:223], v14 offset:5056
  buffer_load_dwordx4 v[240:243], v15, s[8:11], s29 offen
  buffer_load_dwordx4 v[244:247], v15, s[8:11], s29 offen offset:1024
  s_add_u32 s29, s29, 2048
  s_add_u32 m0, s48, s45
  s_waitcnt lgkmcnt(4)
  v_mfma_f32_32x32x16_bf16 v[144:159], v[212:215], v[224:227], v[144:159]
  ds_read_b64_tr_b16 v[208:209], v14 offset:512
  ds_read_b64_tr_b16 v[210:211], v14 offset:5120
  s_nop 0
  buffer_load_dwordx4 v2, s[12:15], s28 offen offset:0 lds
  buffer_load_dwordx4 v3, s[12:15], s28 offen offset:1024 lds
  s_waitcnt lgkmcnt(4)
  v_mfma_f32_32x32x16_bf16 v[160:175], v[216:219], v[224:227], v[160:175]
  ds_read_b64_tr_b16 v[212:213], v14 offset:9216
  ds_read_b64_tr_b16 v[214:215], v14 offset:13824
  buffer_load_dwordx4 v4, s[12:15], s28 offen offset:2048 lds
  buffer_load_dwordx4 v5, s[12:15], s28 offen offset:3072 lds
  s_waitcnt lgkmcnt(4)
  v_mfma_f32_32x32x16_bf16 v[176:191], v[220:223], v[224:227], v[176:191]
  ds_read_b64_tr_b16 v[216:217], v14 offset:9280
  ds_read_b64_tr_b16 v[218:219], v14 offset:13888
  s_add_u32 m0, m0, 4096
  s_nop 0
  buffer_load_dwordx4 v6, s[12:15], s28 offen offset:0 lds
  buffer_load_dwordx4 v7, s[12:15], s28 offen offset:1024 lds
  s_waitcnt lgkmcnt(4)
  v_mfma_f32_32x32x16_bf16 v[192:207], v[208:211], v[224:227], v[192:207]
  ds_read_b64_tr_b16 v[220:221], v14 offset:9344
  ds_read_b64_tr_b16 v[222:223], v14 offset:13952
  buffer_load_dwordx4 v8, s[12:15], s28 offen offset:2048 lds
  buffer_load_dwordx4 v9, s[12:15], s28 offen offset:3072 lds
  s_waitcnt lgkmcnt(4)
  v_mfma_f32_32x32x16_bf16 v[64:79], v[212:215], v[228:231], v[64:79]
  ds_read_b64_tr_b16 v[208:209], v14 offset:9408
  ds_read_b64_tr_b16 v[210:211], v14 offset:14016
  s_add_u32 m0, m0, 4096
  s_nop 0
  buffer_load_dwordx4 v10, s[12:15], s28 offen offset:0 lds
  s_add_u32 s28, s28, 36864
  s_add_u32 s48, s48, 36864
  s_cmp_eq_u32 s48, 110592
  s_cselect_b32 s48, 0, s48
  s_waitcnt lgkmcnt(4)
  v_mfma_f32_32x32x16_bf16 v[80:95], v[216:219], v[228:231], v[80:95]
  ds_read_b64_tr_b16 v[212:213], v14 offset:9472
  ds_read_b64_tr_b16 v[214:215], v14 offset:14080
  s_waitcnt lgkmcnt(4)
  v_mfma_f32_32x32x16_bf16 v[96:111], v[220:223], v[228:231], v[96:111]
  ds_read_b64_tr_b16 v[216:217], v14 offset:9536
  ds_read_b64_tr_b16 v[218:219], v14 offset:14144
  s_waitcnt lgkmcnt(4)
  v_mfma_f32_32x32x16_bf16 v[112:127], v[208:211], v[228:231], v[112:127]
  ds_read_b64_tr_b16 v[220:221], v14 offset:9600
  ds_read_b64_tr_b16 v[222:223], v14 offset:14208
  s_waitcnt lgkmcnt(4)
  v_mfma_f32_32x32x16_bf16 v[128:143], v[212:215], v[228:231], v[128:143]
  ds_read_b64_tr_b16 v[208:209], v14 offset:9664
  ds_read_b64_tr_b16 v[210:211], v14 offset:14272
  s_waitcnt lgkmcnt(4)
  v_mfma_f32_32x32x16_bf16 v[144:159], v[216:219], v[228:231], v[144:159]
  ds_read_b64_tr_b16 v[212:213], v14 offset:9728
  ds_read_b64_tr_b16 v[214:215], v14 offset:14336
  s_waitcnt lgkmcnt(4)
  v_mfma_f32_32x32x16_bf16 v[160:175], v[220:223], v[228:231], v[160:175]
  s_waitcnt lgkmcnt(2)
  v_mfma_f32_32x32x16_bf16 v[176:191], v[208:211], v[228:231], v[176:191]
  s_waitcnt lgkmcnt(0)
  v_mfma_f32_32x32x16_bf16 v[192:207], v[212:215], v[228:231], v[192:207]
  s_add_u32 s35, s35, 36864
  s_cmp_eq_u32 s35, 110592
  s_cselect_b32 s35, 0, s35
  s_waitcnt vmcnt(18)
  s_barrier
  s_add_u32 s36, s36, 1
  s_cmp_lt_u32 s36, 4
  s_cbranch_scc1 k2_gloop
  v_add_u32 v14, s35, v13
  ds_read_b64_tr_b16 v[208:209], v14 offset:0
  ds_read_b64_tr_b16 v[210:211], v14 offset:4608
  ds_read_b64_tr_b16 v[212:213], v14 offset:64
  ds_read_b64_tr_b16 v[214:215], v14 offset:4672
  ds_read_b64_tr_b16 v[216:217], v14 offset:128
  ds_read_b64_tr_b16 v[218:219], v14 offset:4736
  s_waitcnt lgkmcnt(4)
  v_mfma_f32_32x32x16_bf16 v[64:79], v[208:211], v[232:235], v[64:79]
  ds_read_b64_tr_b16 v[220:221], v14 offset:192
  ds_read_b64_tr_b16 v[222:223], v14 offset:4800
  s_add_u32 s34, s49, s47
  s_add_u32 s34, s34, 110592
  s_add_u32 m0, s34, 0
  s_add_u32 s37, s30, 0
  buffer_load_dword v11, s[8:11], s37 offen lds
  s_waitcnt lgkmcnt(4)
  v_mfma_f32_32x32x16_bf16 v[80:95], v[212:215], v[232:235], v[80:95]
  ds_read_b64_tr_b16 v[208:209], v14 offset:256
  ds_read_b64_tr_b16 v[210:211], v14 offset:4864
  s_add_u32 m0, s34, 256
  s_add_u32 s37, s30, 4
  buffer_load_dword v11, s[8:11], s37 offen lds
  s_add_u32 m0, s34, 512
  s_add_u32 s37, s30, 32768
  buffer_load_dword v11, s[8:11], s37 offen lds
  s_waitcnt lgkmcnt(4)
  v_mfma_f32_32x32x16_bf16 v[96:111], v[216:219], v[232:235], v[96:111]
  ds_read_b64_tr_b16 v[212:213], v14 offset:320
  ds_read_b64_tr_b16 v[214:215], v14 offset:4928
  s_add_u32 m0, s34, 768
  s_add_u32 s37, s30, 32772
  buffer_load_dword v11, s[8:11], s37 offen lds
  s_add_u32 m0, s34, s43
  s_nop 0
  buffer_load_dword v16, s[8:11], s31 offen lds
  s_waitcnt lgkmcnt(4)
  v_mfma_f32_32x32x16_bf16 v[112:127], v[220:223], v[232:235], v[112:127]
  ds_read_b64_tr_b16 v[216:217], v14 offset:384
  ds_read_b64_tr_b16 v[218:219], v14 offset:4992
  s_add_u32 m0, s34, s42
  s_mov_b64 exec, s[38:39]
  buffer_load_dwordx4 v12, s[8:11], s32 offen lds
  s_add_u32 m0, m0, 1024
  s_add_u32 s37, s32, 576
  buffer_load_dwordx4 v12, s[8:11], s37 offen lds
  s_mov_b64 exec, -1
  s_add_u32 s30, s30, 512
  s_add_u32 s31, s31, 512
  s_add_u32 s32, s32, 4608
  s_add_u32 s49, s49, 12800
  s_cmp_eq_u32 s49, 51200
  s_cselect_b32 s49, 0, s49
  s_waitcnt lgkmcnt(4)
  v_mfma_f32_32x32x16_bf16 v[128:143], v[208:211], v[232:235], v[128:143]
  ds_read_b64_tr_b16 v[220:221], v14 offset:448
  ds_read_b64_tr_b16 v[222:223], v14 offset:5056
  buffer_load_dwordx4 v[224:227], v15, s[8:11], s29 offen
  buffer_load_dwordx4 v[228:231], v15, s[8:11], s29 offen offset:1024
  s_add_u32 s29, s29, 2048
  s_add_u32 m0, s48, s45
  s_waitcnt lgkmcnt(4)
  v_mfma_f32_32x32x16_bf16 v[144:159], v[212:215], v[232:235], v[144:159]
  ds_read_b64_tr_b16 v[208:209], v14 offset:512
  ds_read_b64_tr_b16 v[210:211], v14 offset:5120
  s_nop 0
  buffer_load_dwordx4 v2, s[12:15], s28 offen offset:0 lds
  buffer_load_dwordx4 v3, s[12:15], s28 offen offset:1024 lds
  s_waitcnt lgkmcnt(4)
  v_mfma_f32_32x32x16_bf16 v[160:175], v[216:219], v[232:235], v[160:175]
  ds_read_b64_tr_b16 v[212:213], v14 offset:9216
  ds_read_b64_tr_b16 v[214:215], v14 offset:13824
  buffer_load_dwordx4 v4, s[12:15], s28 offen offset:2048 lds
  buffer_load_dwordx4 v5, s[12:15], s28 offen offset:3072 lds
  s_waitcnt lgkmcnt(4)
  v_mfma_f32_32x32x16_bf16 v[176:191], v[220:223], v[232:235], v[176:191]
  ds_read_b64_tr_b16 v[216:217], v14 offset:9280
  ds_read_b64_tr_b16 v[218:219], v14 offset:13888
  s_add_u32 m0, m0, 4096
  s_nop 0
  buffer_load_dwordx4 v6, s[12:15], s28 offen offset:0 lds
  buffer_load_dwordx4 v7, s[12:15], s28 offen offset:1024 lds
  s_waitcnt lgkmcnt(4)
  v_mfma_f32_32x32x16_bf16 v[192:207], v[208:211], v[232:235], v[192:207]
  ds_read_b64_tr_b16 v[220:221], v14 offset:9344
  ds_read_b64_tr_b16 v[222:223], v14 offset:13952
  buffer_load_dwordx4 v8, s[12:15], s28 offen offset:2048 lds
  buffer_load_dwordx4 v9, s[12:15], s28 offen offset:3072 lds
  s_waitcnt lgkmcnt(4)
  v_mfma_f32_32x32x16_bf16 v[64:79], v[212:215], v[236:239], v[64:79]
  ds_read_b64_tr_b16 v[208:209], v14 offset:9408
  ds_read_b64_tr_b16 v[210:211], v14 offset:14016
  s_add_u32 m0, m0, 4096
  s_nop 0
  buffer_load_dwordx4 v10, s[12:15], s28 offen offset:0 lds
  s_add_u32 s28, s28, 36864
  s_add_u32 s48, s48, 36864
  s_cmp_eq_u32 s48, 110592
  s_cselect_b32 s48, 0, s48
  s_waitcnt lgkmcnt(4)
  v_mfma_f32_32x32x16_bf16 v[80:95], v[216:219], v[236:239], v[80:95]
  ds_read_b64_tr_b16 v[212:213], v14 offset:9472
  ds_read_b64_tr_b16 v[214:215], v14 offset:14080
  s_waitcnt lgkmcnt(4)
  v_mfma_f32_32x32x16_bf16 v[96:111], v[220:223], v[236:239], v[96:111]
  ds_read_b64_tr_b16 v[216:217], v14 offset:9536
  ds_read_b64_tr_b16 v[218:219], v14 offset:14144
  s_waitcnt lgkmcnt(4)
  v_mfma_f32_32x32x16_bf16 v[112:127], v[208:211], v[236:239], v[112:127]
  ds_read_b64_tr_b16 v[220:221], v14 offset:9600
  ds_read_b64_tr_b16 v[222:223], v14 offset:14208
  s_waitcnt lgkmcnt(4)
  v_mfma_f32_32x32x16_bf16 v[128:143], v[212:215], v[236:239], v[128:143]
  ds_read_b64_tr_b16 v[208:209], v14 offset:9664
  ds_read_b64_tr_b16 v[210:211], v14 offset:14272
  s_waitcnt lgkmcnt(4)
  v_mfma_f32_32x32x16_bf16 v[144:159], v[216:219], v[236:239], v[144:159]
  ds_read_b64_tr_b16 v[212:213], v14 offset:9728
  ds_read_b64_tr_b16 v[214:215], v14 offset:14336
  s_waitcnt lgkmcnt(4)
  v_mfma_f32_32x32x16_bf16 v[160:175], v[220:223], v[236:239], v[160:175]
  s_waitcnt lgkmcnt(2)
  v_mfma_f32_32x32x16_bf16 v[176:191], v[208:211], v[236:239], v[176:191]
  s_waitcnt lgkmcnt(0)
  v_mfma_f32_32x32x16_bf16 v[192:207], v[212:215], v[236:239], v[192:207]
  s_add_u32 s35, s35, 36864
  s_cmp_eq_u32 s35, 110592
  s_cselect_b32 s35, 0, s35
  s_waitcnt vmcnt(18)
  s_barrier
  v_add_u32 v14, s35, v13
  ds_read_b64_tr_b16 v[208:209], v14 offset:0
  ds_read_b64_tr_b16 v[210:211], v14 offset:4608
  ds_read_b64_tr_b16 v[212:213], v14 offset:64
  ds_read_b64_tr_b16 v[214:215], v14 offset:4672
  ds_read_b64_tr_b16 v[216:217], v14 offset:128
  ds_read_b64_tr_b16 v[218:219], v14 offset:4736
  s_waitcnt lgkmcnt(4)
  v_mfma_f32_32x32x16_bf16 v[64:79], v[208:211], v[240:243], v[64:79]
  ds_read_b64_tr_b16 v[220:221], v14 offset:192
  ds_read_b64_tr_b16 v[222:223], v14 offset:4800
  buffer_load_dwordx4 v[232:235], v15, s[8:11], s29 offen
  buffer_load_dwordx4 v[236:239], v15, s[8:11], s29 offen offset:1024
  s_add_u32 s29, s29, 2048
  s_add_u32 m0, s48, s45
  s_waitcnt lgkmcnt(4)
  v_mfma_f32_32x32x16_bf16 v[80:95], v[212:215], v[240:243], v[80:95]
  ds_read_b64_tr_b16 v[208:209], v14 offset:256
  ds_read_b64_tr_b16 v[210:211], v14 offset:4864
  s_nop 0
  buffer_load_dwordx4 v2, s[12:15], s28 offen offset:0 lds
  s_waitcnt lgkmcnt(4)
  v_mfma_f32_32x32x16_bf16 v[96:111], v[216:219], v[240:243], v[96:111]
  ds_read_b64_tr_b16 v[212:213], v14 offset:320
  ds_read_b64_tr_b16 v[214:215], v14 offset:4928
  buffer_load_dwordx4 v3, s[12:15], s28 offen offset:1024 lds
  s_waitcnt lgkmcnt(4)
  v_mfma_f32_32x32x16_bf16 v[112:127], v[220:223], v[240:243], v[112:127]
  ds_read_b64_tr_b16 v[216:217], v14 offset:384
  ds_read_b64_tr_b16 v[218:219], v14 offset:4992
  buffer_load_dwordx4 v4, s[12:15], s28 offen offset:2048 lds
  s_waitcnt lgkmcnt(4)
  v_mfma_f32_32x32x16_bf16 v[128:143], v[208:211], v[240:243], v[128:143]
  ds_read_b64_tr_b16 v[220:221], v14 offset:448
  ds_read_b64_tr_b16 v[222:223], v14 offset:5056
  buffer_load_dwordx4 v5, s[12:15], s28 offen offset:3072 lds
  s_waitcnt lgkmcnt(4)
  v_mfma_f32_32x32x16_bf16 v[144:159], v[212:215], v[240:243], v[144:159]
  ds_read_b64_tr_b16 v[208:209], v14 offset:512
  ds_read_b64_tr_b16 v[210:211], v14 offset:5120
  s_add_u32 m0, m0, 4096
  s_nop 0
  buffer_load_dwordx4 v6, s[12:15], s28 offen offset:0 lds
  buffer_load_dwordx4 v7, s[12:15], s28 offen offset:1024 lds
  s_waitcnt lgkmcnt(4)
  v_mfma_f32_32x32x16_bf16 v[160:175], v[216:219], v[240:243], v[160:175]
  ds_read_b64_tr_b16 v[212:213], v14 offset:9216
  ds_read_b64_tr_b16 v[214:215], v14 offset:13824
  buffer_load_dwordx4 v8, s[12:15], s28 offen offset:2048 lds
  s_waitcnt lgkmcnt(4)
  v_mfma_f32_32x32x16_bf16 v[176:191], v[220:223], v[240:243], v[176:191]
  ds_read_b64_tr_b16 v[216:217], v14 offset:9280
  ds_read_b64_tr_b16 v[218:219], v14 offset:13888
  buffer_load_dwordx4 v9, s[12:15], s28 offen offset:3072 lds
  s_waitcnt lgkmcnt(4)
  v_mfma_f32_32x32x16_bf16 v[192:207], v[208:211], v[240:243], v[192:207]
  ds_read_b64_tr_b16 v[220:221], v14 offset:9344
  ds_read_b64_tr_b16 v[222:223], v14 offset:13952
  s_add_u32 m0, m0, 4096
  s_nop 0
  buffer_load_dwordx4 v10, s[12:15], s28 offen offset:0 lds
  s_waitcnt lgkmcnt(4)
  v_mfma_f32_32x32x16_bf16 v[64:79], v[212:215], v[244:247], v[64:79]
  ds_read_b64_tr_b16 v[208:209], v14 offset:9408
  ds_read_b64_tr_b16 v[210:211], v14 offset:14016
  s_add_u32 s28, s28, 36864
  s_add_u32 s48, s48, 36864
  s_cmp_eq_u32 s48, 110592
  s_cselect_b32 s48, 0, s48
  s_waitcnt lgkmcnt(4)
  v_mfma_f32_32x32x16_bf16 v[80:95], v[216:219], v[244:247], v[80:95]
  ds_read_b64_tr_b16 v[212:213], v14 offset:9472
  ds_read_b64_tr_b16 v[214:215], v14 offset:14080
  s_waitcnt lgkmcnt(4)
  v_mfma_f32_32x32x16_bf16 v[96:111], v[220:223], v[244:247], v[96:111]
  ds_read_b64_tr_b16 v[216:217], v14 offset:9536
  ds_read_b64_tr_b16 v[218:219], v14 offset:14144
  s_waitcnt lgkmcnt(4)
  v_mfma_f32_32x32x16_bf16 v[112:127], v[208:211], v[244:247], v[112:127]
  ds_read_b64_tr_b16 v[220:221], v14 offset:9600
  ds_read_b64_tr_b16 v[222:223], v14 offset:14208
  s_waitcnt lgkmcnt(4)
  v_mfma_f32_32x32x16_bf16 v[128:143], v[212:215], v[244:247], v[128:143]
  ds_read_b64_tr_b16 v[208:209], v14 offset:9664
  ds_read_b64_tr_b16 v[210:211], v14 offset:14272
  s_waitcnt lgkmcnt(4)
  v_mfma_f32_32x32x16_bf16 v[144:159], v[216:219], v[244:247], v[144:159]
  ds_read_b64_tr_b16 v[212:213], v14 offset:9728
  ds_read_b64_tr_b16 v[214:215], v14 offset:14336
  s_waitcnt lgkmcnt(4)
  v_mfma_f32_32x32x16_bf16 v[160:175], v[220:223], v[244:247], v[160:175]
  s_waitcnt lgkmcnt(2)
  v_mfma_f32_32x32x16_bf16 v[176:191], v[208:211], v[244:247], v[176:191]
  s_waitcnt lgkmcnt(0)
  v_mfma_f32_32x32x16_bf16 v[192:207], v[212:215], v[244:247], v[192:207]
  s_add_u32 s35, s35, 36864
  s_cmp_eq_u32 s35, 110592
  s_cselect_b32 s35, 0, s35
  s_waitcnt vmcnt(11)
  s_barrier
  v_add_u32 v14, s35, v13
  ds_read_b64_tr_b16 v[208:209], v14 offset:0
  ds_read_b64_tr_b16 v[210:211], v14 offset:4608
  ds_read_b64_tr_b16 v[212:213], v14 offset:64
  ds_read_b64_tr_b16 v[214:215], v14 offset:4672
  ds_read_b64_tr_b16 v[216:217], v14 offset:128
  ds_read_b64_tr_b16 v[218:219], v14 offset:4736
  s_waitcnt lgkmcnt(4)
  v_mfma_f32_32x32x16_bf16 v[64:79], v[208:211], v[224:227], v[64:79]
  ds_read_b64_tr_b16 v[220:221], v14 offset:192
  ds_read_b64_tr_b16 v[222:223], v14 offset:4800
  buffer_load_dwordx4 v[240:243], v15, s[8:11], s29 offen
  buffer_load_dwordx4 v[244:247], v15, s[8:11], s29 offen offset:1024
  s_add_u32 s29, s29, 2048
  s_add_u32 m0, s48, s45
  s_waitcnt lgkmcnt(4)
  v_mfma_f32_32x32x16_bf16 v[80:95], v[212:215], v[224:227], v[80:95]
  ds_read_b64_tr_b16 v[208:209], v14 offset:256
  ds_read_b64_tr_b16 v[210:211], v14 offset:4864
  s_nop 0
  buffer_load_dwordx4 v2, s[12:15], s28 offen offset:0 lds
  s_waitcnt lgkmcnt(4)
  v_mfma_f32_32x32x16_bf16 v[96:111], v[216:219], v[224:227], v[96:111]
  ds_read_b64_tr_b16 v[212:213], v14 offset:320
  ds_read_b64_tr_b16 v[214:215], v14 offset:4928
  buffer_load_dwordx4 v3, s[12:15], s28 offen offset:1024 lds
  s_waitcnt lgkmcnt(4)
  v_mfma_f32_32x32x16_bf16 v[112:127], v[220:223], v[224:227], v[112:127]
  ds_read_b64_tr_b16 v[216:217], v14 offset:384
  ds_read_b64_tr_b16 v[218:219], v14 offset:4992
  buffer_load_dwordx4 v4, s[12:15], s28 offen offset:2048 lds
  s_waitcnt lgkmcnt(4)
  v_mfma_f32_32x32x16_bf16 v[128:143], v[208:211], v[224:227], v[128:143]
  ds_read_b64_tr_b16 v[220:221], v14 offset:448
  ds_read_b64_tr_b16 v[222:223], v14 offset:5056
  buffer_load_dwordx4 v5, s[12:15], s28 offen offset:3072 lds
  s_waitcnt lgkmcnt(4)
  v_mfma_f32_32x32x16_bf16 v[144:159], v[212:215], v[224:227], v[144:159]
  ds_read_b64_tr_b16 v[208:209], v14 offset:512
  ds_read_b64_tr_b16 v[210:211], v14 offset:5120
  s_add_u32 m0, m0, 4096
  s_nop 0
  buffer_load_dwordx4 v6, s[12:15], s28 offen offset:0 lds
  buffer_load_dwordx4 v7, s[12:15], s28 offen offset:1024 lds
  s_waitcnt lgkmcnt(4)
  v_mfma_f32_32x32x16_bf16 v[160:175], v[216:219], v[224:227], v[160:175]
  ds_read_b64_tr_b16 v[212:213], v14 offset:9216
  ds_read_b64_tr_b16 v[214:215], v14 offset:13824
  buffer_load_dwordx4 v8, s[12:15], s28 offen offset:2048 lds
  s_waitcnt lgkmcnt(4)
  v_mfma_f32_32x32x16_bf16 v[176:191], v[220:223], v[224:227], v[176:191]
  ds_read_b64_tr_b16 v[216:217], v14 offset:9280
  ds_read_b64_tr_b16 v[218:219], v14 offset:13888
  buffer_load_dwordx4 v9, s[12:15], s28 offen offset:3072 lds
  s_waitcnt lgkmcnt(4)
  v_mfma_f32_32x32x16_bf16 v[192:207], v[208:211], v[224:227], v[192:207]
  ds_read_b64_tr_b16 v[220:221], v14 offset:9344
  ds_read_b64_tr_b16 v[222:223], v14 offset:13952
  s_add_u32 m0, m0, 4096
  s_nop 0
  buffer_load_dwordx4 v10, s[12:15], s28 offen offset:0 lds
  s_waitcnt lgkmcnt(4)
  v_mfma_f32_32x32x16_bf16 v[64:79], v[212:215], v[228:231], v[64:79]
  ds_read_b64_tr_b16 v[208:209], v14 offset:9408
  ds_read_b64_tr_b16 v[210:211], v14 offset:14016
  s_add_u32 s28, s28, 36864
  s_add_u32 s48, s48, 36864
  s_cmp_eq_u32 s48, 110592
  s_cselect_b32 s48, 0, s48
  s_waitcnt lgkmcnt(4)
  v_mfma_f32_32x32x16_bf16 v[80:95], v[216:219], v[228:231], v[80:95]
  ds_read_b64_tr_b16 v[212:213], v14 offset:9472
  ds_read_b64_tr_b16 v[214:215], v14 offset:14080
  s_waitcnt lgkmcnt(4)
  v_mfma_f32_32x32x16_bf16 v[96:111], v[220:223], v[228:231], v[96:111]
  ds_read_b64_tr_b16 v[216:217], v14 offset:9536
  ds_read_b64_tr_b16 v[218:219], v14 offset:14144
  s_waitcnt lgkmcnt(4)
  v_mfma_f32_32x32x16_bf16 v[112:127], v[208:211], v[228:231], v[112:127]
  ds_read_b64_tr_b16 v[220:221], v14 offset:9600
  ds_read_b64_tr_b16 v[222:223], v14 offset:14208
  s_waitcnt lgkmcnt(4)
  v_mfma_f32_32x32x16_bf16 v[128:143], v[212:215], v[228:231], v[128:143]
  ds_read_b64_tr_b16 v[208:209], v14 offset:9664
  ds_read_b64_tr_b16 v[210:211], v14 offset:14272
  s_waitcnt lgkmcnt(4)
  v_mfma_f32_32x32x16_bf16 v[144:159], v[216:219], v[228:231], v[144:159]
  ds_read_b64_tr_b16 v[212:213], v14 offset:9728
  ds_read_b64_tr_b16 v[214:215], v14 offset:14336
  s_waitcnt lgkmcnt(4)
  v_mfma_f32_32x32x16_bf16 v[160:175], v[220:223], v[228:231], v[160:175]
  s_waitcnt lgkmcnt(2)
  v_mfma_f32_32x32x16_bf16 v[176:191], v[208:211], v[228:231], v[176:191]
  s_waitcnt lgkmcnt(0)
  v_mfma_f32_32x32x16_bf16 v[192:207], v[212:215], v[228:231], v[192:207]
  s_add_u32 s35, s35, 36864
  s_cmp_eq_u32 s35, 110592
  s_cselect_b32 s35, 0, s35
  s_waitcnt vmcnt(11)
  s_barrier
  v_add_u32 v14, s35, v13
  ds_read_b64_tr_b16 v[208:209], v14 offset:0
  ds_read_b64_tr_b16 v[210:211], v14 offset:4608
  ds_read_b64_tr_b16 v[212:213], v14 offset:64
  ds_read_b64_tr_b16 v[214:215], v14 offset:4672
  ds_read_b64_tr_b16 v[216:217], v14 offset:128
  ds_read_b64_tr_b16 v[218:219], v14 offset:4736
  s_waitcnt lgkmcnt(4)
  v_mfma_f32_32x32x16_bf16 v[64:79], v[208:211], v[232:235], v[64:79]
  ds_read_b64_tr_b16 v[220:221], v14 offset:192
  ds_read_b64_tr_b16 v[222:223], v14 offset:4800
  s_waitcnt lgkmcnt(4)
  v_mfma_f32_32x32x16_bf16 v[80:95], v[212:215], v[232:235], v[80:95]
  ds_read_b64_tr_b16 v[208:209], v14 offset:256
  ds_read_b64_tr_b16 v[210:211], v14 offset:4864
  s_waitcnt lgkmcnt(4)
  v_mfma_f32_32x32x16_bf16 v[96:111], v[216:219], v[232:235], v[96:111]
  ds_read_b64_tr_b16 v[212:213], v14 offset:320
  ds_read_b64_tr_b16 v[214:215], v14 offset:4928
  s_waitcnt lgkmcnt(4)
  v_mfma_f32_32x32x16_bf16 v[112:127], v[220:223], v[232:235], v[112:127]
  ds_read_b64_tr_b16 v[216:217], v14 offset:384
  ds_read_b64_tr_b16 v[218:219], v14 offset:4992
  s_waitcnt lgkmcnt(4)
  v_mfma_f32_32x32x16_bf16 v[128:143], v[208:211], v[232:235], v[128:143]
  ds_read_b64_tr_b16 v[220:221], v14 offset:448
  ds_read_b64_tr_b16 v[222:223], v14 offset:5056
  s_waitcnt lgkmcnt(4)
  v_mfma_f32_32x32x16_bf16 v[144:159], v[212:215], v[232:235], v[144:159]
  ds_read_b64_tr_b16 v[208:209], v14 offset:512
  ds_read_b64_tr_b16 v[210:211], v14 offset:5120
  s_waitcnt lgkmcnt(4)
  v_mfma_f32_32x32x16_bf16 v[160:175], v[216:219], v[232:235], v[160:175]
  ds_read_b64_tr_b16 v[212:213], v14 offset:9216
  ds_read_b64_tr_b16 v[214:215], v14 offset:13824
  s_waitcnt lgkmcnt(4)
  v_mfma_f32_32x32x16_bf16 v[176:191], v[220:223], v[232:235], v[176:191]
  ds_read_b64_tr_b16 v[216:217], v14 offset:9280
  ds_read_b64_tr_b16 v[218:219], v14 offset:13888
  s_waitcnt lgkmcnt(4)
  v_mfma_f32_32x32x16_bf16 v[192:207], v[208:211], v[232:235], v[192:207]
  ds_read_b64_tr_b16 v[220:221], v14 offset:9344
  ds_read_b64_tr_b16 v[222:223], v14 offset:13952
  s_waitcnt lgkmcnt(4)
  v_mfma_f32_32x32x16_bf16 v[64:79], v[212:215], v[236:239], v[64:79]
  ds_read_b64_tr_b16 v[208:209], v14 offset:9408
  ds_read_b64_tr_b16 v[210:211], v14 offset:14016
  s_waitcnt lgkmcnt(4)
  v_mfma_f32_32x32x16_bf16 v[80:95], v[216:219], v[236:239], v[80:95]
  ds_read_b64_tr_b16 v[212:213], v14 offset:9472
  ds_read_b64_tr_b16 v[214:215], v14 offset:14080
  s_waitcnt lgkmcnt(4)
  v_mfma_f32_32x32x16_bf16 v[96:111], v[220:223], v[236:239], v[96:111]
  ds_read_b64_tr_b16 v[216:217], v14 offset:9536
  ds_read_b64_tr_b16 v[218:219], v14 offset:14144
  s_waitcnt lgkmcnt(4)
  v_mfma_f32_32x32x16_bf16 v[112:127], v[208:211], v[236:239], v[112:127]
  ds_read_b64_tr_b16 v[220:221], v14 offset:9600
  ds_read_b64_tr_b16 v[222:223], v14 offset:14208
  s_waitcnt lgkmcnt(4)
  v_mfma_f32_32x32x16_bf16 v[128:143], v[212:215], v[236:239], v[128:143]
  ds_read_b64_tr_b16 v[208:209], v14 offset:9664
  ds_read_b64_tr_b16 v[210:211], v14 offset:14272
  s_waitcnt lgkmcnt(4)
  v_mfma_f32_32x32x16_bf16 v[144:159], v[216:219], v[236:239], v[144:159]
  ds_read_b64_tr_b16 v[212:213], v14 offset:9728
  ds_read_b64_tr_b16 v[214:215], v14 offset:14336
  s_waitcnt lgkmcnt(4)
  v_mfma_f32_32x32x16_bf16 v[160:175], v[220:223], v[236:239], v[160:175]
  s_waitcnt lgkmcnt(2)
  v_mfma_f32_32x32x16_bf16 v[176:191], v[208:211], v[236:239], v[176:191]
  s_waitcnt lgkmcnt(0)
  v_mfma_f32_32x32x16_bf16 v[192:207], v[212:215], v[236:239], v[192:207]
  s_add_u32 s35, s35, 36864
  s_cmp_eq_u32 s35, 110592
  s_cselect_b32 s35, 0, s35
  s_waitcnt vmcnt(0)
  s_barrier
  v_add_u32 v14, s35, v13
  ds_read_b64_tr_b16 v[208:209], v14 offset:0
  ds_read_b64_tr_b16 v[210:211], v14 offset:4608
  ds_read_b64_tr_b16 v[212:213], v14 offset:64
  ds_read_b64_tr_b16 v[214:215], v14 offset:4672
  ds_read_b64_tr_b16 v[216:217], v14 offset:128
  ds_read_b64_tr_b16 v[218:219], v14 offset:4736
  s_waitcnt lgkmcnt(4)
  v_mfma_f32_32x32x16_bf16 v[64:79], v[208:211], v[240:243], v[64:79]
  ds_read_b64_tr_b16 v[220:221], v14 offset:192
  ds_read_b64_tr_b16 v[222:223], v14 offset:4800
  s_waitcnt lgkmcnt(4)
  v_mfma_f32_32x32x16_bf16 v[80:95], v[212:215], v[240:243], v[80:95]
  ds_read_b64_tr_b16 v[208:209], v14 offset:256
  ds_read_b64_tr_b16 v[210:211], v14 offset:4864
  s_waitcnt lgkmcnt(4)
  v_mfma_f32_32x32x16_bf16 v[96:111], v[216:219], v[240:243], v[96:111]
  ds_read_b64_tr_b16 v[212:213], v14 offset:320
  ds_read_b64_tr_b16 v[214:215], v14 offset:4928
  s_waitcnt lgkmcnt(4)
  v_mfma_f32_32x32x16_bf16 v[112:127], v[220:223], v[240:243], v[112:127]
  ds_read_b64_tr_b16 v[216:217], v14 offset:384
  ds_read_b64_tr_b16 v[218:219], v14 offset:4992
  s_waitcnt lgkmcnt(4)
  v_mfma_f32_32x32x16_bf16 v[128:143], v[208:211], v[240:243], v[128:143]
  ds_read_b64_tr_b16 v[220:221], v14 offset:448
  ds_read_b64_tr_b16 v[222:223], v14 offset:5056
  s_waitcnt lgkmcnt(4)
  v_mfma_f32_32x32x16_bf16 v[144:159], v[212:215], v[240:243], v[144:159]
  ds_read_b64_tr_b16 v[208:209], v14 offset:512
  ds_read_b64_tr_b16 v[210:211], v14 offset:5120
  s_waitcnt lgkmcnt(4)
  v_mfma_f32_32x32x16_bf16 v[160:175], v[216:219], v[240:243], v[160:175]
  ds_read_b64_tr_b16 v[212:213], v14 offset:9216
  ds_read_b64_tr_b16 v[214:215], v14 offset:13824
  s_waitcnt lgkmcnt(4)
  v_mfma_f32_32x32x16_bf16 v[176:191], v[220:223], v[240:243], v[176:191]
  ds_read_b64_tr_b16 v[216:217], v14 offset:9280
  ds_read_b64_tr_b16 v[218:219], v14 offset:13888
  s_waitcnt lgkmcnt(4)
  v_mfma_f32_32x32x16_bf16 v[192:207], v[208:211], v[240:243], v[192:207]
  ds_read_b64_tr_b16 v[220:221], v14 offset:9344
  ds_read_b64_tr_b16 v[222:223], v14 offset:13952
  s_waitcnt lgkmcnt(4)
  v_mfma_f32_32x32x16_bf16 v[64:79], v[212:215], v[244:247], v[64:79]
  ds_read_b64_tr_b16 v[208:209], v14 offset:9408
  ds_read_b64_tr_b16 v[210:211], v14 offset:14016
  s_waitcnt lgkmcnt(4)
  v_mfma_f32_32x32x16_bf16 v[80:95], v[216:219], v[244:247], v[80:95]
  ds_read_b64_tr_b16 v[212:213], v14 offset:9472
  ds_read_b64_tr_b16 v[214:215], v14 offset:14080
  s_waitcnt lgkmcnt(4)
  v_mfma_f32_32x32x16_bf16 v[96:111], v[220:223], v[244:247], v[96:111]
  ds_read_b64_tr_b16 v[216:217], v14 offset:9536
  ds_read_b64_tr_b16 v[218:219], v14 offset:14144
  s_waitcnt lgkmcnt(4)
  v_mfma_f32_32x32x16_bf16 v[112:127], v[208:211], v[244:247], v[112:127]
  ds_read_b64_tr_b16 v[220:221], v14 offset:9600
  ds_read_b64_tr_b16 v[222:223], v14 offset:14208
  s_waitcnt lgkmcnt(4)
  v_mfma_f32_32x32x16_bf16 v[128:143], v[212:215], v[244:247], v[128:143]
  ds_read_b64_tr_b16 v[208:209], v14 offset:9664
  ds_read_b64_tr_b16 v[210:211], v14 offset:14272
  s_waitcnt lgkmcnt(4)
  v_mfma_f32_32x32x16_bf16 v[144:159], v[216:219], v[244:247], v[144:159]
  ds_read_b64_tr_b16 v[212:213], v14 offset:9728
  ds_read_b64_tr_b16 v[214:215], v14 offset:14336
  s_waitcnt lgkmcnt(4)
  v_mfma_f32_32x32x16_bf16 v[160:175], v[220:223], v[244:247], v[160:175]
  s_waitcnt lgkmcnt(2)
  v_mfma_f32_32x32x16_bf16 v[176:191], v[208:211], v[244:247], v[176:191]
  s_waitcnt lgkmcnt(0)
  v_mfma_f32_32x32x16_bf16 v[192:207], v[212:215], v[244:247], v[192:207]
  s_add_u32 s35, s35, 36864
  s_cmp_eq_u32 s35, 110592
  s_cselect_b32 s35, 0, s35
  s_nop 15
  s_mul_i32 s19, s24, 36864
  v_add_u32 v17, s19, v15
  s_lshl_b32 s19, s26, 6
  s_add_u32 s19, s19, s46
  s_mul_i32 s19, s19, 18
  s_mul_i32 s20, s27, 9
  s_add_u32 s19, s19, s20
  s_lshl_b32 s19, s19, 11
  s_add_u32 s19, s19, 31457280
  s_cmp_eq_u32 s25, 0
  s_cbranch_scc0 k2_gred1
  ds_write_b128 v17, v[144:147] offset:20480
  ds_write_b128 v17, v[148:151] offset:21504
  ds_write_b128 v17, v[152:155] offset:22528
  ds_write_b128 v17, v[156:159] offset:23552
  ds_write_b128 v17, v[160:163] offset:24576
  ds_write_b128 v17, v[164:167] offset:25600
  ds_write_b128 v17, v[168:171] offset:26624
  ds_write_b128 v17, v[172:175] offset:27648
  ds_write_b128 v17, v[176:179] offset:28672
  ds_write_b128 v17, v[180:183] offset:29696
  ds_write_b128 v17, v[184:187] offset:30720
  ds_write_b128 v17, v[188:191] offset:31744
  ds_write_b128 v17, v[192:195] offset:32768
  ds_write_b128 v17, v[196:199] offset:33792
  ds_write_b128 v17, v[200:203] offset:34816
  ds_write_b128 v17, v[204:207] offset:35840
  s_waitcnt vmcnt(0) lgkmcnt(0)
  s_barrier
  ds_read_b128 v[208:211], v17 offset:0
  ds_read_b128 v[212:215], v17 offset:1024
  ds_read_b128 v[216:219], v17 offset:2048
  ds_read_b128 v[220:223], v17 offset:3072
  ds_read_b128 v[224:227], v17 offset:4096
  ds_read_b128 v[228:231], v17 offset:5120
  ds_read_b128 v[232:235], v17 offset:6144
  ds_read_b128 v[236:239], v17 offset:7168
  s_waitcnt lgkmcnt(4)
  v_add_f32 v64, v64, v208
  v_add_f32 v65, v65, v209
  v_add_f32 v66, v66, v210
  v_add_f32 v67, v67, v211
  v_add_f32 v68, v68, v212
  v_add_f32 v69, v69, v213
  v_add_f32 v70, v70, v214
  v_add_f32 v71, v71, v215
  v_add_f32 v72, v72, v216
  v_add_f32 v73, v73, v217
  v_add_f32 v74, v74, v218
  v_add_f32 v75, v75, v219
  v_add_f32 v76, v76, v220
  v_add_f32 v77, v77, v221
  v_add_f32 v78, v78, v222
  v_add_f32 v79, v79, v223
  v_cvt_pk_bf16_f32 v32, v64, v65
  v_cvt_pk_bf16_f32 v33, v66, v67
  v_cvt_pk_bf16_f32 v34, v68, v69
  v_cvt_pk_bf16_f32 v35, v70, v71
  v_cvt_pk_bf16_f32 v36, v72, v73
  v_cvt_pk_bf16_f32 v37, v74, v75
  v_cvt_pk_bf16_f32 v38, v76, v77
  v_cvt_pk_bf16_f32 v39, v78, v79
  buffer_store_dwordx4 v[32:35], v15, s[8:11], s19 offen sc1
  buffer_store_dwordx4 v[36:39], v15, s[8:11], s19 offen offset:1024 sc1
  s_add_u32 s19, s19, 2048
  ds_read_b128 v[208:211], v17 offset:8192
  ds_read_b128 v[212:215], v17 offset:9216
  ds_read_b128 v[216:219], v17 offset:10240
  ds_read_b128 v[220:223], v17 offset:11264
  s_waitcnt lgkmcnt(4)
  v_add_f32 v80, v80, v224
  v_add_f32 v81, v81, v225
  v_add_f32 v82, v82, v226
  v_add_f32 v83, v83, v227
  v_add_f32 v84, v84, v228
  v_add_f32 v85, v85, v229
  v_add_f32 v86, v86, v230
  v_add_f32 v87, v87, v231
  v_add_f32 v88, v88, v232
  v_add_f32 v89, v89, v233
  v_add_f32 v90, v90, v234
  v_add_f32 v91, v91, v235
  v_add_f32 v92, v92, v236
  v_add_f32 v93, v93, v237
  v_add_f32 v94, v94, v238
  v_add_f32 v95, v95, v239
  v_cvt_pk_bf16_f32 v40, v80, v81
  v_cvt_pk_bf16_f32 v41, v82, v83
  v_cvt_pk_bf16_f32 v42, v84, v85
  v_cvt_pk_bf16_f32 v43, v86, v87
  v_cvt_pk_bf16_f32 v44, v88, v89
  v_cvt_pk_bf16_f32 v45, v90, v91
  v_cvt_pk_bf16_f32 v46, v92, v93
  v_cvt_pk_bf16_f32 v47, v94, v95
  buffer_store_dwordx4 v[40:43], v15, s[8:11], s19 offen sc1
  buffer_store_dwordx4 v[44:47], v15, s[8:11], s19 offen offset:1024 sc1
  s_add_u32 s19, s19, 2048
  ds_read_b128 v[224:227], v17 offset:12288
  ds_read_b128 v[228:231], v17 offset:13312
  ds_read_b128 v[232:235], v17 offset:14336
  ds_read_b128 v[236:239], v17 offset:15360
  s_waitcnt lgkmcnt(4)
  v_add_f32 v96, v96, v208
  v_add_f32 v97, v97, v209
  v_add_f32 v98, v98, v210
  v_add_f32 v99, v99, v211
  v_add_f32 v100, v100, v212
  v_add_f32 v101, v101, v213
  v_add_f32 v102, v102, v214
  v_add_f32 v103, v103, v215
  v_add_f32 v104, v104, v216
  v_add_f32 v105, v105, v217
  v_add_f32 v106, v106, v218
  v_add_f32 v107, v107, v219
  v_add_f32 v108, v108, v220
  v_add_f32 v109, v109, v221
  v_add_f32 v110, v110, v222
  v_add_f32 v111, v111, v223
  v_cvt_pk_bf16_f32 v32, v96, v97
  v_cvt_pk_bf16_f32 v33, v98, v99
  v_cvt_pk_bf16_f32 v34, v100, v101
  v_cvt_pk_bf16_f32 v35, v102, v103
  v_cvt_pk_bf16_f32 v36, v104, v105
  v_cvt_pk_bf16_f32 v37, v106, v107
  v_cvt_pk_bf16_f32 v38, v108, v109
  v_cvt_pk_bf16_f32 v39, v110, v111
  buffer_store_dwordx4 v[32:35], v15, s[8:11], s19 offen sc1
  buffer_store_dwordx4 v[36:39], v15, s[8:11], s19 offen offset:1024 sc1
  s_add_u32 s19, s19, 2048
  ds_read_b128 v[208:211], v17 offset:16384
  ds_read_b128 v[212:215], v17 offset:17408
  ds_read_b128 v[216:219], v17 offset:18432
  ds_read_b128 v[220:223], v17 offset:19456
  s_waitcnt lgkmcnt(4)
  v_add_f32 v112, v112, v224
  v_add_f32 v113, v113, v225
  v_add_f32 v114, v114, v226
  v_add_f32 v115, v115, v227
  v_add_f32 v116, v116, v228
  v_add_f32 v117, v117, v229
  v_add_f32 v118, v118, v230
  v_add_f32 v119, v119, v231
  v_add_f32 v120, v120, v232
  v_add_f32 v121, v121, v233
  v_add_f32 v122, v122, v234
  v_add_f32 v123, v123, v235
  v_add_f32 v124, v124, v236
  v_add_f32 v125, v125, v237
  v_add_f32 v126, v126, v238
  v_add_f32 v127, v127, v239
  v_cvt_pk_bf16_f32 v40, v112, v113
  v_cvt_pk_bf16_f32 v41, v114, v115
  v_cvt_pk_bf16_f32 v42, v116, v117
  v_cvt_pk_bf16_f32 v43, v118, v119
  v_cvt_pk_bf16_f32 v44, v120, v121
  v_cvt_pk_bf16_f32 v45, v122, v123
  v_cvt_pk_bf16_f32 v46, v124, v125
  v_cvt_pk_bf16_f32 v47, v126, v127
  buffer_store_dwordx4 v[40:43], v15, s[8:11], s19 offen sc1
  buffer_store_dwordx4 v[44:47], v15, s[8:11], s19 offen offset:1024 sc1
  s_add_u32 s19, s19, 2048
  s_waitcnt lgkmcnt(0)
  v_add_f32 v128, v128, v208
  v_add_f32 v129, v129, v209
  v_add_f32 v130, v130, v210
  v_add_f32 v131, v131, v211
  v_add_f32 v132, v132, v212
  v_add_f32 v133, v133, v213
  v_add_f32 v134, v134, v214
  v_add_f32 v135, v135, v215
  v_add_f32 v136, v136, v216
  v_add_f32 v137, v137, v217
  v_add_f32 v138, v138, v218
  v_add_f32 v139, v139, v219
  v_add_f32 v140, v140, v220
  v_add_f32 v141, v141, v221
  v_add_f32 v142, v142, v222
  v_add_f32 v143, v143, v223
  v_cvt_pk_bf16_f32 v32, v128, v129
  v_cvt_pk_bf16_f32 v33, v130, v131
  v_cvt_pk_bf16_f32 v34, v132, v133
  v_cvt_pk_bf16_f32 v35, v134, v135
  v_cvt_pk_bf16_f32 v36, v136, v137
  v_cvt_pk_bf16_f32 v37, v138, v139
  v_cvt_pk_bf16_f32 v38, v140, v141
  v_cvt_pk_bf16_f32 v39, v142, v143
  buffer_store_dwordx4 v[32:35], v15, s[8:11], s19 offen sc1
  buffer_store_dwordx4 v[36:39], v15, s[8:11], s19 offen offset:1024 sc1
  s_endpgm
k2_gred1:
  ds_write_b128 v17, v[64:67] offset:0
  ds_write_b128 v17, v[68:71] offset:1024
  ds_write_b128 v17, v[72:75] offset:2048
  ds_write_b128 v17, v[76:79] offset:3072
  ds_write_b128 v17, v[80:83] offset:4096
  ds_write_b128 v17, v[84:87] offset:5120
  ds_write_b128 v17, v[88:91] offset:6144
  ds_write_b128 v17, v[92:95] offset:7168
  ds_write_b128 v17, v[96:99] offset:8192
  ds_write_b128 v17, v[100:103] offset:9216
  ds_write_b128 v17, v[104:107] offset:10240
  ds_write_b128 v17, v[108:111] offset:11264
  ds_write_b128 v17, v[112:115] offset:12288
  ds_write_b128 v17, v[116:119] offset:13312
  ds_write_b128 v17, v[120:123] offset:14336
  ds_write_b128 v17, v[124:127] offset:15360
  ds_write_b128 v17, v[128:131] offset:16384
  ds_write_b128 v17, v[132:135] offset:17408
  ds_write_b128 v17, v[136:139] offset:18432
  ds_write_b128 v17, v[140:143] offset:19456
  s_waitcnt vmcnt(0) lgkmcnt(0)
  s_barrier
  s_add_u32 s19, s19, 10240
  ds_read_b128 v[224:227], v17 offset:20480
  ds_read_b128 v[228:231], v17 offset:21504
  ds_read_b128 v[232:235], v17 offset:22528
  ds_read_b128 v[236:239], v17 offset:23552
  ds_read_b128 v[208:211], v17 offset:24576
  ds_read_b128 v[212:215], v17 offset:25600
  ds_read_b128 v[216:219], v17 offset:26624
  ds_read_b128 v[220:223], v17 offset:27648
  s_waitcnt lgkmcnt(4)
  v_add_f32 v144, v144, v224
  v_add_f32 v145, v145, v225
  v_add_f32 v146, v146, v226
  v_add_f32 v147, v147, v227
  v_add_f32 v148, v148, v228
  v_add_f32 v149, v149, v229
  v_add_f32 v150, v150, v230
  v_add_f32 v151, v151, v231
  v_add_f32 v152, v152, v232
  v_add_f32 v153, v153, v233
  v_add_f32 v154, v154, v234
  v_add_f32 v155, v155, v235
  v_add_f32 v156, v156, v236
  v_add_f32 v157, v157, v237
  v_add_f32 v158, v158, v238
  v_add_f32 v159, v159, v239
  v_cvt_pk_bf16_f32 v40, v144, v145
  v_cvt_pk_bf16_f32 v41, v146, v147
  v_cvt_pk_bf16_f32 v42, v148, v149
  v_cvt_pk_bf16_f32 v43, v150, v151
  v_cvt_pk_bf16_f32 v44, v152, v153
  v_cvt_pk_bf16_f32 v45, v154, v155
  v_cvt_pk_bf16_f32 v46, v156, v157
  v_cvt_pk_bf16_f32 v47, v158, v159
  buffer_store_dwordx4 v[40:43], v15, s[8:11], s19 offen sc1
  buffer_store_dwordx4 v[44:47], v15, s[8:11], s19 offen offset:1024 sc1
  s_add_u32 s19, s19, 2048
  ds_read_b128 v[224:227], v17 offset:28672
  ds_read_b128 v[228:231], v17 offset:29696
  ds_read_b128 v[232:235], v17 offset:30720
  ds_read_b128 v[236:239], v17 offset:31744
  s_waitcnt lgkmcnt(4)
  v_add_f32 v160, v160, v208
  v_add_f32 v161, v161, v209
  v_add_f32 v162, v162, v210
  v_add_f32 v163, v163, v211
  v_add_f32 v164, v164, v212
  v_add_f32 v165, v165, v213
  v_add_f32 v166, v166, v214
  v_add_f32 v167, v167, v215
  v_add_f32 v168, v168, v216
  v_add_f32 v169, v169, v217
  v_add_f32 v170, v170, v218
  v_add_f32 v171, v171, v219
  v_add_f32 v172, v172, v220
  v_add_f32 v173, v173, v221
  v_add_f32 v174, v174, v222
  v_add_f32 v175, v175, v223
  v_cvt_pk_bf16_f32 v32, v160, v161
  v_cvt_pk_bf16_f32 v33, v162, v163
  v_cvt_pk_bf16_f32 v34, v164, v165
  v_cvt_pk_bf16_f32 v35, v166, v167
  v_cvt_pk_bf16_f32 v36, v168, v169
  v_cvt_pk_bf16_f32 v37, v170, v171
  v_cvt_pk_bf16_f32 v38, v172, v173
  v_cvt_pk_bf16_f32 v39, v174, v175
  buffer_store_dwordx4 v[32:35], v15, s[8:11], s19 offen sc1
  buffer_store_dwordx4 v[36:39], v15, s[8:11], s19 offen offset:1024 sc1
  s_add_u32 s19, s19, 2048
  ds_read_b128 v[208:211], v17 offset:32768
  ds_read_b128 v[212:215], v17 offset:33792
  ds_read_b128 v[216:219], v17 offset:34816
  ds_read_b128 v[220:223], v17 offset:35840
  s_waitcnt lgkmcnt(4)
  v_add_f32 v176, v176, v224
  v_add_f32 v177, v177, v225
  v_add_f32 v178, v178, v226
  v_add_f32 v179, v179, v227
  v_add_f32 v180, v180, v228
  v_add_f32 v181, v181, v229
  v_add_f32 v182, v182, v230
  v_add_f32 v183, v183, v231
  v_add_f32 v184, v184, v232
  v_add_f32 v185, v185, v233
  v_add_f32 v186, v186, v234
  v_add_f32 v187, v187, v235
  v_add_f32 v188, v188, v236
  v_add_f32 v189, v189, v237
  v_add_f32 v190, v190, v238
  v_add_f32 v191, v191, v239
  v_cvt_pk_bf16_f32 v40, v176, v177
  v_cvt_pk_bf16_f32 v41, v178, v179
  v_cvt_pk_bf16_f32 v42, v180, v181
  v_cvt_pk_bf16_f32 v43, v182, v183
  v_cvt_pk_bf16_f32 v44, v184, v185
  v_cvt_pk_bf16_f32 v45, v186, v187
  v_cvt_pk_bf16_f32 v46, v188, v189
  v_cvt_pk_bf16_f32 v47, v190, v191
  buffer_store_dwordx4 v[40:43], v15, s[8:11], s19 offen sc1
  buffer_store_dwordx4 v[44:47], v15, s[8:11], s19 offen offset:1024 sc1
  s_add_u32 s19, s19, 2048
  s_waitcnt lgkmcnt(0)
  v_add_f32 v192, v192, v208
  v_add_f32 v193, v193, v209
  v_add_f32 v194, v194, v210
  v_add_f32 v195, v195, v211
  v_add_f32 v196, v196, v212
  v_add_f32 v197, v197, v213
  v_add_f32 v198, v198, v214
  v_add_f32 v199, v199, v215
  v_add_f32 v200, v200, v216
  v_add_f32 v201, v201, v217
  v_add_f32 v202, v202, v218
  v_add_f32 v203, v203, v219
  v_add_f32 v204, v204, v220
  v_add_f32 v205, v205, v221
  v_add_f32 v206, v206, v222
  v_add_f32 v207, v207, v223
  v_cvt_pk_bf16_f32 v32, v192, v193
  v_cvt_pk_bf16_f32 v33, v194, v195
  v_cvt_pk_bf16_f32 v34, v196, v197
  v_cvt_pk_bf16_f32 v35, v198, v199
  v_cvt_pk_bf16_f32 v36, v200, v201
  v_cvt_pk_bf16_f32 v37, v202, v203
  v_cvt_pk_bf16_f32 v38, v204, v205
  v_cvt_pk_bf16_f32 v39, v206, v207
  buffer_store_dwordx4 v[32:35], v15, s[8:11], s19 offen sc1
  buffer_store_dwordx4 v[36:39], v15, s[8:11], s19 offen offset:1024 sc1
  s_endpgm
k2_end:
  s_endpgm
.section .rodata,"a"
.p2align 6
.amdhsa_kernel k2_attn_kernel
  .amdhsa_next_free_vgpr 256
  .amdhsa_next_free_sgpr 100
  .amdhsa_accum_offset 256
  .amdhsa_group_segment_fixed_size 0
  .amdhsa_kernarg_size 80
  .amdhsa_user_sgpr_count 2
  .amdhsa_user_sgpr_kernarg_segment_ptr 1
  .amdhsa_system_sgpr_workgroup_id_x 1
  .amdhsa_float_denorm_mode_32 3
.end_amdhsa_kernel
.text
.globl k3_out_kernel
.p2align 8
.type k3_out_kernel,@function
k3_out_kernel:
  s_cmp_ge_u32 s2, 216
  s_cbranch_scc1 k3_end
  s_load_dwordx2 s[6:7], s[0:1], 72
  s_load_dwordx2 s[4:5], s[0:1], 16
  s_load_dwordx2 s[24:25], s[0:1], 0
  s_load_dwordx2 s[26:27], s[0:1], 56
  v_and_b32 v1, 63, v0
  v_lshrrev_b32 v2, 6, v0
  v_lshlrev_b32 v9, 4, v1
  v_readfirstlane_b32 s28, v2
  s_mul_i32 s30, s2, 2731
  s_lshr_b32 s30, s30, 16
  s_mul_i32 s29, s30, 24
  s_sub_u32 s29, s2, s29
  s_mul_i32 s42, s29, 3
  s_lshl_b32 s43, s29, 1
  s_add_u32 s43, s43, 16
  s_cmp_lt_u32 s29, 16
  s_cselect_b32 s42, s42, s43
  s_cselect_b32 s43, 3, 2
  s_lshr_b32 s31, s28, 1
  s_and_b32 s32, s28, 1
  s_add_u32 s33, s42, s31
  s_cmp_lt_u32 s31, s43
  s_cselect_b32 s44, 1, 0
  s_cselect_b32 s33, s33, s42
  s_waitcnt lgkmcnt(0)
  s_mov_b32 s12, s6
  s_and_b32 s13, s7, 0xffff
  s_mov_b32 s14, 50331648
  s_mov_b32 s15, 0x20000
  s_mov_b32 s8, s4
  s_and_b32 s9, s5, 0xffff
  s_mov_b32 s10, 663552
  s_mov_b32 s11, 0x20000
  v_lshrrev_b32 v3, 3, v1
  v_and_b32 v4, 7, v1
  v_bfe_u32 v5, v3, 1, 1
  v_lshlrev_b32 v5, 2, v5
  v_xor_b32 v4, v4, v5
  v_lshlrev_b32 v4, 4, v4
  v_mul_u32_u24 v5, 1152, v3
  v_add_u32 v5, v5, v4
  v_lshrrev_b32 v6, 2, v3
  v_lshlrev_b32 v6, 2, v6
  v_bfe_u32 v7, v3, 1, 1
  v_add_u32 v6, v6, v7
  v_mul_u32_u24 v6, 18, v6
  v_and_b32 v7, 1, v3
  v_add3_u32 v6, v6, v7, 16
  v_mul_u32_u24 v6, 1152, v6
  v_add_u32 v6, v6, v4
  s_lshl_b32 s36, s30, 7
  s_mul_i32 s35, s28, 6
  s_lshl_b32 s39, s35, 11
  s_mul_i32 s38, s35, 20736
  s_add_u32 s38, s38, s36
  s_add_u32 m0, s39, 0
  s_add_u32 s40, s38, 0
  buffer_load_dwordx4 v5, s[8:11], s40 offen lds
  s_add_u32 m0, s39, 1024
  s_add_u32 s40, s38, 9216
  buffer_load_dwordx4 v5, s[8:11], s40 offen lds
  s_add_u32 m0, s39, 2048
  s_add_u32 s40, s38, 20736
  buffer_load_dwordx4 v5, s[8:11], s40 offen lds
  s_add_u32 m0, s39, 3072
  s_add_u32 s40, s38, 29952
  buffer_load_dwordx4 v5, s[8:11], s40 offen lds
  s_cmp_eq_u32 s28, 5
  s_cbranch_scc1 k3_x2
  s_add_u32 m0, s39, 4096
  s_add_u32 s40, s38, 41472
  buffer_load_dwordx4 v5, s[8:11], s40 offen lds
  s_add_u32 m0, s39, 5120
  s_add_u32 s40, s38, 50688
  buffer_load_dwordx4 v5, s[8:11], s40 offen lds
  s_branch k3_x2e
k3_x2:
  s_add_u32 m0, s39, 4096
  s_add_u32 s40, s36, 0
  buffer_load_dwordx4 v6, s[8:11], s40 offen lds
  s_add_u32 m0, s39, 5120
  s_add_u32 s40, s36, 41472
  buffer_load_dwordx4 v6, s[8:11], s40 offen lds
k3_x2e:
  s_cmp_eq_u32 s28, 5
  s_cbranch_scc1 k3_x3
  s_add_u32 m0, s39, 6144
  s_add_u32 s40, s38, 62208
  buffer_load_dwordx4 v5, s[8:11], s40 offen lds
  s_add_u32 m0, s39, 7168
  s_add_u32 s40, s38, 71424
  buffer_load_dwordx4 v5, s[8:11], s40 offen lds
  s_branch k3_x3e
k3_x3:
  s_add_u32 m0, s39, 6144
  s_add_u32 s40, s36, 165888
  buffer_load_dwordx4 v6, s[8:11], s40 offen lds
  s_add_u32 m0, s39, 7168
  s_add_u32 s40, s36, 207360
  buffer_load_dwordx4 v6, s[8:11], s40 offen lds
k3_x3e:
  s_cmp_eq_u32 s28, 5
  s_cbranch_scc1 k3_x4
  s_add_u32 m0, s39, 8192
  s_add_u32 s40, s38, 82944
  buffer_load_dwordx4 v5, s[8:11], s40 offen lds
  s_add_u32 m0, s39, 9216
  s_add_u32 s40, s38, 92160
  buffer_load_dwordx4 v5, s[8:11], s40 offen lds
  s_branch k3_x4e
k3_x4:
  s_add_u32 m0, s39, 8192
  s_add_u32 s40, s36, 331776
  buffer_load_dwordx4 v6, s[8:11], s40 offen lds
  s_add_u32 m0, s39, 9216
  s_add_u32 s40, s36, 373248
  buffer_load_dwordx4 v6, s[8:11], s40 offen lds
k3_x4e:
  s_cmp_eq_u32 s28, 5
  s_cbranch_scc1 k3_x5
  s_add_u32 m0, s39, 10240
  s_add_u32 s40, s38, 103680
  buffer_load_dwordx4 v5, s[8:11], s40 offen lds
  s_add_u32 m0, s39, 11264
  s_add_u32 s40, s38, 112896
  buffer_load_dwordx4 v5, s[8:11], s40 offen lds
  s_branch k3_x5e
k3_x5:
  s_add_u32 m0, s39, 10240
  s_add_u32 s40, s36, 497664
  buffer_load_dwordx4 v6, s[8:11], s40 offen lds
  s_add_u32 m0, s39, 11264
  s_add_u32 s40, s36, 539136
  buffer_load_dwordx4 v6, s[8:11], s40 offen lds
k3_x5e:
  s_mul_i32 s46, s32, 18
  s_lshl_b32 s46, s46, 6
  s_add_u32 s46, s46, s33
  s_lshl_b32 s46, s46, 10
  s_add_u32 s46, s46, 9437184
  buffer_load_dwordx4 v[64:67], v9, s[12:15], s46 offen
  s_add_u32 s46, s46, 65536
  buffer_load_dwordx4 v[68:71], v9, s[12:15], s46 offen
  s_add_u32 s46, s46, 65536
  buffer_load_dwordx4 v[72:75], v9, s[12:15], s46 offen
  s_add_u32 s46, s46, 65536
  buffer_load_dwordx4 v[76:79], v9, s[12:15], s46 offen
  s_add_u32 s46, s46, 65536
  buffer_load_dwordx4 v[80:83], v9, s[12:15], s46 offen
  s_add_u32 s46, s46, 65536
  buffer_load_dwordx4 v[84:87], v9, s[12:15], s46 offen
  s_add_u32 s46, s46, 65536
  buffer_load_dwordx4 v[88:91], v9, s[12:15], s46 offen
  s_add_u32 s46, s46, 65536
  buffer_load_dwordx4 v[92:95], v9, s[12:15], s46 offen
  s_add_u32 s46, s46, 65536
  buffer_load_dwordx4 v[96:99], v9, s[12:15], s46 offen
  s_add_u32 s46, s46, 65536
  buffer_load_dwordx4 v[100:103], v9, s[12:15], s46 offen
  s_add_u32 s46, s46, 65536
  s_lshl_b32 s47, s32, 7
  s_add_u32 s47, s47, s33
  s_mul_i32 s47, s47, 18
  s_lshl_b32 s38, s30, 1
  s_add_u32 s47, s47, s38
  s_lshl_b32 s47, s47, 11
  s_add_u32 s47, s47, 31457280
  s_mov_b32 s16, s24
  s_and_b32 s17, s25, 0xffff
  s_mov_b32 s18, 2359296
  s_mov_b32 s19, 0x20000
  s_mov_b32 s20, s26
  s_and_b32 s21, s27, 0xffff
  s_mov_b32 s22, 2359296
  s_mov_b32 s23, 0x20000
  v_lshrrev_b32 v10, 3, v0
  v_and_b32 v11, 7, v0
  s_lshl_b32 s45, s43, 5
  v_add_u32 v13, 0, v10
  v_lshrrev_b32 v14, 5, v13
  v_add_u32 v14, s42, v14
  v_and_b32 v15, 15, v13
  v_lshlrev_b32 v15, 2, v15
  v_bfe_u32 v12, v13, 4, 1
  v_add_u32 v15, v15, v12
  v_and_b32 v12, 1, v14
  v_lshl_add_u32 v15, v12, 1, v15
  v_lshrrev_b32 v14, 1, v14
  v_lshl_add_u32 v15, v14, 6, v15
  v_mul_u32_u24 v15, 1152, v15
  v_lshl_add_u32 v15, v11, 4, v15
  v_cmp_gt_u32 vcc, s45, v13
  v_mov_b32 v12, 0x7ffffff0
  s_nop 1
  v_cndmask_b32 v12, v12, v15, vcc
  v_add_u32 v17, 48, v10
  v_lshrrev_b32 v18, 5, v17
  v_add_u32 v18, s42, v18
  v_and_b32 v19, 15, v17
  v_lshlrev_b32 v19, 2, v19
  v_bfe_u32 v16, v17, 4, 1
  v_add_u32 v19, v19, v16
  v_and_b32 v16, 1, v18
  v_lshl_add_u32 v19, v16, 1, v19
  v_lshrrev_b32 v18, 1, v18
  v_lshl_add_u32 v19, v18, 6, v19
  v_mul_u32_u24 v19, 1152, v19
  v_lshl_add_u32 v19, v11, 4, v19
  v_cmp_gt_u32 vcc, s45, v17
  v_mov_b32 v16, 0x7ffffff0
  s_nop 1
  v_cndmask_b32 v16, v16, v19, vcc
  v_and_b32 v20, 15, v1
  v_lshrrev_b32 v21, 2, v20
  v_and_b32 v20, 3, v20
  v_lshlrev_b32 v20, 3, v20
  v_lshrrev_b32 v22, 5, v1
  v_lshl_add_u32 v23, v22, 2, v21
  v_lshl_add_u32 v20, v23, 7, v20
  v_bfe_u32 v23, v1, 4, 1
  v_lshl_add_u32 v20, v23, 5, v20
  v_bfe_u32 v23, v21, 1, 1
  s_mul_i32 s37, s32, 36864
  v_add_u32 v20, s37, v20
  v_lshl_add_u32 v21, v23, 6, v20
  v_xor_b32 v23, 1, v23
  v_lshl_add_u32 v20, v23, 6, v20
  s_waitcnt vmcnt(10)
  s_barrier
  ds_read_b64_tr_b16 v[40:41], v21 offset:0
  ds_read_b64_tr_b16 v[42:43], v21 offset:1024
  ds_read_b64_tr_b16 v[44:45], v20 offset:0
  ds_read_b64_tr_b16 v[46:47], v20 offset:1024
  ds_read_b64_tr_b16 v[48:49], v21 offset:2048
  ds_read_b64_tr_b16 v[50:51], v21 offset:3072
  ds_read_b64_tr_b16 v[52:53], v20 offset:2048
  ds_read_b64_tr_b16 v[54:55], v20 offset:3072
  ds_read_b64_tr_b16 v[56:57], v21 offset:4096
  ds_read_b64_tr_b16 v[58:59], v21 offset:5120
  s_waitcnt lgkmcnt(8)
  s_waitcnt vmcnt(8)
  v_mfma_f32_32x32x16_bf16 v[208:223], v[40:43], v[64:67], 0
  buffer_load_dwordx4 v[104:107], v9, s[12:15], s46 offen
  s_add_u32 s46, s46, 65536
  buffer_load_dwordx4 v[108:111], v9, s[12:15], s46 offen
  s_add_u32 s46, s46, 65536
  ds_read_b64_tr_b16 v[60:61], v20 offset:4096
  ds_read_b64_tr_b16 v[62:63], v20 offset:5120
  s_waitcnt lgkmcnt(8)
  v_mfma_f32_32x32x16_bf16 v[224:239], v[44:47], v[64:67], 0
  buffer_load_dwordx4 v[112:115], v9, s[12:15], s46 offen
  s_add_u32 s46, s46, 65536
  buffer_load_dwordx4 v[116:119], v9, s[12:15], s46 offen
  s_add_u32 s46, s46, 65536
  ds_read_b64_tr_b16 v[40:41], v21 offset:6144
  ds_read_b64_tr_b16 v[42:43], v21 offset:7168
  s_waitcnt lgkmcnt(8)
  v_mfma_f32_32x32x16_bf16 v[208:223], v[48:51], v[68:71], v[208:223]
  buffer_load_dwordx4 v[120:123], v9, s[12:15], s46 offen
  s_add_u32 s46, s46, 65536
  buffer_load_dwordx4 v[124:127], v9, s[12:15], s46 offen
  s_add_u32 s46, s46, 65536
  ds_read_b64_tr_b16 v[44:45], v20 offset:6144
  ds_read_b64_tr_b16 v[46:47], v20 offset:7168
  s_waitcnt lgkmcnt(8)
  v_mfma_f32_32x32x16_bf16 v[224:239], v[52:55], v[68:71], v[224:239]
  buffer_load_dwordx4 v[128:131], v9, s[12:15], s46 offen
  s_add_u32 s46, s46, 65536
  buffer_load_dwordx4 v[132:135], v9, s[12:15], s46 offen
  s_add_u32 s46, s46, 65536
  ds_read_b64_tr_b16 v[48:49], v21 offset:8192
  ds_read_b64_tr_b16 v[50:51], v21 offset:9216
  s_waitcnt lgkmcnt(8)
  s_waitcnt vmcnt(14)
  v_mfma_f32_32x32x16_bf16 v[208:223], v[56:59], v[72:75], v[208:223]
  buffer_load_dwordx4 v[160:163], v9, s[12:15], s47 offen offset:0
  buffer_load_dwordx4 v[164:167], v9, s[12:15], s47 offen offset:1024
  ds_read_b64_tr_b16 v[52:53], v20 offset:8192
  ds_read_b64_tr_b16 v[54:55], v20 offset:9216
  s_waitcnt lgkmcnt(8)
  v_mfma_f32_32x32x16_bf16 v[224:239], v[60:63], v[72:75], v[224:239]
  buffer_load_dwordx4 v[168:171], v9, s[12:15], s47 offen offset:2048
  buffer_load_dwordx4 v[172:175], v9, s[12:15], s47 offen offset:3072
  s_add_u32 s47, s47, 2359296
  ds_read_b64_tr_b16 v[56:57], v21 offset:10240
  ds_read_b64_tr_b16 v[58:59], v21 offset:11264
  s_waitcnt lgkmcnt(8)
  v_mfma_f32_32x32x16_bf16 v[208:223], v[40:43], v[76:79], v[208:223]
  buffer_load_dwordx4 v[176:179], v9, s[12:15], s47 offen offset:0
  buffer_load_dwordx4 v[180:183], v9, s[12:15], s47 offen offset:1024
  ds_read_b64_tr_b16 v[60:61], v20 offset:10240
  ds_read_b64_tr_b16 v[62:63], v20 offset:11264
  s_waitcnt lgkmcnt(8)
  v_mfma_f32_32x32x16_bf16 v[224:239], v[44:47], v[76:79], v[224:239]
  buffer_load_dwordx4 v[184:187], v9, s[12:15], s47 offen offset:2048
  buffer_load_dwordx4 v[188:191], v9, s[12:15], s47 offen offset:3072
  ds_read_b64_tr_b16 v[40:41], v21 offset:12288
  ds_read_b64_tr_b16 v[42:43], v21 offset:13312
  s_waitcnt lgkmcnt(8)
  s_waitcnt vmcnt(20)
  v_mfma_f32_32x32x16_bf16 v[208:223], v[48:51], v[80:83], v[208:223]
  buffer_load_dwordx4 v[192:195], v12, s[16:19], s36 offen
  ds_read_b64_tr_b16 v[44:45], v20 offset:12288
  ds_read_b64_tr_b16 v[46:47], v20 offset:13312
  s_waitcnt lgkmcnt(8)
  v_mfma_f32_32x32x16_bf16 v[224:239], v[52:55], v[80:83], v[224:239]
  buffer_load_dwordx4 v[196:199], v16, s[16:19], s36 offen
  ds_read_b64_tr_b16 v[48:49], v21 offset:14336
  ds_read_b64_tr_b16 v[50:51], v21 offset:15360
  s_waitcnt lgkmcnt(8)
  v_mfma_f32_32x32x16_bf16 v[208:223], v[56:59], v[84:87], v[208:223]
  ds_read_b64_tr_b16 v[52:53], v20 offset:14336
  ds_read_b64_tr_b16 v[54:55], v20 offset:15360
  s_waitcnt lgkmcnt(8)
  v_mfma_f32_32x32x16_bf16 v[224:239], v[60:63], v[84:87], v[224:239]
  ds_read_b64_tr_b16 v[56:57], v21 offset:16384
  ds_read_b64_tr_b16 v[58:59], v21 offset:17408
  s_waitcnt lgkmcnt(8)
  s_waitcnt vmcnt(20)
  v_mfma_f32_32x32x16_bf16 v[208:223], v[40:43], v[88:91], v[208:223]
  ds_read_b64_tr_b16 v[60:61], v20 offset:16384
  ds_read_b64_tr_b16 v[62:63], v20 offset:17408
  s_waitcnt lgkmcnt(8)
  v_mfma_f32_32x32x16_bf16 v[224:239], v[44:47], v[88:91], v[224:239]
  ds_read_b64_tr_b16 v[40:41], v21 offset:18432
  ds_read_b64_tr_b16 v[42:43], v21 offset:19456
  s_waitcnt lgkmcnt(8)
  v_mfma_f32_32x32x16_bf16 v[208:223], v[48:51], v[92:95], v[208:223]
  ds_read_b64_tr_b16 v[44:45], v20 offset:18432
  ds_read_b64_tr_b16 v[46:47], v20 offset:19456
  s_waitcnt lgkmcnt(8)
  v_mfma_f32_32x32x16_bf16 v[224:239], v[52:55], v[92:95], v[224:239]
  ds_read_b64_tr_b16 v[48:49], v21 offset:20480
  ds_read_b64_tr_b16 v[50:51], v21 offset:21504
  s_waitcnt lgkmcnt(8)
  s_waitcnt vmcnt(18)
  v_mfma_f32_32x32x16_bf16 v[208:223], v[56:59], v[96:99], v[208:223]
  ds_read_b64_tr_b16 v[52:53], v20 offset:20480
  ds_read_b64_tr_b16 v[54:55], v20 offset:21504
  s_waitcnt lgkmcnt(8)
  v_mfma_f32_32x32x16_bf16 v[224:239], v[60:63], v[96:99], v[224:239]
  ds_read_b64_tr_b16 v[56:57], v21 offset:22528
  ds_read_b64_tr_b16 v[58:59], v21 offset:23552
  s_waitcnt lgkmcnt(8)
  v_mfma_f32_32x32x16_bf16 v[208:223], v[40:43], v[100:103], v[208:223]
  ds_read_b64_tr_b16 v[60:61], v20 offset:22528
  ds_read_b64_tr_b16 v[62:63], v20 offset:23552
  s_waitcnt lgkmcnt(8)
  v_mfma_f32_32x32x16_bf16 v[224:239], v[44:47], v[100:103], v[224:239]
  ds_read_b64_tr_b16 v[40:41], v21 offset:24576
  ds_read_b64_tr_b16 v[42:43], v21 offset:25600
  s_waitcnt lgkmcnt(8)
  s_waitcnt vmcnt(16)
  v_mfma_f32_32x32x16_bf16 v[208:223], v[48:51], v[104:107], v[208:223]
  ds_read_b64_tr_b16 v[44:45], v20 offset:24576
  ds_read_b64_tr_b16 v[46:47], v20 offset:25600
  s_waitcnt lgkmcnt(8)
  v_mfma_f32_32x32x16_bf16 v[224:239], v[52:55], v[104:107], v[224:239]
  ds_read_b64_tr_b16 v[48:49], v21 offset:26624
  ds_read_b64_tr_b16 v[50:51], v21 offset:27648
  s_waitcnt lgkmcnt(8)
  v_mfma_f32_32x32x16_bf16 v[208:223], v[56:59], v[108:111], v[208:223]
  ds_read_b64_tr_b16 v[52:53], v20 offset:26624
  ds_read_b64_tr_b16 v[54:55], v20 offset:27648
  s_waitcnt lgkmcnt(8)
  v_mfma_f32_32x32x16_bf16 v[224:239], v[60:63], v[108:111], v[224:239]
  ds_read_b64_tr_b16 v[56:57], v21 offset:28672
  ds_read_b64_tr_b16 v[58:59], v21 offset:29696
  s_waitcnt lgkmcnt(8)
  s_waitcnt vmcnt(14)
  v_mfma_f32_32x32x16_bf16 v[208:223], v[40:43], v[112:115], v[208:223]
  ds_read_b64_tr_b16 v[60:61], v20 offset:28672
  ds_read_b64_tr_b16 v[62:63], v20 offset:29696
  s_waitcnt lgkmcnt(8)
  v_mfma_f32_32x32x16_bf16 v[224:239], v[44:47], v[112:115], v[224:239]
  ds_read_b64_tr_b16 v[40:41], v21 offset:30720
  ds_read_b64_tr_b16 v[42:43], v21 offset:31744
  s_waitcnt lgkmcnt(8)
  v_mfma_f32_32x32x16_bf16 v[208:223], v[48:51], v[116:119], v[208:223]
  ds_read_b64_tr_b16 v[44:45], v20 offset:30720
  ds_read_b64_tr_b16 v[46:47], v20 offset:31744
  s_waitcnt lgkmcnt(8)
  v_mfma_f32_32x32x16_bf16 v[224:239], v[52:55], v[116:119], v[224:239]
  ds_read_b64_tr_b16 v[48:49], v21 offset:32768
  ds_read_b64_tr_b16 v[50:51], v21 offset:33792
  s_waitcnt lgkmcnt(8)
  s_waitcnt vmcnt(12)
  v_mfma_f32_32x32x16_bf16 v[208:223], v[56:59], v[120:123], v[208:223]
  ds_read_b64_tr_b16 v[52:53], v20 offset:32768
  ds_read_b64_tr_b16 v[54:55], v20 offset:33792
  s_waitcnt lgkmcnt(8)
  v_mfma_f32_32x32x16_bf16 v[224:239], v[60:63], v[120:123], v[224:239]
  ds_read_b64_tr_b16 v[56:57], v21 offset:34816
  ds_read_b64_tr_b16 v[58:59], v21 offset:35840
  s_waitcnt lgkmcnt(8)
  v_mfma_f32_32x32x16_bf16 v[208:223], v[40:43], v[124:127], v[208:223]
  ds_read_b64_tr_b16 v[60:61], v20 offset:34816
  ds_read_b64_tr_b16 v[62:63], v20 offset:35840
  s_waitcnt lgkmcnt(8)
  v_mfma_f32_32x32x16_bf16 v[224:239], v[44:47], v[124:127], v[224:239]
  s_waitcnt lgkmcnt(6)
  s_waitcnt vmcnt(10)
  v_mfma_f32_32x32x16_bf16 v[208:223], v[48:51], v[128:131], v[208:223]
  s_waitcnt lgkmcnt(4)
  v_mfma_f32_32x32x16_bf16 v[224:239], v[52:55], v[128:131], v[224:239]
  s_waitcnt lgkmcnt(2)
  v_mfma_f32_32x32x16_bf16 v[208:223], v[56:59], v[132:135], v[208:223]
  s_waitcnt lgkmcnt(0)
  v_mfma_f32_32x32x16_bf16 v[224:239], v[60:63], v[132:135], v[224:239]
  s_waitcnt vmcnt(2)
  v_lshlrev_b32 v240, 16, v160
  v_and_b32 v241, 0xffff0000, v160
  v_lshlrev_b32 v200, 16, v176
  v_and_b32 v201, 0xffff0000, v176
  v_add_f32 v240, v240, v200
  v_add_f32 v241, v241, v201
  v_lshlrev_b32 v242, 16, v161
  v_and_b32 v243, 0xffff0000, v161
  v_lshlrev_b32 v200, 16, v177
  v_and_b32 v201, 0xffff0000, v177
  v_add_f32 v242, v242, v200
  v_add_f32 v243, v243, v201
  v_lshlrev_b32 v244, 16, v162
  v_and_b32 v245, 0xffff0000, v162
  v_lshlrev_b32 v200, 16, v178
  v_and_b32 v201, 0xffff0000, v178
  v_add_f32 v244, v244, v200
  v_add_f32 v245, v245, v201
  v_lshlrev_b32 v246, 16, v163
  v_and_b32 v247, 0xffff0000, v163
  v_lshlrev_b32 v200, 16, v179
  v_and_b32 v201, 0xffff0000, v179
  v_add_f32 v246, v246, v200
  v_add_f32 v247, v247, v201
  v_lshlrev_b32 v248, 16, v164
  v_and_b32 v249, 0xffff0000, v164
  v_lshlrev_b32 v200, 16, v180
  v_and_b32 v201, 0xffff0000, v180
  v_add_f32 v248, v248, v200
  v_add_f32 v249, v249, v201
  v_lshlrev_b32 v250, 16, v165
  v_and_b32 v251, 0xffff0000, v165
  v_lshlrev_b32 v200, 16, v181
  v_and_b32 v201, 0xffff0000, v181
  v_add_f32 v250, v250, v200
  v_add_f32 v251, v251, v201
  v_lshlrev_b32 v252, 16, v166
  v_and_b32 v253, 0xffff0000, v166
  v_lshlrev_b32 v200, 16, v182
  v_and_b32 v201, 0xffff0000, v182
  v_add_f32 v252, v252, v200
  v_add_f32 v253, v253, v201
  v_lshlrev_b32 v254, 16, v167
  v_and_b32 v255, 0xffff0000, v167
  v_lshlrev_b32 v200, 16, v183
  v_and_b32 v201, 0xffff0000, v183
  v_add_f32 v254, v254, v200
  v_add_f32 v255, v255, v201
  v_lshlrev_b32 v24, 16, v168
  v_and_b32 v25, 0xffff0000, v168
  v_lshlrev_b32 v200, 16, v184
  v_and_b32 v201, 0xffff0000, v184
  v_add_f32 v24, v24, v200
  v_add_f32 v25, v25, v201
  v_lshlrev_b32 v26, 16, v169
  v_and_b32 v27, 0xffff0000, v169
  v_lshlrev_b32 v200, 16, v185
  v_and_b32 v201, 0xffff0000, v185
  v_add_f32 v26, v26, v200
  v_add_f32 v27, v27, v201
  v_lshlrev_b32 v28, 16, v170
  v_and_b32 v29, 0xffff0000, v170
  v_lshlrev_b32 v200, 16, v186
  v_and_b32 v201, 0xffff0000, v186
  v_add_f32 v28, v28, v200
  v_add_f32 v29, v29, v201
  v_lshlrev_b32 v30, 16, v171
  v_and_b32 v31, 0xffff0000, v171
  v_lshlrev_b32 v200, 16, v187
  v_and_b32 v201, 0xffff0000, v187
  v_add_f32 v30, v30, v200
  v_add_f32 v31, v31, v201
  v_lshlrev_b32 v32, 16, v172
  v_and_b32 v33, 0xffff0000, v172
  v_lshlrev_b32 v200, 16, v188
  v_and_b32 v201, 0xffff0000, v188
  v_add_f32 v32, v32, v200
  v_add_f32 v33, v33, v201
  v_lshlrev_b32 v34, 16, v173
  v_and_b32 v35, 0xffff0000, v173
  v_lshlrev_b32 v200, 16, v189
  v_and_b32 v201, 0xffff0000, v189
  v_add_f32 v34, v34, v200
  v_add_f32 v35, v35, v201
  v_lshlrev_b32 v36, 16, v174
  v_and_b32 v37, 0xffff0000, v174
  v_lshlrev_b32 v200, 16, v190
  v_and_b32 v201, 0xffff0000, v190
  v_add_f32 v36, v36, v200
  v_add_f32 v37, v37, v201
  v_lshlrev_b32 v38, 16, v175
  v_and_b32 v39, 0xffff0000, v175
  v_lshlrev_b32 v200, 16, v191
  v_and_b32 v201, 0xffff0000, v191
  v_add_f32 v38, v38, v200
  v_add_f32 v39, v39, v201
  s_nop 12
  s_mov_b32 s37, 0x3ef5fdf0
  v_fma_f32 v208, v240, s37, v208
  v_fma_f32 v209, v241, s37, v209
  v_fma_f32 v210, v242, s37, v210
  v_fma_f32 v211, v243, s37, v211
  v_fma_f32 v212, v244, s37, v212
  v_fma_f32 v213, v245, s37, v213
  v_fma_f32 v214, v246, s37, v214
  v_fma_f32 v215, v247, s37, v215
  v_fma_f32 v216, v248, s37, v216
  v_fma_f32 v217, v249, s37, v217
  v_fma_f32 v218, v250, s37, v218
  v_fma_f32 v219, v251, s37, v219
  v_fma_f32 v220, v252, s37, v220
  v_fma_f32 v221, v253, s37, v221
  v_fma_f32 v222, v254, s37, v222
  v_fma_f32 v223, v255, s37, v223
  v_fma_f32 v224, v24, s37, v224
  v_fma_f32 v225, v25, s37, v225
  v_fma_f32 v226, v26, s37, v226
  v_fma_f32 v227, v27, s37, v227
  v_fma_f32 v228, v28, s37, v228
  v_fma_f32 v229, v29, s37, v229
  v_fma_f32 v230, v30, s37, v230
  v_fma_f32 v231, v31, s37, v231
  v_fma_f32 v232, v32, s37, v232
  v_fma_f32 v233, v33, s37, v233
  v_fma_f32 v234, v34, s37, v234
  v_fma_f32 v235, v35, s37, v235
  v_fma_f32 v236, v36, s37, v236
  v_fma_f32 v237, v37, s37, v237
  v_fma_f32 v238, v38, s37, v238
  v_fma_f32 v239, v39, s37, v239
  v_and_b32 v23, 31, v1
  s_lshl_b32 s37, s31, 5
  v_add_u32 v23, s37, v23
  v_mul_u32_u24 v23, 272, v23
  v_lshl_add_u32 v23, v22, 4, v23
  s_mul_i32 s37, s32, 26112
  s_add_u32 s37, s37, 73728
  v_add_u32 v23, s37, v23
  ds_write_b128 v23, v[208:211] offset:0
  ds_write_b128 v23, v[212:215] offset:32
  ds_write_b128 v23, v[216:219] offset:64
  ds_write_b128 v23, v[220:223] offset:96
  ds_write_b128 v23, v[224:227] offset:128
  ds_write_b128 v23, v[228:231] offset:160
  ds_write_b128 v23, v[232:235] offset:192
  ds_write_b128 v23, v[236:239] offset:224
  s_waitcnt lgkmcnt(0)
  s_barrier
  v_mul_u32_u24 v23, 272, v10
  v_lshl_add_u32 v23, v11, 5, v23
  v_add_u32 v23, 73728, v23
  ds_read_b128 v[64:67], v23 offset:0
  ds_read_b128 v[68:71], v23 offset:16
  ds_read_b128 v[72:75], v23 offset:26112
  ds_read_b128 v[76:79], v23 offset:26128
  ds_read_b128 v[80:83], v23 offset:13056
  ds_read_b128 v[84:87], v23 offset:13072
  ds_read_b128 v[88:91], v23 offset:39168
  ds_read_b128 v[92:95], v23 offset:39184
  s_waitcnt vmcnt(0) lgkmcnt(0)
  v_add_f32 v64, v64, v72
  v_add_f32 v65, v65, v73
  v_add_f32 v66, v66, v74
  v_add_f32 v67, v67, v75
  v_add_f32 v68, v68, v76
  v_add_f32 v69, v69, v77
  v_add_f32 v70, v70, v78
  v_add_f32 v71, v71, v79
  v_lshlrev_b32 v72, 16, v192
  v_and_b32 v73, 0xffff0000, v192
  v_lshlrev_b32 v74, 16, v193
  v_and_b32 v75, 0xffff0000, v193
  v_lshlrev_b32 v76, 16, v194
  v_and_b32 v77, 0xffff0000, v194
  v_lshlrev_b32 v78, 16, v195
  v_and_b32 v79, 0xffff0000, v195
  v_add_f32 v64, v64, v72
  v_add_f32 v65, v65, v73
  v_add_f32 v66, v66, v74
  v_add_f32 v67, v67, v75
  v_add_f32 v68, v68, v76
  v_add_f32 v69, v69, v77
  v_add_f32 v70, v70, v78
  v_add_f32 v71, v71, v79
  v_cvt_pk_bf16_f32 v100, v64, v65
  v_cvt_pk_bf16_f32 v101, v66, v67
  v_cvt_pk_bf16_f32 v102, v68, v69
  v_cvt_pk_bf16_f32 v103, v70, v71
  buffer_store_dwordx4 v[100:103], v12, s[20:23], s36 offen
  v_add_f32 v80, v80, v88
  v_add_f32 v81, v81, v89
  v_add_f32 v82, v82, v90
  v_add_f32 v83, v83, v91
  v_add_f32 v84, v84, v92
  v_add_f32 v85, v85, v93
  v_add_f32 v86, v86, v94
  v_add_f32 v87, v87, v95
  v_lshlrev_b32 v88, 16, v196
  v_and_b32 v89, 0xffff0000, v196
  v_lshlrev_b32 v90, 16, v197
  v_and_b32 v91, 0xffff0000, v197
  v_lshlrev_b32 v92, 16, v198
  v_and_b32 v93, 0xffff0000, v198
  v_lshlrev_b32 v94, 16, v199
  v_and_b32 v95, 0xffff0000, v199
  v_add_f32 v80, v80, v88
  v_add_f32 v81, v81, v89
  v_add_f32 v82, v82, v90
  v_add_f32 v83, v83, v91
  v_add_f32 v84, v84, v92
  v_add_f32 v85, v85, v93
  v_add_f32 v86, v86, v94
  v_add_f32 v87, v87, v95
  v_cvt_pk_bf16_f32 v104, v80, v81
  v_cvt_pk_bf16_f32 v105, v82, v83
  v_cvt_pk_bf16_f32 v106, v84, v85
  v_cvt_pk_bf16_f32 v107, v86, v87
  buffer_store_dwordx4 v[104:107], v16, s[20:23], s36 offen
k3_end:
  s_endpgm
k3_code_end:
.section .rodata,"a"
.p2align 6
.amdhsa_kernel k3_out_kernel
  .amdhsa_next_free_vgpr 256
  .amdhsa_next_free_sgpr 48
  .amdhsa_accum_offset 256
  .amdhsa_group_segment_fixed_size 0
  .amdhsa_kernarg_size 80
  .amdhsa_user_sgpr_count 2
  .amdhsa_user_sgpr_kernarg_segment_ptr 1
  .amdhsa_system_sgpr_workgroup_id_x 1
  .amdhsa_float_denorm_mode_32 3
.end_amdhsa_kernel
.text
```
